```python
import torch

def _softmax(x, axis=-1):
    return torch.softmax(x, dim=axis)

def _gelu(x):
    return torch.nn.functional.gelu(x, approximate='tanh')

def _silu(x):
    return torch.nn.functional.silu(x)

def _sigmoid(x):
    return torch.sigmoid(x)

def _layernorm(x, axis=-1, eps=1e-05):
    m = x.mean(dim=axis, keepdim=True)
    v = x.var(dim=axis, keepdim=True, unbiased=False)
    return (x - m) / torch.sqrt(v + eps)

def _scatter_add(tgt, idx, src, axis=0):
    return tgt.clone().index_add_(axis, idx, src)

def _segment_sum(src, seg, n):
    out = torch.zeros((n,) + src.shape[1:], dtype=src.dtype)
    return out.index_add_(0, seg, src)

def _pad(x, pw):
    flat = tuple((v for pair in reversed(pw) for v in pair))
    return torch.nn.functional.pad(x, flat)
kernel_name = 'interleave_layers__memory_aug_recurrent_mem_tr__mixer_s_mlp__prompt'

def setup_inputs():

    _w = lambda a: (lambda t: t.to(torch.bfloat16) if t.is_floating_point() else t)(torch.as_tensor(a))

    def _A_setup():
        B, S, Dm = (1, 2048, 640)
        H, Dh = (32, 128)
        M, seg = (8, 32)
        seg = min(seg, S)
        S = S // seg * seg
        return {'x': _w((lambda *s: torch.randn(*s, dtype=torch.bfloat16) * 0.05)(B, S, Dm)), 'mem0': _w((lambda *s: torch.randn(*s, dtype=torch.bfloat16) * 0.8)(B, M, Dm)), 'Wq': _w((lambda *s: torch.randn(*s, dtype=torch.bfloat16) * 0.8)(Dm, H, Dh) * Dm ** (-0.5)), 'Wk': _w((lambda *s: torch.randn(*s, dtype=torch.bfloat16) * 0.8)(Dm, H, Dh) * Dm ** (-0.5)), 'Wv': _w((lambda *s: torch.randn(*s, dtype=torch.bfloat16) * 0.8)(Dm, H, Dh) * Dm ** (-0.5)), 'Wo': _w((lambda *s: torch.randn(*s, dtype=torch.bfloat16) * 0.8)(H, Dh, Dm) * (H * Dh) ** (-0.5)), 'seg_len': seg}
    _A_in = _A_setup()

    def _B_setup():
        B, S, D, F = (1, 2048, 640, 1728)
        return {'x': _w((lambda *s: torch.randn(*s, dtype=torch.bfloat16) * 0.05)(B, S, D)), 'w1': _w((lambda *s: torch.randn(*s, dtype=torch.bfloat16) * 0.8)(D, D) * D ** (-0.5)), 'w2': _w((lambda *s: torch.randn(*s, dtype=torch.bfloat16) * 0.8)(D, D) * D ** (-0.5)), 'w3': _w((lambda *s: torch.randn(*s, dtype=torch.bfloat16) * 0.8)(D, F) * D ** (-0.5)), 'w4': _w((lambda *s: torch.randn(*s, dtype=torch.bfloat16) * 0.8)(F, D) * F ** (-0.5))}
    _B_in = _B_setup()
    return {'A_x': _A_in['x'], 'A_mem0': _A_in['mem0'], 'A_Wq': _A_in['Wq'], 'A_Wk': _A_in['Wk'], 'A_Wv': _A_in['Wv'], 'A_Wo': _A_in['Wo'], 'A_seg_len': _A_in['seg_len'], 'B_x': _B_in['x'], 'B_w1': _B_in['w1'], 'B_w2': _B_in['w2'], 'B_w3': _B_in['w3'], 'B_w4': _B_in['w4']}

def reference(A_x, A_mem0, A_Wq, A_Wk, A_Wv, A_Wo, A_seg_len, B_x, B_w1, B_w2, B_w3, B_w4):

    def _A_ref(x, mem0, Wq, Wk, Wv, Wo, seg_len):
        B, S, Dm = x.shape
        H, Dh = (Wq.shape[1], Wq.shape[2])
        M = mem0.shape[1]
        scale = Dh ** (-0.5)
        n_seg = S // seg_len
        L = M + seg_len
        idx = torch.arange(L)
        mask = (idx[:, None] < M) | (idx[:, None] >= idx[None, :])
        mem = mem0
        outs = []
        for s in range(n_seg):
            xs = x[:, s * seg_len:(s + 1) * seg_len, :].clone()
            h = torch.concatenate([mem, xs], axis=1)
            q = torch.einsum('btd,dhe->bhte', h, Wq)
            k = torch.einsum('btd,dhe->bhte', h, Wk)
            v = torch.einsum('btd,dhe->bhte', h, Wv)
            scores = torch.einsum('bhqe,bhke->bhqk', q, k) * scale
            scores = torch.where(mask[None, None], scores, -1000000000.0)
            p = _softmax(scores, axis=-1)
            o = torch.einsum('bhqk,bhke->bhqe', p, v)
            o = torch.einsum('bhte,hed->btd', o, Wo)
            mem = o[:, :M, :].clone()
            outs.append(o[:, M:, :])
        return torch.concatenate(outs, axis=1)

    def _B_ref(x, w1, w2, w3, w4):
        B, S, D = x.shape
        h = _gelu(_layernorm(x, axis=-1) @ w1)
        c = D // 4
        g0 = _pad(h[:, :, 0 * c:1 * c], ((0, 0), (1, 0), (0, 0)))[:, :S, :]
        g1 = _pad(h[:, :, 1 * c:2 * c], ((0, 0), (0, 1), (0, 0)))[:, 1:, :]
        g2 = _pad(h[:, :, 2 * c:3 * c], ((0, 0), (2, 0), (0, 0)))[:, :S, :]
        g3 = _pad(h[:, :, 3 * c:], ((0, 0), (0, 2), (0, 0)))[:, 2:, :]
        hs = torch.concatenate([g0, g1, g2, g3], axis=-1) @ w2
        x1 = x + hs
        h2 = _gelu(_layernorm(x1, axis=-1) @ w3) @ w4
        return x1 + h2
    x = A_x
    x = x + _A_ref(_layernorm(x, axis=-1), A_mem0, A_Wq, A_Wk, A_Wv, A_Wo, A_seg_len)
    x = x + _B_ref(_layernorm(x, axis=-1), B_w1, B_w2, B_w3, B_w4)
    x = x + _A_ref(_layernorm(x, axis=-1), A_mem0, A_Wq, A_Wk, A_Wv, A_Wo, A_seg_len)
    x = x + _B_ref(_layernorm(x, axis=-1), B_w1, B_w2, B_w3, B_w4)
    return x
```

```asm
; @launch grid=(256,1,1) block=(256,1,1) lds=163840
.amdgcn_target "amdgcn-amd-amdhsa--gfx950"
.text
.globl interleave_layers__memory_aug_recurrent_mem_tr__mixer_s_mlp__prompt_kernel
.p2align 8
.type interleave_layers__memory_aug_recurrent_mem_tr__mixer_s_mlp__prompt_kernel,@function
interleave_layers__memory_aug_recurrent_mem_tr__mixer_s_mlp__prompt_kernel:
    s_cmp_ge_u32 s2, 256
    s_cbranch_scc1 L_done
    s_load_dwordx2 s[4:5], s[0:1], 112
    s_load_dwordx2 s[90:91], s[0:1], 104
    s_load_dwordx2 s[8:9], s[0:1], 0
    s_getreg_b32 s15, hwreg(HW_REG_XCC_ID)
    s_and_b32 s15, s15, 15
    v_lshrrev_b32 v1, 6, v0
    v_mov_b32 v6, 0
    v_readfirstlane_b32 s12, v1
    s_waitcnt lgkmcnt(0)
    s_mov_b32 s3, s86
    s_mov_b32 s6, 268435456
    s_mov_b32 s7, 0x20000
    s_cmp_lg_u32 s12, 0
    s_cbranch_scc1 L_norank
    s_mov_b32 s13, 1
    s_lshl_b32 s16, s15, 2
    s_cselect_b32 s16, s16, 136
    s_atomic_add s13, s[90:91], s16 glc
    s_waitcnt lgkmcnt(0)
    s_lshl_b32 s94, s15, 5
    s_add_u32 s94, s94, s13
    s_cmp_ge_u32 s15, 8
    s_cbranch_scc1 L_over
    s_cmp_lt_u32 s13, 32
    s_cbranch_scc1 L_slot
L_over:
    s_mov_b32 s20, 0
L_ov1:
    s_load_dwordx16 s[48:63], s[90:91], 0 glc
    s_load_dword s21, s[90:91], 136 glc
    s_add_u32 s20, s20, 1
    s_cmp_gt_u32 s20, 65536
    s_cbranch_scc1 L_bail
    s_waitcnt lgkmcnt(0)
    s_mov_b32 s48, s21
    s_mov_b32 s16, s48
    s_add_u32 s16, s16, s49
    s_add_u32 s16, s16, s50
    s_add_u32 s16, s16, s51
    s_add_u32 s16, s16, s52
    s_add_u32 s16, s16, s53
    s_add_u32 s16, s16, s54
    s_add_u32 s16, s16, s55
    s_add_u32 s16, s16, s56
    s_add_u32 s16, s16, s57
    s_add_u32 s16, s16, s58
    s_add_u32 s16, s16, s59
    s_add_u32 s16, s16, s60
    s_add_u32 s16, s16, s61
    s_add_u32 s16, s16, s62
    s_add_u32 s16, s16, s63
    s_sleep 8
    s_cmp_lt_u32 s16, 256
    s_cbranch_scc1 L_ov1
    s_mov_b32 s13, 1
    s_atomic_add s13, s[90:91], 132 glc
    s_waitcnt lgkmcnt(0)
    s_min_u32 s16, s48, 32
    s_add_u32 s94, s16, s13
    s_sub_u32 s13, s94, 32
    s_add_u32 s94, s94, 0
    s_cmp_lt_u32 s94, 32
    s_cbranch_scc1 L_slot
    s_min_u32 s16, s49, 32
    s_add_u32 s94, s16, s13
    s_sub_u32 s13, s94, 32
    s_add_u32 s94, s94, 32
    s_cmp_lt_u32 s94, 64
    s_cbranch_scc1 L_slot
    s_min_u32 s16, s50, 32
    s_add_u32 s94, s16, s13
    s_sub_u32 s13, s94, 32
    s_add_u32 s94, s94, 64
    s_cmp_lt_u32 s94, 96
    s_cbranch_scc1 L_slot
    s_min_u32 s16, s51, 32
    s_add_u32 s94, s16, s13
    s_sub_u32 s13, s94, 32
    s_add_u32 s94, s94, 96
    s_cmp_lt_u32 s94, 128
    s_cbranch_scc1 L_slot
    s_min_u32 s16, s52, 32
    s_add_u32 s94, s16, s13
    s_sub_u32 s13, s94, 32
    s_add_u32 s94, s94, 128
    s_cmp_lt_u32 s94, 160
    s_cbranch_scc1 L_slot
    s_min_u32 s16, s53, 32
    s_add_u32 s94, s16, s13
    s_sub_u32 s13, s94, 32
    s_add_u32 s94, s94, 160
    s_cmp_lt_u32 s94, 192
    s_cbranch_scc1 L_slot
    s_min_u32 s16, s54, 32
    s_add_u32 s94, s16, s13
    s_sub_u32 s13, s94, 32
    s_add_u32 s94, s94, 192
    s_cmp_lt_u32 s94, 224
    s_cbranch_scc1 L_slot
    s_min_u32 s16, s55, 32
    s_add_u32 s94, s16, s13
    s_sub_u32 s13, s94, 32
    s_add_u32 s94, s94, 224
    s_cmp_lt_u32 s94, 256
    s_cbranch_scc1 L_slot
L_bail:
    s_mov_b32 s94, 0xffff
L_slot:
    v_mov_b32 v5, s94
    ds_write_b32 v6, v5
    s_waitcnt lgkmcnt(0)
L_norank:
    s_barrier
    ds_read_b32 v5, v6
    s_waitcnt vmcnt(0) lgkmcnt(0)
    v_readfirstlane_b32 s94, v5
    s_barrier
    s_cmp_ge_u32 s94, 256
    s_cbranch_scc1 L_done
    s_cmp_lt_u32 s94, 64
    s_cbranch_scc1 L_noinit
    s_and_b32 s16, s94, 31
    s_cmp_lt_u32 s16, 11
    s_cbranch_scc1 L_init
    s_cmp_lg_u32 s16, 11
    s_cbranch_scc1 L_noinit
    s_cmp_lg_u32 s12, 0
    s_cbranch_scc1 L_noinit
    s_lshl_b32 s16, s94, 2
    s_add_u32 s16, s16, 168558592
    s_mov_b32 s18, -1
    s_mov_b32 s19, -1
    s_mov_b32 s20, 0
L_meas:
    s_memtime s[22:23]
    s_waitcnt lgkmcnt(0)
    s_load_dword s21, s[4:5], s16 glc
    s_waitcnt lgkmcnt(0)
    s_memtime s[24:25]
    s_waitcnt lgkmcnt(0)
    s_load_dword s21, s[4:5], s16 offset:8192 glc
    s_waitcnt lgkmcnt(0)
    s_memtime s[26:27]
    s_waitcnt lgkmcnt(0)
    s_sub_u32 s22, s24, s22
    s_sub_u32 s24, s26, s24
    s_min_u32 s18, s18, s22
    s_min_u32 s19, s19, s24
    s_add_u32 s20, s20, 1
    s_cmp_lt_u32 s20, 5
    s_cbranch_scc1 L_meas
    s_cmp_lt_u32 s19, s18
    s_cselect_b32 s16, 256, 0
    s_lshr_b32 s17, s94, 5
    s_lshl_b32 s16, s16, s17
    s_add_u32 s16, s16, 1
    s_branch L_idone
L_init:
    s_lshr_b32 s17, s94, 5
    s_sub_u32 s17, s17, 2
    s_mul_i32 s17, s17, 11
    s_add_u32 s17, s17, s16
    s_cmp_ge_u32 s17, 64
    s_cbranch_scc1 L_noinit
    s_mov_b32 s10, 2621440
    s_mov_b32 s11, 0x20000
    v_and_b32 v1, 63, v0
    v_and_b32 v2, 31, v0
    v_mul_u32_u24 v2, 1280, v2
    v_bfe_u32 v3, v0, 5, 1
    v_lshl_add_u32 v2, v3, 4, v2
    v_lshlrev_b32 v3, 4, v1
    v_lshlrev_b32 v4, 3, v1
    v_lshlrev_b32 v5, 4, v0
    s_mul_i32 s20, s17, 40960
    s_mul_i32 s21, s12, 320
    s_add_u32 s21, s21, s20
    buffer_load_dwordx4 v[64:67], v2, s[8:11], s21 offen offset:0
    buffer_load_dwordx4 v[68:71], v2, s[8:11], s21 offen offset:32
    buffer_load_dwordx4 v[72:75], v2, s[8:11], s21 offen offset:64
    buffer_load_dwordx4 v[76:79], v2, s[8:11], s21 offen offset:96
    buffer_load_dwordx4 v[80:83], v2, s[8:11], s21 offen offset:128
    buffer_load_dwordx4 v[84:87], v2, s[8:11], s21 offen offset:160
    buffer_load_dwordx4 v[88:91], v2, s[8:11], s21 offen offset:192
    buffer_load_dwordx4 v[92:95], v2, s[8:11], s21 offen offset:224
    buffer_load_dwordx4 v[96:99], v2, s[8:11], s21 offen offset:256
    buffer_load_dwordx4 v[100:103], v2, s[8:11], s21 offen offset:288
    v_mov_b64 v[24:25], 0
    v_mov_b64 v[26:27], 0
    v_mov_b64 v[28:29], -1
    v_mov_b64 v[30:31], -1
    s_mul_i32 s20, s17, 12288
    s_add_u32 s22, s20, 150994944
    s_add_u32 s23, s20, 154796032
    s_cmp_lt_u32 s17, 32
    s_cselect_b32 s22, s22, s23
    s_add_u32 s21, s20, 167772160
    buffer_store_dwordx4 v[24:27], v5, s[4:7], s21 offen sc1
    buffer_store_dwordx4 v[28:31], v5, s[4:7], s22 offen sc1
    s_add_u32 s21, s21, 4096
    s_add_u32 s22, s22, 4096
    buffer_store_dwordx4 v[24:27], v5, s[4:7], s21 offen sc1
    buffer_store_dwordx4 v[28:31], v5, s[4:7], s22 offen sc1
    s_add_u32 s21, s21, 4096
    s_add_u32 s22, s22, 4096
    buffer_store_dwordx4 v[24:27], v5, s[4:7], s21 offen sc1
    buffer_store_dwordx4 v[28:31], v5, s[4:7], s22 offen sc1
    s_cmp_ge_u32 s17, 10
    s_cbranch_scc1 L_nopad
    s_lshl_b32 s20, s17, 12
    s_add_u32 s21, s20, 184549376
    buffer_store_dwordx4 v[24:27], v5, s[4:7], s21 offen sc1
    s_add_u32 s21, s20, 187211776
    buffer_store_dwordx4 v[24:27], v5, s[4:7], s21 offen sc1
    s_add_u32 s21, s20, 226492416
    buffer_store_dwordx4 v[24:27], v5, s[4:7], s21 offen sc1
    s_add_u32 s21, s20, 229154816
    buffer_store_dwordx4 v[24:27], v5, s[4:7], s21 offen sc1
L_nopad:
    s_mul_i32 s20, s17, 49152
    s_add_u32 s20, s20, 171966464
    s_mul_i32 s21, s12, 10240
    s_add_u32 s21, s21, s20
    s_mul_i32 s22, s12, 1280
    s_add_u32 s22, s22, s20
    s_add_u32 s22, s22, 40960
    s_waitcnt vmcnt(0)
    buffer_store_dwordx4 v[64:67], v3, s[4:7], s21 offen sc1
    buffer_store_dwordx4 v[68:71], v3, s[4:7], s21 offen offset:1024 sc1
    v_lshlrev_b32 v32, 16, v64
    v_and_b32 v33, 0xffff0000, v64
    v_lshlrev_b32 v34, 16, v65
    v_and_b32 v35, 0xffff0000, v65
    v_lshlrev_b32 v36, 16, v66
    v_and_b32 v37, 0xffff0000, v66
    v_lshlrev_b32 v38, 16, v67
    v_and_b32 v39, 0xffff0000, v67
    v_lshlrev_b32 v40, 16, v68
    v_and_b32 v41, 0xffff0000, v68
    v_lshlrev_b32 v42, 16, v69
    v_and_b32 v43, 0xffff0000, v69
    v_lshlrev_b32 v44, 16, v70
    v_and_b32 v45, 0xffff0000, v70
    v_lshlrev_b32 v46, 16, v71
    v_and_b32 v47, 0xffff0000, v71
    v_pk_add_f32 v[8:9], v[32:33], v[34:35]
    v_pk_mul_f32 v[10:11], v[32:33], v[32:33]
    v_pk_fma_f32 v[10:11], v[34:35], v[34:35], v[10:11]
    v_pk_add_f32 v[8:9], v[8:9], v[36:37]
    v_pk_fma_f32 v[10:11], v[36:37], v[36:37], v[10:11]
    v_pk_add_f32 v[8:9], v[8:9], v[38:39]
    v_pk_fma_f32 v[10:11], v[38:39], v[38:39], v[10:11]
    v_pk_add_f32 v[8:9], v[8:9], v[40:41]
    v_pk_fma_f32 v[10:11], v[40:41], v[40:41], v[10:11]
    v_pk_add_f32 v[8:9], v[8:9], v[42:43]
    v_pk_fma_f32 v[10:11], v[42:43], v[42:43], v[10:11]
    v_pk_add_f32 v[8:9], v[8:9], v[44:45]
    v_pk_fma_f32 v[10:11], v[44:45], v[44:45], v[10:11]
    v_pk_add_f32 v[8:9], v[8:9], v[46:47]
    v_pk_fma_f32 v[10:11], v[46:47], v[46:47], v[10:11]
    v_add_f32 v8, v8, v9
    v_add_f32 v9, v10, v11
    v_mov_b32 v10, v8
    v_mov_b32 v11, v9
    s_nop 1
    v_permlane32_swap_b32 v8, v10
    v_permlane32_swap_b32 v9, v11
    v_pk_add_f32 v[8:9], v[8:9], v[10:11]
    s_mov_b64 exec, 0xffffffff
    buffer_store_dwordx2 v[8:9], v4, s[4:7], s22 offen sc1
    s_mov_b64 exec, -1
    s_add_u32 s21, s21, 2048
    s_add_u32 s22, s22, 256
    buffer_store_dwordx4 v[72:75], v3, s[4:7], s21 offen sc1
    buffer_store_dwordx4 v[76:79], v3, s[4:7], s21 offen offset:1024 sc1
    v_lshlrev_b32 v32, 16, v72
    v_and_b32 v33, 0xffff0000, v72
    v_lshlrev_b32 v34, 16, v73
    v_and_b32 v35, 0xffff0000, v73
    v_lshlrev_b32 v36, 16, v74
    v_and_b32 v37, 0xffff0000, v74
    v_lshlrev_b32 v38, 16, v75
    v_and_b32 v39, 0xffff0000, v75
    v_lshlrev_b32 v40, 16, v76
    v_and_b32 v41, 0xffff0000, v76
    v_lshlrev_b32 v42, 16, v77
    v_and_b32 v43, 0xffff0000, v77
    v_lshlrev_b32 v44, 16, v78
    v_and_b32 v45, 0xffff0000, v78
    v_lshlrev_b32 v46, 16, v79
    v_and_b32 v47, 0xffff0000, v79
    v_pk_add_f32 v[12:13], v[32:33], v[34:35]
    v_pk_mul_f32 v[14:15], v[32:33], v[32:33]
    v_pk_fma_f32 v[14:15], v[34:35], v[34:35], v[14:15]
    v_pk_add_f32 v[12:13], v[12:13], v[36:37]
    v_pk_fma_f32 v[14:15], v[36:37], v[36:37], v[14:15]
    v_pk_add_f32 v[12:13], v[12:13], v[38:39]
    v_pk_fma_f32 v[14:15], v[38:39], v[38:39], v[14:15]
    v_pk_add_f32 v[12:13], v[12:13], v[40:41]
    v_pk_fma_f32 v[14:15], v[40:41], v[40:41], v[14:15]
    v_pk_add_f32 v[12:13], v[12:13], v[42:43]
    v_pk_fma_f32 v[14:15], v[42:43], v[42:43], v[14:15]
    v_pk_add_f32 v[12:13], v[12:13], v[44:45]
    v_pk_fma_f32 v[14:15], v[44:45], v[44:45], v[14:15]
    v_pk_add_f32 v[12:13], v[12:13], v[46:47]
    v_pk_fma_f32 v[14:15], v[46:47], v[46:47], v[14:15]
    v_add_f32 v12, v12, v13
    v_add_f32 v13, v14, v15
    v_mov_b32 v14, v12
    v_mov_b32 v15, v13
    s_nop 1
    v_permlane32_swap_b32 v12, v14
    v_permlane32_swap_b32 v13, v15
    v_pk_add_f32 v[12:13], v[12:13], v[14:15]
    s_mov_b64 exec, 0xffffffff
    buffer_store_dwordx2 v[12:13], v4, s[4:7], s22 offen sc1
    s_mov_b64 exec, -1
    s_add_u32 s21, s21, 2048
    s_add_u32 s22, s22, 256
    buffer_store_dwordx4 v[80:83], v3, s[4:7], s21 offen sc1
    buffer_store_dwordx4 v[84:87], v3, s[4:7], s21 offen offset:1024 sc1
    v_lshlrev_b32 v32, 16, v80
    v_and_b32 v33, 0xffff0000, v80
    v_lshlrev_b32 v34, 16, v81
    v_and_b32 v35, 0xffff0000, v81
    v_lshlrev_b32 v36, 16, v82
    v_and_b32 v37, 0xffff0000, v82
    v_lshlrev_b32 v38, 16, v83
    v_and_b32 v39, 0xffff0000, v83
    v_lshlrev_b32 v40, 16, v84
    v_and_b32 v41, 0xffff0000, v84
    v_lshlrev_b32 v42, 16, v85
    v_and_b32 v43, 0xffff0000, v85
    v_lshlrev_b32 v44, 16, v86
    v_and_b32 v45, 0xffff0000, v86
    v_lshlrev_b32 v46, 16, v87
    v_and_b32 v47, 0xffff0000, v87
    v_pk_add_f32 v[8:9], v[32:33], v[34:35]
    v_pk_mul_f32 v[10:11], v[32:33], v[32:33]
    v_pk_fma_f32 v[10:11], v[34:35], v[34:35], v[10:11]
    v_pk_add_f32 v[8:9], v[8:9], v[36:37]
    v_pk_fma_f32 v[10:11], v[36:37], v[36:37], v[10:11]
    v_pk_add_f32 v[8:9], v[8:9], v[38:39]
    v_pk_fma_f32 v[10:11], v[38:39], v[38:39], v[10:11]
    v_pk_add_f32 v[8:9], v[8:9], v[40:41]
    v_pk_fma_f32 v[10:11], v[40:41], v[40:41], v[10:11]
    v_pk_add_f32 v[8:9], v[8:9], v[42:43]
    v_pk_fma_f32 v[10:11], v[42:43], v[42:43], v[10:11]
    v_pk_add_f32 v[8:9], v[8:9], v[44:45]
    v_pk_fma_f32 v[10:11], v[44:45], v[44:45], v[10:11]
    v_pk_add_f32 v[8:9], v[8:9], v[46:47]
    v_pk_fma_f32 v[10:11], v[46:47], v[46:47], v[10:11]
    v_add_f32 v8, v8, v9
    v_add_f32 v9, v10, v11
    v_mov_b32 v10, v8
    v_mov_b32 v11, v9
    s_nop 1
    v_permlane32_swap_b32 v8, v10
    v_permlane32_swap_b32 v9, v11
    v_pk_add_f32 v[8:9], v[8:9], v[10:11]
    s_mov_b64 exec, 0xffffffff
    buffer_store_dwordx2 v[8:9], v4, s[4:7], s22 offen sc1
    s_mov_b64 exec, -1
    s_add_u32 s21, s21, 2048
    s_add_u32 s22, s22, 256
    buffer_store_dwordx4 v[88:91], v3, s[4:7], s21 offen sc1
    buffer_store_dwordx4 v[92:95], v3, s[4:7], s21 offen offset:1024 sc1
    v_lshlrev_b32 v32, 16, v88
    v_and_b32 v33, 0xffff0000, v88
    v_lshlrev_b32 v34, 16, v89
    v_and_b32 v35, 0xffff0000, v89
    v_lshlrev_b32 v36, 16, v90
    v_and_b32 v37, 0xffff0000, v90
    v_lshlrev_b32 v38, 16, v91
    v_and_b32 v39, 0xffff0000, v91
    v_lshlrev_b32 v40, 16, v92
    v_and_b32 v41, 0xffff0000, v92
    v_lshlrev_b32 v42, 16, v93
    v_and_b32 v43, 0xffff0000, v93
    v_lshlrev_b32 v44, 16, v94
    v_and_b32 v45, 0xffff0000, v94
    v_lshlrev_b32 v46, 16, v95
    v_and_b32 v47, 0xffff0000, v95
    v_pk_add_f32 v[12:13], v[32:33], v[34:35]
    v_pk_mul_f32 v[14:15], v[32:33], v[32:33]
    v_pk_fma_f32 v[14:15], v[34:35], v[34:35], v[14:15]
    v_pk_add_f32 v[12:13], v[12:13], v[36:37]
    v_pk_fma_f32 v[14:15], v[36:37], v[36:37], v[14:15]
    v_pk_add_f32 v[12:13], v[12:13], v[38:39]
    v_pk_fma_f32 v[14:15], v[38:39], v[38:39], v[14:15]
    v_pk_add_f32 v[12:13], v[12:13], v[40:41]
    v_pk_fma_f32 v[14:15], v[40:41], v[40:41], v[14:15]
    v_pk_add_f32 v[12:13], v[12:13], v[42:43]
    v_pk_fma_f32 v[14:15], v[42:43], v[42:43], v[14:15]
    v_pk_add_f32 v[12:13], v[12:13], v[44:45]
    v_pk_fma_f32 v[14:15], v[44:45], v[44:45], v[14:15]
    v_pk_add_f32 v[12:13], v[12:13], v[46:47]
    v_pk_fma_f32 v[14:15], v[46:47], v[46:47], v[14:15]
    v_add_f32 v12, v12, v13
    v_add_f32 v13, v14, v15
    v_mov_b32 v14, v12
    v_mov_b32 v15, v13
    s_nop 1
    v_permlane32_swap_b32 v12, v14
    v_permlane32_swap_b32 v13, v15
    v_pk_add_f32 v[12:13], v[12:13], v[14:15]
    s_mov_b64 exec, 0xffffffff
    buffer_store_dwordx2 v[12:13], v4, s[4:7], s22 offen sc1
    s_mov_b64 exec, -1
    s_add_u32 s21, s21, 2048
    s_add_u32 s22, s22, 256
    buffer_store_dwordx4 v[96:99], v3, s[4:7], s21 offen sc1
    buffer_store_dwordx4 v[100:103], v3, s[4:7], s21 offen offset:1024 sc1
    v_lshlrev_b32 v32, 16, v96
    v_and_b32 v33, 0xffff0000, v96
    v_lshlrev_b32 v34, 16, v97
    v_and_b32 v35, 0xffff0000, v97
    v_lshlrev_b32 v36, 16, v98
    v_and_b32 v37, 0xffff0000, v98
    v_lshlrev_b32 v38, 16, v99
    v_and_b32 v39, 0xffff0000, v99
    v_lshlrev_b32 v40, 16, v100
    v_and_b32 v41, 0xffff0000, v100
    v_lshlrev_b32 v42, 16, v101
    v_and_b32 v43, 0xffff0000, v101
    v_lshlrev_b32 v44, 16, v102
    v_and_b32 v45, 0xffff0000, v102
    v_lshlrev_b32 v46, 16, v103
    v_and_b32 v47, 0xffff0000, v103
    v_pk_add_f32 v[8:9], v[32:33], v[34:35]
    v_pk_mul_f32 v[10:11], v[32:33], v[32:33]
    v_pk_fma_f32 v[10:11], v[34:35], v[34:35], v[10:11]
    v_pk_add_f32 v[8:9], v[8:9], v[36:37]
    v_pk_fma_f32 v[10:11], v[36:37], v[36:37], v[10:11]
    v_pk_add_f32 v[8:9], v[8:9], v[38:39]
    v_pk_fma_f32 v[10:11], v[38:39], v[38:39], v[10:11]
    v_pk_add_f32 v[8:9], v[8:9], v[40:41]
    v_pk_fma_f32 v[10:11], v[40:41], v[40:41], v[10:11]
    v_pk_add_f32 v[8:9], v[8:9], v[42:43]
    v_pk_fma_f32 v[10:11], v[42:43], v[42:43], v[10:11]
    v_pk_add_f32 v[8:9], v[8:9], v[44:45]
    v_pk_fma_f32 v[10:11], v[44:45], v[44:45], v[10:11]
    v_pk_add_f32 v[8:9], v[8:9], v[46:47]
    v_pk_fma_f32 v[10:11], v[46:47], v[46:47], v[10:11]
    v_add_f32 v8, v8, v9
    v_add_f32 v9, v10, v11
    v_mov_b32 v10, v8
    v_mov_b32 v11, v9
    s_nop 1
    v_permlane32_swap_b32 v8, v10
    v_permlane32_swap_b32 v9, v11
    v_pk_add_f32 v[8:9], v[8:9], v[10:11]
    s_mov_b64 exec, 0xffffffff
    buffer_store_dwordx2 v[8:9], v4, s[4:7], s22 offen sc1
    s_mov_b64 exec, -1
    s_add_u32 s21, s21, 2048
    s_add_u32 s22, s22, 256
    s_waitcnt vmcnt(0)
    s_barrier
    s_cmp_lg_u32 s12, 0
    s_cbranch_scc1 L_noinit
    s_mov_b32 s16, 1
L_idone:
    s_atomic_add s16, s[90:91], 128
    s_waitcnt lgkmcnt(0)
L_noinit:
    s_getpc_b64 s[16:17]
L_pc:
    s_add_u32 s16, s16, role_table-L_pc
    s_addc_u32 s17, s17, 0
    s_lshl_b32 s18, s94, 3
    s_load_dwordx2 s[96:97], s[16:17], s18
    s_mov_b32 s95, 0
    s_waitcnt lgkmcnt(0)
L_disp:
    s_bfe_u32 s13, s96, 0x80008
    s_bfe_u32 s14, s96, 0x40010
    s_bfe_u32 s15, s96, 0x40014
    s_and_b32 s16, s96, 0xff
    s_cmp_eq_u32 s16, 1
    s_cbranch_scc1 RR
    s_cmp_eq_u32 s16, 2
    s_cbranch_scc1 RQK
    s_cmp_eq_u32 s16, 3
    s_cbranch_scc1 RV
    s_cmp_eq_u32 s16, 4
    s_cbranch_scc1 RAT
    s_cmp_eq_u32 s16, 5
    s_cbranch_scc1 RO
    s_cmp_eq_u32 s16, 6
    s_cbranch_scc1 RRL
    s_cmp_eq_u32 s16, 7
    s_cbranch_scc1 RM1
    s_cmp_eq_u32 s16, 8
    s_cbranch_scc1 RM2
    s_cmp_eq_u32 s16, 9
    s_cbranch_scc1 RM3
    s_cmp_eq_u32 s16, 10
    s_cbranch_scc1 RM4
    s_branch L_fin
L_next:
    s_waitcnt vmcnt(0) lgkmcnt(0)
    s_mov_b32 s96, s97
    s_mov_b32 s97, 0
    s_branch L_disp
L_exit:
    v_mov_b32 v1, s96
    v_mov_b32 v2, 64
    s_mov_b64 exec, 1
    global_store_dword v2, v1, s[90:91]
    s_waitcnt vmcnt(0)
L_fin:
L_done:
    s_endpgm
RR:
    s_barrier
    s_add_u32 s99, s14, s15
    s_load_dwordx2 s[50:51], s[0:1], 16
    s_load_dwordx2 s[52:53], s[0:1], 24
    s_load_dwordx2 s[54:55], s[0:1], 32
    s_load_dwordx2 s[56:57], s[0:1], 40
    s_load_dwordx2 s[58:59], s[0:1], 8
    v_mbcnt_lo_u32_b32 v8, -1, 0
    v_mbcnt_hi_u32_b32 v8, -1, v8
    v_and_b32 v9, 15, v8
    v_lshrrev_b32 v10, 4, v8
    v_lshlrev_b32 v0, 4, v8
    v_and_b32 v11, 1, v8
    v_lshrrev_b32 v12, 1, v10
    v_and_b32 v13, 1, v10
    v_lshlrev_b32 v16, 4, v12
    v_lshl_add_u32 v16, v13, 2, v16
    v_mul_u32_u24 v17, 1280, v16
    s_mul_i32 s30, s12, 320
    v_lshl_add_u32 v18, v9, 3, v17
    v_add_u32 v24, s30, v18
    v_lshl_add_u32 v18, v9, 2, v17
    v_add_u32 v25, s30, v18
    v_add_u32 v25, 256, v25
    v_lshlrev_b32 v17, 13, v10
    v_lshlrev_b32 v18, 2, v13
    v_xor_b32 v18, v18, v9
    v_lshl_add_u32 v17, v18, 4, v17
    s_lshl_b32 s30, s13, 8
    s_lshl_b32 s31, s12, 17
    s_add_u32 s30, s30, s31
    v_add_u32 v26, s30, v17
    v_xor_b32 v29, 128, v26
    v_bfe_u32 v17, v8, 2, 1
    v_lshl_add_u32 v16, v13, 2, v17
    v_bfe_u32 v18, v8, 3, 1
    v_lshl_add_u32 v16, v18, 3, v16
    v_lshlrev_b32 v16, 8, v16
    v_lshl_add_u32 v17, v13, 1, v17
    v_xor_b32 v17, s12, v17
    v_lshl_add_u32 v16, v17, 6, v16
    v_and_b32 v18, 3, v8
    v_lshl_add_u32 v16, v18, 4, v16
    v_mul_u32_u24 v17, 36864, v12
    v_add_u32 v16, v16, v17
    v_add_u32 v27, 16384, v16
    v_add_u32 v30, 73728, v27
    s_mul_i32 s33, s12, 36864
    s_add_u32 s33, s33, 16384
    v_add_u32 v4, s33, v0
    v_bfe_u32 v16, v8, 3, 2
    v_lshlrev_b32 v16, 13, v16
    v_and_b32 v17, 7, v8
    v_lshl_add_u32 v16, v17, 7, v16
    s_and_b32 s30, s13, 3
    s_lshl_b32 s30, s30, 2
    s_add_u32 s30, s30, s12
    s_lshl_b32 s30, s30, 15
    s_lshr_b32 s31, s13, 2
    s_lshl_b32 s31, s31, 10
    s_add_u32 s30, s30, s31
    v_add_u32 v31, s30, v16
    s_mul_i32 s35, s99, 4194304
    s_lshl_b32 s27, s13, 2
    s_add_u32 s27, s27, s12
    s_mul_i32 s26, s27, 20480
    s_add_u32 s26, s26, s35
    s_add_u32 s26, s26, 151519232
    s_mov_b32 s48, 0x05040100
    s_mov_b32 s49, 0x07060302
    s_mov_b32 s10, 5242880
    s_mov_b32 s11, 0x20000
    s_waitcnt lgkmcnt(0)
    s_mov_b32 s8, s56
    s_mov_b32 s9, s57
    s_mul_i32 s30, s13, 163840
    s_lshl_b32 s31, s12, 12
    s_add_u32 s30, s30, s31
    s_add_u32 m0, s31, 0
    s_add_u32 s32, s30, 0
    buffer_load_dwordx4 v0, s[8:11], s32 offen offset:0 lds
    buffer_load_dwordx4 v0, s[8:11], s32 offen offset:1024 lds
    buffer_load_dwordx4 v0, s[8:11], s32 offen offset:2048 lds
    buffer_load_dwordx4 v0, s[8:11], s32 offen offset:3072 lds
    s_add_u32 m0, s31, 16384
    s_add_u32 s32, s30, 16384
    buffer_load_dwordx4 v0, s[8:11], s32 offen offset:0 lds
    buffer_load_dwordx4 v0, s[8:11], s32 offen offset:1024 lds
    buffer_load_dwordx4 v0, s[8:11], s32 offen offset:2048 lds
    buffer_load_dwordx4 v0, s[8:11], s32 offen offset:3072 lds
    s_add_u32 m0, s31, 32768
    s_add_u32 s32, s30, 32768
    buffer_load_dwordx4 v0, s[8:11], s32 offen offset:0 lds
    buffer_load_dwordx4 v0, s[8:11], s32 offen offset:1024 lds
    buffer_load_dwordx4 v0, s[8:11], s32 offen offset:2048 lds
    buffer_load_dwordx4 v0, s[8:11], s32 offen offset:3072 lds
    s_add_u32 m0, s31, 49152
    s_add_u32 s32, s30, 49152
    buffer_load_dwordx4 v0, s[8:11], s32 offen offset:0 lds
    buffer_load_dwordx4 v0, s[8:11], s32 offen offset:1024 lds
    buffer_load_dwordx4 v0, s[8:11], s32 offen offset:2048 lds
    buffer_load_dwordx4 v0, s[8:11], s32 offen offset:3072 lds
    s_add_u32 m0, s31, 65536
    s_add_u32 s32, s30, 65536
    buffer_load_dwordx4 v0, s[8:11], s32 offen offset:0 lds
    buffer_load_dwordx4 v0, s[8:11], s32 offen offset:1024 lds
    buffer_load_dwordx4 v0, s[8:11], s32 offen offset:2048 lds
    buffer_load_dwordx4 v0, s[8:11], s32 offen offset:3072 lds
    s_add_u32 m0, s31, 81920
    s_add_u32 s32, s30, 81920
    buffer_load_dwordx4 v0, s[8:11], s32 offen offset:0 lds
    buffer_load_dwordx4 v0, s[8:11], s32 offen offset:1024 lds
    buffer_load_dwordx4 v0, s[8:11], s32 offen offset:2048 lds
    buffer_load_dwordx4 v0, s[8:11], s32 offen offset:3072 lds
    s_add_u32 m0, s31, 98304
    s_add_u32 s32, s30, 98304
    buffer_load_dwordx4 v0, s[8:11], s32 offen offset:0 lds
    buffer_load_dwordx4 v0, s[8:11], s32 offen offset:1024 lds
    buffer_load_dwordx4 v0, s[8:11], s32 offen offset:2048 lds
    buffer_load_dwordx4 v0, s[8:11], s32 offen offset:3072 lds
    s_add_u32 m0, s31, 114688
    s_add_u32 s32, s30, 114688
    buffer_load_dwordx4 v0, s[8:11], s32 offen offset:0 lds
    buffer_load_dwordx4 v0, s[8:11], s32 offen offset:1024 lds
    buffer_load_dwordx4 v0, s[8:11], s32 offen offset:2048 lds
    buffer_load_dwordx4 v0, s[8:11], s32 offen offset:3072 lds
    s_add_u32 m0, s31, 131072
    s_add_u32 s32, s30, 131072
    buffer_load_dwordx4 v0, s[8:11], s32 offen offset:0 lds
    buffer_load_dwordx4 v0, s[8:11], s32 offen offset:1024 lds
    buffer_load_dwordx4 v0, s[8:11], s32 offen offset:2048 lds
    buffer_load_dwordx4 v0, s[8:11], s32 offen offset:3072 lds
    s_add_u32 m0, s31, 147456
    s_add_u32 s32, s30, 147456
    buffer_load_dwordx4 v0, s[8:11], s32 offen offset:0 lds
    buffer_load_dwordx4 v0, s[8:11], s32 offen offset:1024 lds
    buffer_load_dwordx4 v0, s[8:11], s32 offen offset:2048 lds
    buffer_load_dwordx4 v0, s[8:11], s32 offen offset:3072 lds
    s_waitcnt vmcnt(20)
    s_barrier
    ds_read_b64 v[56:57], v24 offset:0
    ds_read_b64 v[58:59], v24 offset:1280
    ds_read_b64 v[60:61], v24 offset:10240
    ds_read_b64 v[62:63], v24 offset:11520
    ds_read_b64 v[64:65], v24 offset:2560
    ds_read_b64 v[66:67], v24 offset:3840
    ds_read_b64 v[68:69], v24 offset:12800
    ds_read_b64 v[70:71], v24 offset:14080
    ds_read_b64 v[88:89], v24 offset:128
    ds_read_b64 v[90:91], v24 offset:1408
    ds_read_b64 v[92:93], v24 offset:10368
    ds_read_b64 v[94:95], v24 offset:11648
    ds_read_b64 v[96:97], v24 offset:2688
    ds_read_b64 v[98:99], v24 offset:3968
    ds_read_b64 v[100:101], v24 offset:12928
    ds_read_b64 v[102:103], v24 offset:14208
    ds_read_b32 v120, v25 offset:0
    ds_read_b32 v121, v25 offset:1280
    ds_read_b32 v122, v25 offset:10240
    ds_read_b32 v123, v25 offset:11520
    ds_read_b32 v124, v25 offset:2560
    ds_read_b32 v125, v25 offset:3840
    ds_read_b32 v126, v25 offset:12800
    ds_read_b32 v127, v25 offset:14080
    v_add_u32 v24, 40960, v24
    v_add_u32 v25, 40960, v25
    ds_read_b64 v[72:73], v24 offset:0
    ds_read_b64 v[74:75], v24 offset:1280
    ds_read_b64 v[76:77], v24 offset:10240
    ds_read_b64 v[78:79], v24 offset:11520
    ds_read_b64 v[80:81], v24 offset:2560
    ds_read_b64 v[82:83], v24 offset:3840
    ds_read_b64 v[84:85], v24 offset:12800
    ds_read_b64 v[86:87], v24 offset:14080
    ds_read_b64 v[104:105], v24 offset:128
    ds_read_b64 v[106:107], v24 offset:1408
    ds_read_b64 v[108:109], v24 offset:10368
    ds_read_b64 v[110:111], v24 offset:11648
    ds_read_b64 v[112:113], v24 offset:2688
    ds_read_b64 v[114:115], v24 offset:3968
    ds_read_b64 v[116:117], v24 offset:12928
    ds_read_b64 v[118:119], v24 offset:14208
    ds_read_b32 v128, v25 offset:0
    ds_read_b32 v129, v25 offset:1280
    ds_read_b32 v130, v25 offset:10240
    ds_read_b32 v131, v25 offset:11520
    ds_read_b32 v132, v25 offset:2560
    ds_read_b32 v133, v25 offset:3840
    ds_read_b32 v134, v25 offset:12800
    ds_read_b32 v135, v25 offset:14080
    v_add_u32 v24, 40960, v24
    v_add_u32 v25, 40960, v25
    s_waitcnt vmcnt(0)
    s_barrier
    ds_read_b64 v[136:137], v24 offset:0
    ds_read_b64 v[138:139], v24 offset:1280
    ds_read_b64 v[140:141], v24 offset:10240
    ds_read_b64 v[142:143], v24 offset:11520
    ds_read_b64 v[144:145], v24 offset:2560
    ds_read_b64 v[146:147], v24 offset:3840
    ds_read_b64 v[148:149], v24 offset:12800
    ds_read_b64 v[150:151], v24 offset:14080
    ds_read_b64 v[168:169], v24 offset:128
    ds_read_b64 v[170:171], v24 offset:1408
    ds_read_b64 v[172:173], v24 offset:10368
    ds_read_b64 v[174:175], v24 offset:11648
    ds_read_b64 v[176:177], v24 offset:2688
    ds_read_b64 v[178:179], v24 offset:3968
    ds_read_b64 v[180:181], v24 offset:12928
    ds_read_b64 v[182:183], v24 offset:14208
    ds_read_b32 v200, v25 offset:0
    ds_read_b32 v201, v25 offset:1280
    ds_read_b32 v202, v25 offset:10240
    ds_read_b32 v203, v25 offset:11520
    ds_read_b32 v204, v25 offset:2560
    ds_read_b32 v205, v25 offset:3840
    ds_read_b32 v206, v25 offset:12800
    ds_read_b32 v207, v25 offset:14080
    v_add_u32 v24, 40960, v24
    v_add_u32 v25, 40960, v25
    ds_read_b64 v[152:153], v24 offset:0
    ds_read_b64 v[154:155], v24 offset:1280
    ds_read_b64 v[156:157], v24 offset:10240
    ds_read_b64 v[158:159], v24 offset:11520
    ds_read_b64 v[160:161], v24 offset:2560
    ds_read_b64 v[162:163], v24 offset:3840
    ds_read_b64 v[164:165], v24 offset:12800
    ds_read_b64 v[166:167], v24 offset:14080
    ds_read_b64 v[184:185], v24 offset:128
    ds_read_b64 v[186:187], v24 offset:1408
    ds_read_b64 v[188:189], v24 offset:10368
    ds_read_b64 v[190:191], v24 offset:11648
    ds_read_b64 v[192:193], v24 offset:2688
    ds_read_b64 v[194:195], v24 offset:3968
    ds_read_b64 v[196:197], v24 offset:12928
    ds_read_b64 v[198:199], v24 offset:14208
    ds_read_b32 v208, v25 offset:0
    ds_read_b32 v209, v25 offset:1280
    ds_read_b32 v210, v25 offset:10240
    ds_read_b32 v211, v25 offset:11520
    ds_read_b32 v212, v25 offset:2560
    ds_read_b32 v213, v25 offset:3840
    ds_read_b32 v214, v25 offset:12800
    ds_read_b32 v215, v25 offset:14080
    v_add_u32 v24, 40960, v24
    v_add_u32 v25, 40960, v25
    s_waitcnt lgkmcnt(0)
    s_barrier
    s_mov_b32 s8, s50
    s_mov_b32 s9, s51
    s_add_u32 m0, s33, 0
    s_mov_b32 s30, 1048576
    buffer_load_dwordx4 v26, s[8:11], s30 offen lds
    s_add_u32 m0, s33, 1024
    s_mov_b32 s30, 1081344
    buffer_load_dwordx4 v29, s[8:11], s30 offen lds
    s_add_u32 m0, s33, 2048
    s_mov_b32 s30, 1114112
    buffer_load_dwordx4 v26, s[8:11], s30 offen lds
    s_add_u32 m0, s33, 3072
    s_mov_b32 s30, 1146880
    buffer_load_dwordx4 v29, s[8:11], s30 offen lds
    s_add_u32 m0, s33, 4096
    s_mov_b32 s30, 0
    buffer_load_dwordx4 v26, s[8:11], s30 offen lds
    s_add_u32 m0, s33, 5120
    s_mov_b32 s30, 32768
    buffer_load_dwordx4 v29, s[8:11], s30 offen lds
    s_add_u32 m0, s33, 6144
    s_mov_b32 s30, 65536
    buffer_load_dwordx4 v26, s[8:11], s30 offen lds
    s_add_u32 m0, s33, 7168
    s_mov_b32 s30, 98304
    buffer_load_dwordx4 v29, s[8:11], s30 offen lds
    s_add_u32 m0, s33, 8192
    s_mov_b32 s30, 524288
    buffer_load_dwordx4 v26, s[8:11], s30 offen lds
    s_add_u32 m0, s33, 9216
    s_mov_b32 s30, 557056
    buffer_load_dwordx4 v29, s[8:11], s30 offen lds
    s_add_u32 m0, s33, 10240
    s_mov_b32 s30, 589824
    buffer_load_dwordx4 v26, s[8:11], s30 offen lds
    s_add_u32 m0, s33, 11264
    s_mov_b32 s30, 622592
    buffer_load_dwordx4 v29, s[8:11], s30 offen lds
    s_add_u32 m0, s33, 12288
    s_mov_b32 s30, 4718592
    buffer_load_dwordx4 v26, s[8:11], s30 offen lds
    s_add_u32 m0, s33, 13312
    s_mov_b32 s30, 4751360
    buffer_load_dwordx4 v29, s[8:11], s30 offen lds
    s_add_u32 m0, s33, 14336
    s_mov_b32 s30, 4784128
    buffer_load_dwordx4 v26, s[8:11], s30 offen lds
    s_add_u32 m0, s33, 15360
    s_mov_b32 s30, 4816896
    buffer_load_dwordx4 v29, s[8:11], s30 offen lds
    s_mov_b32 s8, s52
    s_mov_b32 s9, s53
    s_add_u32 m0, s33, 16384
    s_mov_b32 s30, 0
    buffer_load_dwordx4 v26, s[8:11], s30 offen lds
    s_add_u32 m0, s33, 17408
    s_mov_b32 s30, 32768
    buffer_load_dwordx4 v29, s[8:11], s30 offen lds
    s_add_u32 m0, s33, 18432
    s_mov_b32 s30, 65536
    buffer_load_dwordx4 v26, s[8:11], s30 offen lds
    s_add_u32 m0, s33, 19456
    s_mov_b32 s30, 98304
    buffer_load_dwordx4 v29, s[8:11], s30 offen lds
    s_add_u32 m0, s33, 20480
    s_mov_b32 s30, 524288
    buffer_load_dwordx4 v26, s[8:11], s30 offen lds
    s_add_u32 m0, s33, 21504
    s_mov_b32 s30, 557056
    buffer_load_dwordx4 v29, s[8:11], s30 offen lds
    s_add_u32 m0, s33, 22528
    s_mov_b32 s30, 589824
    buffer_load_dwordx4 v26, s[8:11], s30 offen lds
    s_add_u32 m0, s33, 23552
    s_mov_b32 s30, 622592
    buffer_load_dwordx4 v29, s[8:11], s30 offen lds
    s_add_u32 m0, s33, 24576
    s_mov_b32 s30, 1048576
    buffer_load_dwordx4 v26, s[8:11], s30 offen lds
    s_add_u32 m0, s33, 25600
    s_mov_b32 s30, 1081344
    buffer_load_dwordx4 v29, s[8:11], s30 offen lds
    s_add_u32 m0, s33, 26624
    s_mov_b32 s30, 1114112
    buffer_load_dwordx4 v26, s[8:11], s30 offen lds
    s_add_u32 m0, s33, 27648
    s_mov_b32 s30, 1146880
    buffer_load_dwordx4 v29, s[8:11], s30 offen lds
    s_add_u32 m0, s33, 28672
    s_mov_b32 s30, 1572864
    buffer_load_dwordx4 v26, s[8:11], s30 offen lds
    s_add_u32 m0, s33, 29696
    s_mov_b32 s30, 1605632
    buffer_load_dwordx4 v29, s[8:11], s30 offen lds
    s_add_u32 m0, s33, 30720
    s_mov_b32 s30, 1638400
    buffer_load_dwordx4 v26, s[8:11], s30 offen lds
    s_add_u32 m0, s33, 31744
    s_mov_b32 s30, 1671168
    buffer_load_dwordx4 v29, s[8:11], s30 offen lds
    s_add_u32 m0, s33, 32768
    s_mov_b32 s30, 2097152
    buffer_load_dwordx4 v26, s[8:11], s30 offen lds
    s_add_u32 m0, s33, 33792
    s_mov_b32 s30, 2129920
    buffer_load_dwordx4 v29, s[8:11], s30 offen lds
    s_add_u32 m0, s33, 34816
    s_mov_b32 s30, 2162688
    buffer_load_dwordx4 v26, s[8:11], s30 offen lds
    s_add_u32 m0, s33, 35840
    s_mov_b32 s30, 2195456
    buffer_load_dwordx4 v29, s[8:11], s30 offen lds
    v_perm_b32 v32, v58, v56, s48
    v_perm_b32 v33, v62, v60, s48
    v_perm_b32 v34, v66, v64, s48
    v_perm_b32 v35, v70, v68, s48
    v_perm_b32 v36, v74, v72, s48
    v_perm_b32 v37, v78, v76, s48
    v_perm_b32 v38, v82, v80, s48
    v_perm_b32 v39, v86, v84, s48
    s_add_u32 s31, s26, 10240
    buffer_store_dwordx4 v[32:35], v0, s[4:7], s31 offen
    buffer_store_dwordx4 v[36:39], v0, s[4:7], s31 offen offset:1024
    v_perm_b32 v40, v58, v56, s49
    v_perm_b32 v41, v62, v60, s49
    v_perm_b32 v42, v66, v64, s49
    v_perm_b32 v43, v70, v68, s49
    v_perm_b32 v44, v74, v72, s49
    v_perm_b32 v45, v78, v76, s49
    v_perm_b32 v46, v82, v80, s49
    v_perm_b32 v47, v86, v84, s49
    s_add_u32 s31, s26, 12288
    buffer_store_dwordx4 v[40:43], v0, s[4:7], s31 offen
    buffer_store_dwordx4 v[44:47], v0, s[4:7], s31 offen offset:1024
    v_perm_b32 v32, v59, v57, s48
    v_perm_b32 v33, v63, v61, s48
    v_perm_b32 v34, v67, v65, s48
    v_perm_b32 v35, v71, v69, s48
    v_perm_b32 v36, v75, v73, s48
    v_perm_b32 v37, v79, v77, s48
    v_perm_b32 v38, v83, v81, s48
    v_perm_b32 v39, v87, v85, s48
    s_add_u32 s31, s26, 14336
    buffer_store_dwordx4 v[32:35], v0, s[4:7], s31 offen
    buffer_store_dwordx4 v[36:39], v0, s[4:7], s31 offen offset:1024
    v_perm_b32 v40, v59, v57, s49
    v_perm_b32 v41, v63, v61, s49
    v_perm_b32 v42, v67, v65, s49
    v_perm_b32 v43, v71, v69, s49
    v_perm_b32 v44, v75, v73, s49
    v_perm_b32 v45, v79, v77, s49
    v_perm_b32 v46, v83, v81, s49
    v_perm_b32 v47, v87, v85, s49
    s_add_u32 s31, s26, 16384
    buffer_store_dwordx4 v[40:43], v0, s[4:7], s31 offen
    buffer_store_dwordx4 v[44:47], v0, s[4:7], s31 offen offset:1024
    v_perm_b32 v32, v90, v88, s48
    v_perm_b32 v33, v94, v92, s48
    v_perm_b32 v34, v98, v96, s48
    v_perm_b32 v35, v102, v100, s48
    v_perm_b32 v36, v106, v104, s48
    v_perm_b32 v37, v110, v108, s48
    v_perm_b32 v38, v114, v112, s48
    v_perm_b32 v39, v118, v116, s48
    v_accvgpr_write_b32 a96, v32
    v_accvgpr_write_b32 a97, v33
    v_accvgpr_write_b32 a98, v34
    v_accvgpr_write_b32 a99, v35
    v_accvgpr_write_b32 a100, v36
    v_accvgpr_write_b32 a101, v37
    v_accvgpr_write_b32 a102, v38
    v_accvgpr_write_b32 a103, v39
    v_perm_b32 v40, v90, v88, s49
    v_perm_b32 v41, v94, v92, s49
    v_perm_b32 v42, v98, v96, s49
    v_perm_b32 v43, v102, v100, s49
    v_perm_b32 v44, v106, v104, s49
    v_perm_b32 v45, v110, v108, s49
    v_perm_b32 v46, v114, v112, s49
    v_perm_b32 v47, v118, v116, s49
    v_accvgpr_write_b32 a104, v40
    v_accvgpr_write_b32 a105, v41
    v_accvgpr_write_b32 a106, v42
    v_accvgpr_write_b32 a107, v43
    v_accvgpr_write_b32 a108, v44
    v_accvgpr_write_b32 a109, v45
    v_accvgpr_write_b32 a110, v46
    v_accvgpr_write_b32 a111, v47
    v_perm_b32 v32, v91, v89, s48
    v_perm_b32 v33, v95, v93, s48
    v_perm_b32 v34, v99, v97, s48
    v_perm_b32 v35, v103, v101, s48
    v_perm_b32 v36, v107, v105, s48
    v_perm_b32 v37, v111, v109, s48
    v_perm_b32 v38, v115, v113, s48
    v_perm_b32 v39, v119, v117, s48
    v_accvgpr_write_b32 a112, v32
    v_accvgpr_write_b32 a113, v33
    v_accvgpr_write_b32 a114, v34
    v_accvgpr_write_b32 a115, v35
    v_accvgpr_write_b32 a116, v36
    v_accvgpr_write_b32 a117, v37
    v_accvgpr_write_b32 a118, v38
    v_accvgpr_write_b32 a119, v39
    v_perm_b32 v40, v91, v89, s49
    v_perm_b32 v41, v95, v93, s49
    v_perm_b32 v42, v99, v97, s49
    v_perm_b32 v43, v103, v101, s49
    v_perm_b32 v44, v107, v105, s49
    v_perm_b32 v45, v111, v109, s49
    v_perm_b32 v46, v115, v113, s49
    v_perm_b32 v47, v119, v117, s49
    v_accvgpr_write_b32 a120, v40
    v_accvgpr_write_b32 a121, v41
    v_accvgpr_write_b32 a122, v42
    v_accvgpr_write_b32 a123, v43
    v_accvgpr_write_b32 a124, v44
    v_accvgpr_write_b32 a125, v45
    v_accvgpr_write_b32 a126, v46
    v_accvgpr_write_b32 a127, v47
    v_perm_b32 v32, v121, v120, s48
    v_perm_b32 v33, v123, v122, s48
    v_perm_b32 v34, v125, v124, s48
    v_perm_b32 v35, v127, v126, s48
    v_perm_b32 v36, v129, v128, s48
    v_perm_b32 v37, v131, v130, s48
    v_perm_b32 v38, v133, v132, s48
    v_perm_b32 v39, v135, v134, s48
    s_add_u32 s31, s26, 18432
    buffer_store_dwordx4 v[32:35], v0, s[4:7], s31 offen
    buffer_store_dwordx4 v[36:39], v0, s[4:7], s31 offen offset:1024
    v_perm_b32 v40, v121, v120, s49
    v_perm_b32 v41, v123, v122, s49
    v_perm_b32 v42, v125, v124, s49
    v_perm_b32 v43, v127, v126, s49
    v_perm_b32 v44, v129, v128, s49
    v_perm_b32 v45, v131, v130, s49
    v_perm_b32 v46, v133, v132, s49
    v_perm_b32 v47, v135, v134, s49
    v_accvgpr_write_b32 a128, v40
    v_accvgpr_write_b32 a129, v41
    v_accvgpr_write_b32 a130, v42
    v_accvgpr_write_b32 a131, v43
    v_accvgpr_write_b32 a132, v44
    v_accvgpr_write_b32 a133, v45
    v_accvgpr_write_b32 a134, v46
    v_accvgpr_write_b32 a135, v47
    v_perm_b32 v32, v138, v136, s48
    v_perm_b32 v33, v142, v140, s48
    v_perm_b32 v34, v146, v144, s48
    v_perm_b32 v35, v150, v148, s48
    v_perm_b32 v36, v154, v152, s48
    v_perm_b32 v37, v158, v156, s48
    v_perm_b32 v38, v162, v160, s48
    v_perm_b32 v39, v166, v164, s48
    v_accvgpr_write_b32 a136, v32
    v_accvgpr_write_b32 a137, v33
    v_accvgpr_write_b32 a138, v34
    v_accvgpr_write_b32 a139, v35
    v_accvgpr_write_b32 a140, v36
    v_accvgpr_write_b32 a141, v37
    v_accvgpr_write_b32 a142, v38
    v_accvgpr_write_b32 a143, v39
    v_perm_b32 v40, v138, v136, s49
    v_perm_b32 v41, v142, v140, s49
    v_perm_b32 v42, v146, v144, s49
    v_perm_b32 v43, v150, v148, s49
    v_perm_b32 v44, v154, v152, s49
    v_perm_b32 v45, v158, v156, s49
    v_perm_b32 v46, v162, v160, s49
    v_perm_b32 v47, v166, v164, s49
    v_accvgpr_write_b32 a144, v40
    v_accvgpr_write_b32 a145, v41
    v_accvgpr_write_b32 a146, v42
    v_accvgpr_write_b32 a147, v43
    v_accvgpr_write_b32 a148, v44
    v_accvgpr_write_b32 a149, v45
    v_accvgpr_write_b32 a150, v46
    v_accvgpr_write_b32 a151, v47
    v_perm_b32 v32, v139, v137, s48
    v_perm_b32 v33, v143, v141, s48
    v_perm_b32 v34, v147, v145, s48
    v_perm_b32 v35, v151, v149, s48
    v_perm_b32 v36, v155, v153, s48
    v_perm_b32 v37, v159, v157, s48
    v_perm_b32 v38, v163, v161, s48
    v_perm_b32 v39, v167, v165, s48
    v_accvgpr_write_b32 a152, v32
    v_accvgpr_write_b32 a153, v33
    v_accvgpr_write_b32 a154, v34
    v_accvgpr_write_b32 a155, v35
    v_accvgpr_write_b32 a156, v36
    v_accvgpr_write_b32 a157, v37
    v_accvgpr_write_b32 a158, v38
    v_accvgpr_write_b32 a159, v39
    v_perm_b32 v40, v139, v137, s49
    v_perm_b32 v41, v143, v141, s49
    v_perm_b32 v42, v147, v145, s49
    v_perm_b32 v43, v151, v149, s49
    v_perm_b32 v44, v155, v153, s49
    v_perm_b32 v45, v159, v157, s49
    v_perm_b32 v46, v163, v161, s49
    v_perm_b32 v47, v167, v165, s49
    v_accvgpr_write_b32 a160, v40
    v_accvgpr_write_b32 a161, v41
    v_accvgpr_write_b32 a162, v42
    v_accvgpr_write_b32 a163, v43
    v_accvgpr_write_b32 a164, v44
    v_accvgpr_write_b32 a165, v45
    v_accvgpr_write_b32 a166, v46
    v_accvgpr_write_b32 a167, v47
    v_perm_b32 v32, v170, v168, s48
    v_perm_b32 v33, v174, v172, s48
    v_perm_b32 v34, v178, v176, s48
    v_perm_b32 v35, v182, v180, s48
    v_perm_b32 v36, v186, v184, s48
    v_perm_b32 v37, v190, v188, s48
    v_perm_b32 v38, v194, v192, s48
    v_perm_b32 v39, v198, v196, s48
    v_accvgpr_write_b32 a168, v32
    v_accvgpr_write_b32 a169, v33
    v_accvgpr_write_b32 a170, v34
    v_accvgpr_write_b32 a171, v35
    v_accvgpr_write_b32 a172, v36
    v_accvgpr_write_b32 a173, v37
    v_accvgpr_write_b32 a174, v38
    v_accvgpr_write_b32 a175, v39
    v_perm_b32 v40, v170, v168, s49
    v_perm_b32 v41, v174, v172, s49
    v_perm_b32 v42, v178, v176, s49
    v_perm_b32 v43, v182, v180, s49
    v_perm_b32 v44, v186, v184, s49
    v_perm_b32 v45, v190, v188, s49
    v_perm_b32 v46, v194, v192, s49
    v_perm_b32 v47, v198, v196, s49
    v_accvgpr_write_b32 a176, v40
    v_accvgpr_write_b32 a177, v41
    v_accvgpr_write_b32 a178, v42
    v_accvgpr_write_b32 a179, v43
    v_accvgpr_write_b32 a180, v44
    v_accvgpr_write_b32 a181, v45
    v_accvgpr_write_b32 a182, v46
    v_accvgpr_write_b32 a183, v47
    v_perm_b32 v32, v171, v169, s48
    v_perm_b32 v33, v175, v173, s48
    v_perm_b32 v34, v179, v177, s48
    v_perm_b32 v35, v183, v181, s48
    v_perm_b32 v36, v187, v185, s48
    v_perm_b32 v37, v191, v189, s48
    v_perm_b32 v38, v195, v193, s48
    v_perm_b32 v39, v199, v197, s48
    v_accvgpr_write_b32 a184, v32
    v_accvgpr_write_b32 a185, v33
    v_accvgpr_write_b32 a186, v34
    v_accvgpr_write_b32 a187, v35
    v_accvgpr_write_b32 a188, v36
    v_accvgpr_write_b32 a189, v37
    v_accvgpr_write_b32 a190, v38
    v_accvgpr_write_b32 a191, v39
    v_perm_b32 v40, v171, v169, s49
    v_perm_b32 v41, v175, v173, s49
    v_perm_b32 v42, v179, v177, s49
    v_perm_b32 v43, v183, v181, s49
    v_perm_b32 v44, v187, v185, s49
    v_perm_b32 v45, v191, v189, s49
    v_perm_b32 v46, v195, v193, s49
    v_perm_b32 v47, v199, v197, s49
    v_accvgpr_write_b32 a192, v40
    v_accvgpr_write_b32 a193, v41
    v_accvgpr_write_b32 a194, v42
    v_accvgpr_write_b32 a195, v43
    v_accvgpr_write_b32 a196, v44
    v_accvgpr_write_b32 a197, v45
    v_accvgpr_write_b32 a198, v46
    v_accvgpr_write_b32 a199, v47
    v_perm_b32 v32, v201, v200, s48
    v_perm_b32 v33, v203, v202, s48
    v_perm_b32 v34, v205, v204, s48
    v_perm_b32 v35, v207, v206, s48
    v_perm_b32 v36, v209, v208, s48
    v_perm_b32 v37, v211, v210, s48
    v_perm_b32 v38, v213, v212, s48
    v_perm_b32 v39, v215, v214, s48
    v_accvgpr_write_b32 a200, v32
    v_accvgpr_write_b32 a201, v33
    v_accvgpr_write_b32 a202, v34
    v_accvgpr_write_b32 a203, v35
    v_accvgpr_write_b32 a204, v36
    v_accvgpr_write_b32 a205, v37
    v_accvgpr_write_b32 a206, v38
    v_accvgpr_write_b32 a207, v39
    v_perm_b32 v40, v201, v200, s49
    v_perm_b32 v41, v203, v202, s49
    v_perm_b32 v42, v205, v204, s49
    v_perm_b32 v43, v207, v206, s49
    v_perm_b32 v44, v209, v208, s49
    v_perm_b32 v45, v211, v210, s49
    v_perm_b32 v46, v213, v212, s49
    v_perm_b32 v47, v215, v214, s49
    v_accvgpr_write_b32 a208, v40
    v_accvgpr_write_b32 a209, v41
    v_accvgpr_write_b32 a210, v42
    v_accvgpr_write_b32 a211, v43
    v_accvgpr_write_b32 a212, v44
    v_accvgpr_write_b32 a213, v45
    v_accvgpr_write_b32 a214, v46
    v_accvgpr_write_b32 a215, v47
    s_waitcnt vmcnt(42)
    s_barrier
    ds_read_b64_tr_b16 v[32:33], v27 offset:0
    ds_read_b64_tr_b16 v[34:35], v27 offset:512
    ds_read_b64_tr_b16 v[36:37], v30 offset:0
    ds_read_b64_tr_b16 v[38:39], v30 offset:512
    ds_read_b64_tr_b16 a[216:217], v27 offset:8
    ds_read_b64_tr_b16 a[218:219], v27 offset:520
    ds_read_b64_tr_b16 a[220:221], v30 offset:8
    ds_read_b64_tr_b16 a[222:223], v30 offset:520
    s_waitcnt vmcnt(38)
    s_waitcnt lgkmcnt(0)
    s_barrier
    s_add_u32 m0, s33, 0
    s_mov_b32 s30, 2621440
    buffer_load_dwordx4 v26, s[8:11], s30 offen lds
    s_add_u32 m0, s33, 1024
    s_mov_b32 s30, 2654208
    buffer_load_dwordx4 v29, s[8:11], s30 offen lds
    s_add_u32 m0, s33, 2048
    s_mov_b32 s30, 2686976
    buffer_load_dwordx4 v26, s[8:11], s30 offen lds
    s_add_u32 m0, s33, 3072
    s_mov_b32 s30, 2719744
    buffer_load_dwordx4 v29, s[8:11], s30 offen lds
    ds_read_b64_tr_b16 a[240:241], v27 offset:4096
    ds_read_b64_tr_b16 a[242:243], v27 offset:4608
    ds_read_b64_tr_b16 a[244:245], v30 offset:4096
    ds_read_b64_tr_b16 a[246:247], v30 offset:4608
    ds_read_b64_tr_b16 a[248:249], v27 offset:4104
    ds_read_b64_tr_b16 a[250:251], v27 offset:4616
    ds_read_b64_tr_b16 a[252:253], v30 offset:4104
    ds_read_b64_tr_b16 a[254:255], v30 offset:4616
    s_add_u32 s31, s26, 8192
    buffer_store_dwordx4 v[32:35], v0, s[4:7], s31 offen
    buffer_store_dwordx4 v[36:39], v0, s[4:7], s31 offen offset:1024
    s_waitcnt vmcnt(40)
    s_waitcnt lgkmcnt(0)
    s_barrier
    s_add_u32 m0, s33, 4096
    s_mov_b32 s30, 3145728
    buffer_load_dwordx4 v26, s[8:11], s30 offen lds
    s_add_u32 m0, s33, 5120
    s_mov_b32 s30, 3178496
    buffer_load_dwordx4 v29, s[8:11], s30 offen lds
    s_add_u32 m0, s33, 6144
    s_mov_b32 s30, 3211264
    buffer_load_dwordx4 v26, s[8:11], s30 offen lds
    s_add_u32 m0, s33, 7168
    s_mov_b32 s30, 3244032
    buffer_load_dwordx4 v29, s[8:11], s30 offen lds
    ds_read_b64_tr_b16 v[32:33], v27 offset:8192
    ds_read_b64_tr_b16 v[34:35], v27 offset:8704
    ds_read_b64_tr_b16 v[36:37], v30 offset:8192
    ds_read_b64_tr_b16 v[38:39], v30 offset:8704
    ds_read_b64_tr_b16 v[40:41], v27 offset:8200
    ds_read_b64_tr_b16 v[42:43], v27 offset:8712
    ds_read_b64_tr_b16 v[44:45], v30 offset:8200
    ds_read_b64_tr_b16 v[46:47], v30 offset:8712
    s_add_u32 s31, s26, 0
    buffer_store_dwordx4 a[240:243], v0, s[4:7], s31 offen
    buffer_store_dwordx4 a[244:247], v0, s[4:7], s31 offen offset:1024
    s_add_u32 s31, s26, 2048
    buffer_store_dwordx4 a[248:251], v0, s[4:7], s31 offen
    buffer_store_dwordx4 a[252:255], v0, s[4:7], s31 offen offset:1024
    s_waitcnt vmcnt(44)
    s_waitcnt lgkmcnt(0)
    s_barrier
    s_add_u32 m0, s33, 8192
    s_mov_b32 s30, 3670016
    buffer_load_dwordx4 v26, s[8:11], s30 offen lds
    s_add_u32 m0, s33, 9216
    s_mov_b32 s30, 3702784
    buffer_load_dwordx4 v29, s[8:11], s30 offen lds
    s_add_u32 m0, s33, 10240
    s_mov_b32 s30, 3735552
    buffer_load_dwordx4 v26, s[8:11], s30 offen lds
    s_add_u32 m0, s33, 11264
    s_mov_b32 s30, 3768320
    buffer_load_dwordx4 v29, s[8:11], s30 offen lds
    ds_read_b64_tr_b16 v[56:57], v27 offset:12288
    ds_read_b64_tr_b16 v[58:59], v27 offset:12800
    ds_read_b64_tr_b16 v[60:61], v30 offset:12288
    ds_read_b64_tr_b16 v[62:63], v30 offset:12800
    ds_read_b64_tr_b16 v[64:65], v27 offset:12296
    ds_read_b64_tr_b16 v[66:67], v27 offset:12808
    ds_read_b64_tr_b16 v[68:69], v30 offset:12296
    ds_read_b64_tr_b16 v[70:71], v30 offset:12808
    s_add_u32 s31, s26, 4096
    buffer_store_dwordx4 v[32:35], v0, s[4:7], s31 offen
    buffer_store_dwordx4 v[36:39], v0, s[4:7], s31 offen offset:1024
    s_add_u32 s31, s26, 6144
    buffer_store_dwordx4 v[40:43], v0, s[4:7], s31 offen
    buffer_store_dwordx4 v[44:47], v0, s[4:7], s31 offen offset:1024
    s_waitcnt vmcnt(48)
    s_waitcnt lgkmcnt(0)
    s_barrier
    s_add_u32 m0, s33, 12288
    s_mov_b32 s30, 4194304
    buffer_load_dwordx4 v26, s[8:11], s30 offen lds
    s_add_u32 m0, s33, 13312
    s_mov_b32 s30, 4227072
    buffer_load_dwordx4 v29, s[8:11], s30 offen lds
    s_add_u32 m0, s33, 14336
    s_mov_b32 s30, 4259840
    buffer_load_dwordx4 v26, s[8:11], s30 offen lds
    s_add_u32 m0, s33, 15360
    s_mov_b32 s30, 4292608
    buffer_load_dwordx4 v29, s[8:11], s30 offen lds
    ds_read_b64_tr_b16 v[72:73], v27 offset:16384
    ds_read_b64_tr_b16 v[74:75], v27 offset:16896
    ds_read_b64_tr_b16 v[76:77], v30 offset:16384
    ds_read_b64_tr_b16 v[78:79], v30 offset:16896
    ds_read_b64_tr_b16 v[80:81], v27 offset:16392
    ds_read_b64_tr_b16 v[82:83], v27 offset:16904
    ds_read_b64_tr_b16 v[84:85], v30 offset:16392
    ds_read_b64_tr_b16 v[86:87], v30 offset:16904
    s_waitcnt vmcnt(48)
    s_waitcnt lgkmcnt(0)
    s_barrier
    s_add_u32 m0, s33, 16384
    s_mov_b32 s30, 4718592
    buffer_load_dwordx4 v26, s[8:11], s30 offen lds
    s_add_u32 m0, s33, 17408
    s_mov_b32 s30, 4751360
    buffer_load_dwordx4 v29, s[8:11], s30 offen lds
    s_add_u32 m0, s33, 18432
    s_mov_b32 s30, 4784128
    buffer_load_dwordx4 v26, s[8:11], s30 offen lds
    s_add_u32 m0, s33, 19456
    s_mov_b32 s30, 4816896
    buffer_load_dwordx4 v29, s[8:11], s30 offen lds
    ds_read_b64_tr_b16 v[88:89], v27 offset:20480
    ds_read_b64_tr_b16 v[90:91], v27 offset:20992
    ds_read_b64_tr_b16 v[92:93], v30 offset:20480
    ds_read_b64_tr_b16 v[94:95], v30 offset:20992
    ds_read_b64_tr_b16 v[96:97], v27 offset:20488
    ds_read_b64_tr_b16 v[98:99], v27 offset:21000
    ds_read_b64_tr_b16 v[100:101], v30 offset:20488
    ds_read_b64_tr_b16 v[102:103], v30 offset:21000
    s_waitcnt vmcnt(48)
    s_waitcnt lgkmcnt(0)
    s_barrier
    s_mov_b32 s8, s54
    s_mov_b32 s9, s55
    s_add_u32 m0, s33, 20480
    s_mov_b32 s30, 524288
    buffer_load_dwordx4 v26, s[8:11], s30 offen lds
    s_add_u32 m0, s33, 21504
    s_mov_b32 s30, 557056
    buffer_load_dwordx4 v29, s[8:11], s30 offen lds
    s_add_u32 m0, s33, 22528
    s_mov_b32 s30, 589824
    buffer_load_dwordx4 v26, s[8:11], s30 offen lds
    s_add_u32 m0, s33, 23552
    s_mov_b32 s30, 622592
    buffer_load_dwordx4 v29, s[8:11], s30 offen lds
    ds_read_b64_tr_b16 v[104:105], v27 offset:24576
    ds_read_b64_tr_b16 v[106:107], v27 offset:25088
    ds_read_b64_tr_b16 v[108:109], v30 offset:24576
    ds_read_b64_tr_b16 v[110:111], v30 offset:25088
    ds_read_b64_tr_b16 v[112:113], v27 offset:24584
    ds_read_b64_tr_b16 v[114:115], v27 offset:25096
    ds_read_b64_tr_b16 v[116:117], v30 offset:24584
    ds_read_b64_tr_b16 v[118:119], v30 offset:25096
    s_waitcnt vmcnt(48)
    s_waitcnt lgkmcnt(0)
    s_barrier
    s_add_u32 m0, s33, 24576
    s_mov_b32 s30, 1048576
    buffer_load_dwordx4 v26, s[8:11], s30 offen lds
    s_add_u32 m0, s33, 25600
    s_mov_b32 s30, 1081344
    buffer_load_dwordx4 v29, s[8:11], s30 offen lds
    s_add_u32 m0, s33, 26624
    s_mov_b32 s30, 1114112
    buffer_load_dwordx4 v26, s[8:11], s30 offen lds
    s_add_u32 m0, s33, 27648
    s_mov_b32 s30, 1146880
    buffer_load_dwordx4 v29, s[8:11], s30 offen lds
    ds_read_b64_tr_b16 v[120:121], v27 offset:28672
    ds_read_b64_tr_b16 v[122:123], v27 offset:29184
    ds_read_b64_tr_b16 v[124:125], v30 offset:28672
    ds_read_b64_tr_b16 v[126:127], v30 offset:29184
    ds_read_b64_tr_b16 v[128:129], v27 offset:28680
    ds_read_b64_tr_b16 v[130:131], v27 offset:29192
    ds_read_b64_tr_b16 v[132:133], v30 offset:28680
    ds_read_b64_tr_b16 v[134:135], v30 offset:29192
    s_waitcnt vmcnt(48)
    s_waitcnt lgkmcnt(0)
    s_barrier
    s_add_u32 m0, s33, 28672
    s_mov_b32 s30, 1572864
    buffer_load_dwordx4 v26, s[8:11], s30 offen lds
    s_add_u32 m0, s33, 29696
    s_mov_b32 s30, 1605632
    buffer_load_dwordx4 v29, s[8:11], s30 offen lds
    s_add_u32 m0, s33, 30720
    s_mov_b32 s30, 1638400
    buffer_load_dwordx4 v26, s[8:11], s30 offen lds
    s_add_u32 m0, s33, 31744
    s_mov_b32 s30, 1671168
    buffer_load_dwordx4 v29, s[8:11], s30 offen lds
    ds_read_b64_tr_b16 v[136:137], v27 offset:32768
    ds_read_b64_tr_b16 v[138:139], v27 offset:33280
    ds_read_b64_tr_b16 v[140:141], v30 offset:32768
    ds_read_b64_tr_b16 v[142:143], v30 offset:33280
    ds_read_b64_tr_b16 v[144:145], v27 offset:32776
    ds_read_b64_tr_b16 v[146:147], v27 offset:33288
    ds_read_b64_tr_b16 v[148:149], v30 offset:32776
    ds_read_b64_tr_b16 v[150:151], v30 offset:33288
    s_waitcnt vmcnt(38)
    s_waitcnt lgkmcnt(0)
    s_barrier
    s_add_u32 m0, s33, 32768
    s_mov_b32 s30, 2097152
    buffer_load_dwordx4 v26, s[8:11], s30 offen lds
    s_add_u32 m0, s33, 33792
    s_mov_b32 s30, 2129920
    buffer_load_dwordx4 v29, s[8:11], s30 offen lds
    s_add_u32 m0, s33, 34816
    s_mov_b32 s30, 2162688
    buffer_load_dwordx4 v26, s[8:11], s30 offen lds
    s_add_u32 m0, s33, 35840
    s_mov_b32 s30, 2195456
    buffer_load_dwordx4 v29, s[8:11], s30 offen lds
    ds_read_b64_tr_b16 v[152:153], v27 offset:0
    ds_read_b64_tr_b16 v[154:155], v27 offset:512
    ds_read_b64_tr_b16 v[156:157], v30 offset:0
    ds_read_b64_tr_b16 v[158:159], v30 offset:512
    ds_read_b64_tr_b16 v[160:161], v27 offset:8
    ds_read_b64_tr_b16 v[162:163], v27 offset:520
    ds_read_b64_tr_b16 v[164:165], v30 offset:8
    ds_read_b64_tr_b16 v[166:167], v30 offset:520
    s_waitcnt vmcnt(36)
    s_waitcnt lgkmcnt(0)
    s_barrier
    s_add_u32 m0, s33, 0
    s_mov_b32 s30, 2621440
    buffer_load_dwordx4 v26, s[8:11], s30 offen lds
    s_add_u32 m0, s33, 1024
    s_mov_b32 s30, 2654208
    buffer_load_dwordx4 v29, s[8:11], s30 offen lds
    s_add_u32 m0, s33, 2048
    s_mov_b32 s30, 2686976
    buffer_load_dwordx4 v26, s[8:11], s30 offen lds
    s_add_u32 m0, s33, 3072
    s_mov_b32 s30, 2719744
    buffer_load_dwordx4 v29, s[8:11], s30 offen lds
    ds_read_b64_tr_b16 v[168:169], v27 offset:4096
    ds_read_b64_tr_b16 v[170:171], v27 offset:4608
    ds_read_b64_tr_b16 v[172:173], v30 offset:4096
    ds_read_b64_tr_b16 v[174:175], v30 offset:4608
    ds_read_b64_tr_b16 v[176:177], v27 offset:4104
    ds_read_b64_tr_b16 v[178:179], v27 offset:4616
    ds_read_b64_tr_b16 v[180:181], v30 offset:4104
    ds_read_b64_tr_b16 v[182:183], v30 offset:4616
    s_waitcnt vmcnt(32)
    s_waitcnt lgkmcnt(0)
    s_barrier
    s_add_u32 m0, s33, 4096
    s_mov_b32 s30, 3145728
    buffer_load_dwordx4 v26, s[8:11], s30 offen lds
    s_add_u32 m0, s33, 5120
    s_mov_b32 s30, 3178496
    buffer_load_dwordx4 v29, s[8:11], s30 offen lds
    s_add_u32 m0, s33, 6144
    s_mov_b32 s30, 3211264
    buffer_load_dwordx4 v26, s[8:11], s30 offen lds
    s_add_u32 m0, s33, 7168
    s_mov_b32 s30, 3244032
    buffer_load_dwordx4 v29, s[8:11], s30 offen lds
    ds_read_b64_tr_b16 v[184:185], v27 offset:8192
    ds_read_b64_tr_b16 v[186:187], v27 offset:8704
    ds_read_b64_tr_b16 v[188:189], v30 offset:8192
    ds_read_b64_tr_b16 v[190:191], v30 offset:8704
    ds_read_b64_tr_b16 v[192:193], v27 offset:8200
    ds_read_b64_tr_b16 v[194:195], v27 offset:8712
    ds_read_b64_tr_b16 v[196:197], v30 offset:8200
    ds_read_b64_tr_b16 v[198:199], v30 offset:8712
    s_waitcnt vmcnt(28)
    s_waitcnt lgkmcnt(0)
    s_barrier
    s_add_u32 m0, s33, 8192
    s_mov_b32 s30, 3670016
    buffer_load_dwordx4 v26, s[8:11], s30 offen lds
    s_add_u32 m0, s33, 9216
    s_mov_b32 s30, 3702784
    buffer_load_dwordx4 v29, s[8:11], s30 offen lds
    s_add_u32 m0, s33, 10240
    s_mov_b32 s30, 3735552
    buffer_load_dwordx4 v26, s[8:11], s30 offen lds
    s_add_u32 m0, s33, 11264
    s_mov_b32 s30, 3768320
    buffer_load_dwordx4 v29, s[8:11], s30 offen lds
    ds_read_b64_tr_b16 v[200:201], v27 offset:12288
    ds_read_b64_tr_b16 v[202:203], v27 offset:12800
    ds_read_b64_tr_b16 v[204:205], v30 offset:12288
    ds_read_b64_tr_b16 v[206:207], v30 offset:12800
    ds_read_b64_tr_b16 v[208:209], v27 offset:12296
    ds_read_b64_tr_b16 v[210:211], v27 offset:12808
    ds_read_b64_tr_b16 v[212:213], v30 offset:12296
    ds_read_b64_tr_b16 v[214:215], v30 offset:12808
    s_waitcnt vmcnt(28)
    s_waitcnt lgkmcnt(0)
    s_barrier
    s_mov_b32 s8, s50
    s_mov_b32 s9, s51
    s_add_u32 m0, s33, 12288
    s_mov_b32 s30, 1572864
    buffer_load_dwordx4 v26, s[8:11], s30 offen lds
    s_add_u32 m0, s33, 13312
    s_mov_b32 s30, 1605632
    buffer_load_dwordx4 v29, s[8:11], s30 offen lds
    s_add_u32 m0, s33, 14336
    s_mov_b32 s30, 1638400
    buffer_load_dwordx4 v26, s[8:11], s30 offen lds
    s_add_u32 m0, s33, 15360
    s_mov_b32 s30, 1671168
    buffer_load_dwordx4 v29, s[8:11], s30 offen lds
    ds_read_b64_tr_b16 v[216:217], v27 offset:16384
    ds_read_b64_tr_b16 v[218:219], v27 offset:16896
    ds_read_b64_tr_b16 v[220:221], v30 offset:16384
    ds_read_b64_tr_b16 v[222:223], v30 offset:16896
    ds_read_b64_tr_b16 v[224:225], v27 offset:16392
    ds_read_b64_tr_b16 v[226:227], v27 offset:16904
    ds_read_b64_tr_b16 v[228:229], v30 offset:16392
    ds_read_b64_tr_b16 v[230:231], v30 offset:16904
    s_waitcnt vmcnt(28)
    s_waitcnt lgkmcnt(0)
    s_barrier
    s_add_u32 m0, s33, 16384
    s_mov_b32 s30, 2097152
    buffer_load_dwordx4 v26, s[8:11], s30 offen lds
    s_add_u32 m0, s33, 17408
    s_mov_b32 s30, 2129920
    buffer_load_dwordx4 v29, s[8:11], s30 offen lds
    s_add_u32 m0, s33, 18432
    s_mov_b32 s30, 2162688
    buffer_load_dwordx4 v26, s[8:11], s30 offen lds
    s_add_u32 m0, s33, 19456
    s_mov_b32 s30, 2195456
    buffer_load_dwordx4 v29, s[8:11], s30 offen lds
    ds_read_b64_tr_b16 v[240:241], v27 offset:20480
    ds_read_b64_tr_b16 v[242:243], v27 offset:20992
    ds_read_b64_tr_b16 v[244:245], v30 offset:20480
    ds_read_b64_tr_b16 v[246:247], v30 offset:20992
    ds_read_b64_tr_b16 v[248:249], v27 offset:20488
    ds_read_b64_tr_b16 v[250:251], v27 offset:21000
    ds_read_b64_tr_b16 v[252:253], v30 offset:20488
    ds_read_b64_tr_b16 v[254:255], v30 offset:21000
    s_waitcnt vmcnt(28)
    s_waitcnt lgkmcnt(0)
    s_barrier
    s_add_u32 m0, s33, 20480
    s_mov_b32 s30, 2621440
    buffer_load_dwordx4 v26, s[8:11], s30 offen lds
    s_add_u32 m0, s33, 21504
    s_mov_b32 s30, 2654208
    buffer_load_dwordx4 v29, s[8:11], s30 offen lds
    s_add_u32 m0, s33, 22528
    s_mov_b32 s30, 2686976
    buffer_load_dwordx4 v26, s[8:11], s30 offen lds
    s_add_u32 m0, s33, 23552
    s_mov_b32 s30, 2719744
    buffer_load_dwordx4 v29, s[8:11], s30 offen lds
    ds_read_b64_tr_b16 a[0:1], v27 offset:24576
    ds_read_b64_tr_b16 a[2:3], v27 offset:25088
    ds_read_b64_tr_b16 a[4:5], v30 offset:24576
    ds_read_b64_tr_b16 a[6:7], v30 offset:25088
    ds_read_b64_tr_b16 a[8:9], v27 offset:24584
    ds_read_b64_tr_b16 a[10:11], v27 offset:25096
    ds_read_b64_tr_b16 a[12:13], v30 offset:24584
    ds_read_b64_tr_b16 a[14:15], v30 offset:25096
    s_waitcnt vmcnt(28)
    s_waitcnt lgkmcnt(0)
    s_barrier
    s_add_u32 m0, s33, 24576
    s_mov_b32 s30, 3145728
    buffer_load_dwordx4 v26, s[8:11], s30 offen lds
    s_add_u32 m0, s33, 25600
    s_mov_b32 s30, 3178496
    buffer_load_dwordx4 v29, s[8:11], s30 offen lds
    s_add_u32 m0, s33, 26624
    s_mov_b32 s30, 3211264
    buffer_load_dwordx4 v26, s[8:11], s30 offen lds
    s_add_u32 m0, s33, 27648
    s_mov_b32 s30, 3244032
    buffer_load_dwordx4 v29, s[8:11], s30 offen lds
    ds_read_b64_tr_b16 a[16:17], v27 offset:28672
    ds_read_b64_tr_b16 a[18:19], v27 offset:29184
    ds_read_b64_tr_b16 a[20:21], v30 offset:28672
    ds_read_b64_tr_b16 a[22:23], v30 offset:29184
    ds_read_b64_tr_b16 a[24:25], v27 offset:28680
    ds_read_b64_tr_b16 a[26:27], v27 offset:29192
    ds_read_b64_tr_b16 a[28:29], v30 offset:28680
    ds_read_b64_tr_b16 a[30:31], v30 offset:29192
    s_waitcnt vmcnt(28)
    s_waitcnt lgkmcnt(0)
    s_barrier
    s_add_u32 m0, s33, 28672
    s_mov_b32 s30, 3670016
    buffer_load_dwordx4 v26, s[8:11], s30 offen lds
    s_add_u32 m0, s33, 29696
    s_mov_b32 s30, 3702784
    buffer_load_dwordx4 v29, s[8:11], s30 offen lds
    s_add_u32 m0, s33, 30720
    s_mov_b32 s30, 3735552
    buffer_load_dwordx4 v26, s[8:11], s30 offen lds
    s_add_u32 m0, s33, 31744
    s_mov_b32 s30, 3768320
    buffer_load_dwordx4 v29, s[8:11], s30 offen lds
    ds_read_b64_tr_b16 a[32:33], v27 offset:32768
    ds_read_b64_tr_b16 a[34:35], v27 offset:33280
    ds_read_b64_tr_b16 a[36:37], v30 offset:32768
    ds_read_b64_tr_b16 a[38:39], v30 offset:33280
    ds_read_b64_tr_b16 a[40:41], v27 offset:32776
    ds_read_b64_tr_b16 a[42:43], v27 offset:33288
    ds_read_b64_tr_b16 a[44:45], v30 offset:32776
    ds_read_b64_tr_b16 a[46:47], v30 offset:33288
    s_waitcnt vmcnt(28)
    s_waitcnt lgkmcnt(0)
    s_barrier
    s_add_u32 m0, s33, 32768
    s_mov_b32 s30, 4194304
    buffer_load_dwordx4 v26, s[8:11], s30 offen lds
    s_add_u32 m0, s33, 33792
    s_mov_b32 s30, 4227072
    buffer_load_dwordx4 v29, s[8:11], s30 offen lds
    s_add_u32 m0, s33, 34816
    s_mov_b32 s30, 4259840
    buffer_load_dwordx4 v26, s[8:11], s30 offen lds
    s_add_u32 m0, s33, 35840
    s_mov_b32 s30, 4292608
    buffer_load_dwordx4 v29, s[8:11], s30 offen lds
    ds_read_b64_tr_b16 a[48:49], v27 offset:0
    ds_read_b64_tr_b16 a[50:51], v27 offset:512
    ds_read_b64_tr_b16 a[52:53], v30 offset:0
    ds_read_b64_tr_b16 a[54:55], v30 offset:512
    ds_read_b64_tr_b16 a[56:57], v27 offset:8
    ds_read_b64_tr_b16 a[58:59], v27 offset:520
    ds_read_b64_tr_b16 a[60:61], v30 offset:8
    ds_read_b64_tr_b16 a[62:63], v30 offset:520
    s_waitcnt vmcnt(28)
    s_waitcnt lgkmcnt(0)
    s_barrier
    s_mov_b32 s8, s54
    s_mov_b32 s9, s55
    s_add_u32 m0, s33, 0
    s_mov_b32 s30, 4194304
    buffer_load_dwordx4 v26, s[8:11], s30 offen lds
    s_add_u32 m0, s33, 1024
    s_mov_b32 s30, 4227072
    buffer_load_dwordx4 v29, s[8:11], s30 offen lds
    s_add_u32 m0, s33, 2048
    s_mov_b32 s30, 4259840
    buffer_load_dwordx4 v26, s[8:11], s30 offen lds
    s_add_u32 m0, s33, 3072
    s_mov_b32 s30, 4292608
    buffer_load_dwordx4 v29, s[8:11], s30 offen lds
    ds_read_b64_tr_b16 a[64:65], v27 offset:4096
    ds_read_b64_tr_b16 a[66:67], v27 offset:4608
    ds_read_b64_tr_b16 a[68:69], v30 offset:4096
    ds_read_b64_tr_b16 a[70:71], v30 offset:4608
    ds_read_b64_tr_b16 a[72:73], v27 offset:4104
    ds_read_b64_tr_b16 a[74:75], v27 offset:4616
    ds_read_b64_tr_b16 a[76:77], v30 offset:4104
    ds_read_b64_tr_b16 a[78:79], v30 offset:4616
    s_waitcnt vmcnt(28)
    s_waitcnt lgkmcnt(0)
    s_barrier
    s_add_u32 m0, s33, 4096
    s_mov_b32 s30, 4718592
    buffer_load_dwordx4 v26, s[8:11], s30 offen lds
    s_add_u32 m0, s33, 5120
    s_mov_b32 s30, 4751360
    buffer_load_dwordx4 v29, s[8:11], s30 offen lds
    s_add_u32 m0, s33, 6144
    s_mov_b32 s30, 4784128
    buffer_load_dwordx4 v26, s[8:11], s30 offen lds
    s_add_u32 m0, s33, 7168
    s_mov_b32 s30, 4816896
    buffer_load_dwordx4 v29, s[8:11], s30 offen lds
    ds_read_b64_tr_b16 a[80:81], v27 offset:8192
    ds_read_b64_tr_b16 a[82:83], v27 offset:8704
    ds_read_b64_tr_b16 a[84:85], v30 offset:8192
    ds_read_b64_tr_b16 a[86:87], v30 offset:8704
    ds_read_b64_tr_b16 a[88:89], v27 offset:8200
    ds_read_b64_tr_b16 a[90:91], v27 offset:8712
    ds_read_b64_tr_b16 a[92:93], v30 offset:8200
    ds_read_b64_tr_b16 a[94:95], v30 offset:8712
    s_waitcnt vmcnt(28)
    s_waitcnt lgkmcnt(0)
    s_barrier
    s_add_u32 m0, s33, 8192
    s_mov_b32 s30, 0
    buffer_load_dwordx4 v26, s[8:11], s30 offen lds
    s_add_u32 m0, s33, 9216
    s_mov_b32 s30, 32768
    buffer_load_dwordx4 v29, s[8:11], s30 offen lds
    s_add_u32 m0, s33, 10240
    s_mov_b32 s30, 65536
    buffer_load_dwordx4 v26, s[8:11], s30 offen lds
    s_add_u32 m0, s33, 11264
    s_mov_b32 s30, 98304
    buffer_load_dwordx4 v29, s[8:11], s30 offen lds
    ds_read_b64_tr_b16 a[240:241], v27 offset:12288
    ds_read_b64_tr_b16 a[242:243], v27 offset:12800
    ds_read_b64_tr_b16 a[244:245], v30 offset:12288
    ds_read_b64_tr_b16 a[246:247], v30 offset:12800
    ds_read_b64_tr_b16 a[248:249], v27 offset:12296
    ds_read_b64_tr_b16 a[250:251], v27 offset:12808
    ds_read_b64_tr_b16 a[252:253], v30 offset:12296
    ds_read_b64_tr_b16 a[254:255], v30 offset:12808
    s_waitcnt vmcnt(28)
    s_waitcnt lgkmcnt(0)
    s_barrier
    ds_read_b64_tr_b16 v[32:33], v27 offset:16384
    ds_read_b64_tr_b16 v[34:35], v27 offset:16896
    ds_read_b64_tr_b16 v[36:37], v30 offset:16384
    ds_read_b64_tr_b16 v[38:39], v30 offset:16896
    ds_read_b64_tr_b16 v[40:41], v27 offset:16392
    ds_read_b64_tr_b16 v[42:43], v27 offset:16904
    ds_read_b64_tr_b16 v[44:45], v30 offset:16392
    ds_read_b64_tr_b16 v[46:47], v30 offset:16904
    ds_write_b128 v4, a[240:243] offset:12288
    ds_write_b128 v4, a[244:247] offset:13312
    ds_write_b128 v4, a[248:251] offset:14336
    ds_write_b128 v4, a[252:255] offset:15360
    s_waitcnt vmcnt(24)
    s_waitcnt lgkmcnt(0)
    s_barrier
    ds_read_b64_tr_b16 a[240:241], v27 offset:20480
    ds_read_b64_tr_b16 a[242:243], v27 offset:20992
    ds_read_b64_tr_b16 a[244:245], v30 offset:20480
    ds_read_b64_tr_b16 a[246:247], v30 offset:20992
    ds_read_b64_tr_b16 a[248:249], v27 offset:20488
    ds_read_b64_tr_b16 a[250:251], v27 offset:21000
    ds_read_b64_tr_b16 a[252:253], v30 offset:20488
    ds_read_b64_tr_b16 a[254:255], v30 offset:21000
    ds_write_b128 v4, v[32:35] offset:16384
    ds_write_b128 v4, v[36:39] offset:17408
    ds_write_b128 v4, v[40:43] offset:18432
    ds_write_b128 v4, v[44:47] offset:19456
    s_waitcnt vmcnt(20)
    s_waitcnt lgkmcnt(0)
    s_barrier
    ds_read_b64_tr_b16 v[32:33], v27 offset:24576
    ds_read_b64_tr_b16 v[34:35], v27 offset:25088
    ds_read_b64_tr_b16 v[36:37], v30 offset:24576
    ds_read_b64_tr_b16 v[38:39], v30 offset:25088
    ds_read_b64_tr_b16 v[40:41], v27 offset:24584
    ds_read_b64_tr_b16 v[42:43], v27 offset:25096
    ds_read_b64_tr_b16 v[44:45], v30 offset:24584
    ds_read_b64_tr_b16 v[46:47], v30 offset:25096
    ds_write_b128 v4, a[240:243] offset:20480
    ds_write_b128 v4, a[244:247] offset:21504
    ds_write_b128 v4, a[248:251] offset:22528
    ds_write_b128 v4, a[252:255] offset:23552
    s_waitcnt vmcnt(16)
    s_waitcnt lgkmcnt(0)
    s_barrier
    ds_read_b64_tr_b16 a[240:241], v27 offset:28672
    ds_read_b64_tr_b16 a[242:243], v27 offset:29184
    ds_read_b64_tr_b16 a[244:245], v30 offset:28672
    ds_read_b64_tr_b16 a[246:247], v30 offset:29184
    ds_read_b64_tr_b16 a[248:249], v27 offset:28680
    ds_read_b64_tr_b16 a[250:251], v27 offset:29192
    ds_read_b64_tr_b16 a[252:253], v30 offset:28680
    ds_read_b64_tr_b16 a[254:255], v30 offset:29192
    ds_write_b128 v4, v[32:35] offset:24576
    ds_write_b128 v4, v[36:39] offset:25600
    ds_write_b128 v4, v[40:43] offset:26624
    ds_write_b128 v4, v[44:47] offset:27648
    s_waitcnt vmcnt(12)
    s_waitcnt lgkmcnt(0)
    s_barrier
    ds_read_b64_tr_b16 v[32:33], v27 offset:32768
    ds_read_b64_tr_b16 v[34:35], v27 offset:33280
    ds_read_b64_tr_b16 v[36:37], v30 offset:32768
    ds_read_b64_tr_b16 v[38:39], v30 offset:33280
    ds_read_b64_tr_b16 v[40:41], v27 offset:32776
    ds_read_b64_tr_b16 v[42:43], v27 offset:33288
    ds_read_b64_tr_b16 v[44:45], v30 offset:32776
    ds_read_b64_tr_b16 v[46:47], v30 offset:33288
    ds_write_b128 v4, a[240:243] offset:28672
    ds_write_b128 v4, a[244:247] offset:29696
    ds_write_b128 v4, a[248:251] offset:30720
    ds_write_b128 v4, a[252:255] offset:31744
    s_waitcnt vmcnt(8)
    s_waitcnt lgkmcnt(0)
    s_barrier
    ds_read_b64_tr_b16 a[240:241], v27 offset:0
    ds_read_b64_tr_b16 a[242:243], v27 offset:512
    ds_read_b64_tr_b16 a[244:245], v30 offset:0
    ds_read_b64_tr_b16 a[246:247], v30 offset:512
    ds_read_b64_tr_b16 a[248:249], v27 offset:8
    ds_read_b64_tr_b16 a[250:251], v27 offset:520
    ds_read_b64_tr_b16 a[252:253], v30 offset:8
    ds_read_b64_tr_b16 a[254:255], v30 offset:520
    ds_write_b128 v4, v[32:35] offset:32768
    ds_write_b128 v4, v[36:39] offset:33792
    ds_write_b128 v4, v[40:43] offset:34816
    ds_write_b128 v4, v[44:47] offset:35840
    s_waitcnt vmcnt(4)
    s_waitcnt lgkmcnt(0)
    s_barrier
    ds_read_b64_tr_b16 v[32:33], v27 offset:4096
    ds_read_b64_tr_b16 v[34:35], v27 offset:4608
    ds_read_b64_tr_b16 v[36:37], v30 offset:4096
    ds_read_b64_tr_b16 v[38:39], v30 offset:4608
    ds_read_b64_tr_b16 v[40:41], v27 offset:4104
    ds_read_b64_tr_b16 v[42:43], v27 offset:4616
    ds_read_b64_tr_b16 v[44:45], v30 offset:4104
    ds_read_b64_tr_b16 v[46:47], v30 offset:4616
    ds_write_b128 v4, a[240:243] offset:0
    ds_write_b128 v4, a[244:247] offset:1024
    ds_write_b128 v4, a[248:251] offset:2048
    ds_write_b128 v4, a[252:255] offset:3072
    s_waitcnt vmcnt(0)
    s_waitcnt lgkmcnt(0)
    s_barrier
    ds_read_b64_tr_b16 a[240:241], v27 offset:8192
    ds_read_b64_tr_b16 a[242:243], v27 offset:8704
    ds_read_b64_tr_b16 a[244:245], v30 offset:8192
    ds_read_b64_tr_b16 a[246:247], v30 offset:8704
    ds_read_b64_tr_b16 v[232:233], v27 offset:8200
    ds_read_b64_tr_b16 v[234:235], v27 offset:8712
    ds_read_b64_tr_b16 v[236:237], v30 offset:8200
    ds_read_b64_tr_b16 v[238:239], v30 offset:8712
    ds_write_b128 v4, v[32:35] offset:4096
    ds_write_b128 v4, v[36:39] offset:5120
    ds_write_b128 v4, v[40:43] offset:6144
    ds_write_b128 v4, v[44:47] offset:7168
    s_waitcnt lgkmcnt(0)
    s_barrier
    ds_write_b128 v4, a[240:243] offset:8192
    ds_write_b128 v4, a[244:247] offset:9216
    ds_write_b128 v4, a[216:219] offset:10240
    ds_write_b128 v4, a[220:223] offset:11264
    s_waitcnt lgkmcnt(0)
    v_mov_b32 v1, 0x44444444
    v_mov_b32 v16, 0xeeeeeeee
    v_bfe_u32 v17, v8, 1, 1
    v_cmp_eq_u32 vcc, 1, v17
    s_nop 1
    v_cndmask_b32 v1, v1, v16, vcc
    v_lshrrev_b32 v18, 2, v9
    v_lshl_add_u32 v18, v18, 1, v11
    v_mul_u32_u24 v19, 1280, v18
    v_lshl_add_u32 v19, v10, 5, v19
    v_lshl_add_u32 v28, v17, 4, v19
    v_and_b32 v19, 13, v9
    v_lshl_add_u32 v19, v12, 4, v19
    v_lshl_add_u32 v19, v13, 1, v19
    v_lshlrev_b32 v19, 4, v19
    s_lshl_b32 s30, s12, 9
    v_add_u32 v19, s30, v19
    v_lshl_add_u32 v20, v12, 3, v18
    v_lshl_add_u32 v20, v13, 5, v20
    v_lshlrev_b32 v20, 4, v20
    s_lshr_b32 s30, s12, 1
    s_lshl_b32 s30, s30, 10
    s_and_b32 s31, s12, 1
    s_lshl_b32 s32, s31, 8
    s_add_u32 s32, s32, s30
    s_add_u32 s32, s32, 2048
    v_add_u32 v20, s32, v20
    v_cndmask_b32 v6, v20, v19, vcc
    v_lshrrev_b32 v14, 3, v9
    v_lshlrev_b32 v14, 4, v14
    v_and_b32 v19, 7, v9
    v_add_u32 v14, v14, v19
    v_lshl_add_u32 v19, v12, 5, v14
    v_lshlrev_b32 v19, 4, v19
    v_lshl_add_u32 v19, v13, 2, v19
    s_lshl_b32 s32, s31, 3
    s_add_u32 s29, s30, s30
    s_add_u32 s29, s29, s32
    s_add_u32 s29, s29, 10208
    s_add_u32 s32, s32, s30
    s_add_u32 s32, s32, 8192
    v_add_u32 v7, s32, v19
    s_lshl_b32 s34, s12, 2
    s_add_u32 s34, s34, 14304
    s_add_u32 s34, s34, 32
    s_lshl_b32 s29, s12, 10
    s_add_u32 s29, s29, 10240
    v_lshl_add_u32 v19, v13, 5, v14
    v_lshlrev_b32 v19, 4, v19
    v_lshl_add_u32 v19, v12, 10, v19
    s_lshl_b32 s30, s12, 11
    v_add_u32 v5, s30, v19
    v_lshlrev_b32 v18, 2, v10
    v_sub_u32 v18, v9, v18
    v_mov_b32 v19, 0x3f80
    v_mov_b32 v20, 0x3f800000
    v_cmp_eq_u32 vcc, 0, v18
    s_nop 1
    v_cndmask_b32 v2, 0, v19, vcc
    v_cmp_eq_u32 vcc, 1, v18
    s_nop 1
    v_cndmask_b32 v2, v2, v20, vcc
    v_cmp_eq_u32 vcc, 2, v18
    s_nop 1
    v_cndmask_b32 v3, 0, v19, vcc
    v_cmp_eq_u32 vcc, 3, v18
    s_nop 1
    v_cndmask_b32 v3, v3, v20, vcc
    v_cmp_eq_u32 vcc, 0, v9
    s_nop 1
    v_cndmask_b32 v32, 0, v19, vcc
    v_cmp_eq_u32 vcc, 4, v9
    s_nop 1
    v_cndmask_b32 v32, v32, v20, vcc
    v_cmp_eq_u32 vcc, 1, v9
    s_nop 1
    v_cndmask_b32 v33, 0, v19, vcc
    v_cmp_eq_u32 vcc, 5, v9
    s_nop 1
    v_cndmask_b32 v33, v33, v20, vcc
    v_cmp_eq_u32 vcc, 2, v9
    s_nop 1
    v_cndmask_b32 v34, 0, v19, vcc
    v_cmp_eq_u32 vcc, 6, v9
    s_nop 1
    v_cndmask_b32 v34, v34, v20, vcc
    v_cmp_eq_u32 vcc, 3, v9
    s_nop 1
    v_cndmask_b32 v35, 0, v19, vcc
    v_cmp_eq_u32 vcc, 7, v9
    s_nop 1
    v_cndmask_b32 v35, v35, v20, vcc
    ds_write_b128 v0, v[32:35] offset:15360
    s_mul_i32 s17, s13, 10368
    s_mul_i32 s30, s12, 2560
    s_add_u32 s17, s17, s30
    s_add_u32 s17, s17, s35
    s_add_u32 s17, s17, 150994944
    s_lshl_b32 s27, s12, 5
    s_add_u32 s27, s27, s13
    s_mul_i32 s30, s27, 3277
    s_lshr_b32 s30, s30, 16
    s_mul_i32 s31, s30, 20
    s_sub_u32 s31, s27, s31
    s_mul_i32 s30, s30, 5
    s_cmp_lt_u32 s31, 16
    s_cbranch_scc0 R_kc
    s_lshr_b32 s32, s31, 3
    s_lshl_b32 s32, s32, 1
    s_add_u32 s30, s30, s32
    s_and_b32 s32, s31, 1
    s_add_u32 s30, s30, s32
    s_and_b32 s31, s31, 7
    s_lshr_b32 s31, s31, 1
    s_branch R_kd
R_kc:
    s_sub_u32 s31, s31, 16
    s_add_u32 s30, s30, 4
R_kd:
    s_lshl_b32 s18, s30, 9
    s_lshl_b32 s31, s31, 6
    s_add_u32 s18, s18, s31
    s_lshl_b32 s32, s27, 7
    s_add_u32 s32, s32, s35
    s_add_u32 s61, s32, 150994944
    s_add_u32 s35, s35, 151355392
    s_mov_b32 s19, 0
    s_mov_b32 s20, 20480
    s_mul_i32 s31, s12, 3
    s_min_u32 s31, s31, 7
    s_lshl_b32 s21, s31, 10
    s_mul_i32 s30, s14, 50331648
    s_lshl_b32 s31, s13, 13
    s_add_u32 s30, s30, s31
    s_add_u32 s22, s30, 16777216
    s_add_u32 s23, s30, 33554432
    s_mul_i32 s30, s14, 8388608
    s_lshl_b32 s31, s13, 12
    s_add_u32 s30, s30, s31
    s_add_u32 s24, s30, 134217728
    s_lshl_b32 s30, s12, 10
    s_add_u32 s24, s24, s30
    s_add_u32 s39, s30, 2048
    s_add_u32 s31, s30, 6144
    s_cmp_lt_u32 s12, 2
    s_cselect_b32 s39, s39, s31
    s_sub_u32 s25, s24, 134217728
    s_add_u32 s25, s25, 255852544
    s_mul_i32 s30, s14, 393216
    s_lshl_b32 s31, s13, 7
    s_add_u32 s36, s30, s31
    s_add_u32 s36, s36, 167837696
    s_mov_b32 s15, 0
    s_lshl_b32 s31, s13, 10
    s_add_u32 s37, s30, s31
    s_lshr_b32 s31, s12, 1
    s_lshl_b32 s31, s31, 7
    s_add_u32 s37, s37, s31
    s_add_u32 s37, s37, 167772160
    s_sub_u32 s38, 1, s14
    s_mul_i32 s98, s38, 58
    s_lshl_b32 s38, s38, 15
    s_mov_b32 s40, 0xcccccccc
    s_mov_b32 s41, 0xcccccccc
    s_mov_b32 s42, 0x33333333
    s_mov_b32 s43, 0x33333333
    s_mov_b32 s44, 0x00ff00ff
    s_mov_b32 s45, 0
    s_mov_b32 s46, 0x3e0293ee
    s_mov_b32 s62, 0x3f803f80
    s_mov_b32 s63, 0x3f803f80
    s_mov_b32 s16, 0
    s_mov_b32 s8, s58
    s_mov_b32 s9, s59
    s_mov_b32 s10, 10240
    s_lshr_b32 s30, s21, 3
    s_waitcnt lgkmcnt(0)
    buffer_load_dwordx4 v[32:35], v28, s[8:11], s30 offen offset:0
    buffer_load_dwordx4 v[36:39], v28, s[8:11], s30 offen offset:128
    buffer_load_dwordx4 v[40:43], v28, s[8:11], s30 offen offset:256
    s_add_u32 s56, s26, 0
    s_add_u32 s57, s26, 4096
    s_add_u32 s58, s26, 8192
    s_add_u32 s59, s26, 12288
    s_add_u32 s60, s26, 16384
    buffer_load_dwordx4 a[216:219], v0, s[4:7], s56 offen offset:0 sc1
    buffer_load_dwordx4 a[220:223], v0, s[4:7], s56 offen offset:1024 sc1
    buffer_load_dwordx4 a[224:227], v0, s[4:7], s56 offen offset:2048 sc1
    buffer_load_dwordx4 a[228:231], v0, s[4:7], s56 offen offset:3072 sc1
    buffer_load_dwordx4 a[232:235], v0, s[4:7], s57 offen offset:0 sc1
    buffer_load_dwordx4 a[236:239], v0, s[4:7], s57 offen offset:1024 sc1
    buffer_load_dwordx4 a[240:243], v0, s[4:7], s57 offen offset:2048 sc1
    buffer_load_dwordx4 a[244:247], v0, s[4:7], s57 offen offset:3072 sc1
    buffer_load_dwordx4 a[248:251], v0, s[4:7], s58 offen offset:0 sc1
    buffer_load_dwordx4 a[252:255], v0, s[4:7], s58 offen offset:1024 sc1
    v_mov_b64 v[8:9], 0
    v_mov_b64 v[10:11], 0
    v_mov_b64 v[12:13], 0
    v_mov_b64 v[14:15], 0
    v_mov_b64 v[16:17], 0
    v_mov_b64 v[18:19], 0
    v_mov_b64 v[20:21], 0
    v_mov_b64 v[22:23], 0
    s_waitcnt vmcnt(0)
    s_add_u32 s8, s61, 0
    s_add_u32 s9, s61, 82944
    s_add_u32 s10, s61, 165888
    s_add_u32 s11, s61, 248832
    v_add_u32 v52, s21, v0
    ds_write_b128 v52, v[32:35] offset:0
    ds_write_b128 v52, v[36:39] offset:1024
    ds_write_b128 v52, v[40:43] offset:2048
    s_mul_i32 s21, s12, 2560
    s_mov_b32 s100, 999
    s_mov_b32 s28, 0
    v_lshrrev_b32 v48, 2, v0
    v_mov_b32 v50, 0
R_in0:
    global_load_dword v49, v48, s[90:91] sc1
    s_add_u32 s28, s28, 1
    s_cmp_gt_u32 s28, 65536
    s_cbranch_scc1 L_exit
    s_waitcnt vmcnt(0)
    v_readlane_b32 s30, v49, 32
    v_readlane_b32 s64, v49, 34
    v_readlane_b32 s65, v49, 1
    s_and_b32 s30, s30, 255
    s_cmp_lt_u32 s30, 70
    s_cbranch_scc1 R_in1
    buffer_load_dword v51, v50, s[4:7], s36 offen sc1
    s_waitcnt vmcnt(0) lgkmcnt(0)
    v_readfirstlane_b32 s33, v51
    s_cmp_eq_u32 s33, 0
    s_cbranch_scc1 R_in1
    s_cmp_eq_u32 s14, 0
    s_cselect_b32 s31, s64, s65
    s_cmp_ge_u32 s31, 32
    s_cbranch_scc1 R_in2
    v_readlane_b32 s66, v49, 2
    v_readlane_b32 s67, v49, 3
    v_readlane_b32 s68, v49, 4
    v_readlane_b32 s69, v49, 5
    v_readlane_b32 s70, v49, 6
    v_readlane_b32 s71, v49, 7
    v_readlane_b32 s72, v49, 8
    v_readlane_b32 s73, v49, 9
    v_readlane_b32 s74, v49, 10
    v_readlane_b32 s75, v49, 11
    v_readlane_b32 s76, v49, 12
    v_readlane_b32 s77, v49, 13
    v_readlane_b32 s78, v49, 14
    v_readlane_b32 s79, v49, 15
    s_add_u32 s64, s64, s65
    s_add_u32 s64, s64, s66
    s_add_u32 s64, s64, s67
    s_add_u32 s64, s64, s68
    s_add_u32 s64, s64, s69
    s_add_u32 s64, s64, s70
    s_add_u32 s64, s64, s71
    s_add_u32 s64, s64, s72
    s_add_u32 s64, s64, s73
    s_add_u32 s64, s64, s74
    s_add_u32 s64, s64, s75
    s_add_u32 s64, s64, s76
    s_add_u32 s64, s64, s77
    s_add_u32 s64, s64, s78
    s_add_u32 s64, s64, s79
    s_cmp_ge_u32 s64, 256
    s_cbranch_scc1 RS_ent
R_in1:
    s_sleep 16
    s_branch R_in0
R_in2:
RF_ent:
    s_branch RF_kvw
.p2align 6
RF_g2:
    v_mov_b64 v[8:9], 0
    v_mov_b64 v[10:11], 0
    v_mov_b64 v[12:13], 0
    v_mov_b64 v[14:15], 0
    v_mov_b64 v[16:17], 0
    v_mov_b64 v[18:19], 0
    v_mov_b64 v[20:21], 0
    v_mov_b64 v[22:23], 0
    v_add_u32 v48, s21, v0
    v_lshrrev_b32 v51, 1, v0
    v_add_u32 v51, s21, v51
    s_mov_b32 s28, 0
    s_barrier
    s_waitcnt lgkmcnt(0)
    s_min_u32 s33, s48, s49
    s_cmp_gt_u32 s33, s16
    s_cbranch_scc1 B_1
    s_load_dword s48, s[4:5], s37 glc
    s_load_dword s49, s[4:5], s37 offset:256 glc
B_1:
    s_waitcnt vmcnt(0)
RF_p2:
    buffer_load_dwordx4 v[32:35], v48, s[4:7], s32 offen sc1
    buffer_load_dwordx4 v[36:39], v48, s[4:7], s32 offen offset:1024 sc1
    buffer_load_dwordx2 v[40:41], v51, s[4:7], s32 offen offset:2048 sc1
    s_add_u32 s28, s28, 1
    s_cmp_gt_u32 s28, 131072
    s_cbranch_scc1 L_exit
    s_waitcnt vmcnt(2)
    ds_write_b128 v48, v[32:35] offset:0
    s_waitcnt vmcnt(1)
    ds_write_b128 v48, v[36:39] offset:1024
    v_max3_u32 v49, v32, v34, v36
    s_waitcnt vmcnt(0)
    ds_write_b64 v51, v[40:41] offset:2048
    v_max3_u32 v49, v49, v38, v40
    v_cmp_eq_u32 vcc, -1, v49
    s_cbranch_vccnz RF_p2
    s_cmp_le_u32 s33, s16
    s_cbranch_scc1 RF_kvc
    s_waitcnt lgkmcnt(0)
RF_step:
    s_barrier
    ds_read_b128 v[52:55], v0 offset:0
    ds_read_b128 v[24:27], v0 offset:1024
    ds_read_b128 v[48:51], v0 offset:2048
    buffer_load_dwordx4 v[32:35], v5, s[4:7], s22 offen sc1
    buffer_load_dwordx4 v[36:39], v5, s[4:7], s22 offen offset:128 sc1
    s_waitcnt lgkmcnt(2)
    v_smfmac_f32_16x16x64_bf16 v[8:11], v[52:55], a[216:223], v1
    ds_read_b128 a[216:219], v4 offset:10240
    v_smfmac_f32_16x16x64_bf16 v[16:19], v[52:55], v[72:79], v1
    ds_read_b128 a[220:223], v4 offset:11264
    v_smfmac_f32_16x16x64_bf16 v[12:15], v[52:55], a[224:231], v1
    ds_read_b128 a[224:227], v4 offset:12288
    v_smfmac_f32_16x16x64_bf16 v[20:23], v[52:55], v[80:87], v1
    ds_read_b128 v[52:55], v0 offset:3072
    ds_read_b128 a[228:231], v4 offset:13312
    s_waitcnt lgkmcnt(6)
    v_smfmac_f32_16x16x64_bf16 v[8:11], v[24:27], a[232:239], v1
    ds_read_b128 a[232:235], v4 offset:14336
    buffer_store_dwordx4 v[28:31], v0, s[4:7], s25 offen sc1
    v_smfmac_f32_16x16x64_bf16 v[16:19], v[24:27], v[88:95], v1
    ds_read_b128 a[236:239], v4 offset:15360
    v_smfmac_f32_16x16x64_bf16 v[12:15], v[24:27], a[240:247], v1
    ds_read_b128 a[240:243], v4 offset:16384
    v_smfmac_f32_16x16x64_bf16 v[20:23], v[24:27], v[96:103], v1
    ds_read_b128 v[24:27], v0 offset:4096
    ds_read_b128 a[244:247], v4 offset:17408
    s_waitcnt lgkmcnt(8)
    v_smfmac_f32_16x16x64_bf16 v[8:11], v[48:51], a[248:255], v1
    ds_read_b128 a[248:251], v4 offset:18432
    v_smfmac_f32_16x16x64_bf16 v[16:19], v[48:51], v[104:111], v1
    ds_read_b128 a[252:255], v4 offset:19456
    v_smfmac_f32_16x16x64_bf16 v[12:15], v[48:51], a[216:223], v1
    ds_read_b128 a[216:219], v4 offset:20480
    v_smfmac_f32_16x16x64_bf16 v[20:23], v[48:51], v[112:119], v1
    ds_read_b128 v[48:51], v0 offset:5120
    ds_read_b128 a[220:223], v4 offset:21504
    s_waitcnt lgkmcnt(8)
    v_smfmac_f32_16x16x64_bf16 v[8:11], v[52:55], a[224:231], v1
    ds_read_b128 a[224:227], v4 offset:22528
    v_smfmac_f32_16x16x64_bf16 v[16:19], v[52:55], v[120:127], v1
    ds_read_b128 a[228:231], v4 offset:23552
    v_smfmac_f32_16x16x64_bf16 v[12:15], v[52:55], a[232:239], v1
    ds_read_b128 a[232:235], v4 offset:24576
    v_smfmac_f32_16x16x64_bf16 v[20:23], v[52:55], v[128:135], v1
    ds_read_b128 v[52:55], v0 offset:6144
    ds_read_b128 a[236:239], v4 offset:25600
    s_waitcnt lgkmcnt(8)
    v_smfmac_f32_16x16x64_bf16 v[8:11], v[24:27], a[240:247], v1
    ds_read_b128 a[240:243], v4 offset:26624
    v_smfmac_f32_16x16x64_bf16 v[16:19], v[24:27], v[136:143], v1
    ds_read_b128 a[244:247], v4 offset:27648
    buffer_load_dwordx4 v[40:43], v5, s[4:7], s23 offen sc1
    v_smfmac_f32_16x16x64_bf16 v[12:15], v[24:27], a[248:255], v1
    ds_read_b128 a[248:251], v4 offset:28672
    v_smfmac_f32_16x16x64_bf16 v[20:23], v[24:27], v[144:151], v1
    ds_read_b128 v[24:27], v0 offset:7168
    ds_read_b128 a[252:255], v4 offset:29696
    s_waitcnt lgkmcnt(8)
    v_smfmac_f32_16x16x64_bf16 v[8:11], v[48:51], a[216:223], v1
    ds_read_b128 a[216:219], v4 offset:30720
    v_smfmac_f32_16x16x64_bf16 v[16:19], v[48:51], v[152:159], v1
    ds_read_b128 a[220:223], v4 offset:31744
    buffer_load_dwordx4 v[44:47], v5, s[4:7], s23 offen offset:128 sc1
    v_smfmac_f32_16x16x64_bf16 v[12:15], v[48:51], a[224:231], v1
    ds_read_b128 a[224:227], v4 offset:32768
    v_smfmac_f32_16x16x64_bf16 v[20:23], v[48:51], v[160:167], v1
    ds_read_b128 v[48:51], v0 offset:8192
    ds_read_b128 a[228:231], v4 offset:33792
    s_waitcnt lgkmcnt(8)
    v_smfmac_f32_16x16x64_bf16 v[8:11], v[52:55], a[232:239], v1
    ds_read_b128 a[232:235], v4 offset:34816
    v_smfmac_f32_16x16x64_bf16 v[16:19], v[52:55], v[168:175], v1
    ds_read_b128 a[236:239], v4 offset:35840
    v_smfmac_f32_16x16x64_bf16 v[12:15], v[52:55], a[240:247], v1
    ds_read_b128 a[240:243], v4 offset:0
    v_smfmac_f32_16x16x64_bf16 v[20:23], v[52:55], v[176:183], v1
    ds_read_b128 v[52:55], v0 offset:9216
    ds_read_b128 a[244:247], v4 offset:1024
    s_waitcnt lgkmcnt(8)
    v_smfmac_f32_16x16x64_bf16 v[8:11], v[24:27], a[248:255], v1
    ds_read_b128 a[248:251], v4 offset:2048
    v_smfmac_f32_16x16x64_bf16 v[16:19], v[24:27], v[184:191], v1
    ds_read_b128 a[252:255], v4 offset:3072
    v_smfmac_f32_16x16x64_bf16 v[12:15], v[24:27], a[216:223], v1
    ds_read_b128 a[216:219], v4 offset:4096
    v_smfmac_f32_16x16x64_bf16 v[20:23], v[24:27], v[192:199], v1
    ds_read_b128 a[220:223], v4 offset:5120
    s_waitcnt lgkmcnt(7)
    v_smfmac_f32_16x16x64_bf16 v[8:11], v[48:51], a[224:231], v1
    ds_read_b128 a[224:227], v4 offset:6144
    v_smfmac_f32_16x16x64_bf16 v[16:19], v[48:51], v[200:207], v1
    ds_read_b128 a[228:231], v4 offset:7168
    v_smfmac_f32_16x16x64_bf16 v[12:15], v[48:51], a[232:239], v1
    ds_read_b128 a[232:235], v4 offset:8192
    v_smfmac_f32_16x16x64_bf16 v[20:23], v[48:51], v[208:215], v1
    ds_read_b128 a[236:239], v4 offset:9216
    s_waitcnt lgkmcnt(9)
    v_smfmac_f32_16x16x64_bf16 v[8:11], v[52:55], v[56:63], v1
    v_mov_b64 v[24:25], 0
    v_smfmac_f32_16x16x64_bf16 v[16:19], v[52:55], v[216:223], v1
    v_mov_b64 v[26:27], 0
    v_smfmac_f32_16x16x64_bf16 v[12:15], v[52:55], v[64:71], v1
    v_mov_b64 v[28:29], 0
    v_smfmac_f32_16x16x64_bf16 v[20:23], v[52:55], v[224:231], v1
    v_mov_b64 v[30:31], 0
    s_waitcnt lgkmcnt(6)
    v_smfmac_f32_16x16x64_bf16 v[24:27], v[48:51], a[240:247], v1
    v_smfmac_f32_16x16x64_bf16 v[28:31], v[48:51], a[248:255], v1
    ds_read_b128 v[48:51], v0 offset:0
    v_add_f32 v8, v8, v10
    v_add_f32 v9, v9, v11
    v_add_f32 v16, v16, v18
    v_add_f32 v17, v17, v19
    v_cvt_pk_bf16_f32 v9, v8, v9
    v_cvt_pk_bf16_f32 v8, v16, v17
    v_add_f32 v12, v12, v14
    v_add_f32 v13, v13, v15
    v_mfma_f32_16x16x16_bf16 v[16:19], v[8:9], v[2:3], 0
    v_add_f32 v20, v20, v22
    v_add_f32 v21, v21, v23
    v_cvt_pk_bf16_f32 v11, v12, v13
    v_cvt_pk_bf16_f32 v10, v20, v21
    s_nop 1
    v_mfma_f32_16x16x16_bf16 v[20:23], v[10:11], v[2:3], 0
    s_waitcnt lgkmcnt(3)
    v_smfmac_f32_16x16x64_bf16 v[24:27], v[52:55], a[216:223], v1
    v_smfmac_f32_16x16x64_bf16 v[28:31], v[52:55], a[224:231], v1
    ds_read_b128 v[52:55], v0 offset:1024
    v_cvt_pk_bf16_f32 v8, v16, v17
    v_cvt_pk_bf16_f32 v9, v18, v19
    s_waitcnt vmcnt(3)
    s_nop 0
    v_cvt_pk_bf16_f32 v10, v20, v21
    v_cvt_pk_bf16_f32 v11, v22, v23
    buffer_load_dwordx4 a[240:243], v0, s[4:7], s58 offen offset:2048 sc1
    buffer_load_dwordx4 a[244:247], v0, s[4:7], s58 offen offset:3072 sc1
    v_mfma_f32_16x16x32_bf16 v[12:15], v[32:35], v[8:11], 0
    v_mfma_f32_16x16x32_bf16 v[16:19], v[36:39], v[8:11], 0
    v_add_u32 v32, s29, v0
    v_add_u32 v33, s34, v0
    v_mfma_f32_16x16x32_bf16 v[20:23], v[8:11], v[8:11], 0
    s_mov_b64 vcc, s[40:41]
    s_waitcnt lgkmcnt(1)
    v_smfmac_f32_16x16x64_bf16 v[24:27], v[48:51], a[232:239], v1
    v_smfmac_f32_16x16x64_bf16 v[28:31], v[48:51], v[232:239], v1
    ds_read_b128 v[48:51], v0 offset:2048
    v_cndmask_b32_dpp v12, v16, v12, vcc quad_perm:[2,3,0,1] row_mask:0xf bank_mask:0xf
    v_cndmask_b32_dpp v13, v17, v13, vcc quad_perm:[2,3,0,1] row_mask:0xf bank_mask:0xf
    v_cndmask_b32_dpp v14, v18, v14, vcc quad_perm:[2,3,0,1] row_mask:0xf bank_mask:0xf
    v_cndmask_b32_dpp v15, v19, v15, vcc quad_perm:[2,3,0,1] row_mask:0xf bank_mask:0xf
    ds_write_b128 v32, v[12:15]
    v_cndmask_b32_dpp v20, v21, v20, vcc quad_perm:[2,3,0,1] row_mask:0xf bank_mask:0xf
    ds_write_b32 v33, v20
    s_waitcnt lgkmcnt(3)
    v_smfmac_f32_16x16x64_bf16 v[24:27], v[52:55], v[240:247], v1
    v_smfmac_f32_16x16x64_bf16 v[28:31], v[52:55], v[248:255], v1
    ds_read_b128 v[52:55], v0 offset:3072
    buffer_load_dwordx4 a[248:251], v0, s[4:7], s59 offen offset:0 sc1
    s_waitcnt lgkmcnt(3)
    v_smfmac_f32_16x16x64_bf16 v[24:27], v[48:51], a[0:7], v1
    v_smfmac_f32_16x16x64_bf16 v[28:31], v[48:51], a[8:15], v1
    ds_read_b128 v[48:51], v0 offset:4096
    s_waitcnt lgkmcnt(1)
    s_barrier
    ds_read_b128 v[12:15], v0 offset:10240
    ds_read_b128 v[16:19], v0 offset:11264
    ds_read_b128 v[20:23], v0 offset:12288
    ds_read_b128 v[32:35], v0 offset:13312
    ds_read_b128 v[36:39], v0 offset:14336
    v_smfmac_f32_16x16x64_bf16 v[24:27], v[52:55], a[16:23], v1
    v_smfmac_f32_16x16x64_bf16 v[28:31], v[52:55], a[24:31], v1
    ds_read_b128 v[52:55], v0 offset:5120
    s_waitcnt lgkmcnt(6)
    v_smfmac_f32_16x16x64_bf16 v[24:27], v[48:51], a[32:39], v1
    v_smfmac_f32_16x16x64_bf16 v[28:31], v[48:51], a[40:47], v1
    ds_read_b128 v[48:51], v0 offset:6144
    buffer_load_dwordx4 a[252:255], v0, s[4:7], s59 offen offset:1024 sc1
    buffer_load_dwordx4 a[216:219], v0, s[4:7], s59 offen offset:2048 sc1
    s_waitcnt lgkmcnt(3)
    v_add_f32 v12, v12, v16
    v_add_f32 v13, v13, v17
    v_pk_add_f32 v[14:15], v[14:15], v[18:19]
    v_pk_add_f32 v[20:21], v[20:21], v[32:33]
    v_pk_add_f32 v[22:23], v[22:23], v[34:35]
    s_waitcnt lgkmcnt(2)
    v_pk_add_f32 v[36:37], v[36:37], v[38:39]
    v_pk_add_f32 v[12:13], v[12:13], v[20:21]
    v_pk_add_f32 v[14:15], v[14:15], v[22:23]
    v_add_f32 v36, v36, v37
    v_max3_f32 v16, v12, v13, v14
    v_max3_f32 v16, v16, v15, v36
    s_waitcnt lgkmcnt(1)
    v_smfmac_f32_16x16x64_bf16 v[24:27], v[52:55], a[48:55], v1
    buffer_load_dwordx4 a[220:223], v0, s[4:7], s59 offen offset:3072 sc1
    v_max_f32_dpp v16, v16, v16 quad_perm:[2,3,0,1] row_mask:0xf bank_mask:0xf
    v_mov_b32 v17, v16
    v_smfmac_f32_16x16x64_bf16 v[28:31], v[52:55], a[56:63], v1
    ds_read_b128 v[52:55], v0 offset:7168
    v_permlane16_swap_b32 v16, v17
    v_max_f32 v16, v16, v17
    v_mov_b32 v17, v16
    s_waitcnt lgkmcnt(1)
    v_smfmac_f32_16x16x64_bf16 v[24:27], v[48:51], a[64:71], v1
    buffer_load_dwordx4 a[224:227], v0, s[4:7], s60 offen offset:0 sc1
    v_permlane32_swap_b32 v16, v17
    v_max_f32 v16, v16, v17
    v_smfmac_f32_16x16x64_bf16 v[28:31], v[48:51], a[72:79], v1
    v_mul_f32 v16, s46, v16
    v_fma_f32 v12, v12, s46, -v16
    s_waitcnt lgkmcnt(0)
    v_smfmac_f32_16x16x64_bf16 v[24:27], v[52:55], a[80:87], v1
    v_fma_f32 v13, v13, s46, -v16
    v_smfmac_f32_16x16x64_bf16 v[28:31], v[52:55], a[88:95], v1
    v_fma_f32 v14, v14, s46, -v16
    v_fma_f32 v15, v15, s46, -v16
    v_fma_f32 v36, v36, s46, -v16
    v_exp_f32 v12, v12
    v_exp_f32 v13, v13
    v_exp_f32 v14, v14
    v_exp_f32 v15, v15
    v_exp_f32 v36, v36
    v_mov_b64 v[48:49], s[62:63]
    v_cvt_pk_bf16_f32 v32, v12, v13
    v_cvt_pk_bf16_f32 v33, v14, v15
    v_mov_b32_dpp v37, v36 quad_perm:[2,3,0,1] row_mask:0xf bank_mask:0xf
    v_mov_b64 v[50:51], s[62:63]
    v_mov_b32_dpp v34, v32 quad_perm:[2,3,0,1] row_mask:0xf bank_mask:0xf
    v_mov_b32_dpp v35, v33 quad_perm:[2,3,0,1] row_mask:0xf bank_mask:0xf
    v_pk_add_f32 v[24:25], v[24:25], v[26:27]
    v_pk_add_f32 v[28:29], v[28:29], v[30:31]
    v_mfma_f32_16x16x32_bf16 v[20:23], v[48:51], v[32:35], 0
    v_cvt_pk_bf16_f32 v52, v36, v37
    v_mov_b32 v53, 0
    s_waitcnt vmcnt(7)
    v_mfma_f32_16x16x32_bf16 v[12:15], v[40:43], v[32:35], 0
    v_cvt_pk_bf16_f32 v24, v24, v25
    v_cvt_pk_bf16_f32 v25, v28, v29
    v_mfma_f32_16x16x32_bf16 v[16:19], v[44:47], v[32:35], 0
    v_mov_b32 v54, 0
    v_mov_b32 v55, v52
    v_mfma_f32_16x16x16_bf16 v[20:23], v[48:49], v[52:53], v[20:23]
    ds_write2_b32 v7, v24, v25 offset0:0 offset1:32
    buffer_load_dwordx4 a[228:231], v0, s[4:7], s60 offen offset:1024 sc1
    v_mfma_f32_16x16x16_bf16 v[12:15], v[24:25], v[52:53], v[12:15]
    buffer_load_dwordx4 a[232:235], v0, s[4:7], s60 offen offset:2048 sc1
    v_mov_b64 v[26:27], 0
    v_mfma_f32_16x16x16_bf16 v[16:19], v[24:25], v[54:55], v[16:19]
    buffer_load_dwordx4 a[236:239], v0, s[4:7], s60 offen offset:3072 sc1
    v_mov_b64 v[28:29], 0
    v_rcp_f32 v20, v20
    v_mov_b64 v[30:31], 0
    v_mov_b32 v21, v20
    v_mov_b64 v[32:33], 0
    s_mov_b64 exec, s[40:41]
    v_pk_mul_f32 v[12:13], v[12:13], v[20:21]
    v_pk_mul_f32 v[14:15], v[14:15], v[20:21]
    v_cvt_pk_bf16_f32 v8, v12, v13
    v_cvt_pk_bf16_f32 v9, v14, v15
    v_pk_mul_f32 v[16:17], v[16:17], v[20:21]
    v_pk_mul_f32 v[18:19], v[18:19], v[20:21]
    v_cvt_pk_bf16_f32 v10, v16, v17
    v_cvt_pk_bf16_f32 v11, v18, v19
    s_mov_b64 exec, -1
    ds_write_b128 v6, v[8:11]
    v_mov_b64 v[12:13], 0
    v_mov_b64 v[14:15], 0
    v_mov_b64 v[16:17], 0
    v_mov_b64 v[18:19], 0
    v_mov_b64 v[20:21], 0
    v_mov_b64 v[22:23], 0
    v_mov_b64 v[40:41], 0
    v_mov_b64 v[42:43], 0
    v_mov_b64 v[44:45], 0
    v_mov_b64 v[46:47], 0
    v_mov_b64 v[8:9], 0
    v_mov_b64 v[10:11], 0
    s_waitcnt lgkmcnt(0)
    s_barrier
    ds_read_b128 v[48:51], v0 offset:0
    ds_read_b128 v[52:55], v0 offset:1024
    s_cmp_eq_u32 s16, 63
    s_cbranch_scc1 RF_fin
    v_mov_b64 v[24:25], 0
    v_mov_b64 v[34:35], 0
    v_mov_b64 v[36:37], 0
    v_mov_b64 v[38:39], 0
    s_waitcnt vmcnt(6)
    s_waitcnt lgkmcnt(1)
    v_smfmac_f32_16x16x64_bf16 v[8:11], v[48:51], a[240:247], v1
    v_smfmac_f32_16x16x64_bf16 v[12:15], v[48:51], a[248:255], v1
    buffer_load_dwordx4 a[240:243], v0, s[4:7], s57 offen offset:2048 sc1
    s_waitcnt vmcnt(3)
    v_smfmac_f32_16x16x64_bf16 v[16:19], v[48:51], a[216:223], v1
    v_smfmac_f32_16x16x64_bf16 v[20:23], v[48:51], a[224:231], v1
    buffer_load_dwordx4 a[244:247], v0, s[4:7], s57 offen offset:3072 sc1
    s_waitcnt lgkmcnt(0)
RF_nf:
    v_smfmac_f32_16x16x64_bf16 v[8:11], v[52:55], a[136:143], v1
    v_smfmac_f32_16x16x64_bf16 v[12:15], v[52:55], a[144:151], v1
    buffer_load_dwordx4 a[248:251], v0, s[4:7], s58 offen offset:0 sc1
    v_smfmac_f32_16x16x64_bf16 v[16:19], v[52:55], a[152:159], v1
    v_smfmac_f32_16x16x64_bf16 v[20:23], v[52:55], a[160:167], v1
    buffer_load_dwordx4 a[252:255], v0, s[4:7], s58 offen offset:1024 sc1
    s_waitcnt vmcnt(4)
    v_smfmac_f32_16x16x64_bf16 v[40:43], v[48:51], a[232:239], v1
    v_smfmac_f32_16x16x64_bf16 v[44:47], v[48:51], a[128:135], v1
    buffer_load_dwordx4 a[216:219], v0, s[4:7], s56 offen offset:0 sc1
    v_smfmac_f32_16x16x64_bf16 v[24:27], v[48:51], a[96:103], v1
    v_add_f32 v8, v8, v10
    v_add_f32 v9, v9, v11
    v_smfmac_f32_16x16x64_bf16 v[28:31], v[48:51], a[104:111], v1
    v_cvt_pk_bf16_f32 v8, v8, v9
    v_bfi_b32 v8, 1, s16, v8
    v_smfmac_f32_16x16x64_bf16 v[32:35], v[48:51], a[112:119], v1
    v_add_f32 v12, v12, v14
    v_add_f32 v13, v13, v15
    v_smfmac_f32_16x16x64_bf16 v[36:39], v[48:51], a[120:127], v1
    v_cvt_pk_bf16_f32 v9, v12, v13
    v_add_f32 v16, v16, v18
    v_smfmac_f32_16x16x64_bf16 v[24:27], v[52:55], a[168:175], v1
    v_add_f32 v17, v17, v19
    v_cvt_pk_bf16_f32 v10, v16, v17
    v_smfmac_f32_16x16x64_bf16 v[28:31], v[52:55], a[176:183], v1
    v_add_f32 v20, v20, v22
    v_add_f32 v21, v21, v23
    v_smfmac_f32_16x16x64_bf16 v[32:35], v[52:55], a[184:191], v1
    v_cvt_pk_bf16_f32 v11, v20, v21
    buffer_store_dwordx4 v[8:11], v0, s[4:7], s17 offen
    v_smfmac_f32_16x16x64_bf16 v[36:39], v[52:55], a[192:199], v1
    v_lshrrev_b32 v12, 1, v0
    v_add_f32 v24, v24, v26
    v_smfmac_f32_16x16x64_bf16 v[40:43], v[52:55], a[200:207], v1
    v_add_f32 v25, v25, v27
    v_smfmac_f32_16x16x64_bf16 v[44:47], v[52:55], a[208:215], v1
    v_cvt_pk_bf16_f32 v24, v24, v25
    v_bfi_b32 v24, 1, s16, v24
    v_add_f32 v28, v28, v30
    v_add_f32 v29, v29, v31
    v_cvt_pk_bf16_f32 v25, v28, v29
    v_pk_add_f32 v[32:33], v[32:33], v[34:35]
    v_cvt_pk_bf16_f32 v26, v32, v33
    v_pk_add_f32 v[36:37], v[36:37], v[38:39]
    v_cvt_pk_bf16_f32 v27, v36, v37
    buffer_store_dwordx4 v[24:27], v0, s[4:7], s17 offen offset:1024
    v_pk_add_f32 v[40:41], v[40:41], v[42:43]
    v_cvt_pk_bf16_f32 v40, v40, v41
    v_bfi_b32 v40, 1, s16, v40
    v_pk_add_f32 v[44:45], v[44:45], v[46:47]
    v_cvt_pk_bf16_f32 v41, v44, v45
    buffer_store_dwordx2 v[40:41], v12, s[4:7], s17 offen offset:2048
    v_add_u32 v53, s39, v0
    v_and_b32 v52, 0xf0, v0
    ds_read_b128 v[28:31], v53
    ds_read_b128 v[48:51], v52 offset:15360
    v_lshrrev_b32 v44, 7, v0
    v_mul_u32_u24 v44, 10240, v44
    v_add_u32 v44, v44, v0
    s_add_u32 s32, s35, s19
    s_add_u32 s33, s35, s20
    s_add_u32 s16, s16, 1
    s_cmp_lt_u32 s16, 36
    s_cselect_b32 s38, s38, 0
    s_xor_b32 s37, s37, s38
    s_cmp_eq_u32 s16, s98
    s_cselect_b32 s30, 327680, 0
    s_add_u32 s37, s37, s30
    s_mov_b32 s20, s19
    s_add_u32 s19, s19, 10240
    s_cmp_eq_u32 s19, 30720
    s_cselect_b32 s19, 0, s19
    s_add_u32 s22, s22, 262144
    s_add_u32 s23, s23, 262144
    s_mov_b32 s25, s24
    s_add_u32 s24, s24, 131072
    s_mov_b32 s28, 0
    s_waitcnt lgkmcnt(0)
    s_load_dword s48, s[4:5], s37 glc
    s_load_dword s49, s[4:5], s37 offset:256 glc
    v_min_u32 v28, -2, v28
    v_min_u32 v29, -2, v29
    v_min_u32 v30, -2, v30
    v_min_u32 v31, -2, v31
    s_cmp_ge_u32 s27, 80
    s_cbranch_scc1 RF_nr
    s_waitcnt vmcnt(0)
    buffer_load_dwordx4 v[8:11], v44, s[4:7], s8 offen sc1
    buffer_load_dwordx4 v[16:19], v44, s[4:7], s9 offen sc1
    buffer_load_dwordx4 v[20:23], v44, s[4:7], s10 offen sc1
    buffer_load_dwordx4 v[32:35], v44, s[4:7], s11 offen sc1
    v_and_b32 v45, 0x40, v0
    v_lshlrev_b32 v45, 2, v45
    v_and_or_b32 v45, v0, 32, v45
    v_lshrrev_b32 v46, 4, v0
    v_and_or_b32 v45, v46, 16, v45
    v_and_or_b32 v45, v12, 8, v45
    v_add_u32 v45, s18, v45
    s_branch RF_p1c
RF_p1:
    s_cmp_lt_u32 s28, 4
    s_cbranch_scc1 RF_p1n
    s_sleep 4
RF_p1n:
    buffer_load_dwordx4 v[8:11], v44, s[4:7], s8 offen sc1
    buffer_load_dwordx4 v[16:19], v44, s[4:7], s9 offen sc1
    buffer_load_dwordx4 v[20:23], v44, s[4:7], s10 offen sc1
    buffer_load_dwordx4 v[32:35], v44, s[4:7], s11 offen sc1
    s_add_u32 s28, s28, 1
    s_cmp_gt_u32 s28, 131072
    s_cbranch_scc1 L_exit
RF_p1c:
    s_waitcnt vmcnt(3)
    v_mfma_f32_16x16x32_bf16 v[36:39], v[48:51], v[8:11], 0
    s_waitcnt vmcnt(2)
    v_mfma_f32_16x16x32_bf16 v[36:39], v[48:51], v[16:19], v[36:39]
    v_bitop3_b32 v46, v8, v16, s16 bitop3:0x42
    s_waitcnt vmcnt(1)
    v_mfma_f32_16x16x32_bf16 v[36:39], v[48:51], v[20:23], v[36:39]
    s_waitcnt vmcnt(0)
    v_mfma_f32_16x16x32_bf16 v[36:39], v[48:51], v[32:35], v[36:39]
    v_bitop3_b32 v47, v20, v32, s16 bitop3:0x42
    v_bitop3_b32 v46, v46, v47, 1 bitop3:0x80
    v_cmp_eq_u32 vcc, 0, v46
    s_cbranch_vccnz RF_p1
RF_p1ok:
    v_mov_b64 v[46:47], -1
    s_nop 2
    v_add_f32_dpp v36, v36, v36 row_ror:8 row_mask:0xf bank_mask:0xf
    v_add_f32_dpp v37, v37, v37 row_ror:8 row_mask:0xf bank_mask:0xf
    v_add_f32_dpp v38, v38, v38 row_ror:8 row_mask:0xf bank_mask:0xf
    v_add_f32_dpp v39, v39, v39 row_ror:8 row_mask:0xf bank_mask:0xf
    s_mov_b64 exec, s[44:45]
    v_cvt_pk_bf16_f32 v36, v36, v37
    v_cvt_pk_bf16_f32 v37, v38, v39
    v_min_u32 v36, -2, v36
    buffer_store_dwordx2 v[36:37], v45, s[4:7], s32 offen
    buffer_store_dwordx2 v[46:47], v45, s[4:7], s33 offen
    s_mov_b64 exec, -1
    buffer_load_dwordx4 a[220:223], v0, s[4:7], s56 offen offset:1024 sc1
    buffer_load_dwordx4 a[224:227], v0, s[4:7], s56 offen offset:2048 sc1
    buffer_load_dwordx4 a[228:231], v0, s[4:7], s56 offen offset:3072 sc1
    buffer_load_dwordx4 a[232:235], v0, s[4:7], s57 offen offset:0 sc1
    buffer_load_dwordx4 a[236:239], v0, s[4:7], s57 offen offset:1024 sc1
    s_branch RF_g2
RF_kvw:
    s_mov_b32 s28, 0
RF_kvl:
    s_load_dword s48, s[4:5], s37 glc
    s_load_dword s49, s[4:5], s37 offset:256 glc
RF_kvc:
    s_waitcnt lgkmcnt(0)
    s_min_u32 s48, s48, s49
    s_cmp_gt_u32 s48, s16
    s_cbranch_scc1 RF_step
    s_add_u32 s28, s28, 1
    s_cmp_gt_u32 s28, 131072
    s_cbranch_scc1 L_exit
    s_sleep 2
    s_branch RF_kvl
RF_nr:
    s_waitcnt vmcnt(0)
    buffer_load_dwordx4 a[220:223], v0, s[4:7], s56 offen offset:1024 sc1
    buffer_load_dwordx4 a[224:227], v0, s[4:7], s56 offen offset:2048 sc1
    buffer_load_dwordx4 a[228:231], v0, s[4:7], s56 offen offset:3072 sc1
    buffer_load_dwordx4 a[232:235], v0, s[4:7], s57 offen offset:0 sc1
    buffer_load_dwordx4 a[236:239], v0, s[4:7], s57 offen offset:1024 sc1
    s_branch RF_g2
RF_fin:
    v_add_u32 v8, s39, v0
    ds_read_b128 v[28:31], v8
    s_waitcnt lgkmcnt(0)
    v_min_u32 v28, -2, v28
    v_min_u32 v29, -2, v29
    v_min_u32 v30, -2, v30
    v_min_u32 v31, -2, v31
    buffer_store_dwordx4 v[28:31], v0, s[4:7], s24 offen sc1
    s_waitcnt vmcnt(0) lgkmcnt(0)
    s_branch L_next
RS_ent:
    s_branch RS_kvw
.p2align 6
RS_g2:
    v_mov_b64 v[8:9], 0
    v_mov_b64 v[10:11], 0
    v_mov_b64 v[12:13], 0
    v_mov_b64 v[14:15], 0
    v_mov_b64 v[16:17], 0
    v_mov_b64 v[18:19], 0
    v_mov_b64 v[20:21], 0
    v_mov_b64 v[22:23], 0
    v_add_u32 v48, s21, v0
    v_lshrrev_b32 v51, 1, v0
    v_add_u32 v51, s21, v51
    s_mov_b32 s28, 0
    s_barrier
    s_waitcnt lgkmcnt(0)
    s_min_u32 s33, s48, s49
    s_cmp_gt_u32 s33, s16
    s_cbranch_scc1 B_2
    s_load_dword s48, s[4:5], s37 glc
    s_load_dword s49, s[4:5], s37 offset:256 glc
B_2:
    s_waitcnt vmcnt(0)
RS_p2:
    buffer_load_dwordx4 v[32:35], v48, s[4:7], s32 offen sc1
    buffer_load_dwordx4 v[36:39], v48, s[4:7], s32 offen offset:1024 sc1
    buffer_load_dwordx2 v[40:41], v51, s[4:7], s32 offen offset:2048 sc1
    s_add_u32 s28, s28, 1
    s_cmp_gt_u32 s28, 131072
    s_cbranch_scc1 L_exit
    s_waitcnt vmcnt(2)
    ds_write_b128 v48, v[32:35] offset:0
    s_waitcnt vmcnt(1)
    ds_write_b128 v48, v[36:39] offset:1024
    v_max3_u32 v49, v32, v34, v36
    s_waitcnt vmcnt(0)
    ds_write_b64 v51, v[40:41] offset:2048
    v_max3_u32 v49, v49, v38, v40
    v_cmp_eq_u32 vcc, -1, v49
    s_cbranch_vccnz RS_p2
    s_cmp_le_u32 s33, s16
    s_cbranch_scc1 RS_kvc
    s_waitcnt lgkmcnt(0)
RS_step:
    s_barrier
    ds_read_b128 v[52:55], v0 offset:0
    ds_read_b128 v[24:27], v0 offset:1024
    ds_read_b128 v[48:51], v0 offset:2048
    buffer_load_dwordx4 v[32:35], v5, s[4:7], s22 offen sc1
    buffer_load_dwordx4 v[36:39], v5, s[4:7], s22 offen offset:128 sc1
    s_waitcnt lgkmcnt(2)
    v_smfmac_f32_16x16x64_bf16 v[8:11], v[52:55], a[216:223], v1
    ds_read_b128 a[216:219], v4 offset:10240
    v_smfmac_f32_16x16x64_bf16 v[16:19], v[52:55], v[72:79], v1
    ds_read_b128 a[220:223], v4 offset:11264
    v_smfmac_f32_16x16x64_bf16 v[12:15], v[52:55], a[224:231], v1
    ds_read_b128 a[224:227], v4 offset:12288
    v_smfmac_f32_16x16x64_bf16 v[20:23], v[52:55], v[80:87], v1
    ds_read_b128 v[52:55], v0 offset:3072
    ds_read_b128 a[228:231], v4 offset:13312
    s_waitcnt lgkmcnt(6)
    v_smfmac_f32_16x16x64_bf16 v[8:11], v[24:27], a[232:239], v1
    ds_read_b128 a[232:235], v4 offset:14336
    buffer_store_dwordx4 v[28:31], v0, s[4:7], s25 offen sc1
    v_smfmac_f32_16x16x64_bf16 v[16:19], v[24:27], v[88:95], v1
    ds_read_b128 a[236:239], v4 offset:15360
    v_smfmac_f32_16x16x64_bf16 v[12:15], v[24:27], a[240:247], v1
    ds_read_b128 a[240:243], v4 offset:16384
    v_smfmac_f32_16x16x64_bf16 v[20:23], v[24:27], v[96:103], v1
    ds_read_b128 v[24:27], v0 offset:4096
    ds_read_b128 a[244:247], v4 offset:17408
    s_waitcnt lgkmcnt(8)
    v_smfmac_f32_16x16x64_bf16 v[8:11], v[48:51], a[248:255], v1
    ds_read_b128 a[248:251], v4 offset:18432
    v_smfmac_f32_16x16x64_bf16 v[16:19], v[48:51], v[104:111], v1
    ds_read_b128 a[252:255], v4 offset:19456
    v_smfmac_f32_16x16x64_bf16 v[12:15], v[48:51], a[216:223], v1
    ds_read_b128 a[216:219], v4 offset:20480
    v_smfmac_f32_16x16x64_bf16 v[20:23], v[48:51], v[112:119], v1
    ds_read_b128 v[48:51], v0 offset:5120
    ds_read_b128 a[220:223], v4 offset:21504
    s_waitcnt lgkmcnt(8)
    v_smfmac_f32_16x16x64_bf16 v[8:11], v[52:55], a[224:231], v1
    ds_read_b128 a[224:227], v4 offset:22528
    v_smfmac_f32_16x16x64_bf16 v[16:19], v[52:55], v[120:127], v1
    ds_read_b128 a[228:231], v4 offset:23552
    v_smfmac_f32_16x16x64_bf16 v[12:15], v[52:55], a[232:239], v1
    ds_read_b128 a[232:235], v4 offset:24576
    v_smfmac_f32_16x16x64_bf16 v[20:23], v[52:55], v[128:135], v1
    ds_read_b128 v[52:55], v0 offset:6144
    ds_read_b128 a[236:239], v4 offset:25600
    s_waitcnt lgkmcnt(8)
    v_smfmac_f32_16x16x64_bf16 v[8:11], v[24:27], a[240:247], v1
    ds_read_b128 a[240:243], v4 offset:26624
    v_smfmac_f32_16x16x64_bf16 v[16:19], v[24:27], v[136:143], v1
    ds_read_b128 a[244:247], v4 offset:27648
    buffer_load_dwordx4 v[40:43], v5, s[4:7], s23 offen sc1
    v_smfmac_f32_16x16x64_bf16 v[12:15], v[24:27], a[248:255], v1
    ds_read_b128 a[248:251], v4 offset:28672
    v_smfmac_f32_16x16x64_bf16 v[20:23], v[24:27], v[144:151], v1
    ds_read_b128 v[24:27], v0 offset:7168
    ds_read_b128 a[252:255], v4 offset:29696
    s_waitcnt lgkmcnt(8)
    v_smfmac_f32_16x16x64_bf16 v[8:11], v[48:51], a[216:223], v1
    ds_read_b128 a[216:219], v4 offset:30720
    v_smfmac_f32_16x16x64_bf16 v[16:19], v[48:51], v[152:159], v1
    ds_read_b128 a[220:223], v4 offset:31744
    buffer_load_dwordx4 v[44:47], v5, s[4:7], s23 offen offset:128 sc1
    v_smfmac_f32_16x16x64_bf16 v[12:15], v[48:51], a[224:231], v1
    ds_read_b128 a[224:227], v4 offset:32768
    v_smfmac_f32_16x16x64_bf16 v[20:23], v[48:51], v[160:167], v1
    ds_read_b128 v[48:51], v0 offset:8192
    ds_read_b128 a[228:231], v4 offset:33792
    s_waitcnt lgkmcnt(8)
    v_smfmac_f32_16x16x64_bf16 v[8:11], v[52:55], a[232:239], v1
    ds_read_b128 a[232:235], v4 offset:34816
    v_smfmac_f32_16x16x64_bf16 v[16:19], v[52:55], v[168:175], v1
    ds_read_b128 a[236:239], v4 offset:35840
    v_smfmac_f32_16x16x64_bf16 v[12:15], v[52:55], a[240:247], v1
    ds_read_b128 a[240:243], v4 offset:0
    v_smfmac_f32_16x16x64_bf16 v[20:23], v[52:55], v[176:183], v1
    ds_read_b128 v[52:55], v0 offset:9216
    ds_read_b128 a[244:247], v4 offset:1024
    s_waitcnt lgkmcnt(8)
    v_smfmac_f32_16x16x64_bf16 v[8:11], v[24:27], a[248:255], v1
    ds_read_b128 a[248:251], v4 offset:2048
    v_smfmac_f32_16x16x64_bf16 v[16:19], v[24:27], v[184:191], v1
    ds_read_b128 a[252:255], v4 offset:3072
    v_smfmac_f32_16x16x64_bf16 v[12:15], v[24:27], a[216:223], v1
    ds_read_b128 a[216:219], v4 offset:4096
    v_smfmac_f32_16x16x64_bf16 v[20:23], v[24:27], v[192:199], v1
    ds_read_b128 a[220:223], v4 offset:5120
    s_waitcnt lgkmcnt(7)
    v_smfmac_f32_16x16x64_bf16 v[8:11], v[48:51], a[224:231], v1
    ds_read_b128 a[224:227], v4 offset:6144
    v_smfmac_f32_16x16x64_bf16 v[16:19], v[48:51], v[200:207], v1
    ds_read_b128 a[228:231], v4 offset:7168
    v_smfmac_f32_16x16x64_bf16 v[12:15], v[48:51], a[232:239], v1
    ds_read_b128 a[232:235], v4 offset:8192
    v_smfmac_f32_16x16x64_bf16 v[20:23], v[48:51], v[208:215], v1
    ds_read_b128 a[236:239], v4 offset:9216
    s_waitcnt lgkmcnt(9)
    v_smfmac_f32_16x16x64_bf16 v[8:11], v[52:55], v[56:63], v1
    v_mov_b64 v[24:25], 0
    v_smfmac_f32_16x16x64_bf16 v[16:19], v[52:55], v[216:223], v1
    v_mov_b64 v[26:27], 0
    v_smfmac_f32_16x16x64_bf16 v[12:15], v[52:55], v[64:71], v1
    v_mov_b64 v[28:29], 0
    v_smfmac_f32_16x16x64_bf16 v[20:23], v[52:55], v[224:231], v1
    v_mov_b64 v[30:31], 0
    s_waitcnt lgkmcnt(6)
    v_smfmac_f32_16x16x64_bf16 v[24:27], v[48:51], a[240:247], v1
    v_smfmac_f32_16x16x64_bf16 v[28:31], v[48:51], a[248:255], v1
    ds_read_b128 v[48:51], v0 offset:0
    v_add_f32 v8, v8, v10
    v_add_f32 v9, v9, v11
    v_add_f32 v16, v16, v18
    v_add_f32 v17, v17, v19
    v_cvt_pk_bf16_f32 v9, v8, v9
    v_cvt_pk_bf16_f32 v8, v16, v17
    v_add_f32 v12, v12, v14
    v_add_f32 v13, v13, v15
    v_mfma_f32_16x16x16_bf16 v[16:19], v[8:9], v[2:3], 0
    v_add_f32 v20, v20, v22
    v_add_f32 v21, v21, v23
    v_cvt_pk_bf16_f32 v11, v12, v13
    v_cvt_pk_bf16_f32 v10, v20, v21
    s_nop 1
    v_mfma_f32_16x16x16_bf16 v[20:23], v[10:11], v[2:3], 0
    s_waitcnt lgkmcnt(3)
    v_smfmac_f32_16x16x64_bf16 v[24:27], v[52:55], a[216:223], v1
    v_smfmac_f32_16x16x64_bf16 v[28:31], v[52:55], a[224:231], v1
    ds_read_b128 v[52:55], v0 offset:1024
    v_cvt_pk_bf16_f32 v8, v16, v17
    v_cvt_pk_bf16_f32 v9, v18, v19
    s_waitcnt vmcnt(3)
    s_nop 0
    v_cvt_pk_bf16_f32 v10, v20, v21
    v_cvt_pk_bf16_f32 v11, v22, v23
    buffer_load_dwordx4 a[240:243], v0, s[4:7], s58 offen offset:2048 sc1
    buffer_load_dwordx4 a[244:247], v0, s[4:7], s58 offen offset:3072 sc1
    v_mfma_f32_16x16x32_bf16 v[12:15], v[32:35], v[8:11], 0
    v_mfma_f32_16x16x32_bf16 v[16:19], v[36:39], v[8:11], 0
    v_add_u32 v32, s29, v0
    v_add_u32 v33, s34, v0
    v_mfma_f32_16x16x32_bf16 v[20:23], v[8:11], v[8:11], 0
    s_mov_b64 vcc, s[40:41]
    s_waitcnt lgkmcnt(1)
    v_smfmac_f32_16x16x64_bf16 v[24:27], v[48:51], a[232:239], v1
    v_smfmac_f32_16x16x64_bf16 v[28:31], v[48:51], v[232:239], v1
    ds_read_b128 v[48:51], v0 offset:2048
    v_cndmask_b32_dpp v12, v16, v12, vcc quad_perm:[2,3,0,1] row_mask:0xf bank_mask:0xf
    v_cndmask_b32_dpp v13, v17, v13, vcc quad_perm:[2,3,0,1] row_mask:0xf bank_mask:0xf
    v_cndmask_b32_dpp v14, v18, v14, vcc quad_perm:[2,3,0,1] row_mask:0xf bank_mask:0xf
    v_cndmask_b32_dpp v15, v19, v15, vcc quad_perm:[2,3,0,1] row_mask:0xf bank_mask:0xf
    ds_write_b128 v32, v[12:15]
    v_cndmask_b32_dpp v20, v21, v20, vcc quad_perm:[2,3,0,1] row_mask:0xf bank_mask:0xf
    ds_write_b32 v33, v20
    s_waitcnt lgkmcnt(3)
    v_smfmac_f32_16x16x64_bf16 v[24:27], v[52:55], v[240:247], v1
    v_smfmac_f32_16x16x64_bf16 v[28:31], v[52:55], v[248:255], v1
    ds_read_b128 v[52:55], v0 offset:3072
    buffer_load_dwordx4 a[248:251], v0, s[4:7], s59 offen offset:0 sc1
    s_waitcnt lgkmcnt(3)
    v_smfmac_f32_16x16x64_bf16 v[24:27], v[48:51], a[0:7], v1
    v_smfmac_f32_16x16x64_bf16 v[28:31], v[48:51], a[8:15], v1
    ds_read_b128 v[48:51], v0 offset:4096
    s_waitcnt lgkmcnt(1)
    s_barrier
    ds_read_b128 v[12:15], v0 offset:10240
    ds_read_b128 v[16:19], v0 offset:11264
    ds_read_b128 v[20:23], v0 offset:12288
    ds_read_b128 v[32:35], v0 offset:13312
    ds_read_b128 v[36:39], v0 offset:14336
    v_smfmac_f32_16x16x64_bf16 v[24:27], v[52:55], a[16:23], v1
    v_smfmac_f32_16x16x64_bf16 v[28:31], v[52:55], a[24:31], v1
    ds_read_b128 v[52:55], v0 offset:5120
    s_waitcnt lgkmcnt(6)
    v_smfmac_f32_16x16x64_bf16 v[24:27], v[48:51], a[32:39], v1
    v_smfmac_f32_16x16x64_bf16 v[28:31], v[48:51], a[40:47], v1
    ds_read_b128 v[48:51], v0 offset:6144
    buffer_load_dwordx4 a[252:255], v0, s[4:7], s59 offen offset:1024 sc1
    buffer_load_dwordx4 a[216:219], v0, s[4:7], s59 offen offset:2048 sc1
    s_waitcnt lgkmcnt(3)
    v_add_f32 v12, v12, v16
    v_add_f32 v13, v13, v17
    v_pk_add_f32 v[14:15], v[14:15], v[18:19]
    v_pk_add_f32 v[20:21], v[20:21], v[32:33]
    v_pk_add_f32 v[22:23], v[22:23], v[34:35]
    s_waitcnt lgkmcnt(2)
    v_pk_add_f32 v[36:37], v[36:37], v[38:39]
    v_pk_add_f32 v[12:13], v[12:13], v[20:21]
    v_pk_add_f32 v[14:15], v[14:15], v[22:23]
    v_add_f32 v36, v36, v37
    v_max3_f32 v16, v12, v13, v14
    v_max3_f32 v16, v16, v15, v36
    s_waitcnt lgkmcnt(1)
    v_smfmac_f32_16x16x64_bf16 v[24:27], v[52:55], a[48:55], v1
    buffer_load_dwordx4 a[220:223], v0, s[4:7], s59 offen offset:3072 sc1
    v_max_f32_dpp v16, v16, v16 quad_perm:[2,3,0,1] row_mask:0xf bank_mask:0xf
    v_mov_b32 v17, v16
    v_smfmac_f32_16x16x64_bf16 v[28:31], v[52:55], a[56:63], v1
    ds_read_b128 v[52:55], v0 offset:7168
    v_permlane16_swap_b32 v16, v17
    v_max_f32 v16, v16, v17
    v_mov_b32 v17, v16
    s_waitcnt lgkmcnt(1)
    v_smfmac_f32_16x16x64_bf16 v[24:27], v[48:51], a[64:71], v1
    buffer_load_dwordx4 a[224:227], v0, s[4:7], s60 offen offset:0 sc1
    v_permlane32_swap_b32 v16, v17
    v_max_f32 v16, v16, v17
    v_smfmac_f32_16x16x64_bf16 v[28:31], v[48:51], a[72:79], v1
    v_mul_f32 v16, s46, v16
    v_fma_f32 v12, v12, s46, -v16
    s_waitcnt lgkmcnt(0)
    v_smfmac_f32_16x16x64_bf16 v[24:27], v[52:55], a[80:87], v1
    v_fma_f32 v13, v13, s46, -v16
    v_smfmac_f32_16x16x64_bf16 v[28:31], v[52:55], a[88:95], v1
    v_fma_f32 v14, v14, s46, -v16
    v_fma_f32 v15, v15, s46, -v16
    v_fma_f32 v36, v36, s46, -v16
    v_exp_f32 v12, v12
    v_exp_f32 v13, v13
    v_exp_f32 v14, v14
    v_exp_f32 v15, v15
    v_exp_f32 v36, v36
    v_mov_b64 v[48:49], s[62:63]
    v_cvt_pk_bf16_f32 v32, v12, v13
    v_cvt_pk_bf16_f32 v33, v14, v15
    v_mov_b32_dpp v37, v36 quad_perm:[2,3,0,1] row_mask:0xf bank_mask:0xf
    v_mov_b64 v[50:51], s[62:63]
    v_mov_b32_dpp v34, v32 quad_perm:[2,3,0,1] row_mask:0xf bank_mask:0xf
    v_mov_b32_dpp v35, v33 quad_perm:[2,3,0,1] row_mask:0xf bank_mask:0xf
    v_pk_add_f32 v[24:25], v[24:25], v[26:27]
    v_pk_add_f32 v[28:29], v[28:29], v[30:31]
    v_mfma_f32_16x16x32_bf16 v[20:23], v[48:51], v[32:35], 0
    v_cvt_pk_bf16_f32 v52, v36, v37
    v_mov_b32 v53, 0
    s_waitcnt vmcnt(7)
    v_mfma_f32_16x16x32_bf16 v[12:15], v[40:43], v[32:35], 0
    v_cvt_pk_bf16_f32 v24, v24, v25
    v_cvt_pk_bf16_f32 v25, v28, v29
    v_mfma_f32_16x16x32_bf16 v[16:19], v[44:47], v[32:35], 0
    v_mov_b32 v54, 0
    v_mov_b32 v55, v52
    v_mfma_f32_16x16x16_bf16 v[20:23], v[48:49], v[52:53], v[20:23]
    ds_write2_b32 v7, v24, v25 offset0:0 offset1:32
    buffer_load_dwordx4 a[228:231], v0, s[4:7], s60 offen offset:1024 sc1
    v_mfma_f32_16x16x16_bf16 v[12:15], v[24:25], v[52:53], v[12:15]
    buffer_load_dwordx4 a[232:235], v0, s[4:7], s60 offen offset:2048 sc1
    v_mov_b64 v[26:27], 0
    v_mfma_f32_16x16x16_bf16 v[16:19], v[24:25], v[54:55], v[16:19]
    buffer_load_dwordx4 a[236:239], v0, s[4:7], s60 offen offset:3072 sc1
    v_mov_b64 v[28:29], 0
    v_rcp_f32 v20, v20
    v_mov_b64 v[30:31], 0
    v_mov_b32 v21, v20
    v_mov_b64 v[32:33], 0
    s_mov_b64 exec, s[40:41]
    v_pk_mul_f32 v[12:13], v[12:13], v[20:21]
    v_pk_mul_f32 v[14:15], v[14:15], v[20:21]
    v_cvt_pk_bf16_f32 v8, v12, v13
    v_cvt_pk_bf16_f32 v9, v14, v15
    v_pk_mul_f32 v[16:17], v[16:17], v[20:21]
    v_pk_mul_f32 v[18:19], v[18:19], v[20:21]
    v_cvt_pk_bf16_f32 v10, v16, v17
    v_cvt_pk_bf16_f32 v11, v18, v19
    s_mov_b64 exec, -1
    ds_write_b128 v6, v[8:11]
    v_mov_b64 v[12:13], 0
    v_mov_b64 v[14:15], 0
    v_mov_b64 v[16:17], 0
    v_mov_b64 v[18:19], 0
    v_mov_b64 v[20:21], 0
    v_mov_b64 v[22:23], 0
    v_mov_b64 v[40:41], 0
    v_mov_b64 v[42:43], 0
    v_mov_b64 v[44:45], 0
    v_mov_b64 v[46:47], 0
    v_mov_b64 v[8:9], 0
    v_mov_b64 v[10:11], 0
    s_waitcnt lgkmcnt(0)
    s_barrier
    ds_read_b128 v[48:51], v0 offset:0
    ds_read_b128 v[52:55], v0 offset:1024
    s_cmp_eq_u32 s16, 63
    s_cbranch_scc1 RS_fin
    v_mov_b64 v[24:25], 0
    v_mov_b64 v[34:35], 0
    v_mov_b64 v[36:37], 0
    v_mov_b64 v[38:39], 0
    s_waitcnt vmcnt(6)
    s_waitcnt lgkmcnt(1)
    v_smfmac_f32_16x16x64_bf16 v[8:11], v[48:51], a[240:247], v1
    v_smfmac_f32_16x16x64_bf16 v[12:15], v[48:51], a[248:255], v1
    buffer_load_dwordx4 a[240:243], v0, s[4:7], s57 offen offset:2048 sc1
    s_waitcnt vmcnt(3)
    v_smfmac_f32_16x16x64_bf16 v[16:19], v[48:51], a[216:223], v1
    v_smfmac_f32_16x16x64_bf16 v[20:23], v[48:51], a[224:231], v1
    buffer_load_dwordx4 a[244:247], v0, s[4:7], s57 offen offset:3072 sc1
    s_waitcnt lgkmcnt(0)
RS_nf:
    v_smfmac_f32_16x16x64_bf16 v[8:11], v[52:55], a[136:143], v1
    v_smfmac_f32_16x16x64_bf16 v[12:15], v[52:55], a[144:151], v1
    buffer_load_dwordx4 a[248:251], v0, s[4:7], s58 offen offset:0 sc1
    v_smfmac_f32_16x16x64_bf16 v[16:19], v[52:55], a[152:159], v1
    v_smfmac_f32_16x16x64_bf16 v[20:23], v[52:55], a[160:167], v1
    buffer_load_dwordx4 a[252:255], v0, s[4:7], s58 offen offset:1024 sc1
    s_waitcnt vmcnt(4)
    v_smfmac_f32_16x16x64_bf16 v[40:43], v[48:51], a[232:239], v1
    v_smfmac_f32_16x16x64_bf16 v[44:47], v[48:51], a[128:135], v1
    buffer_load_dwordx4 a[216:219], v0, s[4:7], s56 offen offset:0 sc1
    v_smfmac_f32_16x16x64_bf16 v[24:27], v[48:51], a[96:103], v1
    v_add_f32 v8, v8, v10
    v_add_f32 v9, v9, v11
    v_smfmac_f32_16x16x64_bf16 v[28:31], v[48:51], a[104:111], v1
    v_cvt_pk_bf16_f32 v8, v8, v9
    v_bfi_b32 v8, 1, s16, v8
    v_smfmac_f32_16x16x64_bf16 v[32:35], v[48:51], a[112:119], v1
    v_add_f32 v12, v12, v14
    v_add_f32 v13, v13, v15
    v_smfmac_f32_16x16x64_bf16 v[36:39], v[48:51], a[120:127], v1
    v_cvt_pk_bf16_f32 v9, v12, v13
    v_add_f32 v16, v16, v18
    v_smfmac_f32_16x16x64_bf16 v[24:27], v[52:55], a[168:175], v1
    v_add_f32 v17, v17, v19
    v_cvt_pk_bf16_f32 v10, v16, v17
    v_smfmac_f32_16x16x64_bf16 v[28:31], v[52:55], a[176:183], v1
    v_add_f32 v20, v20, v22
    v_add_f32 v21, v21, v23
    v_smfmac_f32_16x16x64_bf16 v[32:35], v[52:55], a[184:191], v1
    v_cvt_pk_bf16_f32 v11, v20, v21
    buffer_store_dwordx4 v[8:11], v0, s[4:7], s17 offen sc1
    v_smfmac_f32_16x16x64_bf16 v[36:39], v[52:55], a[192:199], v1
    v_lshrrev_b32 v12, 1, v0
    v_add_f32 v24, v24, v26
    v_smfmac_f32_16x16x64_bf16 v[40:43], v[52:55], a[200:207], v1
    v_add_f32 v25, v25, v27
    v_smfmac_f32_16x16x64_bf16 v[44:47], v[52:55], a[208:215], v1
    v_cvt_pk_bf16_f32 v24, v24, v25
    v_bfi_b32 v24, 1, s16, v24
    v_add_f32 v28, v28, v30
    v_add_f32 v29, v29, v31
    v_cvt_pk_bf16_f32 v25, v28, v29
    v_pk_add_f32 v[32:33], v[32:33], v[34:35]
    v_cvt_pk_bf16_f32 v26, v32, v33
    v_pk_add_f32 v[36:37], v[36:37], v[38:39]
    v_cvt_pk_bf16_f32 v27, v36, v37
    buffer_store_dwordx4 v[24:27], v0, s[4:7], s17 offen offset:1024 sc1
    v_pk_add_f32 v[40:41], v[40:41], v[42:43]
    v_cvt_pk_bf16_f32 v40, v40, v41
    v_bfi_b32 v40, 1, s16, v40
    v_pk_add_f32 v[44:45], v[44:45], v[46:47]
    v_cvt_pk_bf16_f32 v41, v44, v45
    buffer_store_dwordx2 v[40:41], v12, s[4:7], s17 offen offset:2048 sc1
    v_add_u32 v53, s39, v0
    v_and_b32 v52, 0xf0, v0
    ds_read_b128 v[28:31], v53
    ds_read_b128 v[48:51], v52 offset:15360
    v_lshrrev_b32 v44, 7, v0
    v_mul_u32_u24 v44, 10240, v44
    v_add_u32 v44, v44, v0
    s_add_u32 s32, s35, s19
    s_add_u32 s33, s35, s20
    s_add_u32 s16, s16, 1
    s_cmp_lt_u32 s16, 36
    s_cselect_b32 s38, s38, 0
    s_xor_b32 s37, s37, s38
    s_cmp_eq_u32 s16, s98
    s_cselect_b32 s30, 327680, 0
    s_add_u32 s37, s37, s30
    s_mov_b32 s20, s19
    s_add_u32 s19, s19, 10240
    s_cmp_eq_u32 s19, 30720
    s_cselect_b32 s19, 0, s19
    s_add_u32 s22, s22, 262144
    s_add_u32 s23, s23, 262144
    s_mov_b32 s25, s24
    s_add_u32 s24, s24, 131072
    s_mov_b32 s28, 0
    s_waitcnt lgkmcnt(0)
    s_load_dword s48, s[4:5], s37 glc
    s_load_dword s49, s[4:5], s37 offset:256 glc
    v_min_u32 v28, -2, v28
    v_min_u32 v29, -2, v29
    v_min_u32 v30, -2, v30
    v_min_u32 v31, -2, v31
    s_cmp_ge_u32 s27, 80
    s_cbranch_scc1 RS_nr
    s_waitcnt vmcnt(0)
    buffer_load_dwordx4 v[8:11], v44, s[4:7], s8 offen sc1
    buffer_load_dwordx4 v[16:19], v44, s[4:7], s9 offen sc1
    buffer_load_dwordx4 v[20:23], v44, s[4:7], s10 offen sc1
    buffer_load_dwordx4 v[32:35], v44, s[4:7], s11 offen sc1
    v_and_b32 v45, 0x40, v0
    v_lshlrev_b32 v45, 2, v45
    v_and_or_b32 v45, v0, 32, v45
    v_lshrrev_b32 v46, 4, v0
    v_and_or_b32 v45, v46, 16, v45
    v_and_or_b32 v45, v12, 8, v45
    v_add_u32 v45, s18, v45
    s_branch RS_p1c
RS_p1:
    s_cmp_lt_u32 s28, 4
    s_cbranch_scc1 RS_p1n
    s_sleep 4
RS_p1n:
    buffer_load_dwordx4 v[8:11], v44, s[4:7], s8 offen sc1
    buffer_load_dwordx4 v[16:19], v44, s[4:7], s9 offen sc1
    buffer_load_dwordx4 v[20:23], v44, s[4:7], s10 offen sc1
    buffer_load_dwordx4 v[32:35], v44, s[4:7], s11 offen sc1
    s_add_u32 s28, s28, 1
    s_cmp_gt_u32 s28, 131072
    s_cbranch_scc1 L_exit
RS_p1c:
    s_waitcnt vmcnt(3)
    v_mfma_f32_16x16x32_bf16 v[36:39], v[48:51], v[8:11], 0
    s_waitcnt vmcnt(2)
    v_mfma_f32_16x16x32_bf16 v[36:39], v[48:51], v[16:19], v[36:39]
    v_bitop3_b32 v46, v8, v16, s16 bitop3:0x42
    s_waitcnt vmcnt(1)
    v_mfma_f32_16x16x32_bf16 v[36:39], v[48:51], v[20:23], v[36:39]
    s_waitcnt vmcnt(0)
    v_mfma_f32_16x16x32_bf16 v[36:39], v[48:51], v[32:35], v[36:39]
    v_bitop3_b32 v47, v20, v32, s16 bitop3:0x42
    v_bitop3_b32 v46, v46, v47, 1 bitop3:0x80
    v_cmp_eq_u32 vcc, 0, v46
    s_cbranch_vccnz RS_p1
RS_p1ok:
    v_mov_b64 v[46:47], -1
    s_nop 2
    v_add_f32_dpp v36, v36, v36 row_ror:8 row_mask:0xf bank_mask:0xf
    v_add_f32_dpp v37, v37, v37 row_ror:8 row_mask:0xf bank_mask:0xf
    v_add_f32_dpp v38, v38, v38 row_ror:8 row_mask:0xf bank_mask:0xf
    v_add_f32_dpp v39, v39, v39 row_ror:8 row_mask:0xf bank_mask:0xf
    s_mov_b64 exec, s[44:45]
    v_cvt_pk_bf16_f32 v36, v36, v37
    v_cvt_pk_bf16_f32 v37, v38, v39
    v_min_u32 v36, -2, v36
    buffer_store_dwordx2 v[36:37], v45, s[4:7], s32 offen sc1
    buffer_store_dwordx2 v[46:47], v45, s[4:7], s33 offen sc1
    s_mov_b64 exec, -1
    buffer_load_dwordx4 a[220:223], v0, s[4:7], s56 offen offset:1024 sc1
    buffer_load_dwordx4 a[224:227], v0, s[4:7], s56 offen offset:2048 sc1
    buffer_load_dwordx4 a[228:231], v0, s[4:7], s56 offen offset:3072 sc1
    buffer_load_dwordx4 a[232:235], v0, s[4:7], s57 offen offset:0 sc1
    buffer_load_dwordx4 a[236:239], v0, s[4:7], s57 offen offset:1024 sc1
    s_branch RS_g2
RS_kvw:
    s_mov_b32 s28, 0
RS_kvl:
    s_load_dword s48, s[4:5], s37 glc
    s_load_dword s49, s[4:5], s37 offset:256 glc
RS_kvc:
    s_waitcnt lgkmcnt(0)
    s_min_u32 s48, s48, s49
    s_cmp_gt_u32 s48, s16
    s_cbranch_scc1 RS_step
    s_add_u32 s28, s28, 1
    s_cmp_gt_u32 s28, 131072
    s_cbranch_scc1 L_exit
    s_sleep 2
    s_branch RS_kvl
RS_nr:
    s_waitcnt vmcnt(0)
    buffer_load_dwordx4 a[220:223], v0, s[4:7], s56 offen offset:1024 sc1
    buffer_load_dwordx4 a[224:227], v0, s[4:7], s56 offen offset:2048 sc1
    buffer_load_dwordx4 a[228:231], v0, s[4:7], s56 offen offset:3072 sc1
    buffer_load_dwordx4 a[232:235], v0, s[4:7], s57 offen offset:0 sc1
    buffer_load_dwordx4 a[236:239], v0, s[4:7], s57 offen offset:1024 sc1
    s_branch RS_g2
RS_fin:
    v_add_u32 v8, s39, v0
    ds_read_b128 v[28:31], v8
    s_waitcnt lgkmcnt(0)
    v_min_u32 v28, -2, v28
    v_min_u32 v29, -2, v29
    v_min_u32 v30, -2, v30
    v_min_u32 v31, -2, v31
    buffer_store_dwordx4 v[28:31], v0, s[4:7], s24 offen sc1
    s_waitcnt vmcnt(0) lgkmcnt(0)
    s_branch L_next
    s_branch L_next
RQK:
    v_mbcnt_lo_u32_b32 v12, -1, 0
    v_mbcnt_hi_u32_b32 v12, -1, v12
    v_lshlrev_b32 v0, 4, v12
    v_lshlrev_b32 v8, 3, v12
    v_lshlrev_b32 v5, 2, v12
    s_mov_b32 s44, 0
    s_mov_b32 s45, -1
    s_barrier
    s_load_dwordx2 s[8:9], s[0:1], 16
    s_load_dwordx2 s[48:49], s[0:1], 24
    s_mov_b32 s10, 5242880
    s_mov_b32 s11, 0x20000
    s_and_b32 s32, s13, 15
    s_lshl_b32 s32, s32, 9
    s_waitcnt lgkmcnt(0)
    s_cmp_lt_u32 s13, 16
    s_cselect_b32 s8, s8, s48
    s_cselect_b32 s9, s9, s49
    v_lshrrev_b32 v13, 3, v12
    v_and_b32 v14, 7, v12
    s_mov_b32 s30, 8192
    v_mul_lo_u32 v13, v13, s30
    v_lshl_add_u32 v13, v14, 4, v13
    s_mul_i32 s30, s12, 128
    s_add_u32 s30, s30, s32
    v_add_u32 v13, s30, v13
    v_lshrrev_b32 v14, 5, v12
    v_bfe_u32 v15, v12, 2, 2
    v_lshl_add_u32 v15, v14, 3, v15
    v_mul_u32_u24 v15, 128, v15
    v_bfe_u32 v16, v12, 4, 1
    v_lshl_add_u32 v15, v16, 5, v15
    v_and_b32 v16, 1, v12
    v_lshl_add_u32 v15, v16, 4, v15
    v_bfe_u32 v16, v12, 1, 1
    v_lshl_add_u32 v15, v16, 3, v15
    s_mul_i32 s33, s12, 40960
    v_add_u32 v15, s33, v15
    s_add_u32 m0, s33, 0
    s_mov_b32 s30, 0
    buffer_load_dwordx4 v13, s[8:11], s30 offen lds
    s_add_u32 m0, s33, 1024
    s_mov_b32 s30, 65536
    buffer_load_dwordx4 v13, s[8:11], s30 offen lds
    s_add_u32 m0, s33, 2048
    s_mov_b32 s30, 131072
    buffer_load_dwordx4 v13, s[8:11], s30 offen lds
    s_add_u32 m0, s33, 3072
    s_mov_b32 s30, 196608
    buffer_load_dwordx4 v13, s[8:11], s30 offen lds
    s_add_u32 m0, s33, 4096
    s_mov_b32 s30, 262144
    buffer_load_dwordx4 v13, s[8:11], s30 offen lds
    s_add_u32 m0, s33, 5120
    s_mov_b32 s30, 327680
    buffer_load_dwordx4 v13, s[8:11], s30 offen lds
    s_add_u32 m0, s33, 6144
    s_mov_b32 s30, 393216
    buffer_load_dwordx4 v13, s[8:11], s30 offen lds
    s_add_u32 m0, s33, 7168
    s_mov_b32 s30, 458752
    buffer_load_dwordx4 v13, s[8:11], s30 offen lds
    s_add_u32 m0, s33, 8192
    s_mov_b32 s30, 524288
    buffer_load_dwordx4 v13, s[8:11], s30 offen lds
    s_add_u32 m0, s33, 9216
    s_mov_b32 s30, 589824
    buffer_load_dwordx4 v13, s[8:11], s30 offen lds
    s_add_u32 m0, s33, 10240
    s_mov_b32 s30, 655360
    buffer_load_dwordx4 v13, s[8:11], s30 offen lds
    s_add_u32 m0, s33, 11264
    s_mov_b32 s30, 720896
    buffer_load_dwordx4 v13, s[8:11], s30 offen lds
    s_add_u32 m0, s33, 12288
    s_mov_b32 s30, 786432
    buffer_load_dwordx4 v13, s[8:11], s30 offen lds
    s_add_u32 m0, s33, 13312
    s_mov_b32 s30, 851968
    buffer_load_dwordx4 v13, s[8:11], s30 offen lds
    s_add_u32 m0, s33, 14336
    s_mov_b32 s30, 917504
    buffer_load_dwordx4 v13, s[8:11], s30 offen lds
    s_add_u32 m0, s33, 15360
    s_mov_b32 s30, 983040
    buffer_load_dwordx4 v13, s[8:11], s30 offen lds
    s_add_u32 m0, s33, 16384
    s_mov_b32 s30, 1048576
    buffer_load_dwordx4 v13, s[8:11], s30 offen lds
    s_add_u32 m0, s33, 17408
    s_mov_b32 s30, 1114112
    buffer_load_dwordx4 v13, s[8:11], s30 offen lds
    s_add_u32 m0, s33, 18432
    s_mov_b32 s30, 1179648
    buffer_load_dwordx4 v13, s[8:11], s30 offen lds
    s_add_u32 m0, s33, 19456
    s_mov_b32 s30, 1245184
    buffer_load_dwordx4 v13, s[8:11], s30 offen lds
    s_add_u32 m0, s33, 20480
    s_mov_b32 s30, 1310720
    buffer_load_dwordx4 v13, s[8:11], s30 offen lds
    s_add_u32 m0, s33, 21504
    s_mov_b32 s30, 1376256
    buffer_load_dwordx4 v13, s[8:11], s30 offen lds
    s_add_u32 m0, s33, 22528
    s_mov_b32 s30, 1441792
    buffer_load_dwordx4 v13, s[8:11], s30 offen lds
    s_add_u32 m0, s33, 23552
    s_mov_b32 s30, 1507328
    buffer_load_dwordx4 v13, s[8:11], s30 offen lds
    s_add_u32 m0, s33, 24576
    s_mov_b32 s30, 1572864
    buffer_load_dwordx4 v13, s[8:11], s30 offen lds
    s_add_u32 m0, s33, 25600
    s_mov_b32 s30, 1638400
    buffer_load_dwordx4 v13, s[8:11], s30 offen lds
    s_add_u32 m0, s33, 26624
    s_mov_b32 s30, 1703936
    buffer_load_dwordx4 v13, s[8:11], s30 offen lds
    s_add_u32 m0, s33, 27648
    s_mov_b32 s30, 1769472
    buffer_load_dwordx4 v13, s[8:11], s30 offen lds
    s_add_u32 m0, s33, 28672
    s_mov_b32 s30, 1835008
    buffer_load_dwordx4 v13, s[8:11], s30 offen lds
    s_add_u32 m0, s33, 29696
    s_mov_b32 s30, 1900544
    buffer_load_dwordx4 v13, s[8:11], s30 offen lds
    s_add_u32 m0, s33, 30720
    s_mov_b32 s30, 1966080
    buffer_load_dwordx4 v13, s[8:11], s30 offen lds
    s_add_u32 m0, s33, 31744
    s_mov_b32 s30, 2031616
    buffer_load_dwordx4 v13, s[8:11], s30 offen lds
    s_add_u32 m0, s33, 32768
    s_mov_b32 s30, 2097152
    buffer_load_dwordx4 v13, s[8:11], s30 offen lds
    s_add_u32 m0, s33, 33792
    s_mov_b32 s30, 2162688
    buffer_load_dwordx4 v13, s[8:11], s30 offen lds
    s_add_u32 m0, s33, 34816
    s_mov_b32 s30, 2228224
    buffer_load_dwordx4 v13, s[8:11], s30 offen lds
    s_add_u32 m0, s33, 35840
    s_mov_b32 s30, 2293760
    buffer_load_dwordx4 v13, s[8:11], s30 offen lds
    s_add_u32 m0, s33, 36864
    s_mov_b32 s30, 2359296
    buffer_load_dwordx4 v13, s[8:11], s30 offen lds
    s_waitcnt vmcnt(35)
    ds_read_b64_tr_b16 v[192:193], v15 offset:0
    ds_read_b64_tr_b16 v[194:195], v15 offset:512
    ds_read_b64_tr_b16 v[196:197], v15 offset:64
    ds_read_b64_tr_b16 v[198:199], v15 offset:576
    s_add_u32 m0, s33, 37888
    s_mov_b32 s30, 2424832
    buffer_load_dwordx4 v13, s[8:11], s30 offen lds
    s_add_u32 m0, s33, 38912
    s_mov_b32 s30, 2490368
    buffer_load_dwordx4 v13, s[8:11], s30 offen lds
    s_waitcnt vmcnt(35)
    ds_read_b64_tr_b16 v[200:201], v15 offset:2048
    ds_read_b64_tr_b16 v[202:203], v15 offset:2560
    ds_read_b64_tr_b16 v[204:205], v15 offset:2112
    ds_read_b64_tr_b16 v[206:207], v15 offset:2624
    s_add_u32 m0, s33, 39936
    s_mov_b32 s30, 2555904
    buffer_load_dwordx4 v13, s[8:11], s30 offen lds
    s_waitcnt lgkmcnt(4)
    s_add_u32 m0, s33, 0
    s_mov_b32 s30, 2621440
    buffer_load_dwordx4 v13, s[8:11], s30 offen lds
    s_waitcnt vmcnt(35)
    ds_read_b64_tr_b16 v[208:209], v15 offset:4096
    ds_read_b64_tr_b16 v[210:211], v15 offset:4608
    ds_read_b64_tr_b16 v[212:213], v15 offset:4160
    ds_read_b64_tr_b16 v[214:215], v15 offset:4672
    s_add_u32 m0, s33, 1024
    s_mov_b32 s30, 2686976
    buffer_load_dwordx4 v13, s[8:11], s30 offen lds
    s_waitcnt lgkmcnt(4)
    s_add_u32 m0, s33, 2048
    s_mov_b32 s30, 2752512
    buffer_load_dwordx4 v13, s[8:11], s30 offen lds
    s_waitcnt vmcnt(35)
    ds_read_b64_tr_b16 v[216:217], v15 offset:6144
    ds_read_b64_tr_b16 v[218:219], v15 offset:6656
    ds_read_b64_tr_b16 v[220:221], v15 offset:6208
    ds_read_b64_tr_b16 v[222:223], v15 offset:6720
    s_add_u32 m0, s33, 3072
    s_mov_b32 s30, 2818048
    buffer_load_dwordx4 v13, s[8:11], s30 offen lds
    s_waitcnt lgkmcnt(4)
    s_add_u32 m0, s33, 4096
    s_mov_b32 s30, 2883584
    buffer_load_dwordx4 v13, s[8:11], s30 offen lds
    s_waitcnt vmcnt(35)
    ds_read_b64_tr_b16 v[224:225], v15 offset:8192
    ds_read_b64_tr_b16 v[226:227], v15 offset:8704
    ds_read_b64_tr_b16 v[228:229], v15 offset:8256
    ds_read_b64_tr_b16 v[230:231], v15 offset:8768
    s_add_u32 m0, s33, 5120
    s_mov_b32 s30, 2949120
    buffer_load_dwordx4 v13, s[8:11], s30 offen lds
    s_waitcnt lgkmcnt(4)
    s_add_u32 m0, s33, 6144
    s_mov_b32 s30, 3014656
    buffer_load_dwordx4 v13, s[8:11], s30 offen lds
    s_waitcnt vmcnt(35)
    ds_read_b64_tr_b16 v[232:233], v15 offset:10240
    ds_read_b64_tr_b16 v[234:235], v15 offset:10752
    ds_read_b64_tr_b16 v[236:237], v15 offset:10304
    ds_read_b64_tr_b16 v[238:239], v15 offset:10816
    s_add_u32 m0, s33, 7168
    s_mov_b32 s30, 3080192
    buffer_load_dwordx4 v13, s[8:11], s30 offen lds
    s_waitcnt lgkmcnt(4)
    s_add_u32 m0, s33, 8192
    s_mov_b32 s30, 3145728
    buffer_load_dwordx4 v13, s[8:11], s30 offen lds
    s_waitcnt vmcnt(35)
    ds_read_b64_tr_b16 v[240:241], v15 offset:12288
    ds_read_b64_tr_b16 v[242:243], v15 offset:12800
    ds_read_b64_tr_b16 v[244:245], v15 offset:12352
    ds_read_b64_tr_b16 v[246:247], v15 offset:12864
    s_add_u32 m0, s33, 9216
    s_mov_b32 s30, 3211264
    buffer_load_dwordx4 v13, s[8:11], s30 offen lds
    s_waitcnt lgkmcnt(4)
    s_add_u32 m0, s33, 10240
    s_mov_b32 s30, 3276800
    buffer_load_dwordx4 v13, s[8:11], s30 offen lds
    s_waitcnt vmcnt(35)
    ds_read_b64_tr_b16 v[248:249], v15 offset:14336
    ds_read_b64_tr_b16 v[250:251], v15 offset:14848
    ds_read_b64_tr_b16 v[252:253], v15 offset:14400
    ds_read_b64_tr_b16 v[254:255], v15 offset:14912
    s_add_u32 m0, s33, 11264
    s_mov_b32 s30, 3342336
    buffer_load_dwordx4 v13, s[8:11], s30 offen lds
    s_waitcnt lgkmcnt(4)
    s_add_u32 m0, s33, 12288
    s_mov_b32 s30, 3407872
    buffer_load_dwordx4 v13, s[8:11], s30 offen lds
    s_waitcnt vmcnt(35)
    ds_read_b64_tr_b16 a[0:1], v15 offset:16384
    ds_read_b64_tr_b16 a[2:3], v15 offset:16896
    ds_read_b64_tr_b16 a[4:5], v15 offset:16448
    ds_read_b64_tr_b16 a[6:7], v15 offset:16960
    s_add_u32 m0, s33, 13312
    s_mov_b32 s30, 3473408
    buffer_load_dwordx4 v13, s[8:11], s30 offen lds
    s_waitcnt lgkmcnt(4)
    s_add_u32 m0, s33, 14336
    s_mov_b32 s30, 3538944
    buffer_load_dwordx4 v13, s[8:11], s30 offen lds
    s_waitcnt vmcnt(35)
    ds_read_b64_tr_b16 a[8:9], v15 offset:18432
    ds_read_b64_tr_b16 a[10:11], v15 offset:18944
    ds_read_b64_tr_b16 a[12:13], v15 offset:18496
    ds_read_b64_tr_b16 a[14:15], v15 offset:19008
    s_add_u32 m0, s33, 15360
    s_mov_b32 s30, 3604480
    buffer_load_dwordx4 v13, s[8:11], s30 offen lds
    s_waitcnt lgkmcnt(4)
    s_add_u32 m0, s33, 16384
    s_mov_b32 s30, 3670016
    buffer_load_dwordx4 v13, s[8:11], s30 offen lds
    s_waitcnt vmcnt(35)
    ds_read_b64_tr_b16 a[16:17], v15 offset:20480
    ds_read_b64_tr_b16 a[18:19], v15 offset:20992
    ds_read_b64_tr_b16 a[20:21], v15 offset:20544
    ds_read_b64_tr_b16 a[22:23], v15 offset:21056
    s_add_u32 m0, s33, 17408
    s_mov_b32 s30, 3735552
    buffer_load_dwordx4 v13, s[8:11], s30 offen lds
    s_waitcnt lgkmcnt(4)
    s_add_u32 m0, s33, 18432
    s_mov_b32 s30, 3801088
    buffer_load_dwordx4 v13, s[8:11], s30 offen lds
    s_waitcnt vmcnt(35)
    ds_read_b64_tr_b16 a[24:25], v15 offset:22528
    ds_read_b64_tr_b16 a[26:27], v15 offset:23040
    ds_read_b64_tr_b16 a[28:29], v15 offset:22592
    ds_read_b64_tr_b16 a[30:31], v15 offset:23104
    s_add_u32 m0, s33, 19456
    s_mov_b32 s30, 3866624
    buffer_load_dwordx4 v13, s[8:11], s30 offen lds
    s_waitcnt lgkmcnt(4)
    s_add_u32 m0, s33, 20480
    s_mov_b32 s30, 3932160
    buffer_load_dwordx4 v13, s[8:11], s30 offen lds
    s_waitcnt vmcnt(35)
    ds_read_b64_tr_b16 a[32:33], v15 offset:24576
    ds_read_b64_tr_b16 a[34:35], v15 offset:25088
    ds_read_b64_tr_b16 a[36:37], v15 offset:24640
    ds_read_b64_tr_b16 a[38:39], v15 offset:25152
    s_add_u32 m0, s33, 21504
    s_mov_b32 s30, 3997696
    buffer_load_dwordx4 v13, s[8:11], s30 offen lds
    s_waitcnt lgkmcnt(4)
    s_add_u32 m0, s33, 22528
    s_mov_b32 s30, 4063232
    buffer_load_dwordx4 v13, s[8:11], s30 offen lds
    s_waitcnt vmcnt(35)
    ds_read_b64_tr_b16 a[40:41], v15 offset:26624
    ds_read_b64_tr_b16 a[42:43], v15 offset:27136
    ds_read_b64_tr_b16 a[44:45], v15 offset:26688
    ds_read_b64_tr_b16 a[46:47], v15 offset:27200
    s_add_u32 m0, s33, 23552
    s_mov_b32 s30, 4128768
    buffer_load_dwordx4 v13, s[8:11], s30 offen lds
    s_waitcnt lgkmcnt(4)
    s_add_u32 m0, s33, 24576
    s_mov_b32 s30, 4194304
    buffer_load_dwordx4 v13, s[8:11], s30 offen lds
    s_waitcnt vmcnt(35)
    ds_read_b64_tr_b16 a[48:49], v15 offset:28672
    ds_read_b64_tr_b16 a[50:51], v15 offset:29184
    ds_read_b64_tr_b16 a[52:53], v15 offset:28736
    ds_read_b64_tr_b16 a[54:55], v15 offset:29248
    s_add_u32 m0, s33, 25600
    s_mov_b32 s30, 4259840
    buffer_load_dwordx4 v13, s[8:11], s30 offen lds
    s_waitcnt lgkmcnt(4)
    s_add_u32 m0, s33, 26624
    s_mov_b32 s30, 4325376
    buffer_load_dwordx4 v13, s[8:11], s30 offen lds
    s_waitcnt vmcnt(35)
    ds_read_b64_tr_b16 a[56:57], v15 offset:30720
    ds_read_b64_tr_b16 a[58:59], v15 offset:31232
    ds_read_b64_tr_b16 a[60:61], v15 offset:30784
    ds_read_b64_tr_b16 a[62:63], v15 offset:31296
    s_add_u32 m0, s33, 27648
    s_mov_b32 s30, 4390912
    buffer_load_dwordx4 v13, s[8:11], s30 offen lds
    s_waitcnt lgkmcnt(4)
    s_add_u32 m0, s33, 28672
    s_mov_b32 s30, 4456448
    buffer_load_dwordx4 v13, s[8:11], s30 offen lds
    s_waitcnt vmcnt(35)
    ds_read_b64_tr_b16 a[64:65], v15 offset:32768
    ds_read_b64_tr_b16 a[66:67], v15 offset:33280
    ds_read_b64_tr_b16 a[68:69], v15 offset:32832
    ds_read_b64_tr_b16 a[70:71], v15 offset:33344
    s_add_u32 m0, s33, 29696
    s_mov_b32 s30, 4521984
    buffer_load_dwordx4 v13, s[8:11], s30 offen lds
    s_waitcnt lgkmcnt(4)
    s_add_u32 m0, s33, 30720
    s_mov_b32 s30, 4587520
    buffer_load_dwordx4 v13, s[8:11], s30 offen lds
    s_waitcnt vmcnt(35)
    ds_read_b64_tr_b16 a[72:73], v15 offset:34816
    ds_read_b64_tr_b16 a[74:75], v15 offset:35328
    ds_read_b64_tr_b16 a[76:77], v15 offset:34880
    ds_read_b64_tr_b16 a[78:79], v15 offset:35392
    s_add_u32 m0, s33, 31744
    s_mov_b32 s30, 4653056
    buffer_load_dwordx4 v13, s[8:11], s30 offen lds
    s_waitcnt lgkmcnt(4)
    s_add_u32 m0, s33, 32768
    s_mov_b32 s30, 4718592
    buffer_load_dwordx4 v13, s[8:11], s30 offen lds
    s_waitcnt vmcnt(35)
    ds_read_b64_tr_b16 a[80:81], v15 offset:36864
    ds_read_b64_tr_b16 a[82:83], v15 offset:37376
    ds_read_b64_tr_b16 a[84:85], v15 offset:36928
    ds_read_b64_tr_b16 a[86:87], v15 offset:37440
    s_add_u32 m0, s33, 33792
    s_mov_b32 s30, 4784128
    buffer_load_dwordx4 v13, s[8:11], s30 offen lds
    s_waitcnt lgkmcnt(4)
    s_add_u32 m0, s33, 34816
    s_mov_b32 s30, 4849664
    buffer_load_dwordx4 v13, s[8:11], s30 offen lds
    s_waitcnt vmcnt(35)
    ds_read_b64_tr_b16 a[88:89], v15 offset:38912
    ds_read_b64_tr_b16 a[90:91], v15 offset:39424
    ds_read_b64_tr_b16 a[92:93], v15 offset:38976
    ds_read_b64_tr_b16 a[94:95], v15 offset:39488
    s_add_u32 m0, s33, 35840
    s_mov_b32 s30, 4915200
    buffer_load_dwordx4 v13, s[8:11], s30 offen lds
    s_waitcnt lgkmcnt(4)
    s_add_u32 m0, s33, 36864
    s_mov_b32 s30, 4980736
    buffer_load_dwordx4 v13, s[8:11], s30 offen lds
    s_waitcnt vmcnt(35)
    ds_read_b64_tr_b16 a[96:97], v15 offset:0
    ds_read_b64_tr_b16 a[98:99], v15 offset:512
    ds_read_b64_tr_b16 a[100:101], v15 offset:64
    ds_read_b64_tr_b16 a[102:103], v15 offset:576
    s_add_u32 m0, s33, 37888
    s_mov_b32 s30, 5046272
    buffer_load_dwordx4 v13, s[8:11], s30 offen lds
    s_waitcnt lgkmcnt(4)
    s_add_u32 m0, s33, 38912
    s_mov_b32 s30, 5111808
    buffer_load_dwordx4 v13, s[8:11], s30 offen lds
    s_waitcnt vmcnt(35)
    ds_read_b64_tr_b16 a[104:105], v15 offset:2048
    ds_read_b64_tr_b16 a[106:107], v15 offset:2560
    ds_read_b64_tr_b16 a[108:109], v15 offset:2112
    ds_read_b64_tr_b16 a[110:111], v15 offset:2624
    s_add_u32 m0, s33, 39936
    s_mov_b32 s30, 5177344
    buffer_load_dwordx4 v13, s[8:11], s30 offen lds
    s_waitcnt vmcnt(34)
    ds_read_b64_tr_b16 a[112:113], v15 offset:4096
    ds_read_b64_tr_b16 a[114:115], v15 offset:4608
    ds_read_b64_tr_b16 a[116:117], v15 offset:4160
    ds_read_b64_tr_b16 a[118:119], v15 offset:4672
    s_waitcnt vmcnt(32)
    ds_read_b64_tr_b16 a[120:121], v15 offset:6144
    ds_read_b64_tr_b16 a[122:123], v15 offset:6656
    ds_read_b64_tr_b16 a[124:125], v15 offset:6208
    ds_read_b64_tr_b16 a[126:127], v15 offset:6720
    s_waitcnt vmcnt(30)
    ds_read_b64_tr_b16 a[128:129], v15 offset:8192
    ds_read_b64_tr_b16 a[130:131], v15 offset:8704
    ds_read_b64_tr_b16 a[132:133], v15 offset:8256
    ds_read_b64_tr_b16 a[134:135], v15 offset:8768
    s_waitcnt vmcnt(28)
    ds_read_b64_tr_b16 a[136:137], v15 offset:10240
    ds_read_b64_tr_b16 a[138:139], v15 offset:10752
    ds_read_b64_tr_b16 a[140:141], v15 offset:10304
    ds_read_b64_tr_b16 a[142:143], v15 offset:10816
    s_waitcnt vmcnt(26)
    ds_read_b64_tr_b16 a[144:145], v15 offset:12288
    ds_read_b64_tr_b16 a[146:147], v15 offset:12800
    ds_read_b64_tr_b16 a[148:149], v15 offset:12352
    ds_read_b64_tr_b16 a[150:151], v15 offset:12864
    s_waitcnt vmcnt(24)
    ds_read_b64_tr_b16 a[152:153], v15 offset:14336
    ds_read_b64_tr_b16 a[154:155], v15 offset:14848
    ds_read_b64_tr_b16 a[156:157], v15 offset:14400
    ds_read_b64_tr_b16 a[158:159], v15 offset:14912
    s_waitcnt vmcnt(22)
    ds_read_b64_tr_b16 a[160:161], v15 offset:16384
    ds_read_b64_tr_b16 a[162:163], v15 offset:16896
    ds_read_b64_tr_b16 a[164:165], v15 offset:16448
    ds_read_b64_tr_b16 a[166:167], v15 offset:16960
    s_waitcnt vmcnt(20)
    ds_read_b64_tr_b16 a[168:169], v15 offset:18432
    ds_read_b64_tr_b16 a[170:171], v15 offset:18944
    ds_read_b64_tr_b16 a[172:173], v15 offset:18496
    ds_read_b64_tr_b16 a[174:175], v15 offset:19008
    s_waitcnt vmcnt(18)
    ds_read_b64_tr_b16 a[176:177], v15 offset:20480
    ds_read_b64_tr_b16 a[178:179], v15 offset:20992
    ds_read_b64_tr_b16 a[180:181], v15 offset:20544
    ds_read_b64_tr_b16 a[182:183], v15 offset:21056
    s_waitcnt vmcnt(16)
    ds_read_b64_tr_b16 a[184:185], v15 offset:22528
    ds_read_b64_tr_b16 a[186:187], v15 offset:23040
    ds_read_b64_tr_b16 a[188:189], v15 offset:22592
    ds_read_b64_tr_b16 a[190:191], v15 offset:23104
    s_waitcnt vmcnt(14)
    ds_read_b64_tr_b16 a[192:193], v15 offset:24576
    ds_read_b64_tr_b16 a[194:195], v15 offset:25088
    ds_read_b64_tr_b16 a[196:197], v15 offset:24640
    ds_read_b64_tr_b16 a[198:199], v15 offset:25152
    s_waitcnt vmcnt(12)
    ds_read_b64_tr_b16 a[200:201], v15 offset:26624
    ds_read_b64_tr_b16 a[202:203], v15 offset:27136
    ds_read_b64_tr_b16 a[204:205], v15 offset:26688
    ds_read_b64_tr_b16 a[206:207], v15 offset:27200
    s_waitcnt vmcnt(10)
    ds_read_b64_tr_b16 a[208:209], v15 offset:28672
    ds_read_b64_tr_b16 a[210:211], v15 offset:29184
    ds_read_b64_tr_b16 a[212:213], v15 offset:28736
    ds_read_b64_tr_b16 a[214:215], v15 offset:29248
    s_waitcnt vmcnt(8)
    ds_read_b64_tr_b16 a[216:217], v15 offset:30720
    ds_read_b64_tr_b16 a[218:219], v15 offset:31232
    ds_read_b64_tr_b16 a[220:221], v15 offset:30784
    ds_read_b64_tr_b16 a[222:223], v15 offset:31296
    s_waitcnt vmcnt(6)
    ds_read_b64_tr_b16 a[224:225], v15 offset:32768
    ds_read_b64_tr_b16 a[226:227], v15 offset:33280
    ds_read_b64_tr_b16 a[228:229], v15 offset:32832
    ds_read_b64_tr_b16 a[230:231], v15 offset:33344
    s_waitcnt vmcnt(4)
    ds_read_b64_tr_b16 a[232:233], v15 offset:34816
    ds_read_b64_tr_b16 a[234:235], v15 offset:35328
    ds_read_b64_tr_b16 a[236:237], v15 offset:34880
    ds_read_b64_tr_b16 a[238:239], v15 offset:35392
    s_waitcnt vmcnt(2)
    ds_read_b64_tr_b16 a[240:241], v15 offset:36864
    ds_read_b64_tr_b16 a[242:243], v15 offset:37376
    ds_read_b64_tr_b16 a[244:245], v15 offset:36928
    ds_read_b64_tr_b16 a[246:247], v15 offset:37440
    s_waitcnt vmcnt(0)
    ds_read_b64_tr_b16 a[248:249], v15 offset:38912
    ds_read_b64_tr_b16 a[250:251], v15 offset:39424
    ds_read_b64_tr_b16 a[252:253], v15 offset:38976
    ds_read_b64_tr_b16 a[254:255], v15 offset:39488
    s_waitcnt lgkmcnt(0)
    v_mov_b32 v24, 0x3f803f80
    v_mov_b32 v25, 0x3f803f80
    v_mov_b32 v26, 0x3f803f80
    v_mov_b32 v27, 0x3f803f80
    s_nop 1
    v_mfma_f32_32x32x16_bf16 v[48:63], v[24:27], v[192:195], 0
    v_mfma_f32_32x32x16_bf16 v[64:79], v[24:27], v[196:199], 0
    v_mfma_f32_32x32x16_bf16 v[48:63], v[24:27], v[200:203], v[48:63]
    v_mfma_f32_32x32x16_bf16 v[64:79], v[24:27], v[204:207], v[64:79]
    v_mfma_f32_32x32x16_bf16 v[48:63], v[24:27], v[208:211], v[48:63]
    v_mfma_f32_32x32x16_bf16 v[64:79], v[24:27], v[212:215], v[64:79]
    v_mfma_f32_32x32x16_bf16 v[48:63], v[24:27], v[216:219], v[48:63]
    v_mfma_f32_32x32x16_bf16 v[64:79], v[24:27], v[220:223], v[64:79]
    v_mfma_f32_32x32x16_bf16 v[48:63], v[24:27], v[224:227], v[48:63]
    v_mfma_f32_32x32x16_bf16 v[64:79], v[24:27], v[228:231], v[64:79]
    v_mfma_f32_32x32x16_bf16 v[48:63], v[24:27], v[232:235], v[48:63]
    v_mfma_f32_32x32x16_bf16 v[64:79], v[24:27], v[236:239], v[64:79]
    v_mfma_f32_32x32x16_bf16 v[48:63], v[24:27], v[240:243], v[48:63]
    v_mfma_f32_32x32x16_bf16 v[64:79], v[24:27], v[244:247], v[64:79]
    v_mfma_f32_32x32x16_bf16 v[48:63], v[24:27], v[248:251], v[48:63]
    v_mfma_f32_32x32x16_bf16 v[64:79], v[24:27], v[252:255], v[64:79]
    v_mfma_f32_32x32x16_bf16 v[48:63], v[24:27], a[0:3], v[48:63]
    v_mfma_f32_32x32x16_bf16 v[64:79], v[24:27], a[4:7], v[64:79]
    v_mfma_f32_32x32x16_bf16 v[48:63], v[24:27], a[8:11], v[48:63]
    v_mfma_f32_32x32x16_bf16 v[64:79], v[24:27], a[12:15], v[64:79]
    v_mfma_f32_32x32x16_bf16 v[48:63], v[24:27], a[16:19], v[48:63]
    v_mfma_f32_32x32x16_bf16 v[64:79], v[24:27], a[20:23], v[64:79]
    v_mfma_f32_32x32x16_bf16 v[48:63], v[24:27], a[24:27], v[48:63]
    v_mfma_f32_32x32x16_bf16 v[64:79], v[24:27], a[28:31], v[64:79]
    v_mfma_f32_32x32x16_bf16 v[48:63], v[24:27], a[32:35], v[48:63]
    v_mfma_f32_32x32x16_bf16 v[64:79], v[24:27], a[36:39], v[64:79]
    v_mfma_f32_32x32x16_bf16 v[48:63], v[24:27], a[40:43], v[48:63]
    v_mfma_f32_32x32x16_bf16 v[64:79], v[24:27], a[44:47], v[64:79]
    v_mfma_f32_32x32x16_bf16 v[48:63], v[24:27], a[48:51], v[48:63]
    v_mfma_f32_32x32x16_bf16 v[64:79], v[24:27], a[52:55], v[64:79]
    v_mfma_f32_32x32x16_bf16 v[48:63], v[24:27], a[56:59], v[48:63]
    v_mfma_f32_32x32x16_bf16 v[64:79], v[24:27], a[60:63], v[64:79]
    v_mfma_f32_32x32x16_bf16 v[48:63], v[24:27], a[64:67], v[48:63]
    v_mfma_f32_32x32x16_bf16 v[64:79], v[24:27], a[68:71], v[64:79]
    v_mfma_f32_32x32x16_bf16 v[48:63], v[24:27], a[72:75], v[48:63]
    v_mfma_f32_32x32x16_bf16 v[64:79], v[24:27], a[76:79], v[64:79]
    v_mfma_f32_32x32x16_bf16 v[48:63], v[24:27], a[80:83], v[48:63]
    v_mfma_f32_32x32x16_bf16 v[64:79], v[24:27], a[84:87], v[64:79]
    v_mfma_f32_32x32x16_bf16 v[48:63], v[24:27], a[88:91], v[48:63]
    v_mfma_f32_32x32x16_bf16 v[64:79], v[24:27], a[92:95], v[64:79]
    v_mfma_f32_32x32x16_bf16 v[48:63], v[24:27], a[96:99], v[48:63]
    v_mfma_f32_32x32x16_bf16 v[64:79], v[24:27], a[100:103], v[64:79]
    v_mfma_f32_32x32x16_bf16 v[48:63], v[24:27], a[104:107], v[48:63]
    v_mfma_f32_32x32x16_bf16 v[64:79], v[24:27], a[108:111], v[64:79]
    v_mfma_f32_32x32x16_bf16 v[48:63], v[24:27], a[112:115], v[48:63]
    v_mfma_f32_32x32x16_bf16 v[64:79], v[24:27], a[116:119], v[64:79]
    v_mfma_f32_32x32x16_bf16 v[48:63], v[24:27], a[120:123], v[48:63]
    v_mfma_f32_32x32x16_bf16 v[64:79], v[24:27], a[124:127], v[64:79]
    v_mfma_f32_32x32x16_bf16 v[48:63], v[24:27], a[128:131], v[48:63]
    v_mfma_f32_32x32x16_bf16 v[64:79], v[24:27], a[132:135], v[64:79]
    v_mfma_f32_32x32x16_bf16 v[48:63], v[24:27], a[136:139], v[48:63]
    v_mfma_f32_32x32x16_bf16 v[64:79], v[24:27], a[140:143], v[64:79]
    v_mfma_f32_32x32x16_bf16 v[48:63], v[24:27], a[144:147], v[48:63]
    v_mfma_f32_32x32x16_bf16 v[64:79], v[24:27], a[148:151], v[64:79]
    v_mfma_f32_32x32x16_bf16 v[48:63], v[24:27], a[152:155], v[48:63]
    v_mfma_f32_32x32x16_bf16 v[64:79], v[24:27], a[156:159], v[64:79]
    v_mfma_f32_32x32x16_bf16 v[48:63], v[24:27], a[160:163], v[48:63]
    v_mfma_f32_32x32x16_bf16 v[64:79], v[24:27], a[164:167], v[64:79]
    v_mfma_f32_32x32x16_bf16 v[48:63], v[24:27], a[168:171], v[48:63]
    v_mfma_f32_32x32x16_bf16 v[64:79], v[24:27], a[172:175], v[64:79]
    v_mfma_f32_32x32x16_bf16 v[48:63], v[24:27], a[176:179], v[48:63]
    v_mfma_f32_32x32x16_bf16 v[64:79], v[24:27], a[180:183], v[64:79]
    v_mfma_f32_32x32x16_bf16 v[48:63], v[24:27], a[184:187], v[48:63]
    v_mfma_f32_32x32x16_bf16 v[64:79], v[24:27], a[188:191], v[64:79]
    v_mfma_f32_32x32x16_bf16 v[48:63], v[24:27], a[192:195], v[48:63]
    v_mfma_f32_32x32x16_bf16 v[64:79], v[24:27], a[196:199], v[64:79]
    v_mfma_f32_32x32x16_bf16 v[48:63], v[24:27], a[200:203], v[48:63]
    v_mfma_f32_32x32x16_bf16 v[64:79], v[24:27], a[204:207], v[64:79]
    v_mfma_f32_32x32x16_bf16 v[48:63], v[24:27], a[208:211], v[48:63]
    v_mfma_f32_32x32x16_bf16 v[64:79], v[24:27], a[212:215], v[64:79]
    v_mfma_f32_32x32x16_bf16 v[48:63], v[24:27], a[216:219], v[48:63]
    v_mfma_f32_32x32x16_bf16 v[64:79], v[24:27], a[220:223], v[64:79]
    v_mfma_f32_32x32x16_bf16 v[48:63], v[24:27], a[224:227], v[48:63]
    v_mfma_f32_32x32x16_bf16 v[64:79], v[24:27], a[228:231], v[64:79]
    v_mfma_f32_32x32x16_bf16 v[48:63], v[24:27], a[232:235], v[48:63]
    v_mfma_f32_32x32x16_bf16 v[64:79], v[24:27], a[236:239], v[64:79]
    v_mfma_f32_32x32x16_bf16 v[48:63], v[24:27], a[240:243], v[48:63]
    v_mfma_f32_32x32x16_bf16 v[64:79], v[24:27], a[244:247], v[64:79]
    v_mfma_f32_32x32x16_bf16 v[48:63], v[24:27], a[248:251], v[48:63]
    v_mfma_f32_32x32x16_bf16 v[64:79], v[24:27], a[252:255], v[64:79]
    s_nop 15
    v_cvt_pk_bf16_f32 v112, v48, v48
    v_and_b32 v13, 0xffff0000, v112
    v_sub_f32 v13, v48, v13
    v_cvt_pk_bf16_f32 v113, v13, 0
    v_cndmask_b32 v112, v112, 0, s[44:45]
    v_cndmask_b32 v113, v113, 0, s[44:45]
    v_mov_b64 v[114:115], 0
    v_mov_b64 v[122:123], 0
    v_cvt_pk_bf16_f32 v116, v64, v64
    v_and_b32 v13, 0xffff0000, v116
    v_sub_f32 v13, v64, v13
    v_cvt_pk_bf16_f32 v117, v13, 0
    v_cndmask_b32 v116, v116, 0, s[44:45]
    v_cndmask_b32 v117, v117, 0, s[44:45]
    v_mov_b64 v[118:119], 0
    v_mov_b64 v[122:123], 0
    v_and_b32 v13, 31, v12
    v_lshrrev_b32 v14, 5, v12
    v_mov_b32 v4, v0
    v_mul_u32_u24 v3, 2560, v14
    v_lshl_add_u32 v3, v13, 3, v3
    v_add_u32 v3, 40960, v3
    s_mul_i32 s30, s12, 4096
    v_add_u32 v6, s30, v0
    v_add_u32 v7, 1024, v6
    s_mov_b32 s40, 0xc0135761
    s_mov_b32 s41, 0xbdd2d3e8
    s_mov_b32 s42, 0x3acccccd
    s_mov_b32 s43, 0x3727c5ac
    s_mov_b32 s23, 0
    v_mov_b32 v16, 128
P_3:
    global_load_dword v17, v16, s[90:91] sc1
    s_waitcnt vmcnt(0)
    v_readfirstlane_b32 s85, v17
    s_and_b32 s86, s85, 255
    s_cmp_ge_u32 s86, 70
    s_cbranch_scc1 P_4
    s_add_u32 s23, s23, 1
    s_cmp_gt_u32 s23, 65536
    s_cbranch_scc1 L_exit
    s_sleep 16
    s_branch P_3
P_4:
    s_lshr_b32 s85, s85, 8
    s_mov_b32 s80, 0
RQK_job:
    s_mul_i32 s18, s14, 41943040
    s_add_u32 s18, s18, 171966464
    s_mul_i32 s19, s14, 50331648
    s_add_u32 s19, s19, 0
    s_mul_i32 s21, s14, 393216
    s_add_u32 s21, s21, 167772160
    s_lshr_b32 s30, s13, 4
    s_lshl_b32 s31, s30, 24
    s_add_u32 s19, s19, s31
    s_sub_u32 s31, s30, 1
    s_cmp_eq_u32 s30, 0
    s_cselect_b32 s31, 2, s31
    s_lshl_b32 s31, s31, 8
    s_add_u32 s21, s21, s31
    s_and_b32 s30, s13, 15
    s_lshl_b32 s31, s30, 14
    s_add_u32 s19, s19, s31
    s_lshl_b32 s31, s30, 11
    s_add_u32 s21, s21, s31
    s_lshr_b32 s31, s12, 1
    s_lshl_b32 s31, s31, 10
    s_add_u32 s21, s21, s31
    s_and_b32 s31, s12, 1
    s_lshl_b32 s31, s31, 7
    s_add_u32 s21, s21, s31
    s_cmp_eq_u32 s15, 2
    s_cselect_b32 s30, 11, s15
    s_lshl_b32 s30, s30, 15
    s_add_u32 s21, s21, s30
    s_mul_i32 s20, s12, 640
    s_add_u32 s20, s20, 168067072
    s_mov_b32 s25, 1
    s_mov_b32 s16, s15
    s_sub_u32 s17, 2, s14
    s_mov_b32 s28, 0
    s_or_b32 s30, s15, s14
    s_cselect_b32 s46, 64, 36
    s_cmp_eq_u32 s15, 1
    s_cselect_b32 s46, 58, s46
    s_cselect_b32 s30, s13, 99
    s_cmp_lt_u32 s30, 0
    s_cselect_b32 s46, 64, s46
    s_cmp_eq_u32 s15, 2
    s_cselect_b32 s16, 58, s16
    s_mov_b32 s22, 0
    s_mov_b32 s47, 0
    s_mov_b32 s26, 0
    s_mov_b32 s24, 0
    s_mov_b32 s81, 0
    s_lshr_b32 s30, s85, 5
    s_and_b32 s30, s30, 1
    s_lshl_b32 s30, s30, 13
    s_andn2_b32 s20, s20, 0x2000
    s_or_b32 s20, s20, s30
    s_barrier
    s_cmp_lg_u32 s14, 0
    s_cbranch_scc1 G_5
    s_mul_i32 s38, s16, 49152
    s_add_u32 s38, s38, s18
    s_mov_b32 s39, s24
    s_mul_i32 s30, s12, 1280
    s_add_u32 s30, s30, 40960
    s_add_u32 m0, s30, s39
    s_add_u32 s30, s30, s38
    buffer_load_dwordx4 v0, s[4:7], s30 offen sc1 lds
    buffer_load_dword v5, s[4:7], s30 offen offset:1024 sc1 lds
    s_mul_i32 s30, s12, 10240
    s_add_u32 s38, s38, s30
    s_add_u32 s39, s39, s30
    s_mov_b32 m0, s39
    s_nop 0
    buffer_load_dwordx4 v4, s[4:7], s38 offen offset:0 sc1 lds
    buffer_load_dwordx4 v4, s[4:7], s38 offen offset:1024 sc1 lds
    buffer_load_dwordx4 v4, s[4:7], s38 offen offset:2048 sc1 lds
    buffer_load_dwordx4 v4, s[4:7], s38 offen offset:3072 sc1 lds
    s_add_u32 s38, s38, 4096
    s_add_u32 s39, s39, 4096
    s_mov_b32 m0, s39
    s_nop 0
    buffer_load_dwordx4 v4, s[4:7], s38 offen offset:0 sc1 lds
    buffer_load_dwordx4 v4, s[4:7], s38 offen offset:1024 sc1 lds
    buffer_load_dwordx4 v4, s[4:7], s38 offen offset:2048 sc1 lds
    buffer_load_dwordx4 v4, s[4:7], s38 offen offset:3072 sc1 lds
    s_add_u32 s38, s38, 4096
    s_add_u32 s39, s39, 4096
    s_mov_b32 m0, s39
    s_nop 0
    buffer_load_dwordx4 v4, s[4:7], s38 offen offset:0 sc1 lds
    buffer_load_dwordx4 v4, s[4:7], s38 offen offset:1024 sc1 lds
    s_mov_b32 s35, 46080
    s_mov_b32 s36, 92160
    s_mul_i32 s34, s16, 262144
    s_add_u32 s34, s34, s19
    v_mov_b32 v1, v0
    s_waitcnt vmcnt(0)
    s_barrier
    ds_read_b128 v[160:163], v1 offset:0
    ds_read_b128 v[164:167], v1 offset:10240
    ds_read_b128 v[168:171], v1 offset:20480
    ds_read_b128 v[172:175], v1 offset:30720
    ds_read_b128 v[176:179], v1 offset:1024
.p2align 6
RQK_st:
    s_waitcnt lgkmcnt(4)
    v_mfma_f32_32x32x16_bf16 v[48:63], v[192:195], v[160:163], 0
    ds_read_b128 v[180:183], v1 offset:11264
    s_cmp_lt_u32 s16, 35
    s_cselect_b32 s17, s17, 1
    s_add_u32 s29, s16, s17
    v_add_u32 v9, s24, v3
    v_mfma_f32_32x32x16_bf16 v[64:79], v[196:199], v[160:163], 0
    s_cmp_lt_u32 s29, s46
    s_cselect_b32 s32, s29, s16
    s_waitcnt lgkmcnt(4)
    v_mfma_f32_32x32x16_bf16 v[48:63], a[16:19], v[164:167], v[48:63]
    ds_read_b128 v[184:187], v1 offset:21504
    v_mfma_f32_32x32x16_bf16 v[64:79], a[20:23], v[164:167], v[64:79]
    s_mul_i32 s38, s32, 49152
    s_add_u32 s38, s38, s18
    s_mov_b32 s39, s35
    s_mul_i32 s30, s12, 1280
    s_add_u32 s30, s30, 40960
    s_add_u32 m0, s30, s39
    s_add_u32 s30, s30, s38
    buffer_load_dwordx4 v0, s[4:7], s30 offen sc1 lds
    buffer_load_dword v5, s[4:7], s30 offen offset:1024 sc1 lds
    s_waitcnt lgkmcnt(4)
    v_mfma_f32_32x32x16_bf16 v[48:63], a[96:99], v[168:171], v[48:63]
    ds_read_b128 v[188:191], v1 offset:31744
    v_mul_f32 v128, v128, v13
    v_mul_f32 v129, v129, v13
    v_mfma_f32_32x32x16_bf16 v[64:79], a[100:103], v[168:171], v[64:79]
    v_mul_f32 v130, v130, v13
    v_mul_f32 v131, v131, v13
    v_mul_f32 v132, v132, v13
    s_waitcnt lgkmcnt(4)
    v_mfma_f32_32x32x16_bf16 v[48:63], a[176:179], v[172:175], v[48:63]
    ds_read_b128 v[160:163], v1 offset:2048
    v_mul_f32 v133, v133, v13
    v_mul_f32 v134, v134, v13
    v_mfma_f32_32x32x16_bf16 v[64:79], a[180:183], v[172:175], v[64:79]
    s_mul_i32 s30, s12, 10240
    s_add_u32 s38, s38, s30
    s_add_u32 s39, s39, s30
    s_mov_b32 m0, s39
    s_nop 0
    buffer_load_dwordx4 v4, s[4:7], s38 offen offset:0 sc1 lds
    s_waitcnt lgkmcnt(4)
    v_mfma_f32_32x32x16_bf16 v[48:63], v[200:203], v[176:179], v[48:63]
    ds_read_b128 v[164:167], v1 offset:12288
    v_mul_f32 v135, v135, v13
    v_cvt_pk_bf16_f32 v24, v128, v129
    v_mfma_f32_32x32x16_bf16 v[64:79], v[204:207], v[176:179], v[64:79]
    v_cvt_pk_bf16_f32 v25, v130, v131
    v_cvt_pk_bf16_f32 v26, v132, v133
    v_cvt_pk_bf16_f32 v27, v134, v135
    s_waitcnt lgkmcnt(4)
    v_mfma_f32_32x32x16_bf16 v[48:63], a[24:27], v[180:183], v[48:63]
    ds_read_b128 v[168:171], v1 offset:22528
    buffer_store_dwordx4 v[24:27], v6, s[4:7], s34 offen offset:0 sc1
    v_mul_f32 v136, v136, v13
    v_mfma_f32_32x32x16_bf16 v[64:79], a[28:31], v[180:183], v[64:79]
    buffer_load_dwordx4 v4, s[4:7], s38 offen offset:1024 sc1 lds
    s_waitcnt lgkmcnt(4)
    v_mfma_f32_32x32x16_bf16 v[48:63], a[104:107], v[184:187], v[48:63]
    ds_read_b128 v[172:175], v1 offset:32768
    v_mul_f32 v137, v137, v13
    v_mul_f32 v138, v138, v13
    v_mfma_f32_32x32x16_bf16 v[64:79], a[108:111], v[184:187], v[64:79]
    v_mul_f32 v139, v139, v13
    v_mul_f32 v140, v140, v13
    v_mul_f32 v141, v141, v13
    s_waitcnt lgkmcnt(4)
    v_mfma_f32_32x32x16_bf16 v[48:63], a[184:187], v[188:191], v[48:63]
    ds_read_b128 v[176:179], v1 offset:3072
    v_mul_f32 v142, v142, v13
    v_mul_f32 v143, v143, v13
    v_mfma_f32_32x32x16_bf16 v[64:79], a[188:191], v[188:191], v[64:79]
    buffer_load_dwordx4 v4, s[4:7], s38 offen offset:2048 sc1 lds
    s_waitcnt lgkmcnt(4)
    v_mfma_f32_32x32x16_bf16 v[48:63], v[208:211], v[160:163], v[48:63]
    ds_read_b128 v[180:183], v1 offset:13312
    v_cvt_pk_bf16_f32 v28, v136, v137
    v_cvt_pk_bf16_f32 v29, v138, v139
    v_mfma_f32_32x32x16_bf16 v[64:79], v[212:215], v[160:163], v[64:79]
    v_cvt_pk_bf16_f32 v30, v140, v141
    v_cvt_pk_bf16_f32 v31, v142, v143
    buffer_store_dwordx4 v[28:31], v7, s[4:7], s34 offen offset:0 sc1
    s_waitcnt lgkmcnt(4)
    v_mfma_f32_32x32x16_bf16 v[48:63], a[32:35], v[164:167], v[48:63]
    ds_read_b128 v[184:187], v1 offset:23552
    v_mul_f32 v144, v144, v13
    v_mul_f32 v145, v145, v13
    v_mfma_f32_32x32x16_bf16 v[64:79], a[36:39], v[164:167], v[64:79]
    buffer_load_dwordx4 v4, s[4:7], s38 offen offset:3072 sc1 lds
    s_waitcnt lgkmcnt(4)
    v_mfma_f32_32x32x16_bf16 v[48:63], a[112:115], v[168:171], v[48:63]
    ds_read_b128 v[188:191], v1 offset:33792
    v_mul_f32 v146, v146, v13
    v_mul_f32 v147, v147, v13
    v_mfma_f32_32x32x16_bf16 v[64:79], a[116:119], v[168:171], v[64:79]
    v_mul_f32 v148, v148, v13
    v_mul_f32 v149, v149, v13
    v_mul_f32 v150, v150, v13
    s_waitcnt lgkmcnt(4)
    v_mfma_f32_32x32x16_bf16 v[48:63], a[192:195], v[172:175], v[48:63]
    ds_read_b128 v[160:163], v1 offset:4096
    v_mul_f32 v151, v151, v13
    v_cvt_pk_bf16_f32 v32, v144, v145
    v_mfma_f32_32x32x16_bf16 v[64:79], a[196:199], v[172:175], v[64:79]
    s_add_u32 s38, s38, 4096
    s_add_u32 s39, s39, 4096
    s_mov_b32 m0, s39
    s_nop 0
    buffer_load_dwordx4 v4, s[4:7], s38 offen offset:0 sc1 lds
    s_waitcnt lgkmcnt(4)
    v_mfma_f32_32x32x16_bf16 v[48:63], v[216:219], v[176:179], v[48:63]
    ds_read_b128 v[164:167], v1 offset:14336
    v_cvt_pk_bf16_f32 v33, v146, v147
    v_cvt_pk_bf16_f32 v34, v148, v149
    v_mfma_f32_32x32x16_bf16 v[64:79], v[220:223], v[176:179], v[64:79]
    v_cvt_pk_bf16_f32 v35, v150, v151
    buffer_store_dwordx4 v[32:35], v6, s[4:7], s34 offen offset:2048 sc1
    v_mul_f32 v152, v152, v13
    s_waitcnt lgkmcnt(4)
    v_mfma_f32_32x32x16_bf16 v[48:63], a[40:43], v[180:183], v[48:63]
    ds_read_b128 v[168:171], v1 offset:24576
    v_mul_f32 v153, v153, v13
    v_mul_f32 v154, v154, v13
    v_mfma_f32_32x32x16_bf16 v[64:79], a[44:47], v[180:183], v[64:79]
    buffer_load_dwordx4 v4, s[4:7], s38 offen offset:1024 sc1 lds
    s_waitcnt lgkmcnt(4)
    v_mfma_f32_32x32x16_bf16 v[48:63], a[120:123], v[184:187], v[48:63]
    ds_read_b128 v[172:175], v1 offset:34816
    v_mul_f32 v155, v155, v13
    v_mul_f32 v156, v156, v13
    v_mfma_f32_32x32x16_bf16 v[64:79], a[124:127], v[184:187], v[64:79]
    v_mul_f32 v157, v157, v13
    v_mul_f32 v158, v158, v13
    v_mul_f32 v159, v159, v13
    s_waitcnt lgkmcnt(4)
    v_mfma_f32_32x32x16_bf16 v[48:63], a[200:203], v[188:191], v[48:63]
    ds_read_b128 v[176:179], v1 offset:5120
    v_cvt_pk_bf16_f32 v36, v152, v153
    v_cvt_pk_bf16_f32 v37, v154, v155
    v_mfma_f32_32x32x16_bf16 v[64:79], a[204:207], v[188:191], v[64:79]
    buffer_load_dwordx4 v4, s[4:7], s38 offen offset:2048 sc1 lds
    s_waitcnt lgkmcnt(4)
    v_mfma_f32_32x32x16_bf16 v[48:63], v[224:227], v[160:163], v[48:63]
    ds_read_b128 v[180:183], v1 offset:15360
    v_cvt_pk_bf16_f32 v38, v156, v157
    v_cvt_pk_bf16_f32 v39, v158, v159
    v_mfma_f32_32x32x16_bf16 v[64:79], v[228:231], v[160:163], v[64:79]
    buffer_store_dwordx4 v[36:39], v7, s[4:7], s34 offen offset:2048 sc1
    ds_read_b64 v[80:81], v9 offset:0
    ds_read_b64 v[82:83], v9 offset:256
    s_waitcnt lgkmcnt(6)
    v_mfma_f32_32x32x16_bf16 v[48:63], a[48:51], v[164:167], v[48:63]
    ds_read_b128 v[184:187], v1 offset:25600
    ds_read_b64 v[84:85], v9 offset:512
    ds_read_b64 v[86:87], v9 offset:768
    v_mfma_f32_32x32x16_bf16 v[64:79], a[52:55], v[164:167], v[64:79]
    buffer_load_dwordx4 v4, s[4:7], s38 offen offset:3072 sc1 lds
    s_waitcnt lgkmcnt(8)
    v_mfma_f32_32x32x16_bf16 v[48:63], a[128:131], v[168:171], v[48:63]
    ds_read_b128 v[188:191], v1 offset:35840
    s_waitcnt lgkmcnt(5)
    v_mov_b32 v16, v80
    v_mov_b32 v17, v81
    v_mfma_f32_32x32x16_bf16 v[64:79], a[132:135], v[168:171], v[64:79]
    s_waitcnt lgkmcnt(4)
    v_mov_b32 v18, v82
    v_mov_b32 v19, v83
    s_waitcnt lgkmcnt(2)
    v_add_f32 v16, v16, v84
    v_mfma_f32_32x32x16_bf16 v[48:63], a[208:211], v[172:175], v[48:63]
    ds_read_b128 v[160:163], v1 offset:6144
    v_add_f32 v17, v17, v85
    s_waitcnt lgkmcnt(2)
    v_add_f32 v18, v18, v86
    v_mfma_f32_32x32x16_bf16 v[64:79], a[212:215], v[172:175], v[64:79]
    s_add_u32 s38, s38, 4096
    s_add_u32 s39, s39, 4096
    s_mov_b32 m0, s39
    s_nop 0
    buffer_load_dwordx4 v4, s[4:7], s38 offen offset:0 sc1 lds
    v_mfma_f32_32x32x16_bf16 v[48:63], v[232:235], v[176:179], v[48:63]
    ds_read_b128 v[164:167], v1 offset:16384
    v_add_f32 v19, v19, v87
    ds_read_b64 v[80:81], v9 offset:1024
    v_mfma_f32_32x32x16_bf16 v[64:79], v[236:239], v[176:179], v[64:79]
    ds_read_b64 v[82:83], v9 offset:1280
    ds_read_b64 v[84:85], v9 offset:1536
    ds_read_b64 v[86:87], v9 offset:1792
    v_mfma_f32_32x32x16_bf16 v[48:63], a[56:59], v[180:183], v[48:63]
    ds_read_b128 v[168:171], v1 offset:26624
    s_waitcnt lgkmcnt(4)
    v_add_f32 v16, v16, v80
    v_add_f32 v17, v17, v81
    v_mfma_f32_32x32x16_bf16 v[64:79], a[60:63], v[180:183], v[64:79]
    buffer_load_dwordx4 v4, s[4:7], s38 offen offset:1024 sc1 lds
    v_mfma_f32_32x32x16_bf16 v[48:63], a[136:139], v[184:187], v[48:63]
    ds_read_b128 v[172:175], v1 offset:36864
    s_waitcnt lgkmcnt(4)
    v_add_f32 v18, v18, v82
    v_add_f32 v19, v19, v83
    v_mfma_f32_32x32x16_bf16 v[64:79], a[140:143], v[184:187], v[64:79]
    s_waitcnt lgkmcnt(3)
    v_add_f32 v16, v16, v84
    v_add_f32 v17, v17, v85
    s_waitcnt lgkmcnt(2)
    v_add_f32 v18, v18, v86
    v_mfma_f32_32x32x16_bf16 v[48:63], a[216:219], v[188:191], v[48:63]
    ds_read_b128 v[176:179], v1 offset:7168
    v_add_f32 v19, v19, v87
    ds_read_b64 v[80:81], v9 offset:2048
    v_mfma_f32_32x32x16_bf16 v[64:79], a[220:223], v[188:191], v[64:79]
    ds_read_b64 v[82:83], v9 offset:2304
    s_waitcnt lgkmcnt(1)
    v_add_f32 v16, v16, v80
    v_add_f32 v17, v17, v81
    v_mfma_f32_32x32x16_bf16 v[48:63], v[240:243], v[160:163], v[48:63]
    ds_read_b128 v[180:183], v1 offset:17408
    s_waitcnt lgkmcnt(1)
    v_add_f32 v18, v18, v82
    v_add_f32 v19, v19, v83
    v_mfma_f32_32x32x16_bf16 v[64:79], v[244:247], v[160:163], v[64:79]
    v_add_f32 v16, v16, v18
    v_add_f32 v17, v17, v19
    v_mov_b32 v18, v16
    v_mfma_f32_32x32x16_bf16 v[48:63], a[64:67], v[164:167], v[48:63]
    ds_read_b128 v[184:187], v1 offset:27648
    v_mov_b32 v19, v17
    s_nop 1
    v_mfma_f32_32x32x16_bf16 v[64:79], a[68:71], v[164:167], v[64:79]
    v_permlane32_swap_b32 v16, v18
    v_permlane32_swap_b32 v17, v19
    v_add_f32 v16, v16, v18
    v_mfma_f32_32x32x16_bf16 v[48:63], a[144:147], v[168:171], v[48:63]
    ds_read_b128 v[188:191], v1 offset:37888
    v_add_f32 v17, v17, v19
    v_mul_f32 v12, s42, v16
    v_mfma_f32_32x32x16_bf16 v[64:79], a[148:151], v[168:171], v[64:79]
    v_mul_f32 v15, s42, v17
    v_sub_f32 v16, 0, v12
    v_cvt_pk_bf16_f32 v121, v16, v16
    v_mfma_f32_32x32x16_bf16 v[48:63], a[224:227], v[172:175], v[48:63]
    ds_read_b128 v[160:163], v1 offset:8192
    v_fma_f32 v15, -v12, v12, v15
    v_and_b32 v17, 0xffff0000, v121
    v_mfma_f32_32x32x16_bf16 v[64:79], a[228:231], v[172:175], v[64:79]
    v_max_f32 v15, 0, v15
    v_sub_f32 v16, v16, v17
    v_add_f32 v18, s43, v15
    v_mfma_f32_32x32x16_bf16 v[48:63], v[248:251], v[176:179], v[48:63]
    ds_read_b128 v[164:167], v1 offset:18432
    v_cvt_pk_bf16_f32 v120, v17, v16
    v_rsq_f32 v13, v18
    v_mfma_f32_32x32x16_bf16 v[64:79], v[252:255], v[176:179], v[64:79]
    s_nop 0
    v_mfma_f32_32x32x16_bf16 v[48:63], v[112:115], v[120:123], v[48:63]
    v_mfma_f32_32x32x16_bf16 v[64:79], v[116:119], v[120:123], v[64:79]
    s_waitcnt lgkmcnt(4)
    v_mfma_f32_32x32x16_bf16 v[48:63], a[72:75], v[180:183], v[48:63]
    ds_read_b128 v[168:171], v1 offset:28672
    v_mfma_f32_32x32x16_bf16 v[64:79], a[76:79], v[180:183], v[64:79]
    s_waitcnt lgkmcnt(4)
    v_mfma_f32_32x32x16_bf16 v[48:63], a[152:155], v[184:187], v[48:63]
    ds_read_b128 v[172:175], v1 offset:38912
    v_mfma_f32_32x32x16_bf16 v[64:79], a[156:159], v[184:187], v[64:79]
    s_waitcnt lgkmcnt(4)
    v_mfma_f32_32x32x16_bf16 v[48:63], a[232:235], v[188:191], v[48:63]
    ds_read_b128 v[176:179], v1 offset:9216
    v_mfma_f32_32x32x16_bf16 v[64:79], a[236:239], v[188:191], v[64:79]
    s_waitcnt lgkmcnt(4)
    v_mfma_f32_32x32x16_bf16 v[48:63], a[0:3], v[160:163], v[48:63]
    ds_read_b128 v[180:183], v1 offset:19456
    v_mfma_f32_32x32x16_bf16 v[64:79], a[4:7], v[160:163], v[64:79]
    s_waitcnt lgkmcnt(4)
    v_mfma_f32_32x32x16_bf16 v[48:63], a[80:83], v[164:167], v[48:63]
    ds_read_b128 v[184:187], v1 offset:29696
    v_mfma_f32_32x32x16_bf16 v[64:79], a[84:87], v[164:167], v[64:79]
    s_waitcnt lgkmcnt(4)
    v_mfma_f32_32x32x16_bf16 v[48:63], a[160:163], v[168:171], v[48:63]
    ds_read_b128 v[188:191], v1 offset:39936
    v_mfma_f32_32x32x16_bf16 v[64:79], a[164:167], v[168:171], v[64:79]
    s_waitcnt lgkmcnt(4)
    v_mfma_f32_32x32x16_bf16 v[48:63], a[240:243], v[172:175], v[48:63]
    v_add_u32 v1, s35, v0
    s_waitcnt vmcnt(0)
    s_barrier
    ds_read_b128 v[160:163], v1 offset:0
    v_mfma_f32_32x32x16_bf16 v[64:79], a[244:247], v[172:175], v[64:79]
    s_waitcnt lgkmcnt(4)
    v_mfma_f32_32x32x16_bf16 v[48:63], a[8:11], v[176:179], v[48:63]
    ds_read_b128 v[164:167], v1 offset:10240
    s_sub_u32 s63, s26, s47
    s_mov_b32 s47, s26
    s_atomic_add s63, s[4:5], s21
    v_mfma_f32_32x32x16_bf16 v[64:79], a[12:15], v[176:179], v[64:79]
    s_waitcnt lgkmcnt(4)
    v_mfma_f32_32x32x16_bf16 v[48:63], a[88:91], v[180:183], v[48:63]
    ds_read_b128 v[168:171], v1 offset:20480
    s_add_u32 s26, s16, 1
    s_mul_i32 s34, s16, 262144
    s_add_u32 s34, s34, s19
    v_mfma_f32_32x32x16_bf16 v[64:79], a[92:95], v[180:183], v[64:79]
    s_waitcnt lgkmcnt(4)
    v_mfma_f32_32x32x16_bf16 v[48:63], a[168:171], v[184:187], v[48:63]
    ds_read_b128 v[172:175], v1 offset:30720
    s_mov_b32 s30, s24
    s_mov_b32 s24, s35
    s_mov_b32 s35, s36
    v_mfma_f32_32x32x16_bf16 v[64:79], a[172:175], v[184:187], v[64:79]
    s_waitcnt lgkmcnt(4)
    v_mfma_f32_32x32x16_bf16 v[48:63], a[248:251], v[188:191], v[48:63]
    ds_read_b128 v[176:179], v1 offset:1024
    s_mov_b32 s36, s30
    s_mov_b32 s16, s29
    s_cmp_ge_u32 s16, s46
    v_mfma_f32_32x32x16_bf16 v[64:79], a[252:255], v[188:191], v[64:79]
    s_cbranch_scc1 RQK_f0
    s_waitcnt lgkmcnt(4)
    v_mfma_f32_32x32x16_bf16 v[128:143], v[192:195], v[160:163], 0
    ds_read_b128 v[180:183], v1 offset:11264
    s_cmp_lt_u32 s16, 35
    s_cselect_b32 s17, s17, 1
    s_add_u32 s29, s16, s17
    v_add_u32 v9, s24, v3
    v_mfma_f32_32x32x16_bf16 v[144:159], v[196:199], v[160:163], 0
    s_cmp_lt_u32 s29, s46
    s_cselect_b32 s32, s29, s16
    s_waitcnt lgkmcnt(4)
    v_mfma_f32_32x32x16_bf16 v[128:143], a[16:19], v[164:167], v[128:143]
    ds_read_b128 v[184:187], v1 offset:21504
    v_mfma_f32_32x32x16_bf16 v[144:159], a[20:23], v[164:167], v[144:159]
    s_mul_i32 s38, s32, 49152
    s_add_u32 s38, s38, s18
    s_mov_b32 s39, s35
    s_mul_i32 s30, s12, 1280
    s_add_u32 s30, s30, 40960
    s_add_u32 m0, s30, s39
    s_add_u32 s30, s30, s38
    buffer_load_dwordx4 v0, s[4:7], s30 offen sc1 lds
    buffer_load_dword v5, s[4:7], s30 offen offset:1024 sc1 lds
    s_waitcnt lgkmcnt(4)
    v_mfma_f32_32x32x16_bf16 v[128:143], a[96:99], v[168:171], v[128:143]
    ds_read_b128 v[188:191], v1 offset:31744
    v_mul_f32 v48, v48, v13
    v_mul_f32 v49, v49, v13
    v_mfma_f32_32x32x16_bf16 v[144:159], a[100:103], v[168:171], v[144:159]
    v_mul_f32 v50, v50, v13
    v_mul_f32 v51, v51, v13
    v_mul_f32 v52, v52, v13
    s_waitcnt lgkmcnt(4)
    v_mfma_f32_32x32x16_bf16 v[128:143], a[176:179], v[172:175], v[128:143]
    ds_read_b128 v[160:163], v1 offset:2048
    v_mul_f32 v53, v53, v13
    v_mul_f32 v54, v54, v13
    v_mfma_f32_32x32x16_bf16 v[144:159], a[180:183], v[172:175], v[144:159]
    s_mul_i32 s30, s12, 10240
    s_add_u32 s38, s38, s30
    s_add_u32 s39, s39, s30
    s_mov_b32 m0, s39
    s_nop 0
    buffer_load_dwordx4 v4, s[4:7], s38 offen offset:0 sc1 lds
    s_waitcnt lgkmcnt(4)
    v_mfma_f32_32x32x16_bf16 v[128:143], v[200:203], v[176:179], v[128:143]
    ds_read_b128 v[164:167], v1 offset:12288
    v_mul_f32 v55, v55, v13
    v_cvt_pk_bf16_f32 v24, v48, v49
    v_mfma_f32_32x32x16_bf16 v[144:159], v[204:207], v[176:179], v[144:159]
    v_cvt_pk_bf16_f32 v25, v50, v51
    v_cvt_pk_bf16_f32 v26, v52, v53
    v_cvt_pk_bf16_f32 v27, v54, v55
    s_waitcnt lgkmcnt(4)
    v_mfma_f32_32x32x16_bf16 v[128:143], a[24:27], v[180:183], v[128:143]
    ds_read_b128 v[168:171], v1 offset:22528
    buffer_store_dwordx4 v[24:27], v6, s[4:7], s34 offen offset:0 sc1
    v_mul_f32 v56, v56, v13
    v_mfma_f32_32x32x16_bf16 v[144:159], a[28:31], v[180:183], v[144:159]
    buffer_load_dwordx4 v4, s[4:7], s38 offen offset:1024 sc1 lds
    s_waitcnt lgkmcnt(4)
    v_mfma_f32_32x32x16_bf16 v[128:143], a[104:107], v[184:187], v[128:143]
    ds_read_b128 v[172:175], v1 offset:32768
    v_mul_f32 v57, v57, v13
    v_mul_f32 v58, v58, v13
    v_mfma_f32_32x32x16_bf16 v[144:159], a[108:111], v[184:187], v[144:159]
    v_mul_f32 v59, v59, v13
    v_mul_f32 v60, v60, v13
    v_mul_f32 v61, v61, v13
    s_waitcnt lgkmcnt(4)
    v_mfma_f32_32x32x16_bf16 v[128:143], a[184:187], v[188:191], v[128:143]
    ds_read_b128 v[176:179], v1 offset:3072
    v_mul_f32 v62, v62, v13
    v_mul_f32 v63, v63, v13
    v_mfma_f32_32x32x16_bf16 v[144:159], a[188:191], v[188:191], v[144:159]
    buffer_load_dwordx4 v4, s[4:7], s38 offen offset:2048 sc1 lds
    s_waitcnt lgkmcnt(4)
    v_mfma_f32_32x32x16_bf16 v[128:143], v[208:211], v[160:163], v[128:143]
    ds_read_b128 v[180:183], v1 offset:13312
    v_cvt_pk_bf16_f32 v28, v56, v57
    v_cvt_pk_bf16_f32 v29, v58, v59
    v_mfma_f32_32x32x16_bf16 v[144:159], v[212:215], v[160:163], v[144:159]
    v_cvt_pk_bf16_f32 v30, v60, v61
    v_cvt_pk_bf16_f32 v31, v62, v63
    buffer_store_dwordx4 v[28:31], v7, s[4:7], s34 offen offset:0 sc1
    s_waitcnt lgkmcnt(4)
    v_mfma_f32_32x32x16_bf16 v[128:143], a[32:35], v[164:167], v[128:143]
    ds_read_b128 v[184:187], v1 offset:23552
    v_mul_f32 v64, v64, v13
    v_mul_f32 v65, v65, v13
    v_mfma_f32_32x32x16_bf16 v[144:159], a[36:39], v[164:167], v[144:159]
    buffer_load_dwordx4 v4, s[4:7], s38 offen offset:3072 sc1 lds
    s_waitcnt lgkmcnt(4)
    v_mfma_f32_32x32x16_bf16 v[128:143], a[112:115], v[168:171], v[128:143]
    ds_read_b128 v[188:191], v1 offset:33792
    v_mul_f32 v66, v66, v13
    v_mul_f32 v67, v67, v13
    v_mfma_f32_32x32x16_bf16 v[144:159], a[116:119], v[168:171], v[144:159]
    v_mul_f32 v68, v68, v13
    v_mul_f32 v69, v69, v13
    v_mul_f32 v70, v70, v13
    s_waitcnt lgkmcnt(4)
    v_mfma_f32_32x32x16_bf16 v[128:143], a[192:195], v[172:175], v[128:143]
    ds_read_b128 v[160:163], v1 offset:4096
    v_mul_f32 v71, v71, v13
    v_cvt_pk_bf16_f32 v32, v64, v65
    v_mfma_f32_32x32x16_bf16 v[144:159], a[196:199], v[172:175], v[144:159]
    s_add_u32 s38, s38, 4096
    s_add_u32 s39, s39, 4096
    s_mov_b32 m0, s39
    s_nop 0
    buffer_load_dwordx4 v4, s[4:7], s38 offen offset:0 sc1 lds
    s_waitcnt lgkmcnt(4)
    v_mfma_f32_32x32x16_bf16 v[128:143], v[216:219], v[176:179], v[128:143]
    ds_read_b128 v[164:167], v1 offset:14336
    v_cvt_pk_bf16_f32 v33, v66, v67
    v_cvt_pk_bf16_f32 v34, v68, v69
    v_mfma_f32_32x32x16_bf16 v[144:159], v[220:223], v[176:179], v[144:159]
    v_cvt_pk_bf16_f32 v35, v70, v71
    buffer_store_dwordx4 v[32:35], v6, s[4:7], s34 offen offset:2048 sc1
    v_mul_f32 v72, v72, v13
    s_waitcnt lgkmcnt(4)
    v_mfma_f32_32x32x16_bf16 v[128:143], a[40:43], v[180:183], v[128:143]
    ds_read_b128 v[168:171], v1 offset:24576
    v_mul_f32 v73, v73, v13
    v_mul_f32 v74, v74, v13
    v_mfma_f32_32x32x16_bf16 v[144:159], a[44:47], v[180:183], v[144:159]
    buffer_load_dwordx4 v4, s[4:7], s38 offen offset:1024 sc1 lds
    s_waitcnt lgkmcnt(4)
    v_mfma_f32_32x32x16_bf16 v[128:143], a[120:123], v[184:187], v[128:143]
    ds_read_b128 v[172:175], v1 offset:34816
    v_mul_f32 v75, v75, v13
    v_mul_f32 v76, v76, v13
    v_mfma_f32_32x32x16_bf16 v[144:159], a[124:127], v[184:187], v[144:159]
    v_mul_f32 v77, v77, v13
    v_mul_f32 v78, v78, v13
    v_mul_f32 v79, v79, v13
    s_waitcnt lgkmcnt(4)
    v_mfma_f32_32x32x16_bf16 v[128:143], a[200:203], v[188:191], v[128:143]
    ds_read_b128 v[176:179], v1 offset:5120
    v_cvt_pk_bf16_f32 v36, v72, v73
    v_cvt_pk_bf16_f32 v37, v74, v75
    v_mfma_f32_32x32x16_bf16 v[144:159], a[204:207], v[188:191], v[144:159]
    buffer_load_dwordx4 v4, s[4:7], s38 offen offset:2048 sc1 lds
    s_waitcnt lgkmcnt(4)
    v_mfma_f32_32x32x16_bf16 v[128:143], v[224:227], v[160:163], v[128:143]
    ds_read_b128 v[180:183], v1 offset:15360
    v_cvt_pk_bf16_f32 v38, v76, v77
    v_cvt_pk_bf16_f32 v39, v78, v79
    v_mfma_f32_32x32x16_bf16 v[144:159], v[228:231], v[160:163], v[144:159]
    buffer_store_dwordx4 v[36:39], v7, s[4:7], s34 offen offset:2048 sc1
    ds_read_b64 v[80:81], v9 offset:0
    ds_read_b64 v[82:83], v9 offset:256
    s_waitcnt lgkmcnt(6)
    v_mfma_f32_32x32x16_bf16 v[128:143], a[48:51], v[164:167], v[128:143]
    ds_read_b128 v[184:187], v1 offset:25600
    ds_read_b64 v[84:85], v9 offset:512
    ds_read_b64 v[86:87], v9 offset:768
    v_mfma_f32_32x32x16_bf16 v[144:159], a[52:55], v[164:167], v[144:159]
    buffer_load_dwordx4 v4, s[4:7], s38 offen offset:3072 sc1 lds
    s_waitcnt lgkmcnt(8)
    v_mfma_f32_32x32x16_bf16 v[128:143], a[128:131], v[168:171], v[128:143]
    ds_read_b128 v[188:191], v1 offset:35840
    s_waitcnt lgkmcnt(5)
    v_mov_b32 v16, v80
    v_mov_b32 v17, v81
    v_mfma_f32_32x32x16_bf16 v[144:159], a[132:135], v[168:171], v[144:159]
    s_waitcnt lgkmcnt(4)
    v_mov_b32 v18, v82
    v_mov_b32 v19, v83
    s_waitcnt lgkmcnt(2)
    v_add_f32 v16, v16, v84
    v_mfma_f32_32x32x16_bf16 v[128:143], a[208:211], v[172:175], v[128:143]
    ds_read_b128 v[160:163], v1 offset:6144
    v_add_f32 v17, v17, v85
    s_waitcnt lgkmcnt(2)
    v_add_f32 v18, v18, v86
    v_mfma_f32_32x32x16_bf16 v[144:159], a[212:215], v[172:175], v[144:159]
    s_add_u32 s38, s38, 4096
    s_add_u32 s39, s39, 4096
    s_mov_b32 m0, s39
    s_nop 0
    buffer_load_dwordx4 v4, s[4:7], s38 offen offset:0 sc1 lds
    v_mfma_f32_32x32x16_bf16 v[128:143], v[232:235], v[176:179], v[128:143]
    ds_read_b128 v[164:167], v1 offset:16384
    v_add_f32 v19, v19, v87
    ds_read_b64 v[80:81], v9 offset:1024
    v_mfma_f32_32x32x16_bf16 v[144:159], v[236:239], v[176:179], v[144:159]
    ds_read_b64 v[82:83], v9 offset:1280
    ds_read_b64 v[84:85], v9 offset:1536
    ds_read_b64 v[86:87], v9 offset:1792
    v_mfma_f32_32x32x16_bf16 v[128:143], a[56:59], v[180:183], v[128:143]
    ds_read_b128 v[168:171], v1 offset:26624
    s_waitcnt lgkmcnt(4)
    v_add_f32 v16, v16, v80
    v_add_f32 v17, v17, v81
    v_mfma_f32_32x32x16_bf16 v[144:159], a[60:63], v[180:183], v[144:159]
    buffer_load_dwordx4 v4, s[4:7], s38 offen offset:1024 sc1 lds
    v_mfma_f32_32x32x16_bf16 v[128:143], a[136:139], v[184:187], v[128:143]
    ds_read_b128 v[172:175], v1 offset:36864
    s_waitcnt lgkmcnt(4)
    v_add_f32 v18, v18, v82
    v_add_f32 v19, v19, v83
    v_mfma_f32_32x32x16_bf16 v[144:159], a[140:143], v[184:187], v[144:159]
    s_waitcnt lgkmcnt(3)
    v_add_f32 v16, v16, v84
    v_add_f32 v17, v17, v85
    s_waitcnt lgkmcnt(2)
    v_add_f32 v18, v18, v86
    v_mfma_f32_32x32x16_bf16 v[128:143], a[216:219], v[188:191], v[128:143]
    ds_read_b128 v[176:179], v1 offset:7168
    v_add_f32 v19, v19, v87
    ds_read_b64 v[80:81], v9 offset:2048
    v_mfma_f32_32x32x16_bf16 v[144:159], a[220:223], v[188:191], v[144:159]
    ds_read_b64 v[82:83], v9 offset:2304
    s_waitcnt lgkmcnt(1)
    v_add_f32 v16, v16, v80
    v_add_f32 v17, v17, v81
    v_mfma_f32_32x32x16_bf16 v[128:143], v[240:243], v[160:163], v[128:143]
    ds_read_b128 v[180:183], v1 offset:17408
    s_waitcnt lgkmcnt(1)
    v_add_f32 v18, v18, v82
    v_add_f32 v19, v19, v83
    v_mfma_f32_32x32x16_bf16 v[144:159], v[244:247], v[160:163], v[144:159]
    v_add_f32 v16, v16, v18
    v_add_f32 v17, v17, v19
    v_mov_b32 v18, v16
    v_mfma_f32_32x32x16_bf16 v[128:143], a[64:67], v[164:167], v[128:143]
    ds_read_b128 v[184:187], v1 offset:27648
    v_mov_b32 v19, v17
    s_nop 1
    v_mfma_f32_32x32x16_bf16 v[144:159], a[68:71], v[164:167], v[144:159]
    v_permlane32_swap_b32 v16, v18
    v_permlane32_swap_b32 v17, v19
    v_add_f32 v16, v16, v18
    v_mfma_f32_32x32x16_bf16 v[128:143], a[144:147], v[168:171], v[128:143]
    ds_read_b128 v[188:191], v1 offset:37888
    v_add_f32 v17, v17, v19
    v_mul_f32 v12, s42, v16
    v_mfma_f32_32x32x16_bf16 v[144:159], a[148:151], v[168:171], v[144:159]
    v_mul_f32 v15, s42, v17
    v_sub_f32 v16, 0, v12
    v_cvt_pk_bf16_f32 v121, v16, v16
    v_mfma_f32_32x32x16_bf16 v[128:143], a[224:227], v[172:175], v[128:143]
    ds_read_b128 v[160:163], v1 offset:8192
    v_fma_f32 v15, -v12, v12, v15
    v_and_b32 v17, 0xffff0000, v121
    v_mfma_f32_32x32x16_bf16 v[144:159], a[228:231], v[172:175], v[144:159]
    v_max_f32 v15, 0, v15
    v_sub_f32 v16, v16, v17
    v_add_f32 v18, s43, v15
    v_mfma_f32_32x32x16_bf16 v[128:143], v[248:251], v[176:179], v[128:143]
    ds_read_b128 v[164:167], v1 offset:18432
    v_cvt_pk_bf16_f32 v120, v17, v16
    v_rsq_f32 v13, v18
    v_mfma_f32_32x32x16_bf16 v[144:159], v[252:255], v[176:179], v[144:159]
    s_nop 0
    v_mfma_f32_32x32x16_bf16 v[128:143], v[112:115], v[120:123], v[128:143]
    v_mfma_f32_32x32x16_bf16 v[144:159], v[116:119], v[120:123], v[144:159]
    s_waitcnt lgkmcnt(4)
    v_mfma_f32_32x32x16_bf16 v[128:143], a[72:75], v[180:183], v[128:143]
    ds_read_b128 v[168:171], v1 offset:28672
    v_mfma_f32_32x32x16_bf16 v[144:159], a[76:79], v[180:183], v[144:159]
    s_waitcnt lgkmcnt(4)
    v_mfma_f32_32x32x16_bf16 v[128:143], a[152:155], v[184:187], v[128:143]
    ds_read_b128 v[172:175], v1 offset:38912
    v_mfma_f32_32x32x16_bf16 v[144:159], a[156:159], v[184:187], v[144:159]
    s_waitcnt lgkmcnt(4)
    v_mfma_f32_32x32x16_bf16 v[128:143], a[232:235], v[188:191], v[128:143]
    ds_read_b128 v[176:179], v1 offset:9216
    v_mfma_f32_32x32x16_bf16 v[144:159], a[236:239], v[188:191], v[144:159]
    s_waitcnt lgkmcnt(4)
    v_mfma_f32_32x32x16_bf16 v[128:143], a[0:3], v[160:163], v[128:143]
    ds_read_b128 v[180:183], v1 offset:19456
    v_mfma_f32_32x32x16_bf16 v[144:159], a[4:7], v[160:163], v[144:159]
    s_waitcnt lgkmcnt(4)
    v_mfma_f32_32x32x16_bf16 v[128:143], a[80:83], v[164:167], v[128:143]
    ds_read_b128 v[184:187], v1 offset:29696
    v_mfma_f32_32x32x16_bf16 v[144:159], a[84:87], v[164:167], v[144:159]
    s_waitcnt lgkmcnt(4)
    v_mfma_f32_32x32x16_bf16 v[128:143], a[160:163], v[168:171], v[128:143]
    ds_read_b128 v[188:191], v1 offset:39936
    v_mfma_f32_32x32x16_bf16 v[144:159], a[164:167], v[168:171], v[144:159]
    s_waitcnt lgkmcnt(4)
    v_mfma_f32_32x32x16_bf16 v[128:143], a[240:243], v[172:175], v[128:143]
    v_add_u32 v1, s35, v0
    s_waitcnt vmcnt(0)
    s_barrier
    ds_read_b128 v[160:163], v1 offset:0
    v_mfma_f32_32x32x16_bf16 v[144:159], a[244:247], v[172:175], v[144:159]
    s_waitcnt lgkmcnt(4)
    v_mfma_f32_32x32x16_bf16 v[128:143], a[8:11], v[176:179], v[128:143]
    ds_read_b128 v[164:167], v1 offset:10240
    s_sub_u32 s63, s26, s47
    s_mov_b32 s47, s26
    s_atomic_add s63, s[4:5], s21
    v_mfma_f32_32x32x16_bf16 v[144:159], a[12:15], v[176:179], v[144:159]
    s_waitcnt lgkmcnt(4)
    v_mfma_f32_32x32x16_bf16 v[128:143], a[88:91], v[180:183], v[128:143]
    ds_read_b128 v[168:171], v1 offset:20480
    s_add_u32 s26, s16, 1
    s_mul_i32 s34, s16, 262144
    s_add_u32 s34, s34, s19
    v_mfma_f32_32x32x16_bf16 v[144:159], a[92:95], v[180:183], v[144:159]
    s_waitcnt lgkmcnt(4)
    v_mfma_f32_32x32x16_bf16 v[128:143], a[168:171], v[184:187], v[128:143]
    ds_read_b128 v[172:175], v1 offset:30720
    s_mov_b32 s30, s24
    s_mov_b32 s24, s35
    s_mov_b32 s35, s36
    v_mfma_f32_32x32x16_bf16 v[144:159], a[172:175], v[184:187], v[144:159]
    s_waitcnt lgkmcnt(4)
    v_mfma_f32_32x32x16_bf16 v[128:143], a[248:251], v[188:191], v[128:143]
    ds_read_b128 v[176:179], v1 offset:1024
    s_mov_b32 s36, s30
    s_mov_b32 s16, s29
    s_cmp_ge_u32 s16, s46
    v_mfma_f32_32x32x16_bf16 v[144:159], a[252:255], v[188:191], v[144:159]
    s_cbranch_scc0 RQK_st
RQK_f1:
    s_nop 11
    v_mul_f32 v128, v128, v13
    v_mul_f32 v129, v129, v13
    v_mul_f32 v130, v130, v13
    v_mul_f32 v131, v131, v13
    v_mul_f32 v132, v132, v13
    v_mul_f32 v133, v133, v13
    v_mul_f32 v134, v134, v13
    v_mul_f32 v135, v135, v13
    v_cvt_pk_bf16_f32 v24, v128, v129
    v_cvt_pk_bf16_f32 v25, v130, v131
    v_cvt_pk_bf16_f32 v26, v132, v133
    v_cvt_pk_bf16_f32 v27, v134, v135
    buffer_store_dwordx4 v[24:27], v6, s[4:7], s34 offen offset:0 sc1
    v_mul_f32 v136, v136, v13
    v_mul_f32 v137, v137, v13
    v_mul_f32 v138, v138, v13
    v_mul_f32 v139, v139, v13
    v_mul_f32 v140, v140, v13
    v_mul_f32 v141, v141, v13
    v_mul_f32 v142, v142, v13
    v_mul_f32 v143, v143, v13
    v_cvt_pk_bf16_f32 v28, v136, v137
    v_cvt_pk_bf16_f32 v29, v138, v139
    v_cvt_pk_bf16_f32 v30, v140, v141
    v_cvt_pk_bf16_f32 v31, v142, v143
    buffer_store_dwordx4 v[28:31], v7, s[4:7], s34 offen offset:0 sc1
    v_mul_f32 v144, v144, v13
    v_mul_f32 v145, v145, v13
    v_mul_f32 v146, v146, v13
    v_mul_f32 v147, v147, v13
    v_mul_f32 v148, v148, v13
    v_mul_f32 v149, v149, v13
    v_mul_f32 v150, v150, v13
    v_mul_f32 v151, v151, v13
    v_cvt_pk_bf16_f32 v32, v144, v145
    v_cvt_pk_bf16_f32 v33, v146, v147
    v_cvt_pk_bf16_f32 v34, v148, v149
    v_cvt_pk_bf16_f32 v35, v150, v151
    buffer_store_dwordx4 v[32:35], v6, s[4:7], s34 offen offset:2048 sc1
    v_mul_f32 v152, v152, v13
    v_mul_f32 v153, v153, v13
    v_mul_f32 v154, v154, v13
    v_mul_f32 v155, v155, v13
    v_mul_f32 v156, v156, v13
    v_mul_f32 v157, v157, v13
    v_mul_f32 v158, v158, v13
    v_mul_f32 v159, v159, v13
    v_cvt_pk_bf16_f32 v36, v152, v153
    v_cvt_pk_bf16_f32 v37, v154, v155
    v_cvt_pk_bf16_f32 v38, v156, v157
    v_cvt_pk_bf16_f32 v39, v158, v159
    buffer_store_dwordx4 v[36:39], v7, s[4:7], s34 offen offset:2048 sc1
    s_branch G_6
RQK_f0:
    s_nop 11
    v_mul_f32 v48, v48, v13
    v_mul_f32 v49, v49, v13
    v_mul_f32 v50, v50, v13
    v_mul_f32 v51, v51, v13
    v_mul_f32 v52, v52, v13
    v_mul_f32 v53, v53, v13
    v_mul_f32 v54, v54, v13
    v_mul_f32 v55, v55, v13
    v_cvt_pk_bf16_f32 v24, v48, v49
    v_cvt_pk_bf16_f32 v25, v50, v51
    v_cvt_pk_bf16_f32 v26, v52, v53
    v_cvt_pk_bf16_f32 v27, v54, v55
    buffer_store_dwordx4 v[24:27], v6, s[4:7], s34 offen offset:0 sc1
    v_mul_f32 v56, v56, v13
    v_mul_f32 v57, v57, v13
    v_mul_f32 v58, v58, v13
    v_mul_f32 v59, v59, v13
    v_mul_f32 v60, v60, v13
    v_mul_f32 v61, v61, v13
    v_mul_f32 v62, v62, v13
    v_mul_f32 v63, v63, v13
    v_cvt_pk_bf16_f32 v28, v56, v57
    v_cvt_pk_bf16_f32 v29, v58, v59
    v_cvt_pk_bf16_f32 v30, v60, v61
    v_cvt_pk_bf16_f32 v31, v62, v63
    buffer_store_dwordx4 v[28:31], v7, s[4:7], s34 offen offset:0 sc1
    v_mul_f32 v64, v64, v13
    v_mul_f32 v65, v65, v13
    v_mul_f32 v66, v66, v13
    v_mul_f32 v67, v67, v13
    v_mul_f32 v68, v68, v13
    v_mul_f32 v69, v69, v13
    v_mul_f32 v70, v70, v13
    v_mul_f32 v71, v71, v13
    v_cvt_pk_bf16_f32 v32, v64, v65
    v_cvt_pk_bf16_f32 v33, v66, v67
    v_cvt_pk_bf16_f32 v34, v68, v69
    v_cvt_pk_bf16_f32 v35, v70, v71
    buffer_store_dwordx4 v[32:35], v6, s[4:7], s34 offen offset:2048 sc1
    v_mul_f32 v72, v72, v13
    v_mul_f32 v73, v73, v13
    v_mul_f32 v74, v74, v13
    v_mul_f32 v75, v75, v13
    v_mul_f32 v76, v76, v13
    v_mul_f32 v77, v77, v13
    v_mul_f32 v78, v78, v13
    v_mul_f32 v79, v79, v13
    v_cvt_pk_bf16_f32 v36, v72, v73
    v_cvt_pk_bf16_f32 v37, v74, v75
    v_cvt_pk_bf16_f32 v38, v76, v77
    v_cvt_pk_bf16_f32 v39, v78, v79
    buffer_store_dwordx4 v[36:39], v7, s[4:7], s34 offen offset:2048 sc1
G_6:
    s_waitcnt vmcnt(0) lgkmcnt(0)
    s_sub_u32 s63, s26, s47
    s_mov_b32 s47, s26
    s_atomic_add s63, s[4:5], s21
    s_branch RQK_done
G_5:
    v_min_u32 v20, 16, v5
    v_lshlrev_b32 v20, 5, v20
.p2align 6
RQK_loop:
    s_cmp_eq_u32 s22, 1
    s_cbranch_scc1 G_7
    s_cmp_eq_u32 s22, 2
    s_cbranch_scc1 G_9
RQK_poll:
    s_and_b32 s31, s16, s25
    s_lshl_b32 s31, s31, 15
    s_add_u32 s31, s31, s20
    s_add_u32 s37, s16, 1
    s_min_u32 s37, s37, 64
    s_cmp_eq_u32 s14, 0
    s_cselect_b32 s37, 0, s37
    v_mbcnt_lo_u32_b32 v16, -1, 0
    v_min_u32 v16, 4, v16
    v_lshlrev_b32 v16, 7, v16
    s_mov_b32 s23, 0
    s_mov_b64 exec, 0xffffffff
P_10:
    buffer_load_dword v17, v16, s[4:7], s31 offen sc1
    s_waitcnt vmcnt(0)
    v_cmp_gt_u32 vcc, s37, v17
    s_cbranch_vccz P_11
    s_add_u32 s23, s23, 1
    s_cmp_gt_u32 s23, 65536
    s_cbranch_scc1 L_exit
    s_sleep 1
    s_branch P_10
P_11:
    s_mov_b64 exec, -1
RQK_dma:
    s_mul_i32 s38, s16, 49152
    s_add_u32 s38, s38, s18
    s_mov_b32 s39, s24
    s_mul_i32 s30, s12, 1280
    s_add_u32 s30, s30, 40960
    s_add_u32 m0, s30, s39
    s_add_u32 s30, s30, s38
    buffer_load_dwordx4 v0, s[4:7], s30 offen sc1 lds
    buffer_load_dword v5, s[4:7], s30 offen offset:1024 sc1 lds
    s_mul_i32 s30, s12, 10240
    s_add_u32 s38, s38, s30
    s_add_u32 s39, s39, s30
    s_mov_b32 m0, s39
    s_nop 0
    buffer_load_dwordx4 v4, s[4:7], s38 offen offset:0 sc1 lds
    buffer_load_dwordx4 v4, s[4:7], s38 offen offset:1024 sc1 lds
    buffer_load_dwordx4 v4, s[4:7], s38 offen offset:2048 sc1 lds
    buffer_load_dwordx4 v4, s[4:7], s38 offen offset:3072 sc1 lds
    s_add_u32 s38, s38, 4096
    s_add_u32 s39, s39, 4096
    s_mov_b32 m0, s39
    s_nop 0
    buffer_load_dwordx4 v4, s[4:7], s38 offen offset:0 sc1 lds
    buffer_load_dwordx4 v4, s[4:7], s38 offen offset:1024 sc1 lds
    buffer_load_dwordx4 v4, s[4:7], s38 offen offset:2048 sc1 lds
    buffer_load_dwordx4 v4, s[4:7], s38 offen offset:3072 sc1 lds
    s_add_u32 s38, s38, 4096
    s_add_u32 s39, s39, 4096
    s_mov_b32 m0, s39
    s_nop 0
    buffer_load_dwordx4 v4, s[4:7], s38 offen offset:0 sc1 lds
    buffer_load_dwordx4 v4, s[4:7], s38 offen offset:1024 sc1 lds
G_9:
    s_waitcnt vmcnt(6)
    s_branch G_8
G_7:
    s_waitcnt vmcnt(4)
G_8:
    v_add_u32 v1, s24, v0
    v_add_u32 v2, 0x10000, v1
    v_add_u32 v9, s24, v3
    s_cmp_lt_u32 s16, 35
    s_cselect_b32 s17, s17, 1
    s_add_u32 s29, s16, s17
    s_cmp_eq_u32 s22, 1
    s_cselect_b64 vcc, -1, 0
    s_barrier
    ds_read_b128 v[24:27], v1 offset:0
    ds_read_b128 v[28:31], v1 offset:10240
    ds_read_b128 v[32:35], v1 offset:20480
    ds_read_b128 v[36:39], v1 offset:30720
    ds_read_b128 v[40:43], v1 offset:1024
    s_and_b32 s31, s29, s25
    s_lshl_b32 s31, s31, 15
    s_add_u32 s31, s31, s20
    s_add_u32 s37, s29, 1
    s_min_u32 s37, s37, 64
    s_cmp_eq_u32 s14, 0
    s_cselect_b32 s37, 0, s37
    s_mov_b32 s62, s31
    s_waitcnt lgkmcnt(4)
    v_mfma_f32_32x32x16_bf16 v[48:63], v[192:195], v[24:27], 0
    ds_read_b128 v[44:47], v1 offset:11264
    ds_read_b64 v[80:81], v9 offset:0
    ds_read_b64 v[82:83], v9 offset:256
    v_mfma_f32_32x32x16_bf16 v[64:79], v[196:199], v[24:27], 0
    ds_read_b64 v[84:85], v9 offset:512
    ds_read_b64 v[86:87], v9 offset:768
    s_waitcnt lgkmcnt(8)
    v_mfma_f32_32x32x16_bf16 v[48:63], a[16:19], v[28:31], v[48:63]
    ds_read_b128 v[24:27], v1 offset:21504
    s_waitcnt lgkmcnt(4)
    v_mov_b32 v16, v80
    v_mov_b32 v17, v81
    v_mfma_f32_32x32x16_bf16 v[64:79], a[20:23], v[28:31], v[64:79]
    s_waitcnt lgkmcnt(3)
    v_mov_b32 v18, v82
    v_mov_b32 v19, v83
    v_mfma_f32_32x32x16_bf16 v[48:63], a[96:99], v[32:35], v[48:63]
    ds_read_b128 v[28:31], v1 offset:31744
    s_waitcnt lgkmcnt(3)
    v_add_f32 v16, v16, v84
    v_add_f32 v17, v17, v85
    v_mfma_f32_32x32x16_bf16 v[64:79], a[100:103], v[32:35], v[64:79]
    s_waitcnt lgkmcnt(2)
    v_add_f32 v18, v18, v86
    v_add_f32 v19, v19, v87
    v_mfma_f32_32x32x16_bf16 v[48:63], a[176:179], v[36:39], v[48:63]
    ds_read_b128 v[32:35], v1 offset:2048
    ds_read_b64 v[80:81], v9 offset:1024
    ds_read_b64 v[82:83], v9 offset:1280
    v_mfma_f32_32x32x16_bf16 v[64:79], a[180:183], v[36:39], v[64:79]
    ds_read_b64 v[84:85], v9 offset:1536
    ds_read_b64 v[86:87], v9 offset:1792
    v_mfma_f32_32x32x16_bf16 v[48:63], v[200:203], v[40:43], v[48:63]
    ds_read_b128 v[36:39], v1 offset:12288
    s_waitcnt lgkmcnt(4)
    v_add_f32 v16, v16, v80
    v_add_f32 v17, v17, v81
    v_mfma_f32_32x32x16_bf16 v[64:79], v[204:207], v[40:43], v[64:79]
    s_waitcnt lgkmcnt(3)
    v_add_f32 v18, v18, v82
    v_add_f32 v19, v19, v83
    v_mfma_f32_32x32x16_bf16 v[48:63], a[24:27], v[44:47], v[48:63]
    ds_read_b128 v[40:43], v1 offset:22528
    s_waitcnt lgkmcnt(3)
    v_add_f32 v16, v16, v84
    v_add_f32 v17, v17, v85
    v_mfma_f32_32x32x16_bf16 v[64:79], a[28:31], v[44:47], v[64:79]
    s_waitcnt lgkmcnt(2)
    v_add_f32 v18, v18, v86
    v_add_f32 v19, v19, v87
    v_mfma_f32_32x32x16_bf16 v[48:63], a[104:107], v[24:27], v[48:63]
    ds_read_b128 v[44:47], v1 offset:32768
    ds_read_b64 v[80:81], v9 offset:2048
    ds_read_b64 v[82:83], v9 offset:2304
    v_mfma_f32_32x32x16_bf16 v[64:79], a[108:111], v[24:27], v[64:79]
    s_waitcnt lgkmcnt(1)
    v_add_f32 v16, v16, v80
    v_add_f32 v17, v17, v81
    v_mfma_f32_32x32x16_bf16 v[48:63], a[184:187], v[28:31], v[48:63]
    ds_read_b128 v[24:27], v1 offset:3072
    s_waitcnt lgkmcnt(1)
    v_add_f32 v18, v18, v82
    v_add_f32 v19, v19, v83
    v_mfma_f32_32x32x16_bf16 v[64:79], a[188:191], v[28:31], v[64:79]
    v_add_f32 v16, v16, v18
    v_add_f32 v17, v17, v19
    s_cmp_lg_u32 s26, 0
    s_cbranch_scc1 G_12
G_13:
    v_mfma_f32_32x32x16_bf16 v[48:63], v[208:211], v[32:35], v[48:63]
    ds_read_b128 v[28:31], v1 offset:13312
    v_mov_b32 v18, v16
    v_mov_b32 v19, v17
    v_mfma_f32_32x32x16_bf16 v[64:79], v[212:215], v[32:35], v[64:79]
    s_nop 1
    v_permlane32_swap_b32 v16, v18
    v_mfma_f32_32x32x16_bf16 v[48:63], a[32:35], v[36:39], v[48:63]
    ds_read_b128 v[32:35], v1 offset:23552
    v_permlane32_swap_b32 v17, v19
    v_add_f32 v16, v16, v18
    v_mfma_f32_32x32x16_bf16 v[64:79], a[36:39], v[36:39], v[64:79]
    v_add_f32 v17, v17, v19
    v_mul_f32 v12, s42, v16
    v_mfma_f32_32x32x16_bf16 v[48:63], a[112:115], v[40:43], v[48:63]
    ds_read_b128 v[36:39], v1 offset:33792
    v_mul_f32 v15, s42, v17
    v_sub_f32 v16, 0, v12
    v_mfma_f32_32x32x16_bf16 v[64:79], a[116:119], v[40:43], v[64:79]
    v_cvt_pk_bf16_f32 v121, v16, v16
    v_fma_f32 v15, -v12, v12, v15
    v_mfma_f32_32x32x16_bf16 v[48:63], a[192:195], v[44:47], v[48:63]
    s_cbranch_vccnz G_14
    s_waitcnt vmcnt(0)
G_14:
    s_barrier
    ds_read_b128 v[40:43], v1 offset:4096
    v_and_b32 v17, 0xffff0000, v121
    v_max_f32 v15, 0, v15
    v_mfma_f32_32x32x16_bf16 v[64:79], a[196:199], v[44:47], v[64:79]
    v_sub_f32 v16, v16, v17
    v_add_f32 v18, s43, v15
    s_waitcnt lgkmcnt(4)
    v_mfma_f32_32x32x16_bf16 v[48:63], v[216:219], v[24:27], v[48:63]
    ds_read_b128 v[44:47], v1 offset:14336
    v_cvt_pk_bf16_f32 v120, v17, v16
    v_rsq_f32 v13, v18
    v_mfma_f32_32x32x16_bf16 v[64:79], v[220:223], v[24:27], v[64:79]
    s_nop 0
    v_mfma_f32_32x32x16_bf16 v[48:63], v[112:115], v[120:123], v[48:63]
    s_waitcnt lgkmcnt(4)
    v_mfma_f32_32x32x16_bf16 v[48:63], a[40:43], v[28:31], v[48:63]
    ds_read_b128 v[24:27], v1 offset:24576
    v_mfma_f32_32x32x16_bf16 v[64:79], v[116:119], v[120:123], v[64:79]
    v_mfma_f32_32x32x16_bf16 v[64:79], a[44:47], v[28:31], v[64:79]
    s_waitcnt lgkmcnt(4)
    v_mfma_f32_32x32x16_bf16 v[48:63], a[120:123], v[32:35], v[48:63]
    ds_read_b128 v[28:31], v1 offset:34816
    v_mfma_f32_32x32x16_bf16 v[64:79], a[124:127], v[32:35], v[64:79]
    s_waitcnt lgkmcnt(4)
    v_mfma_f32_32x32x16_bf16 v[48:63], a[200:203], v[36:39], v[48:63]
    ds_read_b128 v[32:35], v1 offset:5120
    v_mfma_f32_32x32x16_bf16 v[64:79], a[204:207], v[36:39], v[64:79]
    s_waitcnt lgkmcnt(4)
    v_mfma_f32_32x32x16_bf16 v[48:63], v[224:227], v[40:43], v[48:63]
    ds_read_b128 v[36:39], v1 offset:15360
    v_mfma_f32_32x32x16_bf16 v[64:79], v[228:231], v[40:43], v[64:79]
    s_waitcnt lgkmcnt(4)
    v_mfma_f32_32x32x16_bf16 v[48:63], a[48:51], v[44:47], v[48:63]
    ds_read_b128 v[40:43], v1 offset:25600
    v_mfma_f32_32x32x16_bf16 v[64:79], a[52:55], v[44:47], v[64:79]
    s_waitcnt lgkmcnt(4)
    v_mfma_f32_32x32x16_bf16 v[48:63], a[128:131], v[24:27], v[48:63]
    ds_read_b128 v[44:47], v1 offset:35840
    s_sub_u32 s31, s62, 0
    s_mov_b32 s32, 1
    buffer_load_dword v21, v20, s[4:7], s31 offen sc1
G_15:
    v_mfma_f32_32x32x16_bf16 v[64:79], a[132:135], v[24:27], v[64:79]
    s_waitcnt lgkmcnt(4)
    v_mfma_f32_32x32x16_bf16 v[48:63], a[208:211], v[28:31], v[48:63]
    ds_read_b128 v[24:27], v1 offset:6144
    v_mfma_f32_32x32x16_bf16 v[64:79], a[212:215], v[28:31], v[64:79]
    s_waitcnt lgkmcnt(4)
    v_mfma_f32_32x32x16_bf16 v[48:63], v[232:235], v[32:35], v[48:63]
    ds_read_b128 v[28:31], v1 offset:16384
    v_mfma_f32_32x32x16_bf16 v[64:79], v[236:239], v[32:35], v[64:79]
    s_waitcnt lgkmcnt(4)
    v_mfma_f32_32x32x16_bf16 v[48:63], a[56:59], v[36:39], v[48:63]
    ds_read_b128 v[32:35], v1 offset:26624
    v_mfma_f32_32x32x16_bf16 v[64:79], a[60:63], v[36:39], v[64:79]
    s_waitcnt lgkmcnt(4)
    v_mfma_f32_32x32x16_bf16 v[48:63], a[136:139], v[40:43], v[48:63]
    ds_read_b128 v[36:39], v1 offset:36864
    v_mfma_f32_32x32x16_bf16 v[64:79], a[140:143], v[40:43], v[64:79]
    s_waitcnt lgkmcnt(4)
    v_mfma_f32_32x32x16_bf16 v[48:63], a[216:219], v[44:47], v[48:63]
    ds_read_b128 v[40:43], v1 offset:7168
    v_mfma_f32_32x32x16_bf16 v[64:79], a[220:223], v[44:47], v[64:79]
    s_waitcnt lgkmcnt(4)
    v_mfma_f32_32x32x16_bf16 v[48:63], v[240:243], v[24:27], v[48:63]
    ds_read_b128 v[44:47], v1 offset:17408
    v_mfma_f32_32x32x16_bf16 v[64:79], v[244:247], v[24:27], v[64:79]
    s_waitcnt lgkmcnt(4)
    v_mfma_f32_32x32x16_bf16 v[48:63], a[64:67], v[28:31], v[48:63]
    ds_read_b128 v[24:27], v1 offset:27648
    v_mfma_f32_32x32x16_bf16 v[64:79], a[68:71], v[28:31], v[64:79]
    s_waitcnt lgkmcnt(4)
    v_mfma_f32_32x32x16_bf16 v[48:63], a[144:147], v[32:35], v[48:63]
    ds_read_b128 v[28:31], v1 offset:37888
    v_mfma_f32_32x32x16_bf16 v[64:79], a[148:151], v[32:35], v[64:79]
    s_waitcnt lgkmcnt(4)
    v_mfma_f32_32x32x16_bf16 v[48:63], a[224:227], v[36:39], v[48:63]
    ds_read_b128 v[32:35], v1 offset:8192
    v_mfma_f32_32x32x16_bf16 v[64:79], a[228:231], v[36:39], v[64:79]
    s_cmp_lg_u32 s32, 0
    s_cbranch_scc1 G_17
G_18:
    s_waitcnt lgkmcnt(4)
    v_mfma_f32_32x32x16_bf16 v[48:63], v[248:251], v[40:43], v[48:63]
    ds_read_b128 v[36:39], v1 offset:18432
    v_mfma_f32_32x32x16_bf16 v[64:79], v[252:255], v[40:43], v[64:79]
    s_waitcnt lgkmcnt(4)
    v_mfma_f32_32x32x16_bf16 v[48:63], a[72:75], v[44:47], v[48:63]
    ds_read_b128 v[40:43], v1 offset:28672
    v_mfma_f32_32x32x16_bf16 v[64:79], a[76:79], v[44:47], v[64:79]
    s_waitcnt lgkmcnt(4)
    v_mfma_f32_32x32x16_bf16 v[48:63], a[152:155], v[24:27], v[48:63]
    ds_read_b128 v[44:47], v1 offset:38912
    v_mfma_f32_32x32x16_bf16 v[64:79], a[156:159], v[24:27], v[64:79]
    s_waitcnt lgkmcnt(4)
    v_mfma_f32_32x32x16_bf16 v[48:63], a[232:235], v[28:31], v[48:63]
    ds_read_b128 v[24:27], v1 offset:9216
    v_mfma_f32_32x32x16_bf16 v[64:79], a[236:239], v[28:31], v[64:79]
    s_waitcnt lgkmcnt(4)
    v_mfma_f32_32x32x16_bf16 v[48:63], a[0:3], v[32:35], v[48:63]
    ds_read_b128 v[28:31], v1 offset:19456
    v_mfma_f32_32x32x16_bf16 v[64:79], a[4:7], v[32:35], v[64:79]
    s_waitcnt lgkmcnt(4)
    v_mfma_f32_32x32x16_bf16 v[48:63], a[80:83], v[36:39], v[48:63]
    ds_read_b128 v[32:35], v1 offset:29696
    v_mfma_f32_32x32x16_bf16 v[64:79], a[84:87], v[36:39], v[64:79]
    s_waitcnt lgkmcnt(4)
    v_mfma_f32_32x32x16_bf16 v[48:63], a[160:163], v[40:43], v[48:63]
    ds_read_b128 v[36:39], v1 offset:39936
    v_mfma_f32_32x32x16_bf16 v[64:79], a[164:167], v[40:43], v[64:79]
    s_waitcnt lgkmcnt(4)
    v_mfma_f32_32x32x16_bf16 v[48:63], a[240:243], v[44:47], v[48:63]
    v_mfma_f32_32x32x16_bf16 v[64:79], a[244:247], v[44:47], v[64:79]
    s_waitcnt lgkmcnt(3)
    v_mfma_f32_32x32x16_bf16 v[48:63], a[8:11], v[24:27], v[48:63]
    v_mfma_f32_32x32x16_bf16 v[64:79], a[12:15], v[24:27], v[64:79]
    s_waitcnt lgkmcnt(2)
    v_mfma_f32_32x32x16_bf16 v[48:63], a[88:91], v[28:31], v[48:63]
    v_mfma_f32_32x32x16_bf16 v[64:79], a[92:95], v[28:31], v[64:79]
    s_waitcnt lgkmcnt(1)
    v_mfma_f32_32x32x16_bf16 v[48:63], a[168:171], v[32:35], v[48:63]
    v_mfma_f32_32x32x16_bf16 v[64:79], a[172:175], v[32:35], v[64:79]
    s_waitcnt lgkmcnt(0)
    v_mfma_f32_32x32x16_bf16 v[48:63], a[248:251], v[36:39], v[48:63]
    v_mfma_f32_32x32x16_bf16 v[64:79], a[252:255], v[36:39], v[64:79]
    s_branch G_19
G_12:
    s_waitcnt vmcnt(0)
    s_sub_u32 s63, s26, s47
    s_mov_b32 s47, s26
    s_atomic_add s63, s[4:5], s21
    s_mov_b32 s26, 0
    s_branch G_13
G_17:
    s_waitcnt vmcnt(0)
    v_cmp_gt_u32 vcc, s37, v21
    s_sub_u32 s33, 46080, s24
    s_mov_b32 s22, 0
    s_cbranch_vccnz G_18
    s_cmp_ge_u32 s29, s46
    s_cbranch_scc1 G_18
    s_mov_b32 s22, 1
    s_waitcnt lgkmcnt(4)
    v_mfma_f32_32x32x16_bf16 v[48:63], v[248:251], v[40:43], v[48:63]
    ds_read_b128 v[36:39], v1 offset:18432
    v_mfma_f32_32x32x16_bf16 v[64:79], v[252:255], v[40:43], v[64:79]
    s_mul_i32 s38, s29, 49152
    s_add_u32 s38, s38, s18
    s_mov_b32 s39, s33
    s_mul_i32 s30, s12, 1280
    s_add_u32 s30, s30, 40960
    s_add_u32 m0, s30, s39
    s_add_u32 s30, s30, s38
    buffer_load_dwordx4 v0, s[4:7], s30 offen sc1 lds
    buffer_load_dword v5, s[4:7], s30 offen offset:1024 sc1 lds
    s_waitcnt lgkmcnt(4)
    v_mfma_f32_32x32x16_bf16 v[48:63], a[72:75], v[44:47], v[48:63]
    ds_read_b128 v[40:43], v1 offset:28672
    v_mfma_f32_32x32x16_bf16 v[64:79], a[76:79], v[44:47], v[64:79]
    s_mul_i32 s30, s12, 10240
    s_add_u32 s38, s38, s30
    s_add_u32 s39, s39, s30
    s_mov_b32 m0, s39
    s_nop 0
    buffer_load_dwordx4 v4, s[4:7], s38 offen offset:0 sc1 lds
    s_waitcnt lgkmcnt(4)
    v_mfma_f32_32x32x16_bf16 v[48:63], a[152:155], v[24:27], v[48:63]
    ds_read_b128 v[44:47], v1 offset:38912
    v_mfma_f32_32x32x16_bf16 v[64:79], a[156:159], v[24:27], v[64:79]
    buffer_load_dwordx4 v4, s[4:7], s38 offen offset:1024 sc1 lds
    s_waitcnt lgkmcnt(4)
    v_mfma_f32_32x32x16_bf16 v[48:63], a[232:235], v[28:31], v[48:63]
    ds_read_b128 v[24:27], v1 offset:9216
    v_mfma_f32_32x32x16_bf16 v[64:79], a[236:239], v[28:31], v[64:79]
    buffer_load_dwordx4 v4, s[4:7], s38 offen offset:2048 sc1 lds
    s_waitcnt lgkmcnt(4)
    v_mfma_f32_32x32x16_bf16 v[48:63], a[0:3], v[32:35], v[48:63]
    ds_read_b128 v[28:31], v1 offset:19456
    v_mfma_f32_32x32x16_bf16 v[64:79], a[4:7], v[32:35], v[64:79]
    buffer_load_dwordx4 v4, s[4:7], s38 offen offset:3072 sc1 lds
    s_waitcnt lgkmcnt(4)
    v_mfma_f32_32x32x16_bf16 v[48:63], a[80:83], v[36:39], v[48:63]
    ds_read_b128 v[32:35], v1 offset:29696
    v_mfma_f32_32x32x16_bf16 v[64:79], a[84:87], v[36:39], v[64:79]
    s_add_u32 s38, s38, 4096
    s_add_u32 s39, s39, 4096
    s_mov_b32 m0, s39
    s_nop 0
    buffer_load_dwordx4 v4, s[4:7], s38 offen offset:0 sc1 lds
    s_waitcnt lgkmcnt(4)
    v_mfma_f32_32x32x16_bf16 v[48:63], a[160:163], v[40:43], v[48:63]
    ds_read_b128 v[36:39], v1 offset:39936
    v_mfma_f32_32x32x16_bf16 v[64:79], a[164:167], v[40:43], v[64:79]
    buffer_load_dwordx4 v4, s[4:7], s38 offen offset:1024 sc1 lds
    s_waitcnt lgkmcnt(4)
    v_mfma_f32_32x32x16_bf16 v[48:63], a[240:243], v[44:47], v[48:63]
    v_mfma_f32_32x32x16_bf16 v[64:79], a[244:247], v[44:47], v[64:79]
    buffer_load_dwordx4 v4, s[4:7], s38 offen offset:2048 sc1 lds
    s_waitcnt lgkmcnt(3)
    v_mfma_f32_32x32x16_bf16 v[48:63], a[8:11], v[24:27], v[48:63]
    v_mfma_f32_32x32x16_bf16 v[64:79], a[12:15], v[24:27], v[64:79]
    buffer_load_dwordx4 v4, s[4:7], s38 offen offset:3072 sc1 lds
    s_waitcnt lgkmcnt(2)
    v_mfma_f32_32x32x16_bf16 v[48:63], a[88:91], v[28:31], v[48:63]
    v_mfma_f32_32x32x16_bf16 v[64:79], a[92:95], v[28:31], v[64:79]
    s_add_u32 s38, s38, 4096
    s_add_u32 s39, s39, 4096
    s_mov_b32 m0, s39
    s_nop 0
    buffer_load_dwordx4 v4, s[4:7], s38 offen offset:0 sc1 lds
    s_waitcnt lgkmcnt(1)
    v_mfma_f32_32x32x16_bf16 v[48:63], a[168:171], v[32:35], v[48:63]
    v_mfma_f32_32x32x16_bf16 v[64:79], a[172:175], v[32:35], v[64:79]
    buffer_load_dwordx4 v4, s[4:7], s38 offen offset:1024 sc1 lds
    s_waitcnt lgkmcnt(0)
    v_mfma_f32_32x32x16_bf16 v[48:63], a[248:251], v[36:39], v[48:63]
    v_mfma_f32_32x32x16_bf16 v[64:79], a[252:255], v[36:39], v[64:79]
G_19:
    s_cmp_lg_u32 s22, 0
    s_cbranch_scc1 G_20
    s_sub_u32 s31, s62, 0
    buffer_load_dword v21, v20, s[4:7], s31 offen sc1
G_20:
    s_mul_i32 s30, s16, 262144
    s_add_u32 s32, s30, s28
    s_add_u32 s30, s30, s19
    v_mov_b32 v16, v13
    v_mov_b32 v17, v13
    s_nop 6
    v_pk_mul_f32 v[48:49], v[48:49], v[16:17]
    v_pk_mul_f32 v[50:51], v[50:51], v[16:17]
    v_pk_mul_f32 v[52:53], v[52:53], v[16:17]
    v_pk_mul_f32 v[54:55], v[54:55], v[16:17]
    v_cvt_pk_bf16_f32 v24, v48, v49
    v_cvt_pk_bf16_f32 v25, v50, v51
    v_cvt_pk_bf16_f32 v26, v52, v53
    v_cvt_pk_bf16_f32 v27, v54, v55
    buffer_store_dwordx4 v[24:27], v6, s[4:7], s30 offen offset:0 sc1
    v_pk_mul_f32 v[56:57], v[56:57], v[16:17]
    v_pk_mul_f32 v[58:59], v[58:59], v[16:17]
    v_pk_mul_f32 v[60:61], v[60:61], v[16:17]
    v_pk_mul_f32 v[62:63], v[62:63], v[16:17]
    v_cvt_pk_bf16_f32 v28, v56, v57
    v_cvt_pk_bf16_f32 v29, v58, v59
    v_cvt_pk_bf16_f32 v30, v60, v61
    v_cvt_pk_bf16_f32 v31, v62, v63
    buffer_store_dwordx4 v[28:31], v7, s[4:7], s30 offen offset:0 sc1
    v_pk_mul_f32 v[64:65], v[64:65], v[16:17]
    v_pk_mul_f32 v[66:67], v[66:67], v[16:17]
    v_pk_mul_f32 v[68:69], v[68:69], v[16:17]
    v_pk_mul_f32 v[70:71], v[70:71], v[16:17]
    v_cvt_pk_bf16_f32 v32, v64, v65
    v_cvt_pk_bf16_f32 v33, v66, v67
    v_cvt_pk_bf16_f32 v34, v68, v69
    v_cvt_pk_bf16_f32 v35, v70, v71
    buffer_store_dwordx4 v[32:35], v6, s[4:7], s30 offen offset:2048 sc1
    v_pk_mul_f32 v[72:73], v[72:73], v[16:17]
    v_pk_mul_f32 v[74:75], v[74:75], v[16:17]
    v_pk_mul_f32 v[76:77], v[76:77], v[16:17]
    v_pk_mul_f32 v[78:79], v[78:79], v[16:17]
    v_cvt_pk_bf16_f32 v36, v72, v73
    v_cvt_pk_bf16_f32 v37, v74, v75
    v_cvt_pk_bf16_f32 v38, v76, v77
    v_cvt_pk_bf16_f32 v39, v78, v79
    buffer_store_dwordx4 v[36:39], v7, s[4:7], s30 offen offset:2048 sc1
    s_add_u32 s32, s16, 1
    s_sub_u32 s24, 46080, s24
    s_mov_b32 s26, s32
    s_cmp_lg_u32 s22, 0
    s_cbranch_scc1 G_23
    s_mov_b32 s26, 0
    s_waitcnt lgkmcnt(0)
    s_cmp_ge_u32 s29, s46
    s_cbranch_scc1 G_24
    s_waitcnt vmcnt(4)
    v_cmp_gt_u32 vcc, s37, v21
    s_cbranch_vccnz G_21
    s_mov_b32 s22, 2
    s_mul_i32 s38, s29, 49152
    s_add_u32 s38, s38, s18
    s_mov_b32 s39, s24
    s_mul_i32 s30, s12, 1280
    s_add_u32 s30, s30, 40960
    s_add_u32 m0, s30, s39
    s_add_u32 s30, s30, s38
    buffer_load_dwordx4 v0, s[4:7], s30 offen sc1 lds
    buffer_load_dword v5, s[4:7], s30 offen offset:1024 sc1 lds
    s_mul_i32 s30, s12, 10240
    s_add_u32 s38, s38, s30
    s_add_u32 s39, s39, s30
    s_mov_b32 m0, s39
    s_nop 0
    buffer_load_dwordx4 v4, s[4:7], s38 offen offset:0 sc1 lds
    buffer_load_dwordx4 v4, s[4:7], s38 offen offset:1024 sc1 lds
    buffer_load_dwordx4 v4, s[4:7], s38 offen offset:2048 sc1 lds
    buffer_load_dwordx4 v4, s[4:7], s38 offen offset:3072 sc1 lds
    s_add_u32 s38, s38, 4096
    s_add_u32 s39, s39, 4096
    s_mov_b32 m0, s39
    s_nop 0
    buffer_load_dwordx4 v4, s[4:7], s38 offen offset:0 sc1 lds
    buffer_load_dwordx4 v4, s[4:7], s38 offen offset:1024 sc1 lds
    buffer_load_dwordx4 v4, s[4:7], s38 offen offset:2048 sc1 lds
    buffer_load_dwordx4 v4, s[4:7], s38 offen offset:3072 sc1 lds
    s_add_u32 s38, s38, 4096
    s_add_u32 s39, s39, 4096
    s_mov_b32 m0, s39
    s_nop 0
    buffer_load_dwordx4 v4, s[4:7], s38 offen offset:0 sc1 lds
    buffer_load_dwordx4 v4, s[4:7], s38 offen offset:1024 sc1 lds
    s_waitcnt vmcnt(12)
    s_branch G_22
G_21:
    buffer_load_dword v21, v20, s[4:7], s62 offen sc1
    s_waitcnt vmcnt(1)
    s_sub_u32 s63, s32, s47
    s_mov_b32 s47, s32
    s_atomic_add s63, s[4:5], s21
    s_mov_b32 s16, s29
    s_waitcnt vmcnt(0)
    v_cmp_gt_u32 vcc, s37, v21
    s_cbranch_vccnz RQK_poll
    s_mov_b32 s22, 0
    s_branch RQK_dma
G_24:
    s_waitcnt vmcnt(0)
G_22:
    s_sub_u32 s63, s32, s47
    s_mov_b32 s47, s32
    s_atomic_add s63, s[4:5], s21
G_23:
    s_mov_b32 s16, s29
    s_cmp_lt_u32 s16, s46
    s_cbranch_scc1 RQK_loop
RQK_done:
    s_or_b32 s30, s15, s14
    s_cbranch_scc1 G_25
    s_mov_b32 s14, 1
    s_branch RQK_job
G_25:
    s_branch L_next
RV:
    v_mbcnt_lo_u32_b32 v12, -1, 0
    v_mbcnt_hi_u32_b32 v12, -1, v12
    v_lshlrev_b32 v0, 4, v12
    v_lshlrev_b32 v8, 3, v12
    v_lshlrev_b32 v5, 2, v12
    s_mov_b32 s44, 0
    s_mov_b32 s45, -1
    s_barrier
    s_load_dwordx2 s[8:9], s[0:1], 32
    s_mov_b32 s10, 5242880
    s_mov_b32 s11, 0x20000
    s_and_b32 s32, s13, 15
    s_lshl_b32 s32, s32, 9
    s_waitcnt lgkmcnt(0)
    v_lshrrev_b32 v13, 3, v12
    v_and_b32 v14, 7, v12
    s_mov_b32 s30, 8192
    v_mul_lo_u32 v13, v13, s30
    v_lshl_add_u32 v13, v14, 4, v13
    s_mul_i32 s30, s12, 128
    s_add_u32 s30, s30, s32
    v_add_u32 v13, s30, v13
    v_lshrrev_b32 v14, 5, v12
    v_bfe_u32 v15, v12, 2, 2
    v_lshl_add_u32 v15, v14, 3, v15
    v_mul_u32_u24 v15, 128, v15
    v_bfe_u32 v16, v12, 4, 1
    v_lshl_add_u32 v15, v16, 5, v15
    v_and_b32 v16, 1, v12
    v_lshl_add_u32 v15, v16, 4, v15
    v_bfe_u32 v16, v12, 1, 1
    v_lshl_add_u32 v15, v16, 3, v15
    s_mul_i32 s33, s12, 40960
    v_add_u32 v15, s33, v15
    s_add_u32 m0, s33, 0
    s_mov_b32 s30, 0
    buffer_load_dwordx4 v13, s[8:11], s30 offen lds
    s_add_u32 m0, s33, 1024
    s_mov_b32 s30, 65536
    buffer_load_dwordx4 v13, s[8:11], s30 offen lds
    s_add_u32 m0, s33, 2048
    s_mov_b32 s30, 131072
    buffer_load_dwordx4 v13, s[8:11], s30 offen lds
    s_add_u32 m0, s33, 3072
    s_mov_b32 s30, 196608
    buffer_load_dwordx4 v13, s[8:11], s30 offen lds
    s_add_u32 m0, s33, 4096
    s_mov_b32 s30, 262144
    buffer_load_dwordx4 v13, s[8:11], s30 offen lds
    s_add_u32 m0, s33, 5120
    s_mov_b32 s30, 327680
    buffer_load_dwordx4 v13, s[8:11], s30 offen lds
    s_add_u32 m0, s33, 6144
    s_mov_b32 s30, 393216
    buffer_load_dwordx4 v13, s[8:11], s30 offen lds
    s_add_u32 m0, s33, 7168
    s_mov_b32 s30, 458752
    buffer_load_dwordx4 v13, s[8:11], s30 offen lds
    s_add_u32 m0, s33, 8192
    s_mov_b32 s30, 524288
    buffer_load_dwordx4 v13, s[8:11], s30 offen lds
    s_add_u32 m0, s33, 9216
    s_mov_b32 s30, 589824
    buffer_load_dwordx4 v13, s[8:11], s30 offen lds
    s_add_u32 m0, s33, 10240
    s_mov_b32 s30, 655360
    buffer_load_dwordx4 v13, s[8:11], s30 offen lds
    s_add_u32 m0, s33, 11264
    s_mov_b32 s30, 720896
    buffer_load_dwordx4 v13, s[8:11], s30 offen lds
    s_add_u32 m0, s33, 12288
    s_mov_b32 s30, 786432
    buffer_load_dwordx4 v13, s[8:11], s30 offen lds
    s_add_u32 m0, s33, 13312
    s_mov_b32 s30, 851968
    buffer_load_dwordx4 v13, s[8:11], s30 offen lds
    s_add_u32 m0, s33, 14336
    s_mov_b32 s30, 917504
    buffer_load_dwordx4 v13, s[8:11], s30 offen lds
    s_add_u32 m0, s33, 15360
    s_mov_b32 s30, 983040
    buffer_load_dwordx4 v13, s[8:11], s30 offen lds
    s_add_u32 m0, s33, 16384
    s_mov_b32 s30, 1048576
    buffer_load_dwordx4 v13, s[8:11], s30 offen lds
    s_add_u32 m0, s33, 17408
    s_mov_b32 s30, 1114112
    buffer_load_dwordx4 v13, s[8:11], s30 offen lds
    s_add_u32 m0, s33, 18432
    s_mov_b32 s30, 1179648
    buffer_load_dwordx4 v13, s[8:11], s30 offen lds
    s_add_u32 m0, s33, 19456
    s_mov_b32 s30, 1245184
    buffer_load_dwordx4 v13, s[8:11], s30 offen lds
    s_add_u32 m0, s33, 20480
    s_mov_b32 s30, 1310720
    buffer_load_dwordx4 v13, s[8:11], s30 offen lds
    s_add_u32 m0, s33, 21504
    s_mov_b32 s30, 1376256
    buffer_load_dwordx4 v13, s[8:11], s30 offen lds
    s_add_u32 m0, s33, 22528
    s_mov_b32 s30, 1441792
    buffer_load_dwordx4 v13, s[8:11], s30 offen lds
    s_add_u32 m0, s33, 23552
    s_mov_b32 s30, 1507328
    buffer_load_dwordx4 v13, s[8:11], s30 offen lds
    s_add_u32 m0, s33, 24576
    s_mov_b32 s30, 1572864
    buffer_load_dwordx4 v13, s[8:11], s30 offen lds
    s_add_u32 m0, s33, 25600
    s_mov_b32 s30, 1638400
    buffer_load_dwordx4 v13, s[8:11], s30 offen lds
    s_add_u32 m0, s33, 26624
    s_mov_b32 s30, 1703936
    buffer_load_dwordx4 v13, s[8:11], s30 offen lds
    s_add_u32 m0, s33, 27648
    s_mov_b32 s30, 1769472
    buffer_load_dwordx4 v13, s[8:11], s30 offen lds
    s_add_u32 m0, s33, 28672
    s_mov_b32 s30, 1835008
    buffer_load_dwordx4 v13, s[8:11], s30 offen lds
    s_add_u32 m0, s33, 29696
    s_mov_b32 s30, 1900544
    buffer_load_dwordx4 v13, s[8:11], s30 offen lds
    s_add_u32 m0, s33, 30720
    s_mov_b32 s30, 1966080
    buffer_load_dwordx4 v13, s[8:11], s30 offen lds
    s_add_u32 m0, s33, 31744
    s_mov_b32 s30, 2031616
    buffer_load_dwordx4 v13, s[8:11], s30 offen lds
    s_add_u32 m0, s33, 32768
    s_mov_b32 s30, 2097152
    buffer_load_dwordx4 v13, s[8:11], s30 offen lds
    s_add_u32 m0, s33, 33792
    s_mov_b32 s30, 2162688
    buffer_load_dwordx4 v13, s[8:11], s30 offen lds
    s_add_u32 m0, s33, 34816
    s_mov_b32 s30, 2228224
    buffer_load_dwordx4 v13, s[8:11], s30 offen lds
    s_add_u32 m0, s33, 35840
    s_mov_b32 s30, 2293760
    buffer_load_dwordx4 v13, s[8:11], s30 offen lds
    s_add_u32 m0, s33, 36864
    s_mov_b32 s30, 2359296
    buffer_load_dwordx4 v13, s[8:11], s30 offen lds
    s_waitcnt vmcnt(35)
    ds_read_b64_tr_b16 v[192:193], v15 offset:0
    ds_read_b64_tr_b16 v[194:195], v15 offset:512
    ds_read_b64_tr_b16 v[196:197], v15 offset:64
    ds_read_b64_tr_b16 v[198:199], v15 offset:576
    s_add_u32 m0, s33, 37888
    s_mov_b32 s30, 2424832
    buffer_load_dwordx4 v13, s[8:11], s30 offen lds
    s_add_u32 m0, s33, 38912
    s_mov_b32 s30, 2490368
    buffer_load_dwordx4 v13, s[8:11], s30 offen lds
    s_waitcnt vmcnt(35)
    ds_read_b64_tr_b16 v[200:201], v15 offset:2048
    ds_read_b64_tr_b16 v[202:203], v15 offset:2560
    ds_read_b64_tr_b16 v[204:205], v15 offset:2112
    ds_read_b64_tr_b16 v[206:207], v15 offset:2624
    s_add_u32 m0, s33, 39936
    s_mov_b32 s30, 2555904
    buffer_load_dwordx4 v13, s[8:11], s30 offen lds
    s_waitcnt lgkmcnt(4)
    s_add_u32 m0, s33, 0
    s_mov_b32 s30, 2621440
    buffer_load_dwordx4 v13, s[8:11], s30 offen lds
    s_waitcnt vmcnt(35)
    ds_read_b64_tr_b16 v[208:209], v15 offset:4096
    ds_read_b64_tr_b16 v[210:211], v15 offset:4608
    ds_read_b64_tr_b16 v[212:213], v15 offset:4160
    ds_read_b64_tr_b16 v[214:215], v15 offset:4672
    s_add_u32 m0, s33, 1024
    s_mov_b32 s30, 2686976
    buffer_load_dwordx4 v13, s[8:11], s30 offen lds
    s_waitcnt lgkmcnt(4)
    s_add_u32 m0, s33, 2048
    s_mov_b32 s30, 2752512
    buffer_load_dwordx4 v13, s[8:11], s30 offen lds
    s_waitcnt vmcnt(35)
    ds_read_b64_tr_b16 v[216:217], v15 offset:6144
    ds_read_b64_tr_b16 v[218:219], v15 offset:6656
    ds_read_b64_tr_b16 v[220:221], v15 offset:6208
    ds_read_b64_tr_b16 v[222:223], v15 offset:6720
    s_add_u32 m0, s33, 3072
    s_mov_b32 s30, 2818048
    buffer_load_dwordx4 v13, s[8:11], s30 offen lds
    s_waitcnt lgkmcnt(4)
    s_add_u32 m0, s33, 4096
    s_mov_b32 s30, 2883584
    buffer_load_dwordx4 v13, s[8:11], s30 offen lds
    s_waitcnt vmcnt(35)
    ds_read_b64_tr_b16 v[224:225], v15 offset:8192
    ds_read_b64_tr_b16 v[226:227], v15 offset:8704
    ds_read_b64_tr_b16 v[228:229], v15 offset:8256
    ds_read_b64_tr_b16 v[230:231], v15 offset:8768
    s_add_u32 m0, s33, 5120
    s_mov_b32 s30, 2949120
    buffer_load_dwordx4 v13, s[8:11], s30 offen lds
    s_waitcnt lgkmcnt(4)
    s_add_u32 m0, s33, 6144
    s_mov_b32 s30, 3014656
    buffer_load_dwordx4 v13, s[8:11], s30 offen lds
    s_waitcnt vmcnt(35)
    ds_read_b64_tr_b16 v[232:233], v15 offset:10240
    ds_read_b64_tr_b16 v[234:235], v15 offset:10752
    ds_read_b64_tr_b16 v[236:237], v15 offset:10304
    ds_read_b64_tr_b16 v[238:239], v15 offset:10816
    s_add_u32 m0, s33, 7168
    s_mov_b32 s30, 3080192
    buffer_load_dwordx4 v13, s[8:11], s30 offen lds
    s_waitcnt lgkmcnt(4)
    s_add_u32 m0, s33, 8192
    s_mov_b32 s30, 3145728
    buffer_load_dwordx4 v13, s[8:11], s30 offen lds
    s_waitcnt vmcnt(35)
    ds_read_b64_tr_b16 v[240:241], v15 offset:12288
    ds_read_b64_tr_b16 v[242:243], v15 offset:12800
    ds_read_b64_tr_b16 v[244:245], v15 offset:12352
    ds_read_b64_tr_b16 v[246:247], v15 offset:12864
    s_add_u32 m0, s33, 9216
    s_mov_b32 s30, 3211264
    buffer_load_dwordx4 v13, s[8:11], s30 offen lds
    s_waitcnt lgkmcnt(4)
    s_add_u32 m0, s33, 10240
    s_mov_b32 s30, 3276800
    buffer_load_dwordx4 v13, s[8:11], s30 offen lds
    s_waitcnt vmcnt(35)
    ds_read_b64_tr_b16 v[248:249], v15 offset:14336
    ds_read_b64_tr_b16 v[250:251], v15 offset:14848
    ds_read_b64_tr_b16 v[252:253], v15 offset:14400
    ds_read_b64_tr_b16 v[254:255], v15 offset:14912
    s_add_u32 m0, s33, 11264
    s_mov_b32 s30, 3342336
    buffer_load_dwordx4 v13, s[8:11], s30 offen lds
    s_waitcnt lgkmcnt(4)
    s_add_u32 m0, s33, 12288
    s_mov_b32 s30, 3407872
    buffer_load_dwordx4 v13, s[8:11], s30 offen lds
    s_waitcnt vmcnt(35)
    ds_read_b64_tr_b16 a[0:1], v15 offset:16384
    ds_read_b64_tr_b16 a[2:3], v15 offset:16896
    ds_read_b64_tr_b16 a[4:5], v15 offset:16448
    ds_read_b64_tr_b16 a[6:7], v15 offset:16960
    s_add_u32 m0, s33, 13312
    s_mov_b32 s30, 3473408
    buffer_load_dwordx4 v13, s[8:11], s30 offen lds
    s_waitcnt lgkmcnt(4)
    s_add_u32 m0, s33, 14336
    s_mov_b32 s30, 3538944
    buffer_load_dwordx4 v13, s[8:11], s30 offen lds
    s_waitcnt vmcnt(35)
    ds_read_b64_tr_b16 a[8:9], v15 offset:18432
    ds_read_b64_tr_b16 a[10:11], v15 offset:18944
    ds_read_b64_tr_b16 a[12:13], v15 offset:18496
    ds_read_b64_tr_b16 a[14:15], v15 offset:19008
    s_add_u32 m0, s33, 15360
    s_mov_b32 s30, 3604480
    buffer_load_dwordx4 v13, s[8:11], s30 offen lds
    s_waitcnt lgkmcnt(4)
    s_add_u32 m0, s33, 16384
    s_mov_b32 s30, 3670016
    buffer_load_dwordx4 v13, s[8:11], s30 offen lds
    s_waitcnt vmcnt(35)
    ds_read_b64_tr_b16 a[16:17], v15 offset:20480
    ds_read_b64_tr_b16 a[18:19], v15 offset:20992
    ds_read_b64_tr_b16 a[20:21], v15 offset:20544
    ds_read_b64_tr_b16 a[22:23], v15 offset:21056
    s_add_u32 m0, s33, 17408
    s_mov_b32 s30, 3735552
    buffer_load_dwordx4 v13, s[8:11], s30 offen lds
    s_waitcnt lgkmcnt(4)
    s_add_u32 m0, s33, 18432
    s_mov_b32 s30, 3801088
    buffer_load_dwordx4 v13, s[8:11], s30 offen lds
    s_waitcnt vmcnt(35)
    ds_read_b64_tr_b16 a[24:25], v15 offset:22528
    ds_read_b64_tr_b16 a[26:27], v15 offset:23040
    ds_read_b64_tr_b16 a[28:29], v15 offset:22592
    ds_read_b64_tr_b16 a[30:31], v15 offset:23104
    s_add_u32 m0, s33, 19456
    s_mov_b32 s30, 3866624
    buffer_load_dwordx4 v13, s[8:11], s30 offen lds
    s_waitcnt lgkmcnt(4)
    s_add_u32 m0, s33, 20480
    s_mov_b32 s30, 3932160
    buffer_load_dwordx4 v13, s[8:11], s30 offen lds
    s_waitcnt vmcnt(35)
    ds_read_b64_tr_b16 a[32:33], v15 offset:24576
    ds_read_b64_tr_b16 a[34:35], v15 offset:25088
    ds_read_b64_tr_b16 a[36:37], v15 offset:24640
    ds_read_b64_tr_b16 a[38:39], v15 offset:25152
    s_add_u32 m0, s33, 21504
    s_mov_b32 s30, 3997696
    buffer_load_dwordx4 v13, s[8:11], s30 offen lds
    s_waitcnt lgkmcnt(4)
    s_add_u32 m0, s33, 22528
    s_mov_b32 s30, 4063232
    buffer_load_dwordx4 v13, s[8:11], s30 offen lds
    s_waitcnt vmcnt(35)
    ds_read_b64_tr_b16 a[40:41], v15 offset:26624
    ds_read_b64_tr_b16 a[42:43], v15 offset:27136
    ds_read_b64_tr_b16 a[44:45], v15 offset:26688
    ds_read_b64_tr_b16 a[46:47], v15 offset:27200
    s_add_u32 m0, s33, 23552
    s_mov_b32 s30, 4128768
    buffer_load_dwordx4 v13, s[8:11], s30 offen lds
    s_waitcnt lgkmcnt(4)
    s_add_u32 m0, s33, 24576
    s_mov_b32 s30, 4194304
    buffer_load_dwordx4 v13, s[8:11], s30 offen lds
    s_waitcnt vmcnt(35)
    ds_read_b64_tr_b16 a[48:49], v15 offset:28672
    ds_read_b64_tr_b16 a[50:51], v15 offset:29184
    ds_read_b64_tr_b16 a[52:53], v15 offset:28736
    ds_read_b64_tr_b16 a[54:55], v15 offset:29248
    s_add_u32 m0, s33, 25600
    s_mov_b32 s30, 4259840
    buffer_load_dwordx4 v13, s[8:11], s30 offen lds
    s_waitcnt lgkmcnt(4)
    s_add_u32 m0, s33, 26624
    s_mov_b32 s30, 4325376
    buffer_load_dwordx4 v13, s[8:11], s30 offen lds
    s_waitcnt vmcnt(35)
    ds_read_b64_tr_b16 a[56:57], v15 offset:30720
    ds_read_b64_tr_b16 a[58:59], v15 offset:31232
    ds_read_b64_tr_b16 a[60:61], v15 offset:30784
    ds_read_b64_tr_b16 a[62:63], v15 offset:31296
    s_add_u32 m0, s33, 27648
    s_mov_b32 s30, 4390912
    buffer_load_dwordx4 v13, s[8:11], s30 offen lds
    s_waitcnt lgkmcnt(4)
    s_add_u32 m0, s33, 28672
    s_mov_b32 s30, 4456448
    buffer_load_dwordx4 v13, s[8:11], s30 offen lds
    s_waitcnt vmcnt(35)
    ds_read_b64_tr_b16 a[64:65], v15 offset:32768
    ds_read_b64_tr_b16 a[66:67], v15 offset:33280
    ds_read_b64_tr_b16 a[68:69], v15 offset:32832
    ds_read_b64_tr_b16 a[70:71], v15 offset:33344
    s_add_u32 m0, s33, 29696
    s_mov_b32 s30, 4521984
    buffer_load_dwordx4 v13, s[8:11], s30 offen lds
    s_waitcnt lgkmcnt(4)
    s_add_u32 m0, s33, 30720
    s_mov_b32 s30, 4587520
    buffer_load_dwordx4 v13, s[8:11], s30 offen lds
    s_waitcnt vmcnt(35)
    ds_read_b64_tr_b16 a[72:73], v15 offset:34816
    ds_read_b64_tr_b16 a[74:75], v15 offset:35328
    ds_read_b64_tr_b16 a[76:77], v15 offset:34880
    ds_read_b64_tr_b16 a[78:79], v15 offset:35392
    s_add_u32 m0, s33, 31744
    s_mov_b32 s30, 4653056
    buffer_load_dwordx4 v13, s[8:11], s30 offen lds
    s_waitcnt lgkmcnt(4)
    s_add_u32 m0, s33, 32768
    s_mov_b32 s30, 4718592
    buffer_load_dwordx4 v13, s[8:11], s30 offen lds
    s_waitcnt vmcnt(35)
    ds_read_b64_tr_b16 a[80:81], v15 offset:36864
    ds_read_b64_tr_b16 a[82:83], v15 offset:37376
    ds_read_b64_tr_b16 a[84:85], v15 offset:36928
    ds_read_b64_tr_b16 a[86:87], v15 offset:37440
    s_add_u32 m0, s33, 33792
    s_mov_b32 s30, 4784128
    buffer_load_dwordx4 v13, s[8:11], s30 offen lds
    s_waitcnt lgkmcnt(4)
    s_add_u32 m0, s33, 34816
    s_mov_b32 s30, 4849664
    buffer_load_dwordx4 v13, s[8:11], s30 offen lds
    s_waitcnt vmcnt(35)
    ds_read_b64_tr_b16 a[88:89], v15 offset:38912
    ds_read_b64_tr_b16 a[90:91], v15 offset:39424
    ds_read_b64_tr_b16 a[92:93], v15 offset:38976
    ds_read_b64_tr_b16 a[94:95], v15 offset:39488
    s_add_u32 m0, s33, 35840
    s_mov_b32 s30, 4915200
    buffer_load_dwordx4 v13, s[8:11], s30 offen lds
    s_waitcnt lgkmcnt(4)
    s_add_u32 m0, s33, 36864
    s_mov_b32 s30, 4980736
    buffer_load_dwordx4 v13, s[8:11], s30 offen lds
    s_waitcnt vmcnt(35)
    ds_read_b64_tr_b16 a[96:97], v15 offset:0
    ds_read_b64_tr_b16 a[98:99], v15 offset:512
    ds_read_b64_tr_b16 a[100:101], v15 offset:64
    ds_read_b64_tr_b16 a[102:103], v15 offset:576
    s_add_u32 m0, s33, 37888
    s_mov_b32 s30, 5046272
    buffer_load_dwordx4 v13, s[8:11], s30 offen lds
    s_waitcnt lgkmcnt(4)
    s_add_u32 m0, s33, 38912
    s_mov_b32 s30, 5111808
    buffer_load_dwordx4 v13, s[8:11], s30 offen lds
    s_waitcnt vmcnt(35)
    ds_read_b64_tr_b16 a[104:105], v15 offset:2048
    ds_read_b64_tr_b16 a[106:107], v15 offset:2560
    ds_read_b64_tr_b16 a[108:109], v15 offset:2112
    ds_read_b64_tr_b16 a[110:111], v15 offset:2624
    s_add_u32 m0, s33, 39936
    s_mov_b32 s30, 5177344
    buffer_load_dwordx4 v13, s[8:11], s30 offen lds
    s_waitcnt vmcnt(34)
    ds_read_b64_tr_b16 a[112:113], v15 offset:4096
    ds_read_b64_tr_b16 a[114:115], v15 offset:4608
    ds_read_b64_tr_b16 a[116:117], v15 offset:4160
    ds_read_b64_tr_b16 a[118:119], v15 offset:4672
    s_waitcnt vmcnt(32)
    ds_read_b64_tr_b16 a[120:121], v15 offset:6144
    ds_read_b64_tr_b16 a[122:123], v15 offset:6656
    ds_read_b64_tr_b16 a[124:125], v15 offset:6208
    ds_read_b64_tr_b16 a[126:127], v15 offset:6720
    s_waitcnt vmcnt(30)
    ds_read_b64_tr_b16 a[128:129], v15 offset:8192
    ds_read_b64_tr_b16 a[130:131], v15 offset:8704
    ds_read_b64_tr_b16 a[132:133], v15 offset:8256
    ds_read_b64_tr_b16 a[134:135], v15 offset:8768
    s_waitcnt vmcnt(28)
    ds_read_b64_tr_b16 a[136:137], v15 offset:10240
    ds_read_b64_tr_b16 a[138:139], v15 offset:10752
    ds_read_b64_tr_b16 a[140:141], v15 offset:10304
    ds_read_b64_tr_b16 a[142:143], v15 offset:10816
    s_waitcnt vmcnt(26)
    ds_read_b64_tr_b16 a[144:145], v15 offset:12288
    ds_read_b64_tr_b16 a[146:147], v15 offset:12800
    ds_read_b64_tr_b16 a[148:149], v15 offset:12352
    ds_read_b64_tr_b16 a[150:151], v15 offset:12864
    s_waitcnt vmcnt(24)
    ds_read_b64_tr_b16 a[152:153], v15 offset:14336
    ds_read_b64_tr_b16 a[154:155], v15 offset:14848
    ds_read_b64_tr_b16 a[156:157], v15 offset:14400
    ds_read_b64_tr_b16 a[158:159], v15 offset:14912
    s_waitcnt vmcnt(22)
    ds_read_b64_tr_b16 a[160:161], v15 offset:16384
    ds_read_b64_tr_b16 a[162:163], v15 offset:16896
    ds_read_b64_tr_b16 a[164:165], v15 offset:16448
    ds_read_b64_tr_b16 a[166:167], v15 offset:16960
    s_waitcnt vmcnt(20)
    ds_read_b64_tr_b16 a[168:169], v15 offset:18432
    ds_read_b64_tr_b16 a[170:171], v15 offset:18944
    ds_read_b64_tr_b16 a[172:173], v15 offset:18496
    ds_read_b64_tr_b16 a[174:175], v15 offset:19008
    s_waitcnt vmcnt(18)
    ds_read_b64_tr_b16 a[176:177], v15 offset:20480
    ds_read_b64_tr_b16 a[178:179], v15 offset:20992
    ds_read_b64_tr_b16 a[180:181], v15 offset:20544
    ds_read_b64_tr_b16 a[182:183], v15 offset:21056
    s_waitcnt vmcnt(16)
    ds_read_b64_tr_b16 a[184:185], v15 offset:22528
    ds_read_b64_tr_b16 a[186:187], v15 offset:23040
    ds_read_b64_tr_b16 a[188:189], v15 offset:22592
    ds_read_b64_tr_b16 a[190:191], v15 offset:23104
    s_waitcnt vmcnt(14)
    ds_read_b64_tr_b16 a[192:193], v15 offset:24576
    ds_read_b64_tr_b16 a[194:195], v15 offset:25088
    ds_read_b64_tr_b16 a[196:197], v15 offset:24640
    ds_read_b64_tr_b16 a[198:199], v15 offset:25152
    s_waitcnt vmcnt(12)
    ds_read_b64_tr_b16 a[200:201], v15 offset:26624
    ds_read_b64_tr_b16 a[202:203], v15 offset:27136
    ds_read_b64_tr_b16 a[204:205], v15 offset:26688
    ds_read_b64_tr_b16 a[206:207], v15 offset:27200
    s_waitcnt vmcnt(10)
    ds_read_b64_tr_b16 a[208:209], v15 offset:28672
    ds_read_b64_tr_b16 a[210:211], v15 offset:29184
    ds_read_b64_tr_b16 a[212:213], v15 offset:28736
    ds_read_b64_tr_b16 a[214:215], v15 offset:29248
    s_waitcnt vmcnt(8)
    ds_read_b64_tr_b16 a[216:217], v15 offset:30720
    ds_read_b64_tr_b16 a[218:219], v15 offset:31232
    ds_read_b64_tr_b16 a[220:221], v15 offset:30784
    ds_read_b64_tr_b16 a[222:223], v15 offset:31296
    s_waitcnt vmcnt(6)
    ds_read_b64_tr_b16 a[224:225], v15 offset:32768
    ds_read_b64_tr_b16 a[226:227], v15 offset:33280
    ds_read_b64_tr_b16 a[228:229], v15 offset:32832
    ds_read_b64_tr_b16 a[230:231], v15 offset:33344
    s_waitcnt vmcnt(4)
    ds_read_b64_tr_b16 a[232:233], v15 offset:34816
    ds_read_b64_tr_b16 a[234:235], v15 offset:35328
    ds_read_b64_tr_b16 a[236:237], v15 offset:34880
    ds_read_b64_tr_b16 a[238:239], v15 offset:35392
    s_waitcnt vmcnt(2)
    ds_read_b64_tr_b16 a[240:241], v15 offset:36864
    ds_read_b64_tr_b16 a[242:243], v15 offset:37376
    ds_read_b64_tr_b16 a[244:245], v15 offset:36928
    ds_read_b64_tr_b16 a[246:247], v15 offset:37440
    s_waitcnt vmcnt(0)
    ds_read_b64_tr_b16 a[248:249], v15 offset:38912
    ds_read_b64_tr_b16 a[250:251], v15 offset:39424
    ds_read_b64_tr_b16 a[252:253], v15 offset:38976
    ds_read_b64_tr_b16 a[254:255], v15 offset:39488
    s_waitcnt lgkmcnt(0)
    v_mov_b32 v24, 0x3f803f80
    v_mov_b32 v25, 0x3f803f80
    v_mov_b32 v26, 0x3f803f80
    v_mov_b32 v27, 0x3f803f80
    s_nop 1
    v_mfma_f32_32x32x16_bf16 v[48:63], v[24:27], v[192:195], 0
    v_mfma_f32_32x32x16_bf16 v[64:79], v[24:27], v[196:199], 0
    v_mfma_f32_32x32x16_bf16 v[48:63], v[24:27], v[200:203], v[48:63]
    v_mfma_f32_32x32x16_bf16 v[64:79], v[24:27], v[204:207], v[64:79]
    v_mfma_f32_32x32x16_bf16 v[48:63], v[24:27], v[208:211], v[48:63]
    v_mfma_f32_32x32x16_bf16 v[64:79], v[24:27], v[212:215], v[64:79]
    v_mfma_f32_32x32x16_bf16 v[48:63], v[24:27], v[216:219], v[48:63]
    v_mfma_f32_32x32x16_bf16 v[64:79], v[24:27], v[220:223], v[64:79]
    v_mfma_f32_32x32x16_bf16 v[48:63], v[24:27], v[224:227], v[48:63]
    v_mfma_f32_32x32x16_bf16 v[64:79], v[24:27], v[228:231], v[64:79]
    v_mfma_f32_32x32x16_bf16 v[48:63], v[24:27], v[232:235], v[48:63]
    v_mfma_f32_32x32x16_bf16 v[64:79], v[24:27], v[236:239], v[64:79]
    v_mfma_f32_32x32x16_bf16 v[48:63], v[24:27], v[240:243], v[48:63]
    v_mfma_f32_32x32x16_bf16 v[64:79], v[24:27], v[244:247], v[64:79]
    v_mfma_f32_32x32x16_bf16 v[48:63], v[24:27], v[248:251], v[48:63]
    v_mfma_f32_32x32x16_bf16 v[64:79], v[24:27], v[252:255], v[64:79]
    v_mfma_f32_32x32x16_bf16 v[48:63], v[24:27], a[0:3], v[48:63]
    v_mfma_f32_32x32x16_bf16 v[64:79], v[24:27], a[4:7], v[64:79]
    v_mfma_f32_32x32x16_bf16 v[48:63], v[24:27], a[8:11], v[48:63]
    v_mfma_f32_32x32x16_bf16 v[64:79], v[24:27], a[12:15], v[64:79]
    v_mfma_f32_32x32x16_bf16 v[48:63], v[24:27], a[16:19], v[48:63]
    v_mfma_f32_32x32x16_bf16 v[64:79], v[24:27], a[20:23], v[64:79]
    v_mfma_f32_32x32x16_bf16 v[48:63], v[24:27], a[24:27], v[48:63]
    v_mfma_f32_32x32x16_bf16 v[64:79], v[24:27], a[28:31], v[64:79]
    v_mfma_f32_32x32x16_bf16 v[48:63], v[24:27], a[32:35], v[48:63]
    v_mfma_f32_32x32x16_bf16 v[64:79], v[24:27], a[36:39], v[64:79]
    v_mfma_f32_32x32x16_bf16 v[48:63], v[24:27], a[40:43], v[48:63]
    v_mfma_f32_32x32x16_bf16 v[64:79], v[24:27], a[44:47], v[64:79]
    v_mfma_f32_32x32x16_bf16 v[48:63], v[24:27], a[48:51], v[48:63]
    v_mfma_f32_32x32x16_bf16 v[64:79], v[24:27], a[52:55], v[64:79]
    v_mfma_f32_32x32x16_bf16 v[48:63], v[24:27], a[56:59], v[48:63]
    v_mfma_f32_32x32x16_bf16 v[64:79], v[24:27], a[60:63], v[64:79]
    v_mfma_f32_32x32x16_bf16 v[48:63], v[24:27], a[64:67], v[48:63]
    v_mfma_f32_32x32x16_bf16 v[64:79], v[24:27], a[68:71], v[64:79]
    v_mfma_f32_32x32x16_bf16 v[48:63], v[24:27], a[72:75], v[48:63]
    v_mfma_f32_32x32x16_bf16 v[64:79], v[24:27], a[76:79], v[64:79]
    v_mfma_f32_32x32x16_bf16 v[48:63], v[24:27], a[80:83], v[48:63]
    v_mfma_f32_32x32x16_bf16 v[64:79], v[24:27], a[84:87], v[64:79]
    v_mfma_f32_32x32x16_bf16 v[48:63], v[24:27], a[88:91], v[48:63]
    v_mfma_f32_32x32x16_bf16 v[64:79], v[24:27], a[92:95], v[64:79]
    v_mfma_f32_32x32x16_bf16 v[48:63], v[24:27], a[96:99], v[48:63]
    v_mfma_f32_32x32x16_bf16 v[64:79], v[24:27], a[100:103], v[64:79]
    v_mfma_f32_32x32x16_bf16 v[48:63], v[24:27], a[104:107], v[48:63]
    v_mfma_f32_32x32x16_bf16 v[64:79], v[24:27], a[108:111], v[64:79]
    v_mfma_f32_32x32x16_bf16 v[48:63], v[24:27], a[112:115], v[48:63]
    v_mfma_f32_32x32x16_bf16 v[64:79], v[24:27], a[116:119], v[64:79]
    v_mfma_f32_32x32x16_bf16 v[48:63], v[24:27], a[120:123], v[48:63]
    v_mfma_f32_32x32x16_bf16 v[64:79], v[24:27], a[124:127], v[64:79]
    v_mfma_f32_32x32x16_bf16 v[48:63], v[24:27], a[128:131], v[48:63]
    v_mfma_f32_32x32x16_bf16 v[64:79], v[24:27], a[132:135], v[64:79]
    v_mfma_f32_32x32x16_bf16 v[48:63], v[24:27], a[136:139], v[48:63]
    v_mfma_f32_32x32x16_bf16 v[64:79], v[24:27], a[140:143], v[64:79]
    v_mfma_f32_32x32x16_bf16 v[48:63], v[24:27], a[144:147], v[48:63]
    v_mfma_f32_32x32x16_bf16 v[64:79], v[24:27], a[148:151], v[64:79]
    v_mfma_f32_32x32x16_bf16 v[48:63], v[24:27], a[152:155], v[48:63]
    v_mfma_f32_32x32x16_bf16 v[64:79], v[24:27], a[156:159], v[64:79]
    v_mfma_f32_32x32x16_bf16 v[48:63], v[24:27], a[160:163], v[48:63]
    v_mfma_f32_32x32x16_bf16 v[64:79], v[24:27], a[164:167], v[64:79]
    v_mfma_f32_32x32x16_bf16 v[48:63], v[24:27], a[168:171], v[48:63]
    v_mfma_f32_32x32x16_bf16 v[64:79], v[24:27], a[172:175], v[64:79]
    v_mfma_f32_32x32x16_bf16 v[48:63], v[24:27], a[176:179], v[48:63]
    v_mfma_f32_32x32x16_bf16 v[64:79], v[24:27], a[180:183], v[64:79]
    v_mfma_f32_32x32x16_bf16 v[48:63], v[24:27], a[184:187], v[48:63]
    v_mfma_f32_32x32x16_bf16 v[64:79], v[24:27], a[188:191], v[64:79]
    v_mfma_f32_32x32x16_bf16 v[48:63], v[24:27], a[192:195], v[48:63]
    v_mfma_f32_32x32x16_bf16 v[64:79], v[24:27], a[196:199], v[64:79]
    v_mfma_f32_32x32x16_bf16 v[48:63], v[24:27], a[200:203], v[48:63]
    v_mfma_f32_32x32x16_bf16 v[64:79], v[24:27], a[204:207], v[64:79]
    v_mfma_f32_32x32x16_bf16 v[48:63], v[24:27], a[208:211], v[48:63]
    v_mfma_f32_32x32x16_bf16 v[64:79], v[24:27], a[212:215], v[64:79]
    v_mfma_f32_32x32x16_bf16 v[48:63], v[24:27], a[216:219], v[48:63]
    v_mfma_f32_32x32x16_bf16 v[64:79], v[24:27], a[220:223], v[64:79]
    v_mfma_f32_32x32x16_bf16 v[48:63], v[24:27], a[224:227], v[48:63]
    v_mfma_f32_32x32x16_bf16 v[64:79], v[24:27], a[228:231], v[64:79]
    v_mfma_f32_32x32x16_bf16 v[48:63], v[24:27], a[232:235], v[48:63]
    v_mfma_f32_32x32x16_bf16 v[64:79], v[24:27], a[236:239], v[64:79]
    v_mfma_f32_32x32x16_bf16 v[48:63], v[24:27], a[240:243], v[48:63]
    v_mfma_f32_32x32x16_bf16 v[64:79], v[24:27], a[244:247], v[64:79]
    v_mfma_f32_32x32x16_bf16 v[48:63], v[24:27], a[248:251], v[48:63]
    v_mfma_f32_32x32x16_bf16 v[64:79], v[24:27], a[252:255], v[64:79]
    s_nop 15
    v_cvt_pk_bf16_f32 v112, v48, v48
    v_and_b32 v13, 0xffff0000, v112
    v_sub_f32 v13, v48, v13
    v_cvt_pk_bf16_f32 v113, v13, 0
    v_cndmask_b32 v112, v112, 0, s[44:45]
    v_cndmask_b32 v113, v113, 0, s[44:45]
    v_mov_b64 v[114:115], 0
    v_mov_b64 v[122:123], 0
    v_cvt_pk_bf16_f32 v116, v64, v64
    v_and_b32 v13, 0xffff0000, v116
    v_sub_f32 v13, v64, v13
    v_cvt_pk_bf16_f32 v117, v13, 0
    v_cndmask_b32 v116, v116, 0, s[44:45]
    v_cndmask_b32 v117, v117, 0, s[44:45]
    v_mov_b64 v[118:119], 0
    v_mov_b64 v[122:123], 0
    v_and_b32 v13, 31, v12
    v_lshrrev_b32 v14, 5, v12
    v_mov_b32 v4, v0
    v_mul_u32_u24 v3, 2560, v14
    v_lshl_add_u32 v3, v13, 3, v3
    v_add_u32 v3, 40960, v3
    s_mul_i32 s30, s12, 4096
    v_add_u32 v6, s30, v0
    v_add_u32 v7, 1024, v6
    s_mov_b32 s40, 0xc0135761
    s_mov_b32 s41, 0xbdd2d3e8
    s_mov_b32 s42, 0x3acccccd
    s_mov_b32 s43, 0x3727c5ac
    s_mov_b32 s23, 0
    v_mov_b32 v16, 128
P_26:
    global_load_dword v17, v16, s[90:91] sc1
    s_waitcnt vmcnt(0)
    v_readfirstlane_b32 s85, v17
    s_and_b32 s86, s85, 255
    s_cmp_ge_u32 s86, 70
    s_cbranch_scc1 P_27
    s_add_u32 s23, s23, 1
    s_cmp_gt_u32 s23, 65536
    s_cbranch_scc1 L_exit
    s_sleep 16
    s_branch P_26
P_27:
    s_lshr_b32 s85, s85, 8
    s_mov_b32 s80, 0
RV_job:
    s_mul_i32 s18, s14, 41943040
    s_add_u32 s18, s18, 171966464
    s_mul_i32 s19, s14, 50331648
    s_add_u32 s19, s19, 0
    s_mul_i32 s21, s14, 393216
    s_add_u32 s21, s21, 167772160
    s_lshr_b32 s30, s13, 4
    s_lshl_b32 s31, s30, 24
    s_add_u32 s19, s19, s31
    s_sub_u32 s31, s30, 1
    s_cmp_eq_u32 s30, 0
    s_cselect_b32 s31, 2, s31
    s_lshl_b32 s31, s31, 8
    s_add_u32 s21, s21, s31
    s_and_b32 s30, s13, 15
    s_lshl_b32 s31, s30, 14
    s_add_u32 s19, s19, s31
    s_lshl_b32 s31, s30, 11
    s_add_u32 s21, s21, s31
    s_lshr_b32 s31, s12, 1
    s_lshl_b32 s31, s31, 10
    s_add_u32 s21, s21, s31
    s_and_b32 s31, s12, 1
    s_lshl_b32 s31, s31, 7
    s_add_u32 s21, s21, s31
    s_cmp_eq_u32 s15, 2
    s_cselect_b32 s30, 11, s15
    s_lshl_b32 s30, s30, 15
    s_add_u32 s21, s21, s30
    s_mul_i32 s20, s12, 640
    s_add_u32 s20, s20, 168067072
    s_mov_b32 s25, 1
    s_mov_b32 s16, s15
    s_sub_u32 s17, 2, s14
    s_mov_b32 s28, 0
    s_or_b32 s30, s15, s14
    s_cselect_b32 s46, 64, 36
    s_cmp_eq_u32 s15, 1
    s_cselect_b32 s46, 58, s46
    s_cselect_b32 s30, s13, 99
    s_cmp_lt_u32 s30, 0
    s_cselect_b32 s46, 64, s46
    s_cmp_eq_u32 s15, 2
    s_cselect_b32 s16, 58, s16
    s_mov_b32 s22, 0
    s_mov_b32 s47, 0
    s_mov_b32 s26, 0
    s_mov_b32 s24, 0
    s_mov_b32 s81, 0
    s_lshr_b32 s30, s85, 5
    s_and_b32 s30, s30, 1
    s_lshl_b32 s30, s30, 13
    s_andn2_b32 s20, s20, 0x2000
    s_or_b32 s20, s20, s30
    s_barrier
    s_cmp_lg_u32 s14, 0
    s_cbranch_scc1 G_28
    s_mul_i32 s38, s16, 49152
    s_add_u32 s38, s38, s18
    s_mov_b32 s39, s24
    s_mul_i32 s30, s12, 1280
    s_add_u32 s30, s30, 40960
    s_add_u32 m0, s30, s39
    s_add_u32 s30, s30, s38
    buffer_load_dwordx4 v0, s[4:7], s30 offen sc1 lds
    buffer_load_dword v5, s[4:7], s30 offen offset:1024 sc1 lds
    s_mul_i32 s30, s12, 10240
    s_add_u32 s38, s38, s30
    s_add_u32 s39, s39, s30
    s_mov_b32 m0, s39
    s_nop 0
    buffer_load_dwordx4 v4, s[4:7], s38 offen offset:0 sc1 lds
    buffer_load_dwordx4 v4, s[4:7], s38 offen offset:1024 sc1 lds
    buffer_load_dwordx4 v4, s[4:7], s38 offen offset:2048 sc1 lds
    buffer_load_dwordx4 v4, s[4:7], s38 offen offset:3072 sc1 lds
    s_add_u32 s38, s38, 4096
    s_add_u32 s39, s39, 4096
    s_mov_b32 m0, s39
    s_nop 0
    buffer_load_dwordx4 v4, s[4:7], s38 offen offset:0 sc1 lds
    buffer_load_dwordx4 v4, s[4:7], s38 offen offset:1024 sc1 lds
    buffer_load_dwordx4 v4, s[4:7], s38 offen offset:2048 sc1 lds
    buffer_load_dwordx4 v4, s[4:7], s38 offen offset:3072 sc1 lds
    s_add_u32 s38, s38, 4096
    s_add_u32 s39, s39, 4096
    s_mov_b32 m0, s39
    s_nop 0
    buffer_load_dwordx4 v4, s[4:7], s38 offen offset:0 sc1 lds
    buffer_load_dwordx4 v4, s[4:7], s38 offen offset:1024 sc1 lds
    s_mov_b32 s35, 46080
    s_mov_b32 s36, 92160
    s_mul_i32 s34, s16, 262144
    s_add_u32 s34, s34, s19
    v_mov_b32 v1, v0
    s_waitcnt vmcnt(0)
    s_barrier
    ds_read_b128 v[160:163], v1 offset:0
    ds_read_b128 v[164:167], v1 offset:10240
    ds_read_b128 v[168:171], v1 offset:20480
    ds_read_b128 v[172:175], v1 offset:30720
    ds_read_b128 v[176:179], v1 offset:1024
.p2align 6
RV_st:
    s_waitcnt lgkmcnt(4)
    v_mfma_f32_32x32x16_bf16 v[48:63], v[160:163], v[192:195], 0
    ds_read_b128 v[180:183], v1 offset:11264
    s_cmp_lt_u32 s16, 35
    s_cselect_b32 s17, s17, 1
    s_add_u32 s29, s16, s17
    v_add_u32 v9, s24, v3
    v_mfma_f32_32x32x16_bf16 v[64:79], v[160:163], v[196:199], 0
    s_cmp_lt_u32 s29, s46
    s_cselect_b32 s32, s29, s16
    s_waitcnt lgkmcnt(4)
    v_mfma_f32_32x32x16_bf16 v[48:63], v[164:167], a[16:19], v[48:63]
    ds_read_b128 v[184:187], v1 offset:21504
    v_mfma_f32_32x32x16_bf16 v[64:79], v[164:167], a[20:23], v[64:79]
    s_mul_i32 s38, s32, 49152
    s_add_u32 s38, s38, s18
    s_mov_b32 s39, s35
    s_mul_i32 s30, s12, 1280
    s_add_u32 s30, s30, 40960
    s_add_u32 m0, s30, s39
    s_add_u32 s30, s30, s38
    buffer_load_dwordx4 v0, s[4:7], s30 offen sc1 lds
    buffer_load_dword v5, s[4:7], s30 offen offset:1024 sc1 lds
    s_waitcnt lgkmcnt(4)
    v_mfma_f32_32x32x16_bf16 v[48:63], v[168:171], a[96:99], v[48:63]
    ds_read_b128 v[188:191], v1 offset:31744
    v_mul_f32 v128, v128, v96
    v_mul_f32 v129, v129, v97
    v_mfma_f32_32x32x16_bf16 v[64:79], v[168:171], a[100:103], v[64:79]
    v_mul_f32 v130, v130, v98
    v_mul_f32 v131, v131, v99
    v_mul_f32 v132, v132, v100
    s_waitcnt lgkmcnt(4)
    v_mfma_f32_32x32x16_bf16 v[48:63], v[172:175], a[176:179], v[48:63]
    ds_read_b128 v[160:163], v1 offset:2048
    v_mul_f32 v133, v133, v101
    v_mul_f32 v134, v134, v102
    v_mfma_f32_32x32x16_bf16 v[64:79], v[172:175], a[180:183], v[64:79]
    s_mul_i32 s30, s12, 10240
    s_add_u32 s38, s38, s30
    s_add_u32 s39, s39, s30
    s_mov_b32 m0, s39
    s_nop 0
    buffer_load_dwordx4 v4, s[4:7], s38 offen offset:0 sc1 lds
    s_waitcnt lgkmcnt(4)
    v_mfma_f32_32x32x16_bf16 v[48:63], v[176:179], v[200:203], v[48:63]
    ds_read_b128 v[164:167], v1 offset:12288
    v_mul_f32 v135, v135, v103
    v_cvt_pk_bf16_f32 v24, v128, v129
    v_mfma_f32_32x32x16_bf16 v[64:79], v[176:179], v[204:207], v[64:79]
    v_cvt_pk_bf16_f32 v25, v130, v131
    v_cvt_pk_bf16_f32 v26, v132, v133
    v_cvt_pk_bf16_f32 v27, v134, v135
    s_waitcnt lgkmcnt(4)
    v_mfma_f32_32x32x16_bf16 v[48:63], v[180:183], a[24:27], v[48:63]
    ds_read_b128 v[168:171], v1 offset:22528
    buffer_store_dwordx4 v[24:27], v6, s[4:7], s34 offen offset:0 sc1
    v_mul_f32 v136, v136, v104
    v_mfma_f32_32x32x16_bf16 v[64:79], v[180:183], a[28:31], v[64:79]
    buffer_load_dwordx4 v4, s[4:7], s38 offen offset:1024 sc1 lds
    s_waitcnt lgkmcnt(4)
    v_mfma_f32_32x32x16_bf16 v[48:63], v[184:187], a[104:107], v[48:63]
    ds_read_b128 v[172:175], v1 offset:32768
    v_mul_f32 v137, v137, v105
    v_mul_f32 v138, v138, v106
    v_mfma_f32_32x32x16_bf16 v[64:79], v[184:187], a[108:111], v[64:79]
    v_mul_f32 v139, v139, v107
    v_mul_f32 v140, v140, v108
    v_mul_f32 v141, v141, v109
    s_waitcnt lgkmcnt(4)
    v_mfma_f32_32x32x16_bf16 v[48:63], v[188:191], a[184:187], v[48:63]
    ds_read_b128 v[176:179], v1 offset:3072
    v_mul_f32 v142, v142, v110
    v_mul_f32 v143, v143, v111
    v_mfma_f32_32x32x16_bf16 v[64:79], v[188:191], a[188:191], v[64:79]
    buffer_load_dwordx4 v4, s[4:7], s38 offen offset:2048 sc1 lds
    s_waitcnt lgkmcnt(4)
    v_mfma_f32_32x32x16_bf16 v[48:63], v[160:163], v[208:211], v[48:63]
    ds_read_b128 v[180:183], v1 offset:13312
    v_cvt_pk_bf16_f32 v28, v136, v137
    v_cvt_pk_bf16_f32 v29, v138, v139
    v_mfma_f32_32x32x16_bf16 v[64:79], v[160:163], v[212:215], v[64:79]
    v_cvt_pk_bf16_f32 v30, v140, v141
    v_cvt_pk_bf16_f32 v31, v142, v143
    buffer_store_dwordx4 v[28:31], v7, s[4:7], s34 offen offset:0 sc1
    s_waitcnt lgkmcnt(4)
    v_mfma_f32_32x32x16_bf16 v[48:63], v[164:167], a[32:35], v[48:63]
    ds_read_b128 v[184:187], v1 offset:23552
    v_mul_f32 v144, v144, v96
    v_mul_f32 v145, v145, v97
    v_mfma_f32_32x32x16_bf16 v[64:79], v[164:167], a[36:39], v[64:79]
    buffer_load_dwordx4 v4, s[4:7], s38 offen offset:3072 sc1 lds
    s_waitcnt lgkmcnt(4)
    v_mfma_f32_32x32x16_bf16 v[48:63], v[168:171], a[112:115], v[48:63]
    ds_read_b128 v[188:191], v1 offset:33792
    v_mul_f32 v146, v146, v98
    v_mul_f32 v147, v147, v99
    v_mfma_f32_32x32x16_bf16 v[64:79], v[168:171], a[116:119], v[64:79]
    v_mul_f32 v148, v148, v100
    v_mul_f32 v149, v149, v101
    v_mul_f32 v150, v150, v102
    s_waitcnt lgkmcnt(4)
    v_mfma_f32_32x32x16_bf16 v[48:63], v[172:175], a[192:195], v[48:63]
    ds_read_b128 v[160:163], v1 offset:4096
    v_mul_f32 v151, v151, v103
    v_cvt_pk_bf16_f32 v32, v144, v145
    v_mfma_f32_32x32x16_bf16 v[64:79], v[172:175], a[196:199], v[64:79]
    s_add_u32 s38, s38, 4096
    s_add_u32 s39, s39, 4096
    s_mov_b32 m0, s39
    s_nop 0
    buffer_load_dwordx4 v4, s[4:7], s38 offen offset:0 sc1 lds
    s_waitcnt lgkmcnt(4)
    v_mfma_f32_32x32x16_bf16 v[48:63], v[176:179], v[216:219], v[48:63]
    ds_read_b128 v[164:167], v1 offset:14336
    v_cvt_pk_bf16_f32 v33, v146, v147
    v_cvt_pk_bf16_f32 v34, v148, v149
    v_mfma_f32_32x32x16_bf16 v[64:79], v[176:179], v[220:223], v[64:79]
    v_cvt_pk_bf16_f32 v35, v150, v151
    buffer_store_dwordx4 v[32:35], v6, s[4:7], s34 offen offset:2048 sc1
    v_mul_f32 v152, v152, v104
    s_waitcnt lgkmcnt(4)
    v_mfma_f32_32x32x16_bf16 v[48:63], v[180:183], a[40:43], v[48:63]
    ds_read_b128 v[168:171], v1 offset:24576
    v_mul_f32 v153, v153, v105
    v_mul_f32 v154, v154, v106
    v_mfma_f32_32x32x16_bf16 v[64:79], v[180:183], a[44:47], v[64:79]
    buffer_load_dwordx4 v4, s[4:7], s38 offen offset:1024 sc1 lds
    s_waitcnt lgkmcnt(4)
    v_mfma_f32_32x32x16_bf16 v[48:63], v[184:187], a[120:123], v[48:63]
    ds_read_b128 v[172:175], v1 offset:34816
    v_mul_f32 v155, v155, v107
    v_mul_f32 v156, v156, v108
    v_mfma_f32_32x32x16_bf16 v[64:79], v[184:187], a[124:127], v[64:79]
    v_mul_f32 v157, v157, v109
    v_mul_f32 v158, v158, v110
    v_mul_f32 v159, v159, v111
    s_waitcnt lgkmcnt(4)
    v_mfma_f32_32x32x16_bf16 v[48:63], v[188:191], a[200:203], v[48:63]
    ds_read_b128 v[176:179], v1 offset:5120
    v_cvt_pk_bf16_f32 v36, v152, v153
    v_cvt_pk_bf16_f32 v37, v154, v155
    v_mfma_f32_32x32x16_bf16 v[64:79], v[188:191], a[204:207], v[64:79]
    buffer_load_dwordx4 v4, s[4:7], s38 offen offset:2048 sc1 lds
    s_waitcnt lgkmcnt(4)
    v_mfma_f32_32x32x16_bf16 v[48:63], v[160:163], v[224:227], v[48:63]
    ds_read_b128 v[180:183], v1 offset:15360
    v_cvt_pk_bf16_f32 v38, v156, v157
    v_cvt_pk_bf16_f32 v39, v158, v159
    v_mfma_f32_32x32x16_bf16 v[64:79], v[160:163], v[228:231], v[64:79]
    buffer_store_dwordx4 v[36:39], v7, s[4:7], s34 offen offset:2048 sc1
    ds_read_b64 v[80:81], v9 offset:0
    ds_read_b64 v[82:83], v9 offset:256
    s_waitcnt lgkmcnt(6)
    v_mfma_f32_32x32x16_bf16 v[48:63], v[164:167], a[48:51], v[48:63]
    ds_read_b128 v[184:187], v1 offset:25600
    ds_read_b64 v[84:85], v9 offset:512
    ds_read_b64 v[86:87], v9 offset:768
    v_mfma_f32_32x32x16_bf16 v[64:79], v[164:167], a[52:55], v[64:79]
    buffer_load_dwordx4 v4, s[4:7], s38 offen offset:3072 sc1 lds
    s_waitcnt lgkmcnt(8)
    v_mfma_f32_32x32x16_bf16 v[48:63], v[168:171], a[128:131], v[48:63]
    ds_read_b128 v[188:191], v1 offset:35840
    s_waitcnt lgkmcnt(5)
    v_mov_b32 v16, v80
    v_mov_b32 v17, v81
    v_mfma_f32_32x32x16_bf16 v[64:79], v[168:171], a[132:135], v[64:79]
    s_waitcnt lgkmcnt(4)
    v_mov_b32 v18, v82
    v_mov_b32 v19, v83
    s_waitcnt lgkmcnt(2)
    v_add_f32 v16, v16, v84
    v_mfma_f32_32x32x16_bf16 v[48:63], v[172:175], a[208:211], v[48:63]
    ds_read_b128 v[160:163], v1 offset:6144
    v_add_f32 v17, v17, v85
    s_waitcnt lgkmcnt(2)
    v_add_f32 v18, v18, v86
    v_mfma_f32_32x32x16_bf16 v[64:79], v[172:175], a[212:215], v[64:79]
    s_add_u32 s38, s38, 4096
    s_add_u32 s39, s39, 4096
    s_mov_b32 m0, s39
    s_nop 0
    buffer_load_dwordx4 v4, s[4:7], s38 offen offset:0 sc1 lds
    v_mfma_f32_32x32x16_bf16 v[48:63], v[176:179], v[232:235], v[48:63]
    ds_read_b128 v[164:167], v1 offset:16384
    v_add_f32 v19, v19, v87
    ds_read_b64 v[80:81], v9 offset:1024
    v_mfma_f32_32x32x16_bf16 v[64:79], v[176:179], v[236:239], v[64:79]
    ds_read_b64 v[82:83], v9 offset:1280
    ds_read_b64 v[84:85], v9 offset:1536
    ds_read_b64 v[86:87], v9 offset:1792
    v_mfma_f32_32x32x16_bf16 v[48:63], v[180:183], a[56:59], v[48:63]
    ds_read_b128 v[168:171], v1 offset:26624
    s_waitcnt lgkmcnt(4)
    v_add_f32 v16, v16, v80
    v_add_f32 v17, v17, v81
    v_mfma_f32_32x32x16_bf16 v[64:79], v[180:183], a[60:63], v[64:79]
    buffer_load_dwordx4 v4, s[4:7], s38 offen offset:1024 sc1 lds
    v_mfma_f32_32x32x16_bf16 v[48:63], v[184:187], a[136:139], v[48:63]
    ds_read_b128 v[172:175], v1 offset:36864
    s_waitcnt lgkmcnt(4)
    v_add_f32 v18, v18, v82
    v_add_f32 v19, v19, v83
    v_mfma_f32_32x32x16_bf16 v[64:79], v[184:187], a[140:143], v[64:79]
    s_waitcnt lgkmcnt(3)
    v_add_f32 v16, v16, v84
    v_add_f32 v17, v17, v85
    s_waitcnt lgkmcnt(2)
    v_add_f32 v18, v18, v86
    v_mfma_f32_32x32x16_bf16 v[48:63], v[188:191], a[216:219], v[48:63]
    ds_read_b128 v[176:179], v1 offset:7168
    v_add_f32 v19, v19, v87
    ds_read_b64 v[80:81], v9 offset:2048
    v_mfma_f32_32x32x16_bf16 v[64:79], v[188:191], a[220:223], v[64:79]
    ds_read_b64 v[82:83], v9 offset:2304
    s_waitcnt lgkmcnt(1)
    v_add_f32 v16, v16, v80
    v_add_f32 v17, v17, v81
    v_mfma_f32_32x32x16_bf16 v[48:63], v[160:163], v[240:243], v[48:63]
    ds_read_b128 v[180:183], v1 offset:17408
    s_waitcnt lgkmcnt(1)
    v_add_f32 v18, v18, v82
    v_add_f32 v19, v19, v83
    v_mfma_f32_32x32x16_bf16 v[64:79], v[160:163], v[244:247], v[64:79]
    v_add_f32 v16, v16, v18
    v_add_f32 v17, v17, v19
    v_mov_b32 v18, v16
    v_mfma_f32_32x32x16_bf16 v[48:63], v[164:167], a[64:67], v[48:63]
    ds_read_b128 v[184:187], v1 offset:27648
    v_mov_b32 v19, v17
    s_nop 1
    v_mfma_f32_32x32x16_bf16 v[64:79], v[164:167], a[68:71], v[64:79]
    v_permlane32_swap_b32 v16, v18
    v_permlane32_swap_b32 v17, v19
    v_add_f32 v16, v16, v18
    v_mfma_f32_32x32x16_bf16 v[48:63], v[168:171], a[144:147], v[48:63]
    ds_read_b128 v[188:191], v1 offset:37888
    v_add_f32 v17, v17, v19
    v_mul_f32 v12, s42, v16
    v_mfma_f32_32x32x16_bf16 v[64:79], v[168:171], a[148:151], v[64:79]
    v_mul_f32 v15, s42, v17
    v_sub_f32 v16, 0, v12
    v_cvt_pk_bf16_f32 v121, v16, v16
    v_mfma_f32_32x32x16_bf16 v[48:63], v[172:175], a[224:227], v[48:63]
    ds_read_b128 v[160:163], v1 offset:8192
    v_fma_f32 v15, -v12, v12, v15
    v_and_b32 v17, 0xffff0000, v121
    v_mfma_f32_32x32x16_bf16 v[64:79], v[172:175], a[228:231], v[64:79]
    v_max_f32 v15, 0, v15
    v_sub_f32 v16, v16, v17
    v_add_f32 v18, s43, v15
    v_mfma_f32_32x32x16_bf16 v[48:63], v[176:179], v[248:251], v[48:63]
    ds_read_b128 v[164:167], v1 offset:18432
    v_cvt_pk_bf16_f32 v120, v17, v16
    v_rsq_f32 v13, v18
    v_mfma_f32_32x32x16_bf16 v[64:79], v[176:179], v[252:255], v[64:79]
    s_nop 0
    v_cvt_pk_bf16_f32 v16, v13, v13
    v_and_b32 v16, 0xffff0000, v16
    s_waitcnt lgkmcnt(4)
    v_mfma_f32_32x32x16_bf16 v[48:63], v[180:183], a[72:75], v[48:63]
    ds_read_b128 v[168:171], v1 offset:28672
    v_sub_f32 v17, v13, v16
    v_cvt_pk_bf16_f32 v90, v16, v17
    v_mfma_f32_32x32x16_bf16 v[64:79], v[180:183], a[76:79], v[64:79]
    v_and_b32 v16, 0xffff0000, v90
    v_sub_f32 v17, v17, v16
    v_cvt_pk_bf16_f32 v91, v17, 0
    s_waitcnt lgkmcnt(4)
    v_mfma_f32_32x32x16_bf16 v[48:63], v[184:187], a[152:155], v[48:63]
    ds_read_b128 v[172:175], v1 offset:38912
    v_mov_b32 v16, 0x3f803f80
    v_cndmask_b32 v92, v16, 0, s[44:45]
    v_mfma_f32_32x32x16_bf16 v[64:79], v[184:187], a[156:159], v[64:79]
    v_cndmask_b32 v93, v16, 0, s[44:45]
    s_nop 1
    v_mfma_f32_32x32x8_bf16 v[96:111], v[90:91], v[92:93], 0
    s_waitcnt lgkmcnt(4)
    v_mfma_f32_32x32x16_bf16 v[48:63], v[188:191], a[232:235], v[48:63]
    ds_read_b128 v[176:179], v1 offset:9216
    v_mfma_f32_32x32x16_bf16 v[48:63], v[120:123], v[112:115], v[48:63]
    v_mfma_f32_32x32x16_bf16 v[64:79], v[120:123], v[116:119], v[64:79]
    v_mfma_f32_32x32x16_bf16 v[64:79], v[188:191], a[236:239], v[64:79]
    s_waitcnt lgkmcnt(4)
    v_mfma_f32_32x32x16_bf16 v[48:63], v[160:163], a[0:3], v[48:63]
    ds_read_b128 v[180:183], v1 offset:19456
    v_mfma_f32_32x32x16_bf16 v[64:79], v[160:163], a[4:7], v[64:79]
    s_waitcnt lgkmcnt(4)
    v_mfma_f32_32x32x16_bf16 v[48:63], v[164:167], a[80:83], v[48:63]
    ds_read_b128 v[184:187], v1 offset:29696
    v_mfma_f32_32x32x16_bf16 v[64:79], v[164:167], a[84:87], v[64:79]
    s_waitcnt lgkmcnt(4)
    v_mfma_f32_32x32x16_bf16 v[48:63], v[168:171], a[160:163], v[48:63]
    ds_read_b128 v[188:191], v1 offset:39936
    v_mfma_f32_32x32x16_bf16 v[64:79], v[168:171], a[164:167], v[64:79]
    s_waitcnt lgkmcnt(4)
    v_mfma_f32_32x32x16_bf16 v[48:63], v[172:175], a[240:243], v[48:63]
    v_add_u32 v1, s35, v0
    s_waitcnt vmcnt(0)
    s_barrier
    ds_read_b128 v[160:163], v1 offset:0
    v_mfma_f32_32x32x16_bf16 v[64:79], v[172:175], a[244:247], v[64:79]
    s_waitcnt lgkmcnt(4)
    v_mfma_f32_32x32x16_bf16 v[48:63], v[176:179], a[8:11], v[48:63]
    ds_read_b128 v[164:167], v1 offset:10240
    s_sub_u32 s63, s26, s47
    s_mov_b32 s47, s26
    s_atomic_add s63, s[4:5], s21
    v_mfma_f32_32x32x16_bf16 v[64:79], v[176:179], a[12:15], v[64:79]
    s_waitcnt lgkmcnt(4)
    v_mfma_f32_32x32x16_bf16 v[48:63], v[180:183], a[88:91], v[48:63]
    ds_read_b128 v[168:171], v1 offset:20480
    s_add_u32 s26, s16, 1
    s_mul_i32 s34, s16, 262144
    s_add_u32 s34, s34, s19
    v_mfma_f32_32x32x16_bf16 v[64:79], v[180:183], a[92:95], v[64:79]
    s_waitcnt lgkmcnt(4)
    v_mfma_f32_32x32x16_bf16 v[48:63], v[184:187], a[168:171], v[48:63]
    ds_read_b128 v[172:175], v1 offset:30720
    s_mov_b32 s30, s24
    s_mov_b32 s24, s35
    s_mov_b32 s35, s36
    v_mfma_f32_32x32x16_bf16 v[64:79], v[184:187], a[172:175], v[64:79]
    s_waitcnt lgkmcnt(4)
    v_mfma_f32_32x32x16_bf16 v[48:63], v[188:191], a[248:251], v[48:63]
    ds_read_b128 v[176:179], v1 offset:1024
    s_mov_b32 s36, s30
    s_mov_b32 s16, s29
    s_cmp_ge_u32 s16, s46
    v_mfma_f32_32x32x16_bf16 v[64:79], v[188:191], a[252:255], v[64:79]
    s_cbranch_scc1 RV_f0
    s_waitcnt lgkmcnt(4)
    v_mfma_f32_32x32x16_bf16 v[128:143], v[160:163], v[192:195], 0
    ds_read_b128 v[180:183], v1 offset:11264
    s_cmp_lt_u32 s16, 35
    s_cselect_b32 s17, s17, 1
    s_add_u32 s29, s16, s17
    v_add_u32 v9, s24, v3
    v_mfma_f32_32x32x16_bf16 v[144:159], v[160:163], v[196:199], 0
    s_cmp_lt_u32 s29, s46
    s_cselect_b32 s32, s29, s16
    s_waitcnt lgkmcnt(4)
    v_mfma_f32_32x32x16_bf16 v[128:143], v[164:167], a[16:19], v[128:143]
    ds_read_b128 v[184:187], v1 offset:21504
    v_mfma_f32_32x32x16_bf16 v[144:159], v[164:167], a[20:23], v[144:159]
    s_mul_i32 s38, s32, 49152
    s_add_u32 s38, s38, s18
    s_mov_b32 s39, s35
    s_mul_i32 s30, s12, 1280
    s_add_u32 s30, s30, 40960
    s_add_u32 m0, s30, s39
    s_add_u32 s30, s30, s38
    buffer_load_dwordx4 v0, s[4:7], s30 offen sc1 lds
    buffer_load_dword v5, s[4:7], s30 offen offset:1024 sc1 lds
    s_waitcnt lgkmcnt(4)
    v_mfma_f32_32x32x16_bf16 v[128:143], v[168:171], a[96:99], v[128:143]
    ds_read_b128 v[188:191], v1 offset:31744
    v_mul_f32 v48, v48, v96
    v_mul_f32 v49, v49, v97
    v_mfma_f32_32x32x16_bf16 v[144:159], v[168:171], a[100:103], v[144:159]
    v_mul_f32 v50, v50, v98
    v_mul_f32 v51, v51, v99
    v_mul_f32 v52, v52, v100
    s_waitcnt lgkmcnt(4)
    v_mfma_f32_32x32x16_bf16 v[128:143], v[172:175], a[176:179], v[128:143]
    ds_read_b128 v[160:163], v1 offset:2048
    v_mul_f32 v53, v53, v101
    v_mul_f32 v54, v54, v102
    v_mfma_f32_32x32x16_bf16 v[144:159], v[172:175], a[180:183], v[144:159]
    s_mul_i32 s30, s12, 10240
    s_add_u32 s38, s38, s30
    s_add_u32 s39, s39, s30
    s_mov_b32 m0, s39
    s_nop 0
    buffer_load_dwordx4 v4, s[4:7], s38 offen offset:0 sc1 lds
    s_waitcnt lgkmcnt(4)
    v_mfma_f32_32x32x16_bf16 v[128:143], v[176:179], v[200:203], v[128:143]
    ds_read_b128 v[164:167], v1 offset:12288
    v_mul_f32 v55, v55, v103
    v_cvt_pk_bf16_f32 v24, v48, v49
    v_mfma_f32_32x32x16_bf16 v[144:159], v[176:179], v[204:207], v[144:159]
    v_cvt_pk_bf16_f32 v25, v50, v51
    v_cvt_pk_bf16_f32 v26, v52, v53
    v_cvt_pk_bf16_f32 v27, v54, v55
    s_waitcnt lgkmcnt(4)
    v_mfma_f32_32x32x16_bf16 v[128:143], v[180:183], a[24:27], v[128:143]
    ds_read_b128 v[168:171], v1 offset:22528
    buffer_store_dwordx4 v[24:27], v6, s[4:7], s34 offen offset:0 sc1
    v_mul_f32 v56, v56, v104
    v_mfma_f32_32x32x16_bf16 v[144:159], v[180:183], a[28:31], v[144:159]
    buffer_load_dwordx4 v4, s[4:7], s38 offen offset:1024 sc1 lds
    s_waitcnt lgkmcnt(4)
    v_mfma_f32_32x32x16_bf16 v[128:143], v[184:187], a[104:107], v[128:143]
    ds_read_b128 v[172:175], v1 offset:32768
    v_mul_f32 v57, v57, v105
    v_mul_f32 v58, v58, v106
    v_mfma_f32_32x32x16_bf16 v[144:159], v[184:187], a[108:111], v[144:159]
    v_mul_f32 v59, v59, v107
    v_mul_f32 v60, v60, v108
    v_mul_f32 v61, v61, v109
    s_waitcnt lgkmcnt(4)
    v_mfma_f32_32x32x16_bf16 v[128:143], v[188:191], a[184:187], v[128:143]
    ds_read_b128 v[176:179], v1 offset:3072
    v_mul_f32 v62, v62, v110
    v_mul_f32 v63, v63, v111
    v_mfma_f32_32x32x16_bf16 v[144:159], v[188:191], a[188:191], v[144:159]
    buffer_load_dwordx4 v4, s[4:7], s38 offen offset:2048 sc1 lds
    s_waitcnt lgkmcnt(4)
    v_mfma_f32_32x32x16_bf16 v[128:143], v[160:163], v[208:211], v[128:143]
    ds_read_b128 v[180:183], v1 offset:13312
    v_cvt_pk_bf16_f32 v28, v56, v57
    v_cvt_pk_bf16_f32 v29, v58, v59
    v_mfma_f32_32x32x16_bf16 v[144:159], v[160:163], v[212:215], v[144:159]
    v_cvt_pk_bf16_f32 v30, v60, v61
    v_cvt_pk_bf16_f32 v31, v62, v63
    buffer_store_dwordx4 v[28:31], v7, s[4:7], s34 offen offset:0 sc1
    s_waitcnt lgkmcnt(4)
    v_mfma_f32_32x32x16_bf16 v[128:143], v[164:167], a[32:35], v[128:143]
    ds_read_b128 v[184:187], v1 offset:23552
    v_mul_f32 v64, v64, v96
    v_mul_f32 v65, v65, v97
    v_mfma_f32_32x32x16_bf16 v[144:159], v[164:167], a[36:39], v[144:159]
    buffer_load_dwordx4 v4, s[4:7], s38 offen offset:3072 sc1 lds
    s_waitcnt lgkmcnt(4)
    v_mfma_f32_32x32x16_bf16 v[128:143], v[168:171], a[112:115], v[128:143]
    ds_read_b128 v[188:191], v1 offset:33792
    v_mul_f32 v66, v66, v98
    v_mul_f32 v67, v67, v99
    v_mfma_f32_32x32x16_bf16 v[144:159], v[168:171], a[116:119], v[144:159]
    v_mul_f32 v68, v68, v100
    v_mul_f32 v69, v69, v101
    v_mul_f32 v70, v70, v102
    s_waitcnt lgkmcnt(4)
    v_mfma_f32_32x32x16_bf16 v[128:143], v[172:175], a[192:195], v[128:143]
    ds_read_b128 v[160:163], v1 offset:4096
    v_mul_f32 v71, v71, v103
    v_cvt_pk_bf16_f32 v32, v64, v65
    v_mfma_f32_32x32x16_bf16 v[144:159], v[172:175], a[196:199], v[144:159]
    s_add_u32 s38, s38, 4096
    s_add_u32 s39, s39, 4096
    s_mov_b32 m0, s39
    s_nop 0
    buffer_load_dwordx4 v4, s[4:7], s38 offen offset:0 sc1 lds
    s_waitcnt lgkmcnt(4)
    v_mfma_f32_32x32x16_bf16 v[128:143], v[176:179], v[216:219], v[128:143]
    ds_read_b128 v[164:167], v1 offset:14336
    v_cvt_pk_bf16_f32 v33, v66, v67
    v_cvt_pk_bf16_f32 v34, v68, v69
    v_mfma_f32_32x32x16_bf16 v[144:159], v[176:179], v[220:223], v[144:159]
    v_cvt_pk_bf16_f32 v35, v70, v71
    buffer_store_dwordx4 v[32:35], v6, s[4:7], s34 offen offset:2048 sc1
    v_mul_f32 v72, v72, v104
    s_waitcnt lgkmcnt(4)
    v_mfma_f32_32x32x16_bf16 v[128:143], v[180:183], a[40:43], v[128:143]
    ds_read_b128 v[168:171], v1 offset:24576
    v_mul_f32 v73, v73, v105
    v_mul_f32 v74, v74, v106
    v_mfma_f32_32x32x16_bf16 v[144:159], v[180:183], a[44:47], v[144:159]
    buffer_load_dwordx4 v4, s[4:7], s38 offen offset:1024 sc1 lds
    s_waitcnt lgkmcnt(4)
    v_mfma_f32_32x32x16_bf16 v[128:143], v[184:187], a[120:123], v[128:143]
    ds_read_b128 v[172:175], v1 offset:34816
    v_mul_f32 v75, v75, v107
    v_mul_f32 v76, v76, v108
    v_mfma_f32_32x32x16_bf16 v[144:159], v[184:187], a[124:127], v[144:159]
    v_mul_f32 v77, v77, v109
    v_mul_f32 v78, v78, v110
    v_mul_f32 v79, v79, v111
    s_waitcnt lgkmcnt(4)
    v_mfma_f32_32x32x16_bf16 v[128:143], v[188:191], a[200:203], v[128:143]
    ds_read_b128 v[176:179], v1 offset:5120
    v_cvt_pk_bf16_f32 v36, v72, v73
    v_cvt_pk_bf16_f32 v37, v74, v75
    v_mfma_f32_32x32x16_bf16 v[144:159], v[188:191], a[204:207], v[144:159]
    buffer_load_dwordx4 v4, s[4:7], s38 offen offset:2048 sc1 lds
    s_waitcnt lgkmcnt(4)
    v_mfma_f32_32x32x16_bf16 v[128:143], v[160:163], v[224:227], v[128:143]
    ds_read_b128 v[180:183], v1 offset:15360
    v_cvt_pk_bf16_f32 v38, v76, v77
    v_cvt_pk_bf16_f32 v39, v78, v79
    v_mfma_f32_32x32x16_bf16 v[144:159], v[160:163], v[228:231], v[144:159]
    buffer_store_dwordx4 v[36:39], v7, s[4:7], s34 offen offset:2048 sc1
    ds_read_b64 v[80:81], v9 offset:0
    ds_read_b64 v[82:83], v9 offset:256
    s_waitcnt lgkmcnt(6)
    v_mfma_f32_32x32x16_bf16 v[128:143], v[164:167], a[48:51], v[128:143]
    ds_read_b128 v[184:187], v1 offset:25600
    ds_read_b64 v[84:85], v9 offset:512
    ds_read_b64 v[86:87], v9 offset:768
    v_mfma_f32_32x32x16_bf16 v[144:159], v[164:167], a[52:55], v[144:159]
    buffer_load_dwordx4 v4, s[4:7], s38 offen offset:3072 sc1 lds
    s_waitcnt lgkmcnt(8)
    v_mfma_f32_32x32x16_bf16 v[128:143], v[168:171], a[128:131], v[128:143]
    ds_read_b128 v[188:191], v1 offset:35840
    s_waitcnt lgkmcnt(5)
    v_mov_b32 v16, v80
    v_mov_b32 v17, v81
    v_mfma_f32_32x32x16_bf16 v[144:159], v[168:171], a[132:135], v[144:159]
    s_waitcnt lgkmcnt(4)
    v_mov_b32 v18, v82
    v_mov_b32 v19, v83
    s_waitcnt lgkmcnt(2)
    v_add_f32 v16, v16, v84
    v_mfma_f32_32x32x16_bf16 v[128:143], v[172:175], a[208:211], v[128:143]
    ds_read_b128 v[160:163], v1 offset:6144
    v_add_f32 v17, v17, v85
    s_waitcnt lgkmcnt(2)
    v_add_f32 v18, v18, v86
    v_mfma_f32_32x32x16_bf16 v[144:159], v[172:175], a[212:215], v[144:159]
    s_add_u32 s38, s38, 4096
    s_add_u32 s39, s39, 4096
    s_mov_b32 m0, s39
    s_nop 0
    buffer_load_dwordx4 v4, s[4:7], s38 offen offset:0 sc1 lds
    v_mfma_f32_32x32x16_bf16 v[128:143], v[176:179], v[232:235], v[128:143]
    ds_read_b128 v[164:167], v1 offset:16384
    v_add_f32 v19, v19, v87
    ds_read_b64 v[80:81], v9 offset:1024
    v_mfma_f32_32x32x16_bf16 v[144:159], v[176:179], v[236:239], v[144:159]
    ds_read_b64 v[82:83], v9 offset:1280
    ds_read_b64 v[84:85], v9 offset:1536
    ds_read_b64 v[86:87], v9 offset:1792
    v_mfma_f32_32x32x16_bf16 v[128:143], v[180:183], a[56:59], v[128:143]
    ds_read_b128 v[168:171], v1 offset:26624
    s_waitcnt lgkmcnt(4)
    v_add_f32 v16, v16, v80
    v_add_f32 v17, v17, v81
    v_mfma_f32_32x32x16_bf16 v[144:159], v[180:183], a[60:63], v[144:159]
    buffer_load_dwordx4 v4, s[4:7], s38 offen offset:1024 sc1 lds
    v_mfma_f32_32x32x16_bf16 v[128:143], v[184:187], a[136:139], v[128:143]
    ds_read_b128 v[172:175], v1 offset:36864
    s_waitcnt lgkmcnt(4)
    v_add_f32 v18, v18, v82
    v_add_f32 v19, v19, v83
    v_mfma_f32_32x32x16_bf16 v[144:159], v[184:187], a[140:143], v[144:159]
    s_waitcnt lgkmcnt(3)
    v_add_f32 v16, v16, v84
    v_add_f32 v17, v17, v85
    s_waitcnt lgkmcnt(2)
    v_add_f32 v18, v18, v86
    v_mfma_f32_32x32x16_bf16 v[128:143], v[188:191], a[216:219], v[128:143]
    ds_read_b128 v[176:179], v1 offset:7168
    v_add_f32 v19, v19, v87
    ds_read_b64 v[80:81], v9 offset:2048
    v_mfma_f32_32x32x16_bf16 v[144:159], v[188:191], a[220:223], v[144:159]
    ds_read_b64 v[82:83], v9 offset:2304
    s_waitcnt lgkmcnt(1)
    v_add_f32 v16, v16, v80
    v_add_f32 v17, v17, v81
    v_mfma_f32_32x32x16_bf16 v[128:143], v[160:163], v[240:243], v[128:143]
    ds_read_b128 v[180:183], v1 offset:17408
    s_waitcnt lgkmcnt(1)
    v_add_f32 v18, v18, v82
    v_add_f32 v19, v19, v83
    v_mfma_f32_32x32x16_bf16 v[144:159], v[160:163], v[244:247], v[144:159]
    v_add_f32 v16, v16, v18
    v_add_f32 v17, v17, v19
    v_mov_b32 v18, v16
    v_mfma_f32_32x32x16_bf16 v[128:143], v[164:167], a[64:67], v[128:143]
    ds_read_b128 v[184:187], v1 offset:27648
    v_mov_b32 v19, v17
    s_nop 1
    v_mfma_f32_32x32x16_bf16 v[144:159], v[164:167], a[68:71], v[144:159]
    v_permlane32_swap_b32 v16, v18
    v_permlane32_swap_b32 v17, v19
    v_add_f32 v16, v16, v18
    v_mfma_f32_32x32x16_bf16 v[128:143], v[168:171], a[144:147], v[128:143]
    ds_read_b128 v[188:191], v1 offset:37888
    v_add_f32 v17, v17, v19
    v_mul_f32 v12, s42, v16
    v_mfma_f32_32x32x16_bf16 v[144:159], v[168:171], a[148:151], v[144:159]
    v_mul_f32 v15, s42, v17
    v_sub_f32 v16, 0, v12
    v_cvt_pk_bf16_f32 v121, v16, v16
    v_mfma_f32_32x32x16_bf16 v[128:143], v[172:175], a[224:227], v[128:143]
    ds_read_b128 v[160:163], v1 offset:8192
    v_fma_f32 v15, -v12, v12, v15
    v_and_b32 v17, 0xffff0000, v121
    v_mfma_f32_32x32x16_bf16 v[144:159], v[172:175], a[228:231], v[144:159]
    v_max_f32 v15, 0, v15
    v_sub_f32 v16, v16, v17
    v_add_f32 v18, s43, v15
    v_mfma_f32_32x32x16_bf16 v[128:143], v[176:179], v[248:251], v[128:143]
    ds_read_b128 v[164:167], v1 offset:18432
    v_cvt_pk_bf16_f32 v120, v17, v16
    v_rsq_f32 v13, v18
    v_mfma_f32_32x32x16_bf16 v[144:159], v[176:179], v[252:255], v[144:159]
    s_nop 0
    v_cvt_pk_bf16_f32 v16, v13, v13
    v_and_b32 v16, 0xffff0000, v16
    s_waitcnt lgkmcnt(4)
    v_mfma_f32_32x32x16_bf16 v[128:143], v[180:183], a[72:75], v[128:143]
    ds_read_b128 v[168:171], v1 offset:28672
    v_sub_f32 v17, v13, v16
    v_cvt_pk_bf16_f32 v90, v16, v17
    v_mfma_f32_32x32x16_bf16 v[144:159], v[180:183], a[76:79], v[144:159]
    v_and_b32 v16, 0xffff0000, v90
    v_sub_f32 v17, v17, v16
    v_cvt_pk_bf16_f32 v91, v17, 0
    s_waitcnt lgkmcnt(4)
    v_mfma_f32_32x32x16_bf16 v[128:143], v[184:187], a[152:155], v[128:143]
    ds_read_b128 v[172:175], v1 offset:38912
    v_mov_b32 v16, 0x3f803f80
    v_cndmask_b32 v92, v16, 0, s[44:45]
    v_mfma_f32_32x32x16_bf16 v[144:159], v[184:187], a[156:159], v[144:159]
    v_cndmask_b32 v93, v16, 0, s[44:45]
    s_nop 1
    v_mfma_f32_32x32x8_bf16 v[96:111], v[90:91], v[92:93], 0
    s_waitcnt lgkmcnt(4)
    v_mfma_f32_32x32x16_bf16 v[128:143], v[188:191], a[232:235], v[128:143]
    ds_read_b128 v[176:179], v1 offset:9216
    v_mfma_f32_32x32x16_bf16 v[128:143], v[120:123], v[112:115], v[128:143]
    v_mfma_f32_32x32x16_bf16 v[144:159], v[120:123], v[116:119], v[144:159]
    v_mfma_f32_32x32x16_bf16 v[144:159], v[188:191], a[236:239], v[144:159]
    s_waitcnt lgkmcnt(4)
    v_mfma_f32_32x32x16_bf16 v[128:143], v[160:163], a[0:3], v[128:143]
    ds_read_b128 v[180:183], v1 offset:19456
    v_mfma_f32_32x32x16_bf16 v[144:159], v[160:163], a[4:7], v[144:159]
    s_waitcnt lgkmcnt(4)
    v_mfma_f32_32x32x16_bf16 v[128:143], v[164:167], a[80:83], v[128:143]
    ds_read_b128 v[184:187], v1 offset:29696
    v_mfma_f32_32x32x16_bf16 v[144:159], v[164:167], a[84:87], v[144:159]
    s_waitcnt lgkmcnt(4)
    v_mfma_f32_32x32x16_bf16 v[128:143], v[168:171], a[160:163], v[128:143]
    ds_read_b128 v[188:191], v1 offset:39936
    v_mfma_f32_32x32x16_bf16 v[144:159], v[168:171], a[164:167], v[144:159]
    s_waitcnt lgkmcnt(4)
    v_mfma_f32_32x32x16_bf16 v[128:143], v[172:175], a[240:243], v[128:143]
    v_add_u32 v1, s35, v0
    s_waitcnt vmcnt(0)
    s_barrier
    ds_read_b128 v[160:163], v1 offset:0
    v_mfma_f32_32x32x16_bf16 v[144:159], v[172:175], a[244:247], v[144:159]
    s_waitcnt lgkmcnt(4)
    v_mfma_f32_32x32x16_bf16 v[128:143], v[176:179], a[8:11], v[128:143]
    ds_read_b128 v[164:167], v1 offset:10240
    s_sub_u32 s63, s26, s47
    s_mov_b32 s47, s26
    s_atomic_add s63, s[4:5], s21
    v_mfma_f32_32x32x16_bf16 v[144:159], v[176:179], a[12:15], v[144:159]
    s_waitcnt lgkmcnt(4)
    v_mfma_f32_32x32x16_bf16 v[128:143], v[180:183], a[88:91], v[128:143]
    ds_read_b128 v[168:171], v1 offset:20480
    s_add_u32 s26, s16, 1
    s_mul_i32 s34, s16, 262144
    s_add_u32 s34, s34, s19
    v_mfma_f32_32x32x16_bf16 v[144:159], v[180:183], a[92:95], v[144:159]
    s_waitcnt lgkmcnt(4)
    v_mfma_f32_32x32x16_bf16 v[128:143], v[184:187], a[168:171], v[128:143]
    ds_read_b128 v[172:175], v1 offset:30720
    s_mov_b32 s30, s24
    s_mov_b32 s24, s35
    s_mov_b32 s35, s36
    v_mfma_f32_32x32x16_bf16 v[144:159], v[184:187], a[172:175], v[144:159]
    s_waitcnt lgkmcnt(4)
    v_mfma_f32_32x32x16_bf16 v[128:143], v[188:191], a[248:251], v[128:143]
    ds_read_b128 v[176:179], v1 offset:1024
    s_mov_b32 s36, s30
    s_mov_b32 s16, s29
    s_cmp_ge_u32 s16, s46
    v_mfma_f32_32x32x16_bf16 v[144:159], v[188:191], a[252:255], v[144:159]
    s_cbranch_scc0 RV_st
RV_f1:
    s_nop 11
    v_mul_f32 v128, v128, v96
    v_mul_f32 v129, v129, v97
    v_mul_f32 v130, v130, v98
    v_mul_f32 v131, v131, v99
    v_mul_f32 v132, v132, v100
    v_mul_f32 v133, v133, v101
    v_mul_f32 v134, v134, v102
    v_mul_f32 v135, v135, v103
    v_cvt_pk_bf16_f32 v24, v128, v129
    v_cvt_pk_bf16_f32 v25, v130, v131
    v_cvt_pk_bf16_f32 v26, v132, v133
    v_cvt_pk_bf16_f32 v27, v134, v135
    buffer_store_dwordx4 v[24:27], v6, s[4:7], s34 offen offset:0 sc1
    v_mul_f32 v136, v136, v104
    v_mul_f32 v137, v137, v105
    v_mul_f32 v138, v138, v106
    v_mul_f32 v139, v139, v107
    v_mul_f32 v140, v140, v108
    v_mul_f32 v141, v141, v109
    v_mul_f32 v142, v142, v110
    v_mul_f32 v143, v143, v111
    v_cvt_pk_bf16_f32 v28, v136, v137
    v_cvt_pk_bf16_f32 v29, v138, v139
    v_cvt_pk_bf16_f32 v30, v140, v141
    v_cvt_pk_bf16_f32 v31, v142, v143
    buffer_store_dwordx4 v[28:31], v7, s[4:7], s34 offen offset:0 sc1
    v_mul_f32 v144, v144, v96
    v_mul_f32 v145, v145, v97
    v_mul_f32 v146, v146, v98
    v_mul_f32 v147, v147, v99
    v_mul_f32 v148, v148, v100
    v_mul_f32 v149, v149, v101
    v_mul_f32 v150, v150, v102
    v_mul_f32 v151, v151, v103
    v_cvt_pk_bf16_f32 v32, v144, v145
    v_cvt_pk_bf16_f32 v33, v146, v147
    v_cvt_pk_bf16_f32 v34, v148, v149
    v_cvt_pk_bf16_f32 v35, v150, v151
    buffer_store_dwordx4 v[32:35], v6, s[4:7], s34 offen offset:2048 sc1
    v_mul_f32 v152, v152, v104
    v_mul_f32 v153, v153, v105
    v_mul_f32 v154, v154, v106
    v_mul_f32 v155, v155, v107
    v_mul_f32 v156, v156, v108
    v_mul_f32 v157, v157, v109
    v_mul_f32 v158, v158, v110
    v_mul_f32 v159, v159, v111
    v_cvt_pk_bf16_f32 v36, v152, v153
    v_cvt_pk_bf16_f32 v37, v154, v155
    v_cvt_pk_bf16_f32 v38, v156, v157
    v_cvt_pk_bf16_f32 v39, v158, v159
    buffer_store_dwordx4 v[36:39], v7, s[4:7], s34 offen offset:2048 sc1
    s_branch G_29
RV_f0:
    s_nop 11
    v_mul_f32 v48, v48, v96
    v_mul_f32 v49, v49, v97
    v_mul_f32 v50, v50, v98
    v_mul_f32 v51, v51, v99
    v_mul_f32 v52, v52, v100
    v_mul_f32 v53, v53, v101
    v_mul_f32 v54, v54, v102
    v_mul_f32 v55, v55, v103
    v_cvt_pk_bf16_f32 v24, v48, v49
    v_cvt_pk_bf16_f32 v25, v50, v51
    v_cvt_pk_bf16_f32 v26, v52, v53
    v_cvt_pk_bf16_f32 v27, v54, v55
    buffer_store_dwordx4 v[24:27], v6, s[4:7], s34 offen offset:0 sc1
    v_mul_f32 v56, v56, v104
    v_mul_f32 v57, v57, v105
    v_mul_f32 v58, v58, v106
    v_mul_f32 v59, v59, v107
    v_mul_f32 v60, v60, v108
    v_mul_f32 v61, v61, v109
    v_mul_f32 v62, v62, v110
    v_mul_f32 v63, v63, v111
    v_cvt_pk_bf16_f32 v28, v56, v57
    v_cvt_pk_bf16_f32 v29, v58, v59
    v_cvt_pk_bf16_f32 v30, v60, v61
    v_cvt_pk_bf16_f32 v31, v62, v63
    buffer_store_dwordx4 v[28:31], v7, s[4:7], s34 offen offset:0 sc1
    v_mul_f32 v64, v64, v96
    v_mul_f32 v65, v65, v97
    v_mul_f32 v66, v66, v98
    v_mul_f32 v67, v67, v99
    v_mul_f32 v68, v68, v100
    v_mul_f32 v69, v69, v101
    v_mul_f32 v70, v70, v102
    v_mul_f32 v71, v71, v103
    v_cvt_pk_bf16_f32 v32, v64, v65
    v_cvt_pk_bf16_f32 v33, v66, v67
    v_cvt_pk_bf16_f32 v34, v68, v69
    v_cvt_pk_bf16_f32 v35, v70, v71
    buffer_store_dwordx4 v[32:35], v6, s[4:7], s34 offen offset:2048 sc1
    v_mul_f32 v72, v72, v104
    v_mul_f32 v73, v73, v105
    v_mul_f32 v74, v74, v106
    v_mul_f32 v75, v75, v107
    v_mul_f32 v76, v76, v108
    v_mul_f32 v77, v77, v109
    v_mul_f32 v78, v78, v110
    v_mul_f32 v79, v79, v111
    v_cvt_pk_bf16_f32 v36, v72, v73
    v_cvt_pk_bf16_f32 v37, v74, v75
    v_cvt_pk_bf16_f32 v38, v76, v77
    v_cvt_pk_bf16_f32 v39, v78, v79
    buffer_store_dwordx4 v[36:39], v7, s[4:7], s34 offen offset:2048 sc1
G_29:
    s_waitcnt vmcnt(0) lgkmcnt(0)
    s_sub_u32 s63, s26, s47
    s_mov_b32 s47, s26
    s_atomic_add s63, s[4:5], s21
    s_branch RV_done
G_28:
    v_min_u32 v20, 16, v5
    v_lshlrev_b32 v20, 5, v20
.p2align 6
RV_loop:
    s_cmp_eq_u32 s22, 1
    s_cbranch_scc1 G_30
    s_cmp_eq_u32 s22, 2
    s_cbranch_scc1 G_32
RV_poll:
    s_and_b32 s31, s16, s25
    s_lshl_b32 s31, s31, 15
    s_add_u32 s31, s31, s20
    s_add_u32 s37, s16, 1
    s_min_u32 s37, s37, 64
    s_cmp_eq_u32 s14, 0
    s_cselect_b32 s37, 0, s37
    v_mbcnt_lo_u32_b32 v16, -1, 0
    v_min_u32 v16, 4, v16
    v_lshlrev_b32 v16, 7, v16
    s_mov_b32 s23, 0
    s_mov_b64 exec, 0xffffffff
P_33:
    buffer_load_dword v17, v16, s[4:7], s31 offen sc1
    s_waitcnt vmcnt(0)
    v_cmp_gt_u32 vcc, s37, v17
    s_cbranch_vccz P_34
    s_add_u32 s23, s23, 1
    s_cmp_gt_u32 s23, 65536
    s_cbranch_scc1 L_exit
    s_sleep 1
    s_branch P_33
P_34:
    s_mov_b64 exec, -1
RV_dma:
    s_mul_i32 s38, s16, 49152
    s_add_u32 s38, s38, s18
    s_mov_b32 s39, s24
    s_mul_i32 s30, s12, 1280
    s_add_u32 s30, s30, 40960
    s_add_u32 m0, s30, s39
    s_add_u32 s30, s30, s38
    buffer_load_dwordx4 v0, s[4:7], s30 offen sc1 lds
    buffer_load_dword v5, s[4:7], s30 offen offset:1024 sc1 lds
    s_mul_i32 s30, s12, 10240
    s_add_u32 s38, s38, s30
    s_add_u32 s39, s39, s30
    s_mov_b32 m0, s39
    s_nop 0
    buffer_load_dwordx4 v4, s[4:7], s38 offen offset:0 sc1 lds
    buffer_load_dwordx4 v4, s[4:7], s38 offen offset:1024 sc1 lds
    buffer_load_dwordx4 v4, s[4:7], s38 offen offset:2048 sc1 lds
    buffer_load_dwordx4 v4, s[4:7], s38 offen offset:3072 sc1 lds
    s_add_u32 s38, s38, 4096
    s_add_u32 s39, s39, 4096
    s_mov_b32 m0, s39
    s_nop 0
    buffer_load_dwordx4 v4, s[4:7], s38 offen offset:0 sc1 lds
    buffer_load_dwordx4 v4, s[4:7], s38 offen offset:1024 sc1 lds
    buffer_load_dwordx4 v4, s[4:7], s38 offen offset:2048 sc1 lds
    buffer_load_dwordx4 v4, s[4:7], s38 offen offset:3072 sc1 lds
    s_add_u32 s38, s38, 4096
    s_add_u32 s39, s39, 4096
    s_mov_b32 m0, s39
    s_nop 0
    buffer_load_dwordx4 v4, s[4:7], s38 offen offset:0 sc1 lds
    buffer_load_dwordx4 v4, s[4:7], s38 offen offset:1024 sc1 lds
G_32:
    s_waitcnt vmcnt(6)
    s_branch G_31
G_30:
    s_waitcnt vmcnt(4)
G_31:
    v_add_u32 v1, s24, v0
    v_add_u32 v2, 0x10000, v1
    v_add_u32 v9, s24, v3
    s_cmp_lt_u32 s16, 35
    s_cselect_b32 s17, s17, 1
    s_add_u32 s29, s16, s17
    s_cmp_eq_u32 s22, 1
    s_cselect_b64 vcc, -1, 0
    s_barrier
    ds_read_b128 v[24:27], v1 offset:0
    ds_read_b128 v[28:31], v1 offset:10240
    ds_read_b128 v[32:35], v1 offset:20480
    ds_read_b128 v[36:39], v1 offset:30720
    ds_read_b128 v[40:43], v1 offset:1024
    s_and_b32 s31, s29, s25
    s_lshl_b32 s31, s31, 15
    s_add_u32 s31, s31, s20
    s_add_u32 s37, s29, 1
    s_min_u32 s37, s37, 64
    s_cmp_eq_u32 s14, 0
    s_cselect_b32 s37, 0, s37
    s_mov_b32 s62, s31
    s_waitcnt lgkmcnt(4)
    v_mfma_f32_32x32x16_bf16 v[48:63], v[24:27], v[192:195], 0
    ds_read_b128 v[44:47], v1 offset:11264
    ds_read_b64 v[80:81], v9 offset:0
    ds_read_b64 v[82:83], v9 offset:256
    v_mfma_f32_32x32x16_bf16 v[64:79], v[24:27], v[196:199], 0
    ds_read_b64 v[84:85], v9 offset:512
    ds_read_b64 v[86:87], v9 offset:768
    s_waitcnt lgkmcnt(8)
    v_mfma_f32_32x32x16_bf16 v[48:63], v[28:31], a[16:19], v[48:63]
    ds_read_b128 v[24:27], v1 offset:21504
    s_waitcnt lgkmcnt(4)
    v_mov_b32 v16, v80
    v_mov_b32 v17, v81
    v_mfma_f32_32x32x16_bf16 v[64:79], v[28:31], a[20:23], v[64:79]
    s_waitcnt lgkmcnt(3)
    v_mov_b32 v18, v82
    v_mov_b32 v19, v83
    v_mfma_f32_32x32x16_bf16 v[48:63], v[32:35], a[96:99], v[48:63]
    ds_read_b128 v[28:31], v1 offset:31744
    s_waitcnt lgkmcnt(3)
    v_add_f32 v16, v16, v84
    v_add_f32 v17, v17, v85
    v_mfma_f32_32x32x16_bf16 v[64:79], v[32:35], a[100:103], v[64:79]
    s_waitcnt lgkmcnt(2)
    v_add_f32 v18, v18, v86
    v_add_f32 v19, v19, v87
    v_mfma_f32_32x32x16_bf16 v[48:63], v[36:39], a[176:179], v[48:63]
    ds_read_b128 v[32:35], v1 offset:2048
    ds_read_b64 v[80:81], v9 offset:1024
    ds_read_b64 v[82:83], v9 offset:1280
    v_mfma_f32_32x32x16_bf16 v[64:79], v[36:39], a[180:183], v[64:79]
    ds_read_b64 v[84:85], v9 offset:1536
    ds_read_b64 v[86:87], v9 offset:1792
    v_mfma_f32_32x32x16_bf16 v[48:63], v[40:43], v[200:203], v[48:63]
    ds_read_b128 v[36:39], v1 offset:12288
    s_waitcnt lgkmcnt(4)
    v_add_f32 v16, v16, v80
    v_add_f32 v17, v17, v81
    v_mfma_f32_32x32x16_bf16 v[64:79], v[40:43], v[204:207], v[64:79]
    s_waitcnt lgkmcnt(3)
    v_add_f32 v18, v18, v82
    v_add_f32 v19, v19, v83
    v_mfma_f32_32x32x16_bf16 v[48:63], v[44:47], a[24:27], v[48:63]
    ds_read_b128 v[40:43], v1 offset:22528
    s_waitcnt lgkmcnt(3)
    v_add_f32 v16, v16, v84
    v_add_f32 v17, v17, v85
    v_mfma_f32_32x32x16_bf16 v[64:79], v[44:47], a[28:31], v[64:79]
    s_waitcnt lgkmcnt(2)
    v_add_f32 v18, v18, v86
    v_add_f32 v19, v19, v87
    v_mfma_f32_32x32x16_bf16 v[48:63], v[24:27], a[104:107], v[48:63]
    ds_read_b128 v[44:47], v1 offset:32768
    ds_read_b64 v[80:81], v9 offset:2048
    ds_read_b64 v[82:83], v9 offset:2304
    v_mfma_f32_32x32x16_bf16 v[64:79], v[24:27], a[108:111], v[64:79]
    s_waitcnt lgkmcnt(1)
    v_add_f32 v16, v16, v80
    v_add_f32 v17, v17, v81
    v_mfma_f32_32x32x16_bf16 v[48:63], v[28:31], a[184:187], v[48:63]
    ds_read_b128 v[24:27], v1 offset:3072
    s_waitcnt lgkmcnt(1)
    v_add_f32 v18, v18, v82
    v_add_f32 v19, v19, v83
    v_mfma_f32_32x32x16_bf16 v[64:79], v[28:31], a[188:191], v[64:79]
    v_add_f32 v16, v16, v18
    v_add_f32 v17, v17, v19
    s_cmp_lg_u32 s26, 0
    s_cbranch_scc1 G_35
G_36:
    v_mfma_f32_32x32x16_bf16 v[48:63], v[32:35], v[208:211], v[48:63]
    ds_read_b128 v[28:31], v1 offset:13312
    v_mov_b32 v18, v16
    v_mov_b32 v19, v17
    v_mfma_f32_32x32x16_bf16 v[64:79], v[32:35], v[212:215], v[64:79]
    s_nop 1
    v_permlane32_swap_b32 v16, v18
    v_mfma_f32_32x32x16_bf16 v[48:63], v[36:39], a[32:35], v[48:63]
    ds_read_b128 v[32:35], v1 offset:23552
    v_permlane32_swap_b32 v17, v19
    v_add_f32 v16, v16, v18
    v_mfma_f32_32x32x16_bf16 v[64:79], v[36:39], a[36:39], v[64:79]
    v_add_f32 v17, v17, v19
    v_mul_f32 v12, s42, v16
    v_mfma_f32_32x32x16_bf16 v[48:63], v[40:43], a[112:115], v[48:63]
    ds_read_b128 v[36:39], v1 offset:33792
    v_mul_f32 v15, s42, v17
    v_sub_f32 v16, 0, v12
    v_mfma_f32_32x32x16_bf16 v[64:79], v[40:43], a[116:119], v[64:79]
    v_cvt_pk_bf16_f32 v121, v16, v16
    v_fma_f32 v15, -v12, v12, v15
    v_mfma_f32_32x32x16_bf16 v[48:63], v[44:47], a[192:195], v[48:63]
    s_cbranch_vccnz G_37
    s_waitcnt vmcnt(0)
G_37:
    s_barrier
    ds_read_b128 v[40:43], v1 offset:4096
    v_and_b32 v17, 0xffff0000, v121
    v_max_f32 v15, 0, v15
    v_mfma_f32_32x32x16_bf16 v[64:79], v[44:47], a[196:199], v[64:79]
    v_sub_f32 v16, v16, v17
    v_add_f32 v18, s43, v15
    s_waitcnt lgkmcnt(4)
    v_mfma_f32_32x32x16_bf16 v[48:63], v[24:27], v[216:219], v[48:63]
    ds_read_b128 v[44:47], v1 offset:14336
    v_cvt_pk_bf16_f32 v120, v17, v16
    v_rsq_f32 v13, v18
    v_mfma_f32_32x32x16_bf16 v[64:79], v[24:27], v[220:223], v[64:79]
    s_nop 0
    v_cvt_pk_bf16_f32 v16, v13, v13
    s_waitcnt lgkmcnt(4)
    v_mfma_f32_32x32x16_bf16 v[48:63], v[28:31], a[40:43], v[48:63]
    ds_read_b128 v[24:27], v1 offset:24576
    v_and_b32 v16, 0xffff0000, v16
    v_sub_f32 v17, v13, v16
    v_mfma_f32_32x32x16_bf16 v[64:79], v[28:31], a[44:47], v[64:79]
    v_cvt_pk_bf16_f32 v90, v16, v17
    v_and_b32 v16, 0xffff0000, v90
    s_waitcnt lgkmcnt(4)
    v_mfma_f32_32x32x16_bf16 v[48:63], v[32:35], a[120:123], v[48:63]
    ds_read_b128 v[28:31], v1 offset:34816
    v_sub_f32 v17, v17, v16
    v_cvt_pk_bf16_f32 v91, v17, 0
    v_mfma_f32_32x32x16_bf16 v[64:79], v[32:35], a[124:127], v[64:79]
    v_mov_b32 v16, 0x3f803f80
    v_cndmask_b32 v92, v16, 0, s[44:45]
    s_waitcnt lgkmcnt(4)
    v_mfma_f32_32x32x16_bf16 v[48:63], v[36:39], a[200:203], v[48:63]
    ds_read_b128 v[32:35], v1 offset:5120
    v_cndmask_b32 v93, v16, 0, s[44:45]
    s_nop 1
    v_mfma_f32_32x32x16_bf16 v[64:79], v[36:39], a[204:207], v[64:79]
    v_mfma_f32_32x32x8_bf16 v[96:111], v[90:91], v[92:93], 0
    v_mfma_f32_32x32x16_bf16 v[48:63], v[120:123], v[112:115], v[48:63]
    s_waitcnt lgkmcnt(4)
    v_mfma_f32_32x32x16_bf16 v[48:63], v[40:43], v[224:227], v[48:63]
    ds_read_b128 v[36:39], v1 offset:15360
    v_mfma_f32_32x32x16_bf16 v[64:79], v[120:123], v[116:119], v[64:79]
    v_mfma_f32_32x32x16_bf16 v[64:79], v[40:43], v[228:231], v[64:79]
    s_waitcnt lgkmcnt(4)
    v_mfma_f32_32x32x16_bf16 v[48:63], v[44:47], a[48:51], v[48:63]
    ds_read_b128 v[40:43], v1 offset:25600
    v_mfma_f32_32x32x16_bf16 v[64:79], v[44:47], a[52:55], v[64:79]
    s_waitcnt lgkmcnt(4)
    v_mfma_f32_32x32x16_bf16 v[48:63], v[24:27], a[128:131], v[48:63]
    ds_read_b128 v[44:47], v1 offset:35840
    s_sub_u32 s31, s62, 0
    s_mov_b32 s32, 1
    buffer_load_dword v21, v20, s[4:7], s31 offen sc1
G_38:
    v_mfma_f32_32x32x16_bf16 v[64:79], v[24:27], a[132:135], v[64:79]
    s_waitcnt lgkmcnt(4)
    v_mfma_f32_32x32x16_bf16 v[48:63], v[28:31], a[208:211], v[48:63]
    ds_read_b128 v[24:27], v1 offset:6144
    v_mfma_f32_32x32x16_bf16 v[64:79], v[28:31], a[212:215], v[64:79]
    s_waitcnt lgkmcnt(4)
    v_mfma_f32_32x32x16_bf16 v[48:63], v[32:35], v[232:235], v[48:63]
    ds_read_b128 v[28:31], v1 offset:16384
    v_mfma_f32_32x32x16_bf16 v[64:79], v[32:35], v[236:239], v[64:79]
    s_waitcnt lgkmcnt(4)
    v_mfma_f32_32x32x16_bf16 v[48:63], v[36:39], a[56:59], v[48:63]
    ds_read_b128 v[32:35], v1 offset:26624
    v_mfma_f32_32x32x16_bf16 v[64:79], v[36:39], a[60:63], v[64:79]
    s_waitcnt lgkmcnt(4)
    v_mfma_f32_32x32x16_bf16 v[48:63], v[40:43], a[136:139], v[48:63]
    ds_read_b128 v[36:39], v1 offset:36864
    v_mfma_f32_32x32x16_bf16 v[64:79], v[40:43], a[140:143], v[64:79]
    s_waitcnt lgkmcnt(4)
    v_mfma_f32_32x32x16_bf16 v[48:63], v[44:47], a[216:219], v[48:63]
    ds_read_b128 v[40:43], v1 offset:7168
    v_mfma_f32_32x32x16_bf16 v[64:79], v[44:47], a[220:223], v[64:79]
    s_waitcnt lgkmcnt(4)
    v_mfma_f32_32x32x16_bf16 v[48:63], v[24:27], v[240:243], v[48:63]
    ds_read_b128 v[44:47], v1 offset:17408
    v_mfma_f32_32x32x16_bf16 v[64:79], v[24:27], v[244:247], v[64:79]
    s_waitcnt lgkmcnt(4)
    v_mfma_f32_32x32x16_bf16 v[48:63], v[28:31], a[64:67], v[48:63]
    ds_read_b128 v[24:27], v1 offset:27648
    v_mfma_f32_32x32x16_bf16 v[64:79], v[28:31], a[68:71], v[64:79]
    s_waitcnt lgkmcnt(4)
    v_mfma_f32_32x32x16_bf16 v[48:63], v[32:35], a[144:147], v[48:63]
    ds_read_b128 v[28:31], v1 offset:37888
    v_mfma_f32_32x32x16_bf16 v[64:79], v[32:35], a[148:151], v[64:79]
    s_waitcnt lgkmcnt(4)
    v_mfma_f32_32x32x16_bf16 v[48:63], v[36:39], a[224:227], v[48:63]
    ds_read_b128 v[32:35], v1 offset:8192
    v_mfma_f32_32x32x16_bf16 v[64:79], v[36:39], a[228:231], v[64:79]
    s_cmp_lg_u32 s32, 0
    s_cbranch_scc1 G_40
G_41:
    s_waitcnt lgkmcnt(4)
    v_mfma_f32_32x32x16_bf16 v[48:63], v[40:43], v[248:251], v[48:63]
    ds_read_b128 v[36:39], v1 offset:18432
    v_mfma_f32_32x32x16_bf16 v[64:79], v[40:43], v[252:255], v[64:79]
    s_waitcnt lgkmcnt(4)
    v_mfma_f32_32x32x16_bf16 v[48:63], v[44:47], a[72:75], v[48:63]
    ds_read_b128 v[40:43], v1 offset:28672
    v_mfma_f32_32x32x16_bf16 v[64:79], v[44:47], a[76:79], v[64:79]
    s_waitcnt lgkmcnt(4)
    v_mfma_f32_32x32x16_bf16 v[48:63], v[24:27], a[152:155], v[48:63]
    ds_read_b128 v[44:47], v1 offset:38912
    v_mfma_f32_32x32x16_bf16 v[64:79], v[24:27], a[156:159], v[64:79]
    s_waitcnt lgkmcnt(4)
    v_mfma_f32_32x32x16_bf16 v[48:63], v[28:31], a[232:235], v[48:63]
    ds_read_b128 v[24:27], v1 offset:9216
    v_mfma_f32_32x32x16_bf16 v[64:79], v[28:31], a[236:239], v[64:79]
    s_waitcnt lgkmcnt(4)
    v_mfma_f32_32x32x16_bf16 v[48:63], v[32:35], a[0:3], v[48:63]
    ds_read_b128 v[28:31], v1 offset:19456
    v_mfma_f32_32x32x16_bf16 v[64:79], v[32:35], a[4:7], v[64:79]
    s_waitcnt lgkmcnt(4)
    v_mfma_f32_32x32x16_bf16 v[48:63], v[36:39], a[80:83], v[48:63]
    ds_read_b128 v[32:35], v1 offset:29696
    v_mfma_f32_32x32x16_bf16 v[64:79], v[36:39], a[84:87], v[64:79]
    s_waitcnt lgkmcnt(4)
    v_mfma_f32_32x32x16_bf16 v[48:63], v[40:43], a[160:163], v[48:63]
    ds_read_b128 v[36:39], v1 offset:39936
    v_mfma_f32_32x32x16_bf16 v[64:79], v[40:43], a[164:167], v[64:79]
    s_waitcnt lgkmcnt(4)
    v_mfma_f32_32x32x16_bf16 v[48:63], v[44:47], a[240:243], v[48:63]
    v_mfma_f32_32x32x16_bf16 v[64:79], v[44:47], a[244:247], v[64:79]
    s_waitcnt lgkmcnt(3)
    v_mfma_f32_32x32x16_bf16 v[48:63], v[24:27], a[8:11], v[48:63]
    v_mfma_f32_32x32x16_bf16 v[64:79], v[24:27], a[12:15], v[64:79]
    s_waitcnt lgkmcnt(2)
    v_mfma_f32_32x32x16_bf16 v[48:63], v[28:31], a[88:91], v[48:63]
    v_mfma_f32_32x32x16_bf16 v[64:79], v[28:31], a[92:95], v[64:79]
    s_waitcnt lgkmcnt(1)
    v_mfma_f32_32x32x16_bf16 v[48:63], v[32:35], a[168:171], v[48:63]
    v_mfma_f32_32x32x16_bf16 v[64:79], v[32:35], a[172:175], v[64:79]
    s_waitcnt lgkmcnt(0)
    v_mfma_f32_32x32x16_bf16 v[48:63], v[36:39], a[248:251], v[48:63]
    v_mfma_f32_32x32x16_bf16 v[64:79], v[36:39], a[252:255], v[64:79]
    s_branch G_42
G_35:
    s_waitcnt vmcnt(0)
    s_sub_u32 s63, s26, s47
    s_mov_b32 s47, s26
    s_atomic_add s63, s[4:5], s21
    s_mov_b32 s26, 0
    s_branch G_36
G_40:
    s_waitcnt vmcnt(0)
    v_cmp_gt_u32 vcc, s37, v21
    s_sub_u32 s33, 46080, s24
    s_mov_b32 s22, 0
    s_cbranch_vccnz G_41
    s_cmp_ge_u32 s29, s46
    s_cbranch_scc1 G_41
    s_mov_b32 s22, 1
    s_waitcnt lgkmcnt(4)
    v_mfma_f32_32x32x16_bf16 v[48:63], v[40:43], v[248:251], v[48:63]
    ds_read_b128 v[36:39], v1 offset:18432
    v_mfma_f32_32x32x16_bf16 v[64:79], v[40:43], v[252:255], v[64:79]
    s_mul_i32 s38, s29, 49152
    s_add_u32 s38, s38, s18
    s_mov_b32 s39, s33
    s_mul_i32 s30, s12, 1280
    s_add_u32 s30, s30, 40960
    s_add_u32 m0, s30, s39
    s_add_u32 s30, s30, s38
    buffer_load_dwordx4 v0, s[4:7], s30 offen sc1 lds
    buffer_load_dword v5, s[4:7], s30 offen offset:1024 sc1 lds
    s_waitcnt lgkmcnt(4)
    v_mfma_f32_32x32x16_bf16 v[48:63], v[44:47], a[72:75], v[48:63]
    ds_read_b128 v[40:43], v1 offset:28672
    v_mfma_f32_32x32x16_bf16 v[64:79], v[44:47], a[76:79], v[64:79]
    s_mul_i32 s30, s12, 10240
    s_add_u32 s38, s38, s30
    s_add_u32 s39, s39, s30
    s_mov_b32 m0, s39
    s_nop 0
    buffer_load_dwordx4 v4, s[4:7], s38 offen offset:0 sc1 lds
    s_waitcnt lgkmcnt(4)
    v_mfma_f32_32x32x16_bf16 v[48:63], v[24:27], a[152:155], v[48:63]
    ds_read_b128 v[44:47], v1 offset:38912
    v_mfma_f32_32x32x16_bf16 v[64:79], v[24:27], a[156:159], v[64:79]
    buffer_load_dwordx4 v4, s[4:7], s38 offen offset:1024 sc1 lds
    s_waitcnt lgkmcnt(4)
    v_mfma_f32_32x32x16_bf16 v[48:63], v[28:31], a[232:235], v[48:63]
    ds_read_b128 v[24:27], v1 offset:9216
    v_mfma_f32_32x32x16_bf16 v[64:79], v[28:31], a[236:239], v[64:79]
    buffer_load_dwordx4 v4, s[4:7], s38 offen offset:2048 sc1 lds
    s_waitcnt lgkmcnt(4)
    v_mfma_f32_32x32x16_bf16 v[48:63], v[32:35], a[0:3], v[48:63]
    ds_read_b128 v[28:31], v1 offset:19456
    v_mfma_f32_32x32x16_bf16 v[64:79], v[32:35], a[4:7], v[64:79]
    buffer_load_dwordx4 v4, s[4:7], s38 offen offset:3072 sc1 lds
    s_waitcnt lgkmcnt(4)
    v_mfma_f32_32x32x16_bf16 v[48:63], v[36:39], a[80:83], v[48:63]
    ds_read_b128 v[32:35], v1 offset:29696
    v_mfma_f32_32x32x16_bf16 v[64:79], v[36:39], a[84:87], v[64:79]
    s_add_u32 s38, s38, 4096
    s_add_u32 s39, s39, 4096
    s_mov_b32 m0, s39
    s_nop 0
    buffer_load_dwordx4 v4, s[4:7], s38 offen offset:0 sc1 lds
    s_waitcnt lgkmcnt(4)
    v_mfma_f32_32x32x16_bf16 v[48:63], v[40:43], a[160:163], v[48:63]
    ds_read_b128 v[36:39], v1 offset:39936
    v_mfma_f32_32x32x16_bf16 v[64:79], v[40:43], a[164:167], v[64:79]
    buffer_load_dwordx4 v4, s[4:7], s38 offen offset:1024 sc1 lds
    s_waitcnt lgkmcnt(4)
    v_mfma_f32_32x32x16_bf16 v[48:63], v[44:47], a[240:243], v[48:63]
    v_mfma_f32_32x32x16_bf16 v[64:79], v[44:47], a[244:247], v[64:79]
    buffer_load_dwordx4 v4, s[4:7], s38 offen offset:2048 sc1 lds
    s_waitcnt lgkmcnt(3)
    v_mfma_f32_32x32x16_bf16 v[48:63], v[24:27], a[8:11], v[48:63]
    v_mfma_f32_32x32x16_bf16 v[64:79], v[24:27], a[12:15], v[64:79]
    buffer_load_dwordx4 v4, s[4:7], s38 offen offset:3072 sc1 lds
    s_waitcnt lgkmcnt(2)
    v_mfma_f32_32x32x16_bf16 v[48:63], v[28:31], a[88:91], v[48:63]
    v_mfma_f32_32x32x16_bf16 v[64:79], v[28:31], a[92:95], v[64:79]
    s_add_u32 s38, s38, 4096
    s_add_u32 s39, s39, 4096
    s_mov_b32 m0, s39
    s_nop 0
    buffer_load_dwordx4 v4, s[4:7], s38 offen offset:0 sc1 lds
    s_waitcnt lgkmcnt(1)
    v_mfma_f32_32x32x16_bf16 v[48:63], v[32:35], a[168:171], v[48:63]
    v_mfma_f32_32x32x16_bf16 v[64:79], v[32:35], a[172:175], v[64:79]
    buffer_load_dwordx4 v4, s[4:7], s38 offen offset:1024 sc1 lds
    s_waitcnt lgkmcnt(0)
    v_mfma_f32_32x32x16_bf16 v[48:63], v[36:39], a[248:251], v[48:63]
    v_mfma_f32_32x32x16_bf16 v[64:79], v[36:39], a[252:255], v[64:79]
G_42:
    s_cmp_lg_u32 s22, 0
    s_cbranch_scc1 G_43
    s_sub_u32 s31, s62, 0
    buffer_load_dword v21, v20, s[4:7], s31 offen sc1
G_43:
    s_mul_i32 s30, s16, 262144
    s_add_u32 s32, s30, s28
    s_add_u32 s30, s30, s19
    s_nop 6
    v_pk_mul_f32 v[48:49], v[48:49], v[96:97]
    v_pk_mul_f32 v[50:51], v[50:51], v[98:99]
    v_pk_mul_f32 v[52:53], v[52:53], v[100:101]
    v_pk_mul_f32 v[54:55], v[54:55], v[102:103]
    v_cvt_pk_bf16_f32 v24, v48, v49
    v_cvt_pk_bf16_f32 v25, v50, v51
    v_cvt_pk_bf16_f32 v26, v52, v53
    v_cvt_pk_bf16_f32 v27, v54, v55
    buffer_store_dwordx4 v[24:27], v6, s[4:7], s30 offen offset:0 sc1
    v_pk_mul_f32 v[56:57], v[56:57], v[104:105]
    v_pk_mul_f32 v[58:59], v[58:59], v[106:107]
    v_pk_mul_f32 v[60:61], v[60:61], v[108:109]
    v_pk_mul_f32 v[62:63], v[62:63], v[110:111]
    v_cvt_pk_bf16_f32 v28, v56, v57
    v_cvt_pk_bf16_f32 v29, v58, v59
    v_cvt_pk_bf16_f32 v30, v60, v61
    v_cvt_pk_bf16_f32 v31, v62, v63
    buffer_store_dwordx4 v[28:31], v7, s[4:7], s30 offen offset:0 sc1
    v_pk_mul_f32 v[64:65], v[64:65], v[96:97]
    v_pk_mul_f32 v[66:67], v[66:67], v[98:99]
    v_pk_mul_f32 v[68:69], v[68:69], v[100:101]
    v_pk_mul_f32 v[70:71], v[70:71], v[102:103]
    v_cvt_pk_bf16_f32 v32, v64, v65
    v_cvt_pk_bf16_f32 v33, v66, v67
    v_cvt_pk_bf16_f32 v34, v68, v69
    v_cvt_pk_bf16_f32 v35, v70, v71
    buffer_store_dwordx4 v[32:35], v6, s[4:7], s30 offen offset:2048 sc1
    v_pk_mul_f32 v[72:73], v[72:73], v[104:105]
    v_pk_mul_f32 v[74:75], v[74:75], v[106:107]
    v_pk_mul_f32 v[76:77], v[76:77], v[108:109]
    v_pk_mul_f32 v[78:79], v[78:79], v[110:111]
    v_cvt_pk_bf16_f32 v36, v72, v73
    v_cvt_pk_bf16_f32 v37, v74, v75
    v_cvt_pk_bf16_f32 v38, v76, v77
    v_cvt_pk_bf16_f32 v39, v78, v79
    buffer_store_dwordx4 v[36:39], v7, s[4:7], s30 offen offset:2048 sc1
    s_add_u32 s32, s16, 1
    s_sub_u32 s24, 46080, s24
    s_mov_b32 s26, s32
    s_cmp_lg_u32 s22, 0
    s_cbranch_scc1 G_46
    s_mov_b32 s26, 0
    s_waitcnt lgkmcnt(0)
    s_cmp_ge_u32 s29, s46
    s_cbranch_scc1 G_47
    s_waitcnt vmcnt(4)
    v_cmp_gt_u32 vcc, s37, v21
    s_cbranch_vccnz G_44
    s_mov_b32 s22, 2
    s_mul_i32 s38, s29, 49152
    s_add_u32 s38, s38, s18
    s_mov_b32 s39, s24
    s_mul_i32 s30, s12, 1280
    s_add_u32 s30, s30, 40960
    s_add_u32 m0, s30, s39
    s_add_u32 s30, s30, s38
    buffer_load_dwordx4 v0, s[4:7], s30 offen sc1 lds
    buffer_load_dword v5, s[4:7], s30 offen offset:1024 sc1 lds
    s_mul_i32 s30, s12, 10240
    s_add_u32 s38, s38, s30
    s_add_u32 s39, s39, s30
    s_mov_b32 m0, s39
    s_nop 0
    buffer_load_dwordx4 v4, s[4:7], s38 offen offset:0 sc1 lds
    buffer_load_dwordx4 v4, s[4:7], s38 offen offset:1024 sc1 lds
    buffer_load_dwordx4 v4, s[4:7], s38 offen offset:2048 sc1 lds
    buffer_load_dwordx4 v4, s[4:7], s38 offen offset:3072 sc1 lds
    s_add_u32 s38, s38, 4096
    s_add_u32 s39, s39, 4096
    s_mov_b32 m0, s39
    s_nop 0
    buffer_load_dwordx4 v4, s[4:7], s38 offen offset:0 sc1 lds
    buffer_load_dwordx4 v4, s[4:7], s38 offen offset:1024 sc1 lds
    buffer_load_dwordx4 v4, s[4:7], s38 offen offset:2048 sc1 lds
    buffer_load_dwordx4 v4, s[4:7], s38 offen offset:3072 sc1 lds
    s_add_u32 s38, s38, 4096
    s_add_u32 s39, s39, 4096
    s_mov_b32 m0, s39
    s_nop 0
    buffer_load_dwordx4 v4, s[4:7], s38 offen offset:0 sc1 lds
    buffer_load_dwordx4 v4, s[4:7], s38 offen offset:1024 sc1 lds
    s_waitcnt vmcnt(12)
    s_branch G_45
G_44:
    buffer_load_dword v21, v20, s[4:7], s62 offen sc1
    s_waitcnt vmcnt(1)
    s_sub_u32 s63, s32, s47
    s_mov_b32 s47, s32
    s_atomic_add s63, s[4:5], s21
    s_mov_b32 s16, s29
    s_waitcnt vmcnt(0)
    v_cmp_gt_u32 vcc, s37, v21
    s_cbranch_vccnz RV_poll
    s_mov_b32 s22, 0
    s_branch RV_dma
G_47:
    s_waitcnt vmcnt(0)
G_45:
    s_sub_u32 s63, s32, s47
    s_mov_b32 s47, s32
    s_atomic_add s63, s[4:5], s21
G_46:
    s_mov_b32 s16, s29
    s_cmp_lt_u32 s16, s46
    s_cbranch_scc1 RV_loop
RV_done:
    s_or_b32 s30, s15, s14
    s_cbranch_scc1 G_48
    s_mov_b32 s14, 1
    s_branch RV_job
G_48:
    s_branch L_next
RO:
    v_mbcnt_lo_u32_b32 v12, -1, 0
    v_mbcnt_hi_u32_b32 v12, -1, v12
    v_lshlrev_b32 v0, 4, v12
    v_lshlrev_b32 v8, 3, v12
    v_lshlrev_b32 v5, 2, v12
    s_mov_b32 s44, 0
    s_mov_b32 s45, -1
    s_barrier
    s_load_dwordx2 s[8:9], s[0:1], 40
    s_mov_b32 s10, 5242880
    s_mov_b32 s11, 0x20000
    s_and_b32 s32, s13, 3
    s_mul_i32 s32, s32, 1310720
    s_lshr_b32 s30, s13, 2
    s_lshl_b32 s30, s30, 8
    s_add_u32 s32, s32, s30
    s_waitcnt lgkmcnt(0)
    v_lshrrev_b32 v13, 2, v12
    v_and_b32 v14, 3, v12
    s_mov_b32 s30, 1280
    v_mul_lo_u32 v13, v13, s30
    v_lshl_add_u32 v13, v14, 4, v13
    s_mul_i32 s30, s12, 64
    s_add_u32 s30, s30, s32
    v_add_u32 v13, s30, v13
    v_lshrrev_b32 v14, 5, v12
    v_bfe_u32 v15, v12, 2, 2
    v_lshl_add_u32 v15, v14, 3, v15
    v_mul_u32_u24 v15, 64, v15
    v_bfe_u32 v16, v12, 4, 1
    v_lshl_add_u32 v15, v16, 5, v15
    v_and_b32 v16, 1, v12
    v_lshl_add_u32 v15, v16, 4, v15
    v_bfe_u32 v16, v12, 1, 1
    v_lshl_add_u32 v15, v16, 3, v15
    s_mul_i32 s33, s12, 40960
    v_add_u32 v15, s33, v15
    s_add_u32 m0, s33, 0
    s_mov_b32 s30, 0
    buffer_load_dwordx4 v13, s[8:11], s30 offen lds
    s_add_u32 m0, s33, 1024
    s_mov_b32 s30, 20480
    buffer_load_dwordx4 v13, s[8:11], s30 offen lds
    s_add_u32 m0, s33, 2048
    s_mov_b32 s30, 40960
    buffer_load_dwordx4 v13, s[8:11], s30 offen lds
    s_add_u32 m0, s33, 3072
    s_mov_b32 s30, 61440
    buffer_load_dwordx4 v13, s[8:11], s30 offen lds
    s_add_u32 m0, s33, 4096
    s_mov_b32 s30, 81920
    buffer_load_dwordx4 v13, s[8:11], s30 offen lds
    s_add_u32 m0, s33, 5120
    s_mov_b32 s30, 102400
    buffer_load_dwordx4 v13, s[8:11], s30 offen lds
    s_add_u32 m0, s33, 6144
    s_mov_b32 s30, 122880
    buffer_load_dwordx4 v13, s[8:11], s30 offen lds
    s_add_u32 m0, s33, 7168
    s_mov_b32 s30, 143360
    buffer_load_dwordx4 v13, s[8:11], s30 offen lds
    s_add_u32 m0, s33, 8192
    s_mov_b32 s30, 163840
    buffer_load_dwordx4 v13, s[8:11], s30 offen lds
    s_add_u32 m0, s33, 9216
    s_mov_b32 s30, 184320
    buffer_load_dwordx4 v13, s[8:11], s30 offen lds
    s_add_u32 m0, s33, 10240
    s_mov_b32 s30, 204800
    buffer_load_dwordx4 v13, s[8:11], s30 offen lds
    s_add_u32 m0, s33, 11264
    s_mov_b32 s30, 225280
    buffer_load_dwordx4 v13, s[8:11], s30 offen lds
    s_add_u32 m0, s33, 12288
    s_mov_b32 s30, 245760
    buffer_load_dwordx4 v13, s[8:11], s30 offen lds
    s_add_u32 m0, s33, 13312
    s_mov_b32 s30, 266240
    buffer_load_dwordx4 v13, s[8:11], s30 offen lds
    s_add_u32 m0, s33, 14336
    s_mov_b32 s30, 286720
    buffer_load_dwordx4 v13, s[8:11], s30 offen lds
    s_add_u32 m0, s33, 15360
    s_mov_b32 s30, 307200
    buffer_load_dwordx4 v13, s[8:11], s30 offen lds
    s_add_u32 m0, s33, 16384
    s_mov_b32 s30, 327680
    buffer_load_dwordx4 v13, s[8:11], s30 offen lds
    s_add_u32 m0, s33, 17408
    s_mov_b32 s30, 348160
    buffer_load_dwordx4 v13, s[8:11], s30 offen lds
    s_add_u32 m0, s33, 18432
    s_mov_b32 s30, 368640
    buffer_load_dwordx4 v13, s[8:11], s30 offen lds
    s_add_u32 m0, s33, 19456
    s_mov_b32 s30, 389120
    buffer_load_dwordx4 v13, s[8:11], s30 offen lds
    s_add_u32 m0, s33, 20480
    s_mov_b32 s30, 409600
    buffer_load_dwordx4 v13, s[8:11], s30 offen lds
    s_add_u32 m0, s33, 21504
    s_mov_b32 s30, 430080
    buffer_load_dwordx4 v13, s[8:11], s30 offen lds
    s_add_u32 m0, s33, 22528
    s_mov_b32 s30, 450560
    buffer_load_dwordx4 v13, s[8:11], s30 offen lds
    s_add_u32 m0, s33, 23552
    s_mov_b32 s30, 471040
    buffer_load_dwordx4 v13, s[8:11], s30 offen lds
    s_add_u32 m0, s33, 24576
    s_mov_b32 s30, 491520
    buffer_load_dwordx4 v13, s[8:11], s30 offen lds
    s_add_u32 m0, s33, 25600
    s_mov_b32 s30, 512000
    buffer_load_dwordx4 v13, s[8:11], s30 offen lds
    s_add_u32 m0, s33, 26624
    s_mov_b32 s30, 532480
    buffer_load_dwordx4 v13, s[8:11], s30 offen lds
    s_add_u32 m0, s33, 27648
    s_mov_b32 s30, 552960
    buffer_load_dwordx4 v13, s[8:11], s30 offen lds
    s_add_u32 m0, s33, 28672
    s_mov_b32 s30, 573440
    buffer_load_dwordx4 v13, s[8:11], s30 offen lds
    s_add_u32 m0, s33, 29696
    s_mov_b32 s30, 593920
    buffer_load_dwordx4 v13, s[8:11], s30 offen lds
    s_add_u32 m0, s33, 30720
    s_mov_b32 s30, 614400
    buffer_load_dwordx4 v13, s[8:11], s30 offen lds
    s_add_u32 m0, s33, 31744
    s_mov_b32 s30, 634880
    buffer_load_dwordx4 v13, s[8:11], s30 offen lds
    s_add_u32 m0, s33, 32768
    s_mov_b32 s30, 655360
    buffer_load_dwordx4 v13, s[8:11], s30 offen lds
    s_add_u32 m0, s33, 33792
    s_mov_b32 s30, 675840
    buffer_load_dwordx4 v13, s[8:11], s30 offen lds
    s_add_u32 m0, s33, 34816
    s_mov_b32 s30, 696320
    buffer_load_dwordx4 v13, s[8:11], s30 offen lds
    s_add_u32 m0, s33, 35840
    s_mov_b32 s30, 716800
    buffer_load_dwordx4 v13, s[8:11], s30 offen lds
    s_waitcnt vmcnt(35)
    ds_read_b64_tr_b16 a[0:1], v15 offset:0
    ds_read_b64_tr_b16 a[2:3], v15 offset:256
    s_add_u32 m0, s33, 36864
    s_mov_b32 s30, 737280
    buffer_load_dwordx4 v13, s[8:11], s30 offen lds
    s_waitcnt vmcnt(35)
    ds_read_b64_tr_b16 a[4:5], v15 offset:1024
    ds_read_b64_tr_b16 a[6:7], v15 offset:1280
    s_add_u32 m0, s33, 37888
    s_mov_b32 s30, 757760
    buffer_load_dwordx4 v13, s[8:11], s30 offen lds
    s_waitcnt vmcnt(35)
    ds_read_b64_tr_b16 a[8:9], v15 offset:2048
    ds_read_b64_tr_b16 a[10:11], v15 offset:2304
    s_add_u32 m0, s33, 38912
    s_mov_b32 s30, 778240
    buffer_load_dwordx4 v13, s[8:11], s30 offen lds
    s_waitcnt vmcnt(35)
    ds_read_b64_tr_b16 a[12:13], v15 offset:3072
    ds_read_b64_tr_b16 a[14:15], v15 offset:3328
    s_add_u32 m0, s33, 39936
    s_mov_b32 s30, 798720
    buffer_load_dwordx4 v13, s[8:11], s30 offen lds
    s_waitcnt vmcnt(35)
    ds_read_b64_tr_b16 a[16:17], v15 offset:4096
    ds_read_b64_tr_b16 a[18:19], v15 offset:4352
    s_waitcnt lgkmcnt(8)
    s_add_u32 m0, s33, 0
    s_mov_b32 s30, 819200
    buffer_load_dwordx4 v13, s[8:11], s30 offen lds
    s_waitcnt vmcnt(35)
    ds_read_b64_tr_b16 a[20:21], v15 offset:5120
    ds_read_b64_tr_b16 a[22:23], v15 offset:5376
    s_waitcnt lgkmcnt(8)
    s_add_u32 m0, s33, 1024
    s_mov_b32 s30, 839680
    buffer_load_dwordx4 v13, s[8:11], s30 offen lds
    s_waitcnt vmcnt(35)
    ds_read_b64_tr_b16 a[24:25], v15 offset:6144
    ds_read_b64_tr_b16 a[26:27], v15 offset:6400
    s_waitcnt lgkmcnt(8)
    s_add_u32 m0, s33, 2048
    s_mov_b32 s30, 860160
    buffer_load_dwordx4 v13, s[8:11], s30 offen lds
    s_waitcnt vmcnt(35)
    ds_read_b64_tr_b16 a[28:29], v15 offset:7168
    ds_read_b64_tr_b16 a[30:31], v15 offset:7424
    s_waitcnt lgkmcnt(8)
    s_add_u32 m0, s33, 3072
    s_mov_b32 s30, 880640
    buffer_load_dwordx4 v13, s[8:11], s30 offen lds
    s_waitcnt vmcnt(35)
    ds_read_b64_tr_b16 a[32:33], v15 offset:8192
    ds_read_b64_tr_b16 a[34:35], v15 offset:8448
    s_waitcnt lgkmcnt(8)
    s_add_u32 m0, s33, 4096
    s_mov_b32 s30, 901120
    buffer_load_dwordx4 v13, s[8:11], s30 offen lds
    s_waitcnt vmcnt(35)
    ds_read_b64_tr_b16 a[36:37], v15 offset:9216
    ds_read_b64_tr_b16 a[38:39], v15 offset:9472
    s_waitcnt lgkmcnt(8)
    s_add_u32 m0, s33, 5120
    s_mov_b32 s30, 921600
    buffer_load_dwordx4 v13, s[8:11], s30 offen lds
    s_waitcnt vmcnt(35)
    ds_read_b64_tr_b16 a[40:41], v15 offset:10240
    ds_read_b64_tr_b16 a[42:43], v15 offset:10496
    s_waitcnt lgkmcnt(8)
    s_add_u32 m0, s33, 6144
    s_mov_b32 s30, 942080
    buffer_load_dwordx4 v13, s[8:11], s30 offen lds
    s_waitcnt vmcnt(35)
    ds_read_b64_tr_b16 a[44:45], v15 offset:11264
    ds_read_b64_tr_b16 a[46:47], v15 offset:11520
    s_waitcnt lgkmcnt(8)
    s_add_u32 m0, s33, 7168
    s_mov_b32 s30, 962560
    buffer_load_dwordx4 v13, s[8:11], s30 offen lds
    s_waitcnt vmcnt(35)
    ds_read_b64_tr_b16 a[48:49], v15 offset:12288
    ds_read_b64_tr_b16 a[50:51], v15 offset:12544
    s_waitcnt lgkmcnt(8)
    s_add_u32 m0, s33, 8192
    s_mov_b32 s30, 983040
    buffer_load_dwordx4 v13, s[8:11], s30 offen lds
    s_waitcnt vmcnt(35)
    ds_read_b64_tr_b16 a[52:53], v15 offset:13312
    ds_read_b64_tr_b16 a[54:55], v15 offset:13568
    s_waitcnt lgkmcnt(8)
    s_add_u32 m0, s33, 9216
    s_mov_b32 s30, 1003520
    buffer_load_dwordx4 v13, s[8:11], s30 offen lds
    s_waitcnt vmcnt(35)
    ds_read_b64_tr_b16 a[56:57], v15 offset:14336
    ds_read_b64_tr_b16 a[58:59], v15 offset:14592
    s_waitcnt lgkmcnt(8)
    s_add_u32 m0, s33, 10240
    s_mov_b32 s30, 1024000
    buffer_load_dwordx4 v13, s[8:11], s30 offen lds
    s_waitcnt vmcnt(35)
    ds_read_b64_tr_b16 a[60:61], v15 offset:15360
    ds_read_b64_tr_b16 a[62:63], v15 offset:15616
    s_waitcnt lgkmcnt(8)
    s_add_u32 m0, s33, 11264
    s_mov_b32 s30, 1044480
    buffer_load_dwordx4 v13, s[8:11], s30 offen lds
    s_waitcnt vmcnt(35)
    ds_read_b64_tr_b16 a[64:65], v15 offset:16384
    ds_read_b64_tr_b16 a[66:67], v15 offset:16640
    s_waitcnt lgkmcnt(8)
    s_add_u32 m0, s33, 12288
    s_mov_b32 s30, 1064960
    buffer_load_dwordx4 v13, s[8:11], s30 offen lds
    s_waitcnt vmcnt(35)
    ds_read_b64_tr_b16 a[68:69], v15 offset:17408
    ds_read_b64_tr_b16 a[70:71], v15 offset:17664
    s_waitcnt lgkmcnt(8)
    s_add_u32 m0, s33, 13312
    s_mov_b32 s30, 1085440
    buffer_load_dwordx4 v13, s[8:11], s30 offen lds
    s_waitcnt vmcnt(35)
    ds_read_b64_tr_b16 a[72:73], v15 offset:18432
    ds_read_b64_tr_b16 a[74:75], v15 offset:18688
    s_waitcnt lgkmcnt(8)
    s_add_u32 m0, s33, 14336
    s_mov_b32 s30, 1105920
    buffer_load_dwordx4 v13, s[8:11], s30 offen lds
    s_waitcnt vmcnt(35)
    ds_read_b64_tr_b16 a[76:77], v15 offset:19456
    ds_read_b64_tr_b16 a[78:79], v15 offset:19712
    s_waitcnt lgkmcnt(8)
    s_add_u32 m0, s33, 15360
    s_mov_b32 s30, 1126400
    buffer_load_dwordx4 v13, s[8:11], s30 offen lds
    s_waitcnt vmcnt(35)
    ds_read_b64_tr_b16 a[80:81], v15 offset:20480
    ds_read_b64_tr_b16 a[82:83], v15 offset:20736
    s_waitcnt lgkmcnt(8)
    s_add_u32 m0, s33, 16384
    s_mov_b32 s30, 1146880
    buffer_load_dwordx4 v13, s[8:11], s30 offen lds
    s_waitcnt vmcnt(35)
    ds_read_b64_tr_b16 a[84:85], v15 offset:21504
    ds_read_b64_tr_b16 a[86:87], v15 offset:21760
    s_waitcnt lgkmcnt(8)
    s_add_u32 m0, s33, 17408
    s_mov_b32 s30, 1167360
    buffer_load_dwordx4 v13, s[8:11], s30 offen lds
    s_waitcnt vmcnt(35)
    ds_read_b64_tr_b16 a[88:89], v15 offset:22528
    ds_read_b64_tr_b16 a[90:91], v15 offset:22784
    s_waitcnt lgkmcnt(8)
    s_add_u32 m0, s33, 18432
    s_mov_b32 s30, 1187840
    buffer_load_dwordx4 v13, s[8:11], s30 offen lds
    s_waitcnt vmcnt(35)
    ds_read_b64_tr_b16 a[92:93], v15 offset:23552
    ds_read_b64_tr_b16 a[94:95], v15 offset:23808
    s_waitcnt lgkmcnt(8)
    s_add_u32 m0, s33, 19456
    s_mov_b32 s30, 1208320
    buffer_load_dwordx4 v13, s[8:11], s30 offen lds
    s_waitcnt vmcnt(35)
    ds_read_b64_tr_b16 a[96:97], v15 offset:24576
    ds_read_b64_tr_b16 a[98:99], v15 offset:24832
    s_waitcnt lgkmcnt(8)
    s_add_u32 m0, s33, 20480
    s_mov_b32 s30, 1228800
    buffer_load_dwordx4 v13, s[8:11], s30 offen lds
    s_waitcnt vmcnt(35)
    ds_read_b64_tr_b16 a[100:101], v15 offset:25600
    ds_read_b64_tr_b16 a[102:103], v15 offset:25856
    s_waitcnt lgkmcnt(8)
    s_add_u32 m0, s33, 21504
    s_mov_b32 s30, 1249280
    buffer_load_dwordx4 v13, s[8:11], s30 offen lds
    s_waitcnt vmcnt(35)
    ds_read_b64_tr_b16 a[104:105], v15 offset:26624
    ds_read_b64_tr_b16 a[106:107], v15 offset:26880
    s_waitcnt lgkmcnt(8)
    s_add_u32 m0, s33, 22528
    s_mov_b32 s30, 1269760
    buffer_load_dwordx4 v13, s[8:11], s30 offen lds
    s_waitcnt vmcnt(35)
    ds_read_b64_tr_b16 a[108:109], v15 offset:27648
    ds_read_b64_tr_b16 a[110:111], v15 offset:27904
    s_waitcnt lgkmcnt(8)
    s_add_u32 m0, s33, 23552
    s_mov_b32 s30, 1290240
    buffer_load_dwordx4 v13, s[8:11], s30 offen lds
    s_waitcnt vmcnt(35)
    ds_read_b64_tr_b16 a[112:113], v15 offset:28672
    ds_read_b64_tr_b16 a[114:115], v15 offset:28928
    s_waitcnt vmcnt(34)
    ds_read_b64_tr_b16 a[116:117], v15 offset:29696
    ds_read_b64_tr_b16 a[118:119], v15 offset:29952
    s_waitcnt vmcnt(33)
    ds_read_b64_tr_b16 a[120:121], v15 offset:30720
    ds_read_b64_tr_b16 a[122:123], v15 offset:30976
    s_waitcnt vmcnt(32)
    ds_read_b64_tr_b16 a[124:125], v15 offset:31744
    ds_read_b64_tr_b16 a[126:127], v15 offset:32000
    s_waitcnt vmcnt(31)
    ds_read_b64_tr_b16 a[128:129], v15 offset:32768
    ds_read_b64_tr_b16 a[130:131], v15 offset:33024
    s_waitcnt vmcnt(30)
    ds_read_b64_tr_b16 a[132:133], v15 offset:33792
    ds_read_b64_tr_b16 a[134:135], v15 offset:34048
    s_waitcnt vmcnt(29)
    ds_read_b64_tr_b16 a[136:137], v15 offset:34816
    ds_read_b64_tr_b16 a[138:139], v15 offset:35072
    s_waitcnt vmcnt(28)
    ds_read_b64_tr_b16 a[140:141], v15 offset:35840
    ds_read_b64_tr_b16 a[142:143], v15 offset:36096
    s_waitcnt vmcnt(27)
    ds_read_b64_tr_b16 a[144:145], v15 offset:36864
    ds_read_b64_tr_b16 a[146:147], v15 offset:37120
    s_waitcnt vmcnt(26)
    ds_read_b64_tr_b16 a[148:149], v15 offset:37888
    ds_read_b64_tr_b16 a[150:151], v15 offset:38144
    s_waitcnt vmcnt(25)
    ds_read_b64_tr_b16 a[152:153], v15 offset:38912
    ds_read_b64_tr_b16 a[154:155], v15 offset:39168
    s_waitcnt vmcnt(24)
    ds_read_b64_tr_b16 a[156:157], v15 offset:39936
    ds_read_b64_tr_b16 a[158:159], v15 offset:40192
    s_waitcnt vmcnt(23)
    ds_read_b64_tr_b16 a[160:161], v15 offset:0
    ds_read_b64_tr_b16 a[162:163], v15 offset:256
    s_waitcnt vmcnt(22)
    ds_read_b64_tr_b16 a[164:165], v15 offset:1024
    ds_read_b64_tr_b16 a[166:167], v15 offset:1280
    s_waitcnt vmcnt(21)
    ds_read_b64_tr_b16 a[168:169], v15 offset:2048
    ds_read_b64_tr_b16 a[170:171], v15 offset:2304
    s_waitcnt vmcnt(20)
    ds_read_b64_tr_b16 a[172:173], v15 offset:3072
    ds_read_b64_tr_b16 a[174:175], v15 offset:3328
    s_waitcnt vmcnt(19)
    ds_read_b64_tr_b16 a[176:177], v15 offset:4096
    ds_read_b64_tr_b16 a[178:179], v15 offset:4352
    s_waitcnt vmcnt(18)
    ds_read_b64_tr_b16 a[180:181], v15 offset:5120
    ds_read_b64_tr_b16 a[182:183], v15 offset:5376
    s_waitcnt vmcnt(17)
    ds_read_b64_tr_b16 a[184:185], v15 offset:6144
    ds_read_b64_tr_b16 a[186:187], v15 offset:6400
    s_waitcnt vmcnt(16)
    ds_read_b64_tr_b16 a[188:189], v15 offset:7168
    ds_read_b64_tr_b16 a[190:191], v15 offset:7424
    s_waitcnt vmcnt(15)
    ds_read_b64_tr_b16 a[192:193], v15 offset:8192
    ds_read_b64_tr_b16 a[194:195], v15 offset:8448
    s_waitcnt vmcnt(14)
    ds_read_b64_tr_b16 a[196:197], v15 offset:9216
    ds_read_b64_tr_b16 a[198:199], v15 offset:9472
    s_waitcnt vmcnt(13)
    ds_read_b64_tr_b16 a[200:201], v15 offset:10240
    ds_read_b64_tr_b16 a[202:203], v15 offset:10496
    s_waitcnt vmcnt(12)
    ds_read_b64_tr_b16 a[204:205], v15 offset:11264
    ds_read_b64_tr_b16 a[206:207], v15 offset:11520
    s_waitcnt vmcnt(11)
    ds_read_b64_tr_b16 a[208:209], v15 offset:12288
    ds_read_b64_tr_b16 a[210:211], v15 offset:12544
    s_waitcnt vmcnt(10)
    ds_read_b64_tr_b16 a[212:213], v15 offset:13312
    ds_read_b64_tr_b16 a[214:215], v15 offset:13568
    s_waitcnt vmcnt(9)
    ds_read_b64_tr_b16 a[216:217], v15 offset:14336
    ds_read_b64_tr_b16 a[218:219], v15 offset:14592
    s_waitcnt vmcnt(8)
    ds_read_b64_tr_b16 a[220:221], v15 offset:15360
    ds_read_b64_tr_b16 a[222:223], v15 offset:15616
    s_waitcnt vmcnt(7)
    ds_read_b64_tr_b16 a[224:225], v15 offset:16384
    ds_read_b64_tr_b16 a[226:227], v15 offset:16640
    s_waitcnt vmcnt(6)
    ds_read_b64_tr_b16 a[228:229], v15 offset:17408
    ds_read_b64_tr_b16 a[230:231], v15 offset:17664
    s_waitcnt vmcnt(5)
    ds_read_b64_tr_b16 a[232:233], v15 offset:18432
    ds_read_b64_tr_b16 a[234:235], v15 offset:18688
    s_waitcnt vmcnt(4)
    ds_read_b64_tr_b16 a[236:237], v15 offset:19456
    ds_read_b64_tr_b16 a[238:239], v15 offset:19712
    s_waitcnt vmcnt(3)
    ds_read_b64_tr_b16 a[240:241], v15 offset:20480
    ds_read_b64_tr_b16 a[242:243], v15 offset:20736
    s_waitcnt vmcnt(2)
    ds_read_b64_tr_b16 a[244:245], v15 offset:21504
    ds_read_b64_tr_b16 a[246:247], v15 offset:21760
    s_waitcnt vmcnt(1)
    ds_read_b64_tr_b16 a[248:249], v15 offset:22528
    ds_read_b64_tr_b16 a[250:251], v15 offset:22784
    s_waitcnt vmcnt(0)
    ds_read_b64_tr_b16 a[252:253], v15 offset:23552
    ds_read_b64_tr_b16 a[254:255], v15 offset:23808
    s_waitcnt lgkmcnt(0)
    v_and_b32 v13, 31, v12
    v_lshrrev_b32 v14, 5, v12
    v_mov_b32 v4, v0
    v_mul_u32_u24 v3, 2560, v14
    v_lshl_add_u32 v3, v13, 3, v3
    v_add_u32 v3, 40960, v3
    s_mul_i32 s30, s12, 2048
    v_add_u32 v6, s30, v0
    v_add_u32 v7, 1024, v6
    s_mov_b32 s40, 0xc0135761
    s_mov_b32 s41, 0xbdd2d3e8
    s_mov_b32 s42, 0x3acccccd
    s_mov_b32 s43, 0x3727c5ac
    s_mov_b32 s23, 0
    v_mov_b32 v16, 128
P_49:
    global_load_dword v17, v16, s[90:91] sc1
    s_waitcnt vmcnt(0)
    v_readfirstlane_b32 s85, v17
    s_and_b32 s86, s85, 255
    s_cmp_ge_u32 s86, 70
    s_cbranch_scc1 P_50
    s_add_u32 s23, s23, 1
    s_cmp_gt_u32 s23, 65536
    s_cbranch_scc1 L_exit
    s_sleep 16
    s_branch P_49
P_50:
    s_lshr_b32 s85, s85, 8
    s_mov_b32 s80, 0
RO_job:
    s_mul_i32 s18, s14, 16777216
    s_add_u32 s18, s18, 100663296
    s_mul_i32 s19, s14, 41943040
    s_add_u32 s19, s19, 197132288
    s_mul_i32 s20, s14, 393216
    s_add_u32 s20, s20, 167870464
    s_mul_i32 s21, s14, 393216
    s_add_u32 s21, s21, 167903232
    s_lshl_b32 s30, s13, 2
    s_add_u32 s30, s30, s12
    s_lshl_b32 s31, s30, 7
    s_add_u32 s21, s21, s31
    s_add_u32 s27, s20, s31
    s_lshl_b32 s31, s30, 8
    s_add_u32 s28, s19, s31
    s_add_u32 s28, s28, 40960
    s_lshl_b32 s32, s30, 11
    s_mul_i32 s31, s12, 8
    s_and_b32 s31, s31, -4
    s_lshl_b32 s31, s31, 5
    s_add_u32 s20, s20, s31
    s_mov_b32 s25, 0
    s_mov_b32 s16, 0
    s_mov_b32 s17, 1
    s_mov_b32 s46, 64
    s_lshl_b32 s33, s13, 13
    s_mul_i32 s21, s14, 393216
    s_add_u32 s21, s21, 167903232
    s_and_b32 s30, s13, 3
    s_lshl_b32 s31, s30, 16
    s_add_u32 s18, s18, s31
    s_mul_i32 s31, s30, 2621440
    s_add_u32 s19, s19, s31
    s_lshl_b32 s31, s30, 10
    s_add_u32 s20, s20, s31
    s_lshl_b32 s31, s30, 7
    s_add_u32 s21, s21, s31
    s_lshr_b32 s30, s13, 2
    s_lshl_b32 s31, s30, 13
    s_add_u32 s19, s19, s31
    s_lshl_b32 s31, s30, 11
    s_add_u32 s21, s21, s31
    s_lshl_b32 s31, s12, 9
    s_add_u32 s21, s21, s31
    s_and_b32 s31, s21, 0x2000
    s_add_u32 s21, s21, s31
    s_mov_b32 s22, 0
    s_mov_b32 s47, 0
    s_mov_b32 s26, 0
    s_mov_b32 s24, 0
    s_mov_b32 s81, 0
    s_cmp_eq_u32 s14, 0
    s_cselect_b32 s30, 2, 7
    s_lshr_b32 s30, s85, s30
    s_and_b32 s30, s30, 1
    s_lshl_b32 s30, s30, 13
    s_andn2_b32 s20, s20, 0x2000
    s_or_b32 s20, s20, s30
    s_cmp_eq_u32 s14, 0
    s_cselect_b32 s30, 2, 7
    s_lshr_b32 s30, s85, s30
    s_and_b32 s30, s30, 1
    s_lshl_b32 s30, s30, 13
    s_andn2_b32 s21, s21, 0x2000
    s_or_b32 s21, s21, s30
    s_sub_u32 s46, 64, s14
    s_cmp_eq_u32 s80, 0
    s_cbranch_scc1 G_51
    s_mov_b32 s16, 63
    s_mov_b32 s46, 64
    s_mov_b32 s47, 63
    s_sub_u32 s21, s21, 393216
    s_lshr_b32 s30, s85, 2
    s_and_b32 s30, s30, 1
    s_lshl_b32 s30, s30, 13
    s_andn2_b32 s21, s21, 0x2000
    s_or_b32 s21, s21, s30
    s_sub_u32 s20, s20, 393216
    s_mov_b32 s81, 1
    s_lshr_b32 s30, s85, 2
    s_and_b32 s30, s30, 1
    s_lshl_b32 s30, s30, 13
    s_andn2_b32 s20, s20, 0x2000
    s_or_b32 s20, s20, s30
G_51:
    s_barrier
    v_min_u32 v20, 4, v5
    v_lshlrev_b32 v20, 5, v20
.p2align 6
RO_loop:
    s_cmp_eq_u32 s22, 1
    s_cbranch_scc1 G_52
    s_cmp_eq_u32 s22, 2
    s_cbranch_scc1 G_54
RO_poll:
    s_and_b32 s31, s16, s25
    s_lshl_b32 s31, s31, 15
    s_add_u32 s31, s31, s20
    s_add_u32 s37, s16, 1
    s_min_u32 s37, s37, 64
    s_add_u32 s37, s37, s81
    v_mbcnt_lo_u32_b32 v16, -1, 0
    v_min_u32 v16, 1, v16
    v_lshlrev_b32 v16, 7, v16
    s_mov_b32 s23, 0
    s_mov_b64 exec, 0xffffffff
P_55:
    buffer_load_dword v17, v16, s[4:7], s31 offen sc1
    s_waitcnt vmcnt(0)
    v_cmp_gt_u32 vcc, s37, v17
    s_cbranch_vccz P_56
    s_add_u32 s23, s23, 1
    s_cmp_gt_u32 s23, 65536
    s_cbranch_scc1 L_exit
    s_sleep 1
    s_branch P_55
P_56:
    s_mov_b64 exec, -1
RO_dma:
    s_mul_i32 s38, s16, 262144
    s_add_u32 s38, s38, s18
    s_mov_b32 s39, s24
    s_mul_i32 s30, s12, 16384
    s_add_u32 s38, s38, s30
    s_add_u32 s39, s39, s30
    s_mov_b32 m0, s39
    s_nop 0
    buffer_load_dwordx4 v4, s[4:7], s38 offen offset:0 sc1 lds
    buffer_load_dwordx4 v4, s[4:7], s38 offen offset:1024 sc1 lds
    buffer_load_dwordx4 v4, s[4:7], s38 offen offset:2048 sc1 lds
    buffer_load_dwordx4 v4, s[4:7], s38 offen offset:3072 sc1 lds
    s_add_u32 s38, s38, 4096
    s_add_u32 s39, s39, 4096
    s_mov_b32 m0, s39
    s_nop 0
    buffer_load_dwordx4 v4, s[4:7], s38 offen offset:0 sc1 lds
    buffer_load_dwordx4 v4, s[4:7], s38 offen offset:1024 sc1 lds
    buffer_load_dwordx4 v4, s[4:7], s38 offen offset:2048 sc1 lds
    buffer_load_dwordx4 v4, s[4:7], s38 offen offset:3072 sc1 lds
    s_add_u32 s38, s38, 4096
    s_add_u32 s39, s39, 4096
    s_mov_b32 m0, s39
    s_nop 0
    buffer_load_dwordx4 v4, s[4:7], s38 offen offset:0 sc1 lds
    buffer_load_dwordx4 v4, s[4:7], s38 offen offset:1024 sc1 lds
    buffer_load_dwordx4 v4, s[4:7], s38 offen offset:2048 sc1 lds
    buffer_load_dwordx4 v4, s[4:7], s38 offen offset:3072 sc1 lds
    s_add_u32 s38, s38, 4096
    s_add_u32 s39, s39, 4096
    s_mov_b32 m0, s39
    s_nop 0
    buffer_load_dwordx4 v4, s[4:7], s38 offen offset:0 sc1 lds
    buffer_load_dwordx4 v4, s[4:7], s38 offen offset:1024 sc1 lds
    buffer_load_dwordx4 v4, s[4:7], s38 offen offset:2048 sc1 lds
    buffer_load_dwordx4 v4, s[4:7], s38 offen offset:3072 sc1 lds
G_54:
    s_waitcnt vmcnt(13)
    s_branch G_53
G_52:
    s_waitcnt vmcnt(2)
G_53:
    v_add_u32 v1, s24, v0
    v_add_u32 v2, 0x10000, v1
    v_add_u32 v9, s24, v3
    s_add_u32 s29, s16, s17
    s_cmp_eq_u32 s22, 1
    s_cselect_b64 vcc, -1, 0
    s_barrier
    ds_read_b128 v[24:27], v1 offset:0
    ds_read_b128 v[28:31], v1 offset:16384
    ds_read_b128 v[32:35], v1 offset:32768
    ds_read_b128 v[36:39], v1 offset:49152
    ds_read_b128 v[40:43], v1 offset:1024
    s_and_b32 s31, s29, s25
    s_lshl_b32 s31, s31, 15
    s_add_u32 s31, s31, s20
    s_add_u32 s37, s29, 1
    s_min_u32 s37, s37, 64
    s_add_u32 s37, s37, s81
    s_mov_b32 s62, s31
    s_waitcnt lgkmcnt(4)
    v_mfma_f32_32x32x16_bf16 v[48:63], a[0:3], v[24:27], 0
    ds_read_b128 v[44:47], v1 offset:17408
    s_waitcnt lgkmcnt(4)
    v_mfma_f32_32x32x16_bf16 v[48:63], a[64:67], v[28:31], v[48:63]
    ds_read_b128 v[24:27], v1 offset:33792
    s_waitcnt lgkmcnt(4)
    v_mfma_f32_32x32x16_bf16 v[48:63], a[128:131], v[32:35], v[48:63]
    ds_read_b128 v[28:31], v1 offset:50176
    s_waitcnt lgkmcnt(4)
    v_mfma_f32_32x32x16_bf16 v[48:63], a[192:195], v[36:39], v[48:63]
    ds_read_b128 v[32:35], v1 offset:2048
    s_waitcnt lgkmcnt(4)
    v_mfma_f32_32x32x16_bf16 v[48:63], a[4:7], v[40:43], v[48:63]
    ds_read_b128 v[36:39], v1 offset:18432
    s_waitcnt lgkmcnt(4)
    v_mfma_f32_32x32x16_bf16 v[48:63], a[68:71], v[44:47], v[48:63]
    ds_read_b128 v[40:43], v1 offset:34816
    s_waitcnt lgkmcnt(4)
    v_mfma_f32_32x32x16_bf16 v[48:63], a[132:135], v[24:27], v[48:63]
    ds_read_b128 v[44:47], v1 offset:51200
    s_waitcnt lgkmcnt(4)
    v_mfma_f32_32x32x16_bf16 v[48:63], a[196:199], v[28:31], v[48:63]
    s_cbranch_vccnz G_59
    s_waitcnt vmcnt(10)
G_59:
    s_barrier
    ds_read_b128 v[24:27], v1 offset:3072
    s_waitcnt lgkmcnt(4)
    v_mfma_f32_32x32x16_bf16 v[48:63], a[8:11], v[32:35], v[48:63]
    ds_read_b128 v[28:31], v1 offset:19456
    s_waitcnt lgkmcnt(4)
    v_mfma_f32_32x32x16_bf16 v[48:63], a[72:75], v[36:39], v[48:63]
    ds_read_b128 v[32:35], v1 offset:35840
    s_waitcnt lgkmcnt(4)
    v_mfma_f32_32x32x16_bf16 v[48:63], a[136:139], v[40:43], v[48:63]
    ds_read_b128 v[36:39], v1 offset:52224
    s_waitcnt lgkmcnt(4)
    v_mfma_f32_32x32x16_bf16 v[48:63], a[200:203], v[44:47], v[48:63]
    ds_read_b128 v[40:43], v1 offset:4096
    s_waitcnt lgkmcnt(4)
    v_mfma_f32_32x32x16_bf16 v[48:63], a[12:15], v[24:27], v[48:63]
    ds_read_b128 v[44:47], v1 offset:20480
    s_waitcnt lgkmcnt(4)
    v_mfma_f32_32x32x16_bf16 v[48:63], a[76:79], v[28:31], v[48:63]
    ds_read_b128 v[24:27], v1 offset:36864
    s_cmp_lg_u32 s26, 0
    s_cbranch_scc1 G_57
G_58:
    s_waitcnt lgkmcnt(4)
    v_mfma_f32_32x32x16_bf16 v[48:63], a[140:143], v[32:35], v[48:63]
    ds_read_b128 v[28:31], v1 offset:53248
    s_waitcnt lgkmcnt(4)
    v_mfma_f32_32x32x16_bf16 v[48:63], a[204:207], v[36:39], v[48:63]
    ds_read_b128 v[32:35], v1 offset:5120
    s_waitcnt lgkmcnt(4)
    v_mfma_f32_32x32x16_bf16 v[48:63], a[16:19], v[40:43], v[48:63]
    ds_read_b128 v[36:39], v1 offset:21504
    s_waitcnt lgkmcnt(4)
    v_mfma_f32_32x32x16_bf16 v[48:63], a[80:83], v[44:47], v[48:63]
    ds_read_b128 v[40:43], v1 offset:37888
    s_waitcnt lgkmcnt(4)
    v_mfma_f32_32x32x16_bf16 v[48:63], a[144:147], v[24:27], v[48:63]
    ds_read_b128 v[44:47], v1 offset:54272
    s_waitcnt lgkmcnt(4)
    v_mfma_f32_32x32x16_bf16 v[48:63], a[208:211], v[28:31], v[48:63]
    s_cbranch_vccnz G_60
    s_waitcnt vmcnt(6)
G_60:
    s_barrier
    ds_read_b128 v[24:27], v1 offset:6144
    s_waitcnt lgkmcnt(4)
    v_mfma_f32_32x32x16_bf16 v[48:63], a[20:23], v[32:35], v[48:63]
    ds_read_b128 v[28:31], v1 offset:22528
    s_waitcnt lgkmcnt(4)
    v_mfma_f32_32x32x16_bf16 v[48:63], a[84:87], v[36:39], v[48:63]
    ds_read_b128 v[32:35], v1 offset:38912
    s_waitcnt lgkmcnt(4)
    v_mfma_f32_32x32x16_bf16 v[48:63], a[148:151], v[40:43], v[48:63]
    ds_read_b128 v[36:39], v1 offset:55296
    s_sub_u32 s31, s62, 0
    s_mov_b32 s32, s22
    s_cmp_eq_u32 s22, 0
    s_cbranch_scc1 G_61
    buffer_load_dword v21, v20, s[4:7], s31 offen sc1
G_61:
    s_waitcnt lgkmcnt(4)
    v_mfma_f32_32x32x16_bf16 v[48:63], a[212:215], v[44:47], v[48:63]
    ds_read_b128 v[40:43], v1 offset:7168
    s_waitcnt lgkmcnt(4)
    v_mfma_f32_32x32x16_bf16 v[48:63], a[24:27], v[24:27], v[48:63]
    ds_read_b128 v[44:47], v1 offset:23552
    s_waitcnt lgkmcnt(4)
    v_mfma_f32_32x32x16_bf16 v[48:63], a[88:91], v[28:31], v[48:63]
    ds_read_b128 v[24:27], v1 offset:39936
    s_waitcnt lgkmcnt(4)
    v_mfma_f32_32x32x16_bf16 v[48:63], a[152:155], v[32:35], v[48:63]
    ds_read_b128 v[28:31], v1 offset:56320
    s_waitcnt lgkmcnt(4)
    v_mfma_f32_32x32x16_bf16 v[48:63], a[216:219], v[36:39], v[48:63]
    ds_read_b128 v[32:35], v1 offset:8192
    s_waitcnt lgkmcnt(4)
    v_mfma_f32_32x32x16_bf16 v[48:63], a[28:31], v[40:43], v[48:63]
    ds_read_b128 v[36:39], v1 offset:24576
    s_waitcnt lgkmcnt(4)
    v_mfma_f32_32x32x16_bf16 v[48:63], a[92:95], v[44:47], v[48:63]
    ds_read_b128 v[40:43], v1 offset:40960
    s_waitcnt lgkmcnt(4)
    v_mfma_f32_32x32x16_bf16 v[48:63], a[156:159], v[24:27], v[48:63]
    ds_read_b128 v[44:47], v1 offset:57344
    s_waitcnt lgkmcnt(4)
    v_mfma_f32_32x32x16_bf16 v[48:63], a[220:223], v[28:31], v[48:63]
    ds_read_b128 v[24:27], v1 offset:9216
    s_waitcnt lgkmcnt(4)
    v_mfma_f32_32x32x16_bf16 v[48:63], a[32:35], v[32:35], v[48:63]
    ds_read_b128 v[28:31], v1 offset:25600
    s_waitcnt lgkmcnt(4)
    v_mfma_f32_32x32x16_bf16 v[48:63], a[96:99], v[36:39], v[48:63]
    ds_read_b128 v[32:35], v1 offset:41984
    s_waitcnt lgkmcnt(4)
    v_mfma_f32_32x32x16_bf16 v[48:63], a[160:163], v[40:43], v[48:63]
    ds_read_b128 v[36:39], v1 offset:58368
    s_waitcnt lgkmcnt(4)
    v_mfma_f32_32x32x16_bf16 v[48:63], a[224:227], v[44:47], v[48:63]
    s_cbranch_vccnz G_62
    s_waitcnt vmcnt(0)
G_62:
    s_barrier
    ds_read_b128 v[40:43], v1 offset:10240
    s_waitcnt lgkmcnt(4)
    v_mfma_f32_32x32x16_bf16 v[48:63], a[36:39], v[24:27], v[48:63]
    ds_read_b128 v[44:47], v1 offset:26624
    s_waitcnt lgkmcnt(4)
    v_mfma_f32_32x32x16_bf16 v[48:63], a[100:103], v[28:31], v[48:63]
    ds_read_b128 v[24:27], v1 offset:43008
    s_waitcnt lgkmcnt(4)
    v_mfma_f32_32x32x16_bf16 v[48:63], a[164:167], v[32:35], v[48:63]
    ds_read_b128 v[28:31], v1 offset:59392
    s_waitcnt lgkmcnt(4)
    v_mfma_f32_32x32x16_bf16 v[48:63], a[228:231], v[36:39], v[48:63]
    ds_read_b128 v[32:35], v1 offset:11264
    s_waitcnt lgkmcnt(4)
    v_mfma_f32_32x32x16_bf16 v[48:63], a[40:43], v[40:43], v[48:63]
    ds_read_b128 v[36:39], v1 offset:27648
    s_waitcnt lgkmcnt(4)
    v_mfma_f32_32x32x16_bf16 v[48:63], a[104:107], v[44:47], v[48:63]
    ds_read_b128 v[40:43], v1 offset:44032
    s_waitcnt lgkmcnt(4)
    v_mfma_f32_32x32x16_bf16 v[48:63], a[168:171], v[24:27], v[48:63]
    ds_read_b128 v[44:47], v1 offset:60416
    s_waitcnt lgkmcnt(4)
    v_mfma_f32_32x32x16_bf16 v[48:63], a[232:235], v[28:31], v[48:63]
    ds_read_b128 v[24:27], v1 offset:12288
    s_cmp_lg_u32 s32, 0
    s_cbranch_scc1 G_64
G_65:
    s_waitcnt lgkmcnt(4)
    v_mfma_f32_32x32x16_bf16 v[48:63], a[44:47], v[32:35], v[48:63]
    ds_read_b128 v[28:31], v1 offset:28672
    s_waitcnt lgkmcnt(4)
    v_mfma_f32_32x32x16_bf16 v[48:63], a[108:111], v[36:39], v[48:63]
    ds_read_b128 v[32:35], v1 offset:45056
    s_waitcnt lgkmcnt(4)
    v_mfma_f32_32x32x16_bf16 v[48:63], a[172:175], v[40:43], v[48:63]
    ds_read_b128 v[36:39], v1 offset:61440
    s_waitcnt lgkmcnt(4)
    v_mfma_f32_32x32x16_bf16 v[48:63], a[236:239], v[44:47], v[48:63]
    ds_read_b128 v[40:43], v1 offset:13312
    s_waitcnt lgkmcnt(4)
    v_mfma_f32_32x32x16_bf16 v[48:63], a[48:51], v[24:27], v[48:63]
    ds_read_b128 v[44:47], v1 offset:29696
    s_waitcnt lgkmcnt(4)
    v_mfma_f32_32x32x16_bf16 v[48:63], a[112:115], v[28:31], v[48:63]
    ds_read_b128 v[24:27], v1 offset:46080
    s_waitcnt lgkmcnt(4)
    v_mfma_f32_32x32x16_bf16 v[48:63], a[176:179], v[32:35], v[48:63]
    ds_read_b128 v[28:31], v1 offset:62464
    s_waitcnt lgkmcnt(4)
    v_mfma_f32_32x32x16_bf16 v[48:63], a[240:243], v[36:39], v[48:63]
    ds_read_b128 v[32:35], v1 offset:14336
    s_waitcnt lgkmcnt(4)
    v_mfma_f32_32x32x16_bf16 v[48:63], a[52:55], v[40:43], v[48:63]
    ds_read_b128 v[36:39], v1 offset:30720
    s_waitcnt lgkmcnt(4)
    v_mfma_f32_32x32x16_bf16 v[48:63], a[116:119], v[44:47], v[48:63]
    ds_read_b128 v[40:43], v1 offset:47104
    s_waitcnt lgkmcnt(4)
    v_mfma_f32_32x32x16_bf16 v[48:63], a[180:183], v[24:27], v[48:63]
    ds_read_b128 v[44:47], v1 offset:63488
    s_waitcnt lgkmcnt(4)
    v_mfma_f32_32x32x16_bf16 v[48:63], a[244:247], v[28:31], v[48:63]
    ds_read_b128 v[24:27], v1 offset:15360
    s_waitcnt lgkmcnt(4)
    v_mfma_f32_32x32x16_bf16 v[48:63], a[56:59], v[32:35], v[48:63]
    ds_read_b128 v[28:31], v1 offset:31744
    s_waitcnt lgkmcnt(4)
    v_mfma_f32_32x32x16_bf16 v[48:63], a[120:123], v[36:39], v[48:63]
    ds_read_b128 v[32:35], v1 offset:48128
    s_waitcnt lgkmcnt(4)
    v_mfma_f32_32x32x16_bf16 v[48:63], a[184:187], v[40:43], v[48:63]
    ds_read_b128 v[36:39], v1 offset:64512
    s_waitcnt lgkmcnt(4)
    v_mfma_f32_32x32x16_bf16 v[48:63], a[248:251], v[44:47], v[48:63]
    s_waitcnt lgkmcnt(3)
    v_mfma_f32_32x32x16_bf16 v[48:63], a[60:63], v[24:27], v[48:63]
    s_waitcnt lgkmcnt(2)
    v_mfma_f32_32x32x16_bf16 v[48:63], a[124:127], v[28:31], v[48:63]
    s_waitcnt lgkmcnt(1)
    v_mfma_f32_32x32x16_bf16 v[48:63], a[188:191], v[32:35], v[48:63]
    s_waitcnt lgkmcnt(0)
    v_mfma_f32_32x32x16_bf16 v[48:63], a[252:255], v[36:39], v[48:63]
    s_branch G_66
G_57:
    s_waitcnt vmcnt(0)
    s_sub_u32 s63, s26, s47
    s_mov_b32 s47, s26
    s_atomic_add s63, s[4:5], s21
    s_mov_b32 s26, 0
    s_branch G_58
G_64:
    s_waitcnt vmcnt(0)
    v_cmp_gt_u32 vcc, s37, v21
    s_sub_u32 s33, 65536, s24
    s_mov_b32 s22, 0
    s_cbranch_vccnz G_65
    s_cmp_ge_u32 s29, s46
    s_cbranch_scc1 G_65
    s_mov_b32 s22, 1
    s_waitcnt lgkmcnt(4)
    v_mfma_f32_32x32x16_bf16 v[48:63], a[44:47], v[32:35], v[48:63]
    ds_read_b128 v[28:31], v1 offset:28672
    s_mul_i32 s38, s29, 262144
    s_add_u32 s38, s38, s18
    s_mov_b32 s39, s33
    s_mul_i32 s30, s12, 16384
    s_add_u32 s38, s38, s30
    s_add_u32 s39, s39, s30
    s_mov_b32 m0, s39
    s_nop 0
    buffer_load_dwordx4 v4, s[4:7], s38 offen offset:0 sc1 lds
    s_waitcnt lgkmcnt(4)
    v_mfma_f32_32x32x16_bf16 v[48:63], a[108:111], v[36:39], v[48:63]
    ds_read_b128 v[32:35], v1 offset:45056
    buffer_load_dwordx4 v4, s[4:7], s38 offen offset:1024 sc1 lds
    s_waitcnt lgkmcnt(4)
    v_mfma_f32_32x32x16_bf16 v[48:63], a[172:175], v[40:43], v[48:63]
    ds_read_b128 v[36:39], v1 offset:61440
    buffer_load_dwordx4 v4, s[4:7], s38 offen offset:2048 sc1 lds
    s_waitcnt lgkmcnt(4)
    v_mfma_f32_32x32x16_bf16 v[48:63], a[236:239], v[44:47], v[48:63]
    ds_read_b128 v[40:43], v1 offset:13312
    buffer_load_dwordx4 v4, s[4:7], s38 offen offset:3072 sc1 lds
    s_waitcnt lgkmcnt(4)
    v_mfma_f32_32x32x16_bf16 v[48:63], a[48:51], v[24:27], v[48:63]
    ds_read_b128 v[44:47], v1 offset:29696
    s_add_u32 s38, s38, 4096
    s_add_u32 s39, s39, 4096
    s_mov_b32 m0, s39
    s_nop 0
    buffer_load_dwordx4 v4, s[4:7], s38 offen offset:0 sc1 lds
    s_waitcnt lgkmcnt(4)
    v_mfma_f32_32x32x16_bf16 v[48:63], a[112:115], v[28:31], v[48:63]
    ds_read_b128 v[24:27], v1 offset:46080
    buffer_load_dwordx4 v4, s[4:7], s38 offen offset:1024 sc1 lds
    s_waitcnt lgkmcnt(4)
    v_mfma_f32_32x32x16_bf16 v[48:63], a[176:179], v[32:35], v[48:63]
    ds_read_b128 v[28:31], v1 offset:62464
    buffer_load_dwordx4 v4, s[4:7], s38 offen offset:2048 sc1 lds
    s_waitcnt lgkmcnt(4)
    v_mfma_f32_32x32x16_bf16 v[48:63], a[240:243], v[36:39], v[48:63]
    ds_read_b128 v[32:35], v1 offset:14336
    buffer_load_dwordx4 v4, s[4:7], s38 offen offset:3072 sc1 lds
    s_waitcnt lgkmcnt(4)
    v_mfma_f32_32x32x16_bf16 v[48:63], a[52:55], v[40:43], v[48:63]
    ds_read_b128 v[36:39], v1 offset:30720
    s_add_u32 s38, s38, 4096
    s_add_u32 s39, s39, 4096
    s_mov_b32 m0, s39
    s_nop 0
    buffer_load_dwordx4 v4, s[4:7], s38 offen offset:0 sc1 lds
    s_waitcnt lgkmcnt(4)
    v_mfma_f32_32x32x16_bf16 v[48:63], a[116:119], v[44:47], v[48:63]
    ds_read_b128 v[40:43], v1 offset:47104
    buffer_load_dwordx4 v4, s[4:7], s38 offen offset:1024 sc1 lds
    s_waitcnt lgkmcnt(4)
    v_mfma_f32_32x32x16_bf16 v[48:63], a[180:183], v[24:27], v[48:63]
    ds_read_b128 v[44:47], v1 offset:63488
    buffer_load_dwordx4 v4, s[4:7], s38 offen offset:2048 sc1 lds
    s_waitcnt lgkmcnt(4)
    v_mfma_f32_32x32x16_bf16 v[48:63], a[244:247], v[28:31], v[48:63]
    ds_read_b128 v[24:27], v1 offset:15360
    buffer_load_dwordx4 v4, s[4:7], s38 offen offset:3072 sc1 lds
    s_waitcnt lgkmcnt(4)
    v_mfma_f32_32x32x16_bf16 v[48:63], a[56:59], v[32:35], v[48:63]
    ds_read_b128 v[28:31], v1 offset:31744
    s_add_u32 s38, s38, 4096
    s_add_u32 s39, s39, 4096
    s_mov_b32 m0, s39
    s_nop 0
    buffer_load_dwordx4 v4, s[4:7], s38 offen offset:0 sc1 lds
    s_waitcnt lgkmcnt(4)
    v_mfma_f32_32x32x16_bf16 v[48:63], a[120:123], v[36:39], v[48:63]
    ds_read_b128 v[32:35], v1 offset:48128
    buffer_load_dwordx4 v4, s[4:7], s38 offen offset:1024 sc1 lds
    s_waitcnt lgkmcnt(4)
    v_mfma_f32_32x32x16_bf16 v[48:63], a[184:187], v[40:43], v[48:63]
    ds_read_b128 v[36:39], v1 offset:64512
    buffer_load_dwordx4 v4, s[4:7], s38 offen offset:2048 sc1 lds
    s_waitcnt lgkmcnt(4)
    v_mfma_f32_32x32x16_bf16 v[48:63], a[248:251], v[44:47], v[48:63]
    buffer_load_dwordx4 v4, s[4:7], s38 offen offset:3072 sc1 lds
    s_waitcnt lgkmcnt(3)
    v_mfma_f32_32x32x16_bf16 v[48:63], a[60:63], v[24:27], v[48:63]
    s_waitcnt lgkmcnt(2)
    v_mfma_f32_32x32x16_bf16 v[48:63], a[124:127], v[28:31], v[48:63]
    s_waitcnt lgkmcnt(1)
    v_mfma_f32_32x32x16_bf16 v[48:63], a[188:191], v[32:35], v[48:63]
    s_waitcnt lgkmcnt(0)
    v_mfma_f32_32x32x16_bf16 v[48:63], a[252:255], v[36:39], v[48:63]
G_66:
    s_cmp_lg_u32 s22, 0
    s_cbranch_scc1 G_67
    s_sub_u32 s31, s62, 0
    buffer_load_dword v21, v20, s[4:7], s31 offen sc1
G_67:
    s_mul_i32 s30, s16, 40960
    s_add_u32 s32, s30, s28
    s_add_u32 s30, s30, s19
    s_nop 6
    v_cvt_pk_bf16_f32 v24, v48, v49
    v_cvt_pk_bf16_f32 v25, v50, v51
    v_cvt_pk_bf16_f32 v26, v52, v53
    v_cvt_pk_bf16_f32 v27, v54, v55
    buffer_store_dwordx4 v[24:27], v6, s[4:7], s30 offen offset:0 sc1
    v_cvt_pk_bf16_f32 v28, v56, v57
    v_cvt_pk_bf16_f32 v29, v58, v59
    v_cvt_pk_bf16_f32 v30, v60, v61
    v_cvt_pk_bf16_f32 v31, v62, v63
    buffer_store_dwordx4 v[28:31], v7, s[4:7], s30 offen offset:0 sc1
    s_add_u32 s32, s16, 1
    s_sub_u32 s24, 65536, s24
    s_mov_b32 s26, s32
    s_cmp_lg_u32 s22, 0
    s_cbranch_scc1 G_70
    s_mov_b32 s26, 0
    s_waitcnt lgkmcnt(0)
    s_cmp_ge_u32 s29, s46
    s_cbranch_scc1 G_71
    s_waitcnt vmcnt(2)
    v_cmp_gt_u32 vcc, s37, v21
    s_cbranch_vccnz G_68
    s_mov_b32 s22, 2
    s_mul_i32 s38, s29, 262144
    s_add_u32 s38, s38, s18
    s_mov_b32 s39, s24
    s_mul_i32 s30, s12, 16384
    s_add_u32 s38, s38, s30
    s_add_u32 s39, s39, s30
    s_mov_b32 m0, s39
    s_nop 0
    buffer_load_dwordx4 v4, s[4:7], s38 offen offset:0 sc1 lds
    buffer_load_dwordx4 v4, s[4:7], s38 offen offset:1024 sc1 lds
    buffer_load_dwordx4 v4, s[4:7], s38 offen offset:2048 sc1 lds
    buffer_load_dwordx4 v4, s[4:7], s38 offen offset:3072 sc1 lds
    s_add_u32 s38, s38, 4096
    s_add_u32 s39, s39, 4096
    s_mov_b32 m0, s39
    s_nop 0
    buffer_load_dwordx4 v4, s[4:7], s38 offen offset:0 sc1 lds
    buffer_load_dwordx4 v4, s[4:7], s38 offen offset:1024 sc1 lds
    buffer_load_dwordx4 v4, s[4:7], s38 offen offset:2048 sc1 lds
    buffer_load_dwordx4 v4, s[4:7], s38 offen offset:3072 sc1 lds
    s_add_u32 s38, s38, 4096
    s_add_u32 s39, s39, 4096
    s_mov_b32 m0, s39
    s_nop 0
    buffer_load_dwordx4 v4, s[4:7], s38 offen offset:0 sc1 lds
    buffer_load_dwordx4 v4, s[4:7], s38 offen offset:1024 sc1 lds
    buffer_load_dwordx4 v4, s[4:7], s38 offen offset:2048 sc1 lds
    buffer_load_dwordx4 v4, s[4:7], s38 offen offset:3072 sc1 lds
    s_add_u32 s38, s38, 4096
    s_add_u32 s39, s39, 4096
    s_mov_b32 m0, s39
    s_nop 0
    buffer_load_dwordx4 v4, s[4:7], s38 offen offset:0 sc1 lds
    buffer_load_dwordx4 v4, s[4:7], s38 offen offset:1024 sc1 lds
    buffer_load_dwordx4 v4, s[4:7], s38 offen offset:2048 sc1 lds
    buffer_load_dwordx4 v4, s[4:7], s38 offen offset:3072 sc1 lds
    s_waitcnt vmcnt(16)
    s_branch G_69
G_68:
    buffer_load_dword v21, v20, s[4:7], s62 offen sc1
    s_waitcnt vmcnt(1)
    s_sub_u32 s63, s32, s47
    s_mov_b32 s47, s32
    s_atomic_add s63, s[4:5], s21
    s_mov_b32 s16, s29
    s_waitcnt vmcnt(0)
    v_cmp_gt_u32 vcc, s37, v21
    s_cbranch_vccnz RO_poll
    s_mov_b32 s22, 0
    s_branch RO_dma
G_71:
    s_waitcnt vmcnt(0)
G_69:
    s_sub_u32 s63, s32, s47
    s_mov_b32 s47, s32
    s_atomic_add s63, s[4:5], s21
G_70:
    s_mov_b32 s16, s29
    s_cmp_lt_u32 s16, s46
    s_cbranch_scc1 RO_loop
RO_done:
    s_cmp_lg_u32 s14, 0
    s_cbranch_scc1 G_72
    s_mov_b32 s14, 1
    s_mov_b32 s80, 1
    s_branch RO_job
G_72:
    s_branch L_next
RM1:
    v_mbcnt_lo_u32_b32 v12, -1, 0
    v_mbcnt_hi_u32_b32 v12, -1, v12
    v_lshlrev_b32 v0, 4, v12
    v_lshlrev_b32 v8, 3, v12
    v_lshlrev_b32 v5, 2, v12
    s_mov_b32 s44, 0
    s_mov_b32 s45, -1
    s_barrier
    s_load_dwordx2 s[8:9], s[0:1], 64
    s_mov_b32 s10, 819200
    s_mov_b32 s11, 0x20000
    s_lshl_b32 s32, s13, 8
    s_waitcnt lgkmcnt(0)
    v_lshrrev_b32 v13, 2, v12
    v_and_b32 v14, 3, v12
    s_mov_b32 s30, 1280
    v_mul_lo_u32 v13, v13, s30
    v_lshl_add_u32 v13, v14, 4, v13
    s_mul_i32 s30, s12, 64
    s_add_u32 s30, s30, s32
    v_add_u32 v13, s30, v13
    v_lshrrev_b32 v14, 5, v12
    v_bfe_u32 v15, v12, 2, 2
    v_lshl_add_u32 v15, v14, 3, v15
    v_mul_u32_u24 v15, 64, v15
    v_bfe_u32 v16, v12, 4, 1
    v_lshl_add_u32 v15, v16, 5, v15
    v_and_b32 v16, 1, v12
    v_lshl_add_u32 v15, v16, 4, v15
    v_bfe_u32 v16, v12, 1, 1
    v_lshl_add_u32 v15, v16, 3, v15
    s_mul_i32 s33, s12, 40960
    v_add_u32 v15, s33, v15
    s_add_u32 m0, s33, 0
    s_mov_b32 s30, 0
    buffer_load_dwordx4 v13, s[8:11], s30 offen lds
    s_add_u32 m0, s33, 1024
    s_mov_b32 s30, 20480
    buffer_load_dwordx4 v13, s[8:11], s30 offen lds
    s_add_u32 m0, s33, 2048
    s_mov_b32 s30, 40960
    buffer_load_dwordx4 v13, s[8:11], s30 offen lds
    s_add_u32 m0, s33, 3072
    s_mov_b32 s30, 61440
    buffer_load_dwordx4 v13, s[8:11], s30 offen lds
    s_add_u32 m0, s33, 4096
    s_mov_b32 s30, 81920
    buffer_load_dwordx4 v13, s[8:11], s30 offen lds
    s_add_u32 m0, s33, 5120
    s_mov_b32 s30, 102400
    buffer_load_dwordx4 v13, s[8:11], s30 offen lds
    s_add_u32 m0, s33, 6144
    s_mov_b32 s30, 122880
    buffer_load_dwordx4 v13, s[8:11], s30 offen lds
    s_add_u32 m0, s33, 7168
    s_mov_b32 s30, 143360
    buffer_load_dwordx4 v13, s[8:11], s30 offen lds
    s_add_u32 m0, s33, 8192
    s_mov_b32 s30, 163840
    buffer_load_dwordx4 v13, s[8:11], s30 offen lds
    s_add_u32 m0, s33, 9216
    s_mov_b32 s30, 184320
    buffer_load_dwordx4 v13, s[8:11], s30 offen lds
    s_add_u32 m0, s33, 10240
    s_mov_b32 s30, 204800
    buffer_load_dwordx4 v13, s[8:11], s30 offen lds
    s_add_u32 m0, s33, 11264
    s_mov_b32 s30, 225280
    buffer_load_dwordx4 v13, s[8:11], s30 offen lds
    s_add_u32 m0, s33, 12288
    s_mov_b32 s30, 245760
    buffer_load_dwordx4 v13, s[8:11], s30 offen lds
    s_add_u32 m0, s33, 13312
    s_mov_b32 s30, 266240
    buffer_load_dwordx4 v13, s[8:11], s30 offen lds
    s_add_u32 m0, s33, 14336
    s_mov_b32 s30, 286720
    buffer_load_dwordx4 v13, s[8:11], s30 offen lds
    s_add_u32 m0, s33, 15360
    s_mov_b32 s30, 307200
    buffer_load_dwordx4 v13, s[8:11], s30 offen lds
    s_add_u32 m0, s33, 16384
    s_mov_b32 s30, 327680
    buffer_load_dwordx4 v13, s[8:11], s30 offen lds
    s_add_u32 m0, s33, 17408
    s_mov_b32 s30, 348160
    buffer_load_dwordx4 v13, s[8:11], s30 offen lds
    s_add_u32 m0, s33, 18432
    s_mov_b32 s30, 368640
    buffer_load_dwordx4 v13, s[8:11], s30 offen lds
    s_add_u32 m0, s33, 19456
    s_mov_b32 s30, 389120
    buffer_load_dwordx4 v13, s[8:11], s30 offen lds
    s_add_u32 m0, s33, 20480
    s_mov_b32 s30, 409600
    buffer_load_dwordx4 v13, s[8:11], s30 offen lds
    s_add_u32 m0, s33, 21504
    s_mov_b32 s30, 430080
    buffer_load_dwordx4 v13, s[8:11], s30 offen lds
    s_add_u32 m0, s33, 22528
    s_mov_b32 s30, 450560
    buffer_load_dwordx4 v13, s[8:11], s30 offen lds
    s_add_u32 m0, s33, 23552
    s_mov_b32 s30, 471040
    buffer_load_dwordx4 v13, s[8:11], s30 offen lds
    s_add_u32 m0, s33, 24576
    s_mov_b32 s30, 491520
    buffer_load_dwordx4 v13, s[8:11], s30 offen lds
    s_add_u32 m0, s33, 25600
    s_mov_b32 s30, 512000
    buffer_load_dwordx4 v13, s[8:11], s30 offen lds
    s_add_u32 m0, s33, 26624
    s_mov_b32 s30, 532480
    buffer_load_dwordx4 v13, s[8:11], s30 offen lds
    s_add_u32 m0, s33, 27648
    s_mov_b32 s30, 552960
    buffer_load_dwordx4 v13, s[8:11], s30 offen lds
    s_add_u32 m0, s33, 28672
    s_mov_b32 s30, 573440
    buffer_load_dwordx4 v13, s[8:11], s30 offen lds
    s_add_u32 m0, s33, 29696
    s_mov_b32 s30, 593920
    buffer_load_dwordx4 v13, s[8:11], s30 offen lds
    s_add_u32 m0, s33, 30720
    s_mov_b32 s30, 614400
    buffer_load_dwordx4 v13, s[8:11], s30 offen lds
    s_add_u32 m0, s33, 31744
    s_mov_b32 s30, 634880
    buffer_load_dwordx4 v13, s[8:11], s30 offen lds
    s_add_u32 m0, s33, 32768
    s_mov_b32 s30, 655360
    buffer_load_dwordx4 v13, s[8:11], s30 offen lds
    s_add_u32 m0, s33, 33792
    s_mov_b32 s30, 675840
    buffer_load_dwordx4 v13, s[8:11], s30 offen lds
    s_add_u32 m0, s33, 34816
    s_mov_b32 s30, 696320
    buffer_load_dwordx4 v13, s[8:11], s30 offen lds
    s_add_u32 m0, s33, 35840
    s_mov_b32 s30, 716800
    buffer_load_dwordx4 v13, s[8:11], s30 offen lds
    s_waitcnt vmcnt(35)
    ds_read_b64_tr_b16 a[96:97], v15 offset:0
    ds_read_b64_tr_b16 a[98:99], v15 offset:256
    s_add_u32 m0, s33, 36864
    s_mov_b32 s30, 737280
    buffer_load_dwordx4 v13, s[8:11], s30 offen lds
    s_waitcnt vmcnt(35)
    ds_read_b64_tr_b16 a[100:101], v15 offset:1024
    ds_read_b64_tr_b16 a[102:103], v15 offset:1280
    s_add_u32 m0, s33, 37888
    s_mov_b32 s30, 757760
    buffer_load_dwordx4 v13, s[8:11], s30 offen lds
    s_waitcnt vmcnt(35)
    ds_read_b64_tr_b16 a[104:105], v15 offset:2048
    ds_read_b64_tr_b16 a[106:107], v15 offset:2304
    s_add_u32 m0, s33, 38912
    s_mov_b32 s30, 778240
    buffer_load_dwordx4 v13, s[8:11], s30 offen lds
    s_waitcnt vmcnt(35)
    ds_read_b64_tr_b16 a[108:109], v15 offset:3072
    ds_read_b64_tr_b16 a[110:111], v15 offset:3328
    s_add_u32 m0, s33, 39936
    s_mov_b32 s30, 798720
    buffer_load_dwordx4 v13, s[8:11], s30 offen lds
    s_waitcnt vmcnt(35)
    ds_read_b64_tr_b16 a[112:113], v15 offset:4096
    ds_read_b64_tr_b16 a[114:115], v15 offset:4352
    s_waitcnt vmcnt(34)
    ds_read_b64_tr_b16 a[116:117], v15 offset:5120
    ds_read_b64_tr_b16 a[118:119], v15 offset:5376
    s_waitcnt vmcnt(33)
    ds_read_b64_tr_b16 a[120:121], v15 offset:6144
    ds_read_b64_tr_b16 a[122:123], v15 offset:6400
    s_waitcnt vmcnt(32)
    ds_read_b64_tr_b16 a[124:125], v15 offset:7168
    ds_read_b64_tr_b16 a[126:127], v15 offset:7424
    s_waitcnt vmcnt(31)
    ds_read_b64_tr_b16 a[128:129], v15 offset:8192
    ds_read_b64_tr_b16 a[130:131], v15 offset:8448
    s_waitcnt vmcnt(30)
    ds_read_b64_tr_b16 a[132:133], v15 offset:9216
    ds_read_b64_tr_b16 a[134:135], v15 offset:9472
    s_waitcnt vmcnt(29)
    ds_read_b64_tr_b16 a[136:137], v15 offset:10240
    ds_read_b64_tr_b16 a[138:139], v15 offset:10496
    s_waitcnt vmcnt(28)
    ds_read_b64_tr_b16 a[140:141], v15 offset:11264
    ds_read_b64_tr_b16 a[142:143], v15 offset:11520
    s_waitcnt vmcnt(27)
    ds_read_b64_tr_b16 a[144:145], v15 offset:12288
    ds_read_b64_tr_b16 a[146:147], v15 offset:12544
    s_waitcnt vmcnt(26)
    ds_read_b64_tr_b16 a[148:149], v15 offset:13312
    ds_read_b64_tr_b16 a[150:151], v15 offset:13568
    s_waitcnt vmcnt(25)
    ds_read_b64_tr_b16 a[152:153], v15 offset:14336
    ds_read_b64_tr_b16 a[154:155], v15 offset:14592
    s_waitcnt vmcnt(24)
    ds_read_b64_tr_b16 a[156:157], v15 offset:15360
    ds_read_b64_tr_b16 a[158:159], v15 offset:15616
    s_waitcnt vmcnt(23)
    ds_read_b64_tr_b16 a[160:161], v15 offset:16384
    ds_read_b64_tr_b16 a[162:163], v15 offset:16640
    s_waitcnt vmcnt(22)
    ds_read_b64_tr_b16 a[164:165], v15 offset:17408
    ds_read_b64_tr_b16 a[166:167], v15 offset:17664
    s_waitcnt vmcnt(21)
    ds_read_b64_tr_b16 a[168:169], v15 offset:18432
    ds_read_b64_tr_b16 a[170:171], v15 offset:18688
    s_waitcnt vmcnt(20)
    ds_read_b64_tr_b16 a[172:173], v15 offset:19456
    ds_read_b64_tr_b16 a[174:175], v15 offset:19712
    s_waitcnt vmcnt(19)
    ds_read_b64_tr_b16 a[176:177], v15 offset:20480
    ds_read_b64_tr_b16 a[178:179], v15 offset:20736
    s_waitcnt vmcnt(18)
    ds_read_b64_tr_b16 a[180:181], v15 offset:21504
    ds_read_b64_tr_b16 a[182:183], v15 offset:21760
    s_waitcnt vmcnt(17)
    ds_read_b64_tr_b16 a[184:185], v15 offset:22528
    ds_read_b64_tr_b16 a[186:187], v15 offset:22784
    s_waitcnt vmcnt(16)
    ds_read_b64_tr_b16 a[188:189], v15 offset:23552
    ds_read_b64_tr_b16 a[190:191], v15 offset:23808
    s_waitcnt vmcnt(15)
    ds_read_b64_tr_b16 a[192:193], v15 offset:24576
    ds_read_b64_tr_b16 a[194:195], v15 offset:24832
    s_waitcnt vmcnt(14)
    ds_read_b64_tr_b16 a[196:197], v15 offset:25600
    ds_read_b64_tr_b16 a[198:199], v15 offset:25856
    s_waitcnt vmcnt(13)
    ds_read_b64_tr_b16 a[200:201], v15 offset:26624
    ds_read_b64_tr_b16 a[202:203], v15 offset:26880
    s_waitcnt vmcnt(12)
    ds_read_b64_tr_b16 a[204:205], v15 offset:27648
    ds_read_b64_tr_b16 a[206:207], v15 offset:27904
    s_waitcnt vmcnt(11)
    ds_read_b64_tr_b16 a[208:209], v15 offset:28672
    ds_read_b64_tr_b16 a[210:211], v15 offset:28928
    s_waitcnt vmcnt(10)
    ds_read_b64_tr_b16 a[212:213], v15 offset:29696
    ds_read_b64_tr_b16 a[214:215], v15 offset:29952
    s_waitcnt vmcnt(9)
    ds_read_b64_tr_b16 a[216:217], v15 offset:30720
    ds_read_b64_tr_b16 a[218:219], v15 offset:30976
    s_waitcnt vmcnt(8)
    ds_read_b64_tr_b16 a[220:221], v15 offset:31744
    ds_read_b64_tr_b16 a[222:223], v15 offset:32000
    s_waitcnt vmcnt(7)
    ds_read_b64_tr_b16 a[224:225], v15 offset:32768
    ds_read_b64_tr_b16 a[226:227], v15 offset:33024
    s_waitcnt vmcnt(6)
    ds_read_b64_tr_b16 a[228:229], v15 offset:33792
    ds_read_b64_tr_b16 a[230:231], v15 offset:34048
    s_waitcnt vmcnt(5)
    ds_read_b64_tr_b16 a[232:233], v15 offset:34816
    ds_read_b64_tr_b16 a[234:235], v15 offset:35072
    s_waitcnt vmcnt(4)
    ds_read_b64_tr_b16 a[236:237], v15 offset:35840
    ds_read_b64_tr_b16 a[238:239], v15 offset:36096
    s_waitcnt vmcnt(3)
    ds_read_b64_tr_b16 a[240:241], v15 offset:36864
    ds_read_b64_tr_b16 a[242:243], v15 offset:37120
    s_waitcnt vmcnt(2)
    ds_read_b64_tr_b16 a[244:245], v15 offset:37888
    ds_read_b64_tr_b16 a[246:247], v15 offset:38144
    s_waitcnt vmcnt(1)
    ds_read_b64_tr_b16 a[248:249], v15 offset:38912
    ds_read_b64_tr_b16 a[250:251], v15 offset:39168
    s_waitcnt vmcnt(0)
    ds_read_b64_tr_b16 a[252:253], v15 offset:39936
    ds_read_b64_tr_b16 a[254:255], v15 offset:40192
    s_waitcnt lgkmcnt(0)
    v_mov_b32 v24, 0x3f803f80
    v_mov_b32 v25, 0x3f803f80
    v_mov_b32 v26, 0x3f803f80
    v_mov_b32 v27, 0x3f803f80
    s_nop 1
    v_mfma_f32_32x32x16_bf16 v[48:63], v[24:27], a[96:99], 0
    v_mfma_f32_32x32x16_bf16 v[48:63], v[24:27], a[100:103], v[48:63]
    v_mfma_f32_32x32x16_bf16 v[48:63], v[24:27], a[104:107], v[48:63]
    v_mfma_f32_32x32x16_bf16 v[48:63], v[24:27], a[108:111], v[48:63]
    v_mfma_f32_32x32x16_bf16 v[48:63], v[24:27], a[112:115], v[48:63]
    v_mfma_f32_32x32x16_bf16 v[48:63], v[24:27], a[116:119], v[48:63]
    v_mfma_f32_32x32x16_bf16 v[48:63], v[24:27], a[120:123], v[48:63]
    v_mfma_f32_32x32x16_bf16 v[48:63], v[24:27], a[124:127], v[48:63]
    v_mfma_f32_32x32x16_bf16 v[48:63], v[24:27], a[128:131], v[48:63]
    v_mfma_f32_32x32x16_bf16 v[48:63], v[24:27], a[132:135], v[48:63]
    v_mfma_f32_32x32x16_bf16 v[48:63], v[24:27], a[136:139], v[48:63]
    v_mfma_f32_32x32x16_bf16 v[48:63], v[24:27], a[140:143], v[48:63]
    v_mfma_f32_32x32x16_bf16 v[48:63], v[24:27], a[144:147], v[48:63]
    v_mfma_f32_32x32x16_bf16 v[48:63], v[24:27], a[148:151], v[48:63]
    v_mfma_f32_32x32x16_bf16 v[48:63], v[24:27], a[152:155], v[48:63]
    v_mfma_f32_32x32x16_bf16 v[48:63], v[24:27], a[156:159], v[48:63]
    v_mfma_f32_32x32x16_bf16 v[48:63], v[24:27], a[160:163], v[48:63]
    v_mfma_f32_32x32x16_bf16 v[48:63], v[24:27], a[164:167], v[48:63]
    v_mfma_f32_32x32x16_bf16 v[48:63], v[24:27], a[168:171], v[48:63]
    v_mfma_f32_32x32x16_bf16 v[48:63], v[24:27], a[172:175], v[48:63]
    v_mfma_f32_32x32x16_bf16 v[48:63], v[24:27], a[176:179], v[48:63]
    v_mfma_f32_32x32x16_bf16 v[48:63], v[24:27], a[180:183], v[48:63]
    v_mfma_f32_32x32x16_bf16 v[48:63], v[24:27], a[184:187], v[48:63]
    v_mfma_f32_32x32x16_bf16 v[48:63], v[24:27], a[188:191], v[48:63]
    v_mfma_f32_32x32x16_bf16 v[48:63], v[24:27], a[192:195], v[48:63]
    v_mfma_f32_32x32x16_bf16 v[48:63], v[24:27], a[196:199], v[48:63]
    v_mfma_f32_32x32x16_bf16 v[48:63], v[24:27], a[200:203], v[48:63]
    v_mfma_f32_32x32x16_bf16 v[48:63], v[24:27], a[204:207], v[48:63]
    v_mfma_f32_32x32x16_bf16 v[48:63], v[24:27], a[208:211], v[48:63]
    v_mfma_f32_32x32x16_bf16 v[48:63], v[24:27], a[212:215], v[48:63]
    v_mfma_f32_32x32x16_bf16 v[48:63], v[24:27], a[216:219], v[48:63]
    v_mfma_f32_32x32x16_bf16 v[48:63], v[24:27], a[220:223], v[48:63]
    v_mfma_f32_32x32x16_bf16 v[48:63], v[24:27], a[224:227], v[48:63]
    v_mfma_f32_32x32x16_bf16 v[48:63], v[24:27], a[228:231], v[48:63]
    v_mfma_f32_32x32x16_bf16 v[48:63], v[24:27], a[232:235], v[48:63]
    v_mfma_f32_32x32x16_bf16 v[48:63], v[24:27], a[236:239], v[48:63]
    v_mfma_f32_32x32x16_bf16 v[48:63], v[24:27], a[240:243], v[48:63]
    v_mfma_f32_32x32x16_bf16 v[48:63], v[24:27], a[244:247], v[48:63]
    v_mfma_f32_32x32x16_bf16 v[48:63], v[24:27], a[248:251], v[48:63]
    v_mfma_f32_32x32x16_bf16 v[48:63], v[24:27], a[252:255], v[48:63]
    s_nop 15
    v_cvt_pk_bf16_f32 v96, v48, v48
    v_and_b32 v13, 0xffff0000, v96
    v_sub_f32 v13, v48, v13
    v_cvt_pk_bf16_f32 v97, v13, 0
    v_cndmask_b32 v96, v96, 0, s[44:45]
    v_cndmask_b32 v97, v97, 0, s[44:45]
    v_mov_b64 v[98:99], 0
    v_mov_b64 v[106:107], 0
    v_and_b32 v13, 31, v12
    v_lshrrev_b32 v14, 5, v12
    v_mov_b32 v4, v0
    v_mul_u32_u24 v3, 2560, v14
    v_lshl_add_u32 v3, v13, 3, v3
    v_add_u32 v3, 40960, v3
    s_mul_i32 s30, s12, 2048
    v_add_u32 v6, s30, v0
    v_add_u32 v7, 1024, v6
    s_mov_b32 s40, 0xc0135761
    s_mov_b32 s41, 0xbdd2d3e8
    s_mov_b32 s42, 0x3acccccd
    s_mov_b32 s43, 0x3727c5ac
    s_mov_b32 s23, 0
    v_mov_b32 v16, 128
P_73:
    global_load_dword v17, v16, s[90:91] sc1
    s_waitcnt vmcnt(0)
    v_readfirstlane_b32 s85, v17
    s_and_b32 s86, s85, 255
    s_cmp_ge_u32 s86, 70
    s_cbranch_scc1 P_74
    s_add_u32 s23, s23, 1
    s_cmp_gt_u32 s23, 65536
    s_cbranch_scc1 L_exit
    s_sleep 16
    s_branch P_73
P_74:
    s_lshr_b32 s85, s85, 8
    s_mov_b32 s80, 0
RM1_job:
    s_mul_i32 s18, s14, 41943040
    s_add_u32 s18, s18, 175112192
    s_mul_i32 s19, s14, 41943040
    s_add_u32 s19, s19, 184590336
    s_mul_i32 s20, s14, 393216
    s_add_u32 s20, s20, 167936000
    s_mul_i32 s21, s14, 393216
    s_add_u32 s21, s21, 167968768
    s_lshl_b32 s30, s13, 2
    s_add_u32 s30, s30, s12
    s_lshl_b32 s31, s30, 7
    s_add_u32 s21, s21, s31
    s_add_u32 s27, s20, s31
    s_lshl_b32 s31, s30, 8
    s_add_u32 s28, s19, s31
    s_add_u32 s28, s28, 40960
    s_lshl_b32 s32, s30, 11
    s_mul_i32 s31, s12, 20
    s_and_b32 s31, s31, -4
    s_lshl_b32 s31, s31, 5
    s_add_u32 s20, s20, s31
    s_mov_b32 s25, 0
    s_mov_b32 s16, 0
    s_mov_b32 s17, 1
    s_mov_b32 s46, 64
    s_lshl_b32 s33, s13, 13
    s_mul_i32 s36, s14, 41943040
    s_add_u32 s36, s36, 178257920
    s_add_u32 s19, s19, s33
    s_add_u32 s36, s36, s33
    s_mov_b32 s22, 0
    s_mov_b32 s47, 0
    s_mov_b32 s26, 0
    s_mov_b32 s24, 0
    s_mov_b32 s81, 0
    s_cmp_eq_u32 s14, 0
    s_cselect_b32 s30, 4, 3
    s_lshr_b32 s30, s85, s30
    s_and_b32 s30, s30, 1
    s_lshl_b32 s30, s30, 13
    s_andn2_b32 s20, s20, 0x2000
    s_or_b32 s20, s20, s30
    s_lshr_b32 s30, s85, 4
    s_and_b32 s30, s30, 1
    s_lshl_b32 s30, s30, 13
    s_andn2_b32 s21, s21, 0x2000
    s_or_b32 s21, s21, s30
    s_sub_u32 s46, 64, s14
    s_cmp_eq_u32 s80, 0
    s_cbranch_scc1 G_75
    s_mov_b32 s16, 63
    s_mov_b32 s46, 64
    s_mov_b32 s47, 63
    s_sub_u32 s21, s21, 393216
    s_lshr_b32 s30, s85, 4
    s_and_b32 s30, s30, 1
    s_lshl_b32 s30, s30, 13
    s_andn2_b32 s21, s21, 0x2000
    s_or_b32 s21, s21, s30
    s_sub_u32 s20, s20, 393216
    s_mov_b32 s81, 1
    s_lshr_b32 s30, s85, 4
    s_and_b32 s30, s30, 1
    s_lshl_b32 s30, s30, 13
    s_andn2_b32 s20, s20, 0x2000
    s_or_b32 s20, s20, s30
G_75:
    s_barrier
    v_min_u32 v20, 16, v5
    v_lshlrev_b32 v20, 5, v20
.p2align 6
RM1_loop:
    s_cmp_eq_u32 s22, 1
    s_cbranch_scc1 G_76
    s_cmp_eq_u32 s22, 2
    s_cbranch_scc1 G_78
RM1_poll:
    s_and_b32 s31, s16, s25
    s_lshl_b32 s31, s31, 15
    s_add_u32 s31, s31, s20
    s_add_u32 s37, s16, 1
    s_min_u32 s37, s37, 64
    s_add_u32 s37, s37, s81
    v_mbcnt_lo_u32_b32 v16, -1, 0
    v_min_u32 v16, 4, v16
    v_lshlrev_b32 v16, 7, v16
    s_mov_b32 s23, 0
    s_mov_b64 exec, 0xffffffff
P_79:
    buffer_load_dword v17, v16, s[4:7], s31 offen sc1
    s_waitcnt vmcnt(0)
    v_cmp_gt_u32 vcc, s37, v17
    s_cbranch_vccz P_80
    s_add_u32 s23, s23, 1
    s_cmp_gt_u32 s23, 65536
    s_cbranch_scc1 L_exit
    s_sleep 1
    s_branch P_79
P_80:
    s_mov_b64 exec, -1
RM1_dma:
    s_mul_i32 s38, s16, 49152
    s_add_u32 s38, s38, s18
    s_mov_b32 s39, s24
    s_mul_i32 s30, s12, 1280
    s_add_u32 s30, s30, 40960
    s_add_u32 m0, s30, s39
    s_add_u32 s30, s30, s38
    buffer_load_dwordx4 v0, s[4:7], s30 offen sc1 lds
    buffer_load_dword v5, s[4:7], s30 offen offset:1024 sc1 lds
    s_mul_i32 s30, s12, 10240
    s_add_u32 s38, s38, s30
    s_add_u32 s39, s39, s30
    s_mov_b32 m0, s39
    s_nop 0
    buffer_load_dwordx4 v4, s[4:7], s38 offen offset:0 sc1 lds
    buffer_load_dwordx4 v4, s[4:7], s38 offen offset:1024 sc1 lds
    buffer_load_dwordx4 v4, s[4:7], s38 offen offset:2048 sc1 lds
    buffer_load_dwordx4 v4, s[4:7], s38 offen offset:3072 sc1 lds
    s_add_u32 s38, s38, 4096
    s_add_u32 s39, s39, 4096
    s_mov_b32 m0, s39
    s_nop 0
    buffer_load_dwordx4 v4, s[4:7], s38 offen offset:0 sc1 lds
    buffer_load_dwordx4 v4, s[4:7], s38 offen offset:1024 sc1 lds
    buffer_load_dwordx4 v4, s[4:7], s38 offen offset:2048 sc1 lds
    buffer_load_dwordx4 v4, s[4:7], s38 offen offset:3072 sc1 lds
    s_add_u32 s38, s38, 4096
    s_add_u32 s39, s39, 4096
    s_mov_b32 m0, s39
    s_nop 0
    buffer_load_dwordx4 v4, s[4:7], s38 offen offset:0 sc1 lds
    buffer_load_dwordx4 v4, s[4:7], s38 offen offset:1024 sc1 lds
G_78:
    s_waitcnt vmcnt(7)
    s_branch G_77
G_76:
    s_waitcnt vmcnt(3)
G_77:
    v_add_u32 v1, s24, v0
    v_add_u32 v2, 0x10000, v1
    v_add_u32 v9, s24, v3
    s_add_u32 s29, s16, s17
    s_cmp_eq_u32 s22, 1
    s_cselect_b64 vcc, -1, 0
    s_barrier
    ds_read_b128 v[24:27], v1 offset:0
    ds_read_b128 v[28:31], v1 offset:10240
    ds_read_b128 v[32:35], v1 offset:20480
    ds_read_b128 v[36:39], v1 offset:30720
    ds_read_b128 v[40:43], v1 offset:1024
    s_and_b32 s31, s29, s25
    s_lshl_b32 s31, s31, 15
    s_add_u32 s31, s31, s20
    s_add_u32 s37, s29, 1
    s_min_u32 s37, s37, 64
    s_add_u32 s37, s37, s81
    s_mov_b32 s62, s31
    s_waitcnt lgkmcnt(4)
    v_mfma_f32_32x32x16_bf16 v[48:63], a[96:99], v[24:27], 0
    ds_read_b128 v[44:47], v1 offset:11264
    s_sub_u32 s31, s62, 0
    s_mov_b32 s32, s22
    s_cmp_eq_u32 s22, 0
    s_cbranch_scc1 G_83
    buffer_load_dword v21, v20, s[4:7], s31 offen sc1
G_83:
    ds_read_b64 v[64:65], v9 offset:0
    ds_read_b64 v[66:67], v9 offset:256
    ds_read_b64 v[68:69], v9 offset:512
    s_waitcnt lgkmcnt(7)
    v_mfma_f32_32x32x16_bf16 v[48:63], a[136:139], v[28:31], v[48:63]
    ds_read_b128 v[24:27], v1 offset:21504
    ds_read_b64 v[70:71], v9 offset:768
    s_waitcnt lgkmcnt(4)
    v_mov_b32 v16, v64
    v_mov_b32 v17, v65
    v_mfma_f32_32x32x16_bf16 v[48:63], a[176:179], v[32:35], v[48:63]
    ds_read_b128 v[28:31], v1 offset:31744
    s_waitcnt lgkmcnt(4)
    v_mov_b32 v18, v66
    v_mov_b32 v19, v67
    s_waitcnt lgkmcnt(3)
    v_add_f32 v16, v16, v68
    v_mfma_f32_32x32x16_bf16 v[48:63], a[216:219], v[36:39], v[48:63]
    ds_read_b128 v[32:35], v1 offset:2048
    v_add_f32 v17, v17, v69
    s_waitcnt lgkmcnt(2)
    v_add_f32 v18, v18, v70
    v_add_f32 v19, v19, v71
    v_mfma_f32_32x32x16_bf16 v[48:63], a[100:103], v[40:43], v[48:63]
    ds_read_b128 v[36:39], v1 offset:12288
    ds_read_b64 v[64:65], v9 offset:1024
    ds_read_b64 v[66:67], v9 offset:1280
    ds_read_b64 v[68:69], v9 offset:1536
    v_mfma_f32_32x32x16_bf16 v[48:63], a[140:143], v[44:47], v[48:63]
    ds_read_b128 v[40:43], v1 offset:22528
    ds_read_b64 v[70:71], v9 offset:1792
    s_waitcnt lgkmcnt(4)
    v_add_f32 v16, v16, v64
    v_add_f32 v17, v17, v65
    v_mfma_f32_32x32x16_bf16 v[48:63], a[180:183], v[24:27], v[48:63]
    ds_read_b128 v[44:47], v1 offset:32768
    s_waitcnt lgkmcnt(4)
    v_add_f32 v18, v18, v66
    v_add_f32 v19, v19, v67
    s_waitcnt lgkmcnt(3)
    v_add_f32 v16, v16, v68
    v_mfma_f32_32x32x16_bf16 v[48:63], a[220:223], v[28:31], v[48:63]
    s_cbranch_vccnz G_84
    s_waitcnt vmcnt(4)
G_84:
    s_barrier
    ds_read_b128 v[24:27], v1 offset:3072
    v_add_f32 v17, v17, v69
    s_waitcnt lgkmcnt(2)
    v_add_f32 v18, v18, v70
    v_add_f32 v19, v19, v71
    v_mfma_f32_32x32x16_bf16 v[48:63], a[104:107], v[32:35], v[48:63]
    ds_read_b128 v[28:31], v1 offset:13312
    ds_read_b64 v[64:65], v9 offset:2048
    ds_read_b64 v[66:67], v9 offset:2304
    s_waitcnt lgkmcnt(1)
    v_add_f32 v16, v16, v64
    v_mfma_f32_32x32x16_bf16 v[48:63], a[144:147], v[36:39], v[48:63]
    ds_read_b128 v[32:35], v1 offset:23552
    v_add_f32 v17, v17, v65
    s_waitcnt lgkmcnt(1)
    v_add_f32 v18, v18, v66
    v_add_f32 v19, v19, v67
    v_mfma_f32_32x32x16_bf16 v[48:63], a[184:187], v[40:43], v[48:63]
    ds_read_b128 v[36:39], v1 offset:33792
    v_add_f32 v16, v16, v18
    v_add_f32 v17, v17, v19
    v_mov_b32 v18, v16
    v_mfma_f32_32x32x16_bf16 v[48:63], a[224:227], v[44:47], v[48:63]
    ds_read_b128 v[40:43], v1 offset:4096
    v_mov_b32 v19, v17
    s_nop 1
    v_permlane32_swap_b32 v16, v18
    v_mfma_f32_32x32x16_bf16 v[48:63], a[108:111], v[24:27], v[48:63]
    ds_read_b128 v[44:47], v1 offset:14336
    v_permlane32_swap_b32 v17, v19
    v_add_f32 v16, v16, v18
    v_add_f32 v17, v17, v19
    v_mfma_f32_32x32x16_bf16 v[48:63], a[148:151], v[28:31], v[48:63]
    ds_read_b128 v[24:27], v1 offset:24576
    v_mul_f32 v12, s42, v16
    v_mul_f32 v15, s42, v17
    v_sub_f32 v16, 0, v12
    s_cmp_lg_u32 s26, 0
    s_cbranch_scc1 G_81
G_82:
    s_waitcnt lgkmcnt(4)
    v_mfma_f32_32x32x16_bf16 v[48:63], a[188:191], v[32:35], v[48:63]
    ds_read_b128 v[28:31], v1 offset:34816
    v_cvt_pk_bf16_f32 v105, v16, v16
    v_fma_f32 v15, -v12, v12, v15
    v_and_b32 v17, 0xffff0000, v105
    s_waitcnt lgkmcnt(4)
    v_mfma_f32_32x32x16_bf16 v[48:63], a[228:231], v[36:39], v[48:63]
    ds_read_b128 v[32:35], v1 offset:5120
    v_max_f32 v15, 0, v15
    v_sub_f32 v16, v16, v17
    v_add_f32 v18, s43, v15
    s_waitcnt lgkmcnt(4)
    v_mfma_f32_32x32x16_bf16 v[48:63], a[112:115], v[40:43], v[48:63]
    ds_read_b128 v[36:39], v1 offset:15360
    v_cvt_pk_bf16_f32 v104, v17, v16
    v_rsq_f32 v13, v18
    s_nop 0
    s_waitcnt lgkmcnt(4)
    v_mfma_f32_32x32x16_bf16 v[48:63], a[152:155], v[44:47], v[48:63]
    ds_read_b128 v[40:43], v1 offset:25600
    v_mul_f32 v16, v13, v13
    v_fma_f32 v16, v16, v15, s43
    v_rsq_f32 v16, v16
    s_waitcnt lgkmcnt(4)
    v_mfma_f32_32x32x16_bf16 v[48:63], a[192:195], v[24:27], v[48:63]
    ds_read_b128 v[44:47], v1 offset:35840
    s_nop 0
    v_mul_f32 v14, v16, v13
    v_mfma_f32_32x32x16_bf16 v[48:63], v[96:99], v[104:107], v[48:63]
    s_waitcnt lgkmcnt(4)
    v_mfma_f32_32x32x16_bf16 v[48:63], a[232:235], v[28:31], v[48:63]
    s_cbranch_vccnz G_85
    s_waitcnt vmcnt(0)
G_85:
    s_barrier
    ds_read_b128 v[24:27], v1 offset:6144
    s_waitcnt lgkmcnt(4)
    v_mfma_f32_32x32x16_bf16 v[48:63], a[116:119], v[32:35], v[48:63]
    ds_read_b128 v[28:31], v1 offset:16384
    s_waitcnt lgkmcnt(4)
    v_mfma_f32_32x32x16_bf16 v[48:63], a[156:159], v[36:39], v[48:63]
    ds_read_b128 v[32:35], v1 offset:26624
    s_waitcnt lgkmcnt(4)
    v_mfma_f32_32x32x16_bf16 v[48:63], a[196:199], v[40:43], v[48:63]
    ds_read_b128 v[36:39], v1 offset:36864
    s_waitcnt lgkmcnt(4)
    v_mfma_f32_32x32x16_bf16 v[48:63], a[236:239], v[44:47], v[48:63]
    ds_read_b128 v[40:43], v1 offset:7168
    s_cmp_lg_u32 s32, 0
    s_cbranch_scc1 G_87
G_88:
    s_waitcnt lgkmcnt(4)
    v_mfma_f32_32x32x16_bf16 v[48:63], a[120:123], v[24:27], v[48:63]
    ds_read_b128 v[44:47], v1 offset:17408
    s_waitcnt lgkmcnt(4)
    v_mfma_f32_32x32x16_bf16 v[48:63], a[160:163], v[28:31], v[48:63]
    ds_read_b128 v[24:27], v1 offset:27648
    s_waitcnt lgkmcnt(4)
    v_mfma_f32_32x32x16_bf16 v[48:63], a[200:203], v[32:35], v[48:63]
    ds_read_b128 v[28:31], v1 offset:37888
    s_waitcnt lgkmcnt(4)
    v_mfma_f32_32x32x16_bf16 v[48:63], a[240:243], v[36:39], v[48:63]
    ds_read_b128 v[32:35], v1 offset:8192
    s_waitcnt lgkmcnt(4)
    v_mfma_f32_32x32x16_bf16 v[48:63], a[124:127], v[40:43], v[48:63]
    ds_read_b128 v[36:39], v1 offset:18432
    s_waitcnt lgkmcnt(4)
    v_mfma_f32_32x32x16_bf16 v[48:63], a[164:167], v[44:47], v[48:63]
    ds_read_b128 v[40:43], v1 offset:28672
    s_waitcnt lgkmcnt(4)
    v_mfma_f32_32x32x16_bf16 v[48:63], a[204:207], v[24:27], v[48:63]
    ds_read_b128 v[44:47], v1 offset:38912
    s_waitcnt lgkmcnt(4)
    v_mfma_f32_32x32x16_bf16 v[48:63], a[244:247], v[28:31], v[48:63]
    ds_read_b128 v[24:27], v1 offset:9216
    s_waitcnt lgkmcnt(4)
    v_mfma_f32_32x32x16_bf16 v[48:63], a[128:131], v[32:35], v[48:63]
    ds_read_b128 v[28:31], v1 offset:19456
    s_waitcnt lgkmcnt(4)
    v_mfma_f32_32x32x16_bf16 v[48:63], a[168:171], v[36:39], v[48:63]
    ds_read_b128 v[32:35], v1 offset:29696
    s_waitcnt lgkmcnt(4)
    v_mfma_f32_32x32x16_bf16 v[48:63], a[208:211], v[40:43], v[48:63]
    ds_read_b128 v[36:39], v1 offset:39936
    s_waitcnt lgkmcnt(4)
    v_mfma_f32_32x32x16_bf16 v[48:63], a[248:251], v[44:47], v[48:63]
    s_waitcnt lgkmcnt(3)
    v_mfma_f32_32x32x16_bf16 v[48:63], a[132:135], v[24:27], v[48:63]
    s_waitcnt lgkmcnt(2)
    v_mfma_f32_32x32x16_bf16 v[48:63], a[172:175], v[28:31], v[48:63]
    s_waitcnt lgkmcnt(1)
    v_mfma_f32_32x32x16_bf16 v[48:63], a[212:215], v[32:35], v[48:63]
    s_waitcnt lgkmcnt(0)
    v_mfma_f32_32x32x16_bf16 v[48:63], a[252:255], v[36:39], v[48:63]
    s_branch G_89
G_81:
    s_waitcnt vmcnt(1)
    s_sub_u32 s63, s26, s47
    s_mov_b32 s47, s26
    s_atomic_add s63, s[4:5], s21
    s_mov_b32 s26, 0
    s_branch G_82
G_87:
    s_waitcnt vmcnt(0)
    v_cmp_gt_u32 vcc, s37, v21
    s_sub_u32 s33, 46080, s24
    s_mov_b32 s22, 0
    s_cbranch_vccnz G_88
    s_cmp_ge_u32 s29, s46
    s_cbranch_scc1 G_88
    s_mov_b32 s22, 1
    s_waitcnt lgkmcnt(4)
    v_mfma_f32_32x32x16_bf16 v[48:63], a[120:123], v[24:27], v[48:63]
    ds_read_b128 v[44:47], v1 offset:17408
    s_mul_i32 s38, s29, 49152
    s_add_u32 s38, s38, s18
    s_mov_b32 s39, s33
    s_mul_i32 s30, s12, 1280
    s_add_u32 s30, s30, 40960
    s_add_u32 m0, s30, s39
    s_add_u32 s30, s30, s38
    buffer_load_dwordx4 v0, s[4:7], s30 offen sc1 lds
    buffer_load_dword v5, s[4:7], s30 offen offset:1024 sc1 lds
    s_waitcnt lgkmcnt(4)
    v_mfma_f32_32x32x16_bf16 v[48:63], a[160:163], v[28:31], v[48:63]
    ds_read_b128 v[24:27], v1 offset:27648
    s_mul_i32 s30, s12, 10240
    s_add_u32 s38, s38, s30
    s_add_u32 s39, s39, s30
    s_mov_b32 m0, s39
    s_nop 0
    buffer_load_dwordx4 v4, s[4:7], s38 offen offset:0 sc1 lds
    s_waitcnt lgkmcnt(4)
    v_mfma_f32_32x32x16_bf16 v[48:63], a[200:203], v[32:35], v[48:63]
    ds_read_b128 v[28:31], v1 offset:37888
    buffer_load_dwordx4 v4, s[4:7], s38 offen offset:1024 sc1 lds
    s_waitcnt lgkmcnt(4)
    v_mfma_f32_32x32x16_bf16 v[48:63], a[240:243], v[36:39], v[48:63]
    ds_read_b128 v[32:35], v1 offset:8192
    buffer_load_dwordx4 v4, s[4:7], s38 offen offset:2048 sc1 lds
    s_waitcnt lgkmcnt(4)
    v_mfma_f32_32x32x16_bf16 v[48:63], a[124:127], v[40:43], v[48:63]
    ds_read_b128 v[36:39], v1 offset:18432
    buffer_load_dwordx4 v4, s[4:7], s38 offen offset:3072 sc1 lds
    s_waitcnt lgkmcnt(4)
    v_mfma_f32_32x32x16_bf16 v[48:63], a[164:167], v[44:47], v[48:63]
    ds_read_b128 v[40:43], v1 offset:28672
    s_add_u32 s38, s38, 4096
    s_add_u32 s39, s39, 4096
    s_mov_b32 m0, s39
    s_nop 0
    buffer_load_dwordx4 v4, s[4:7], s38 offen offset:0 sc1 lds
    s_waitcnt lgkmcnt(4)
    v_mfma_f32_32x32x16_bf16 v[48:63], a[204:207], v[24:27], v[48:63]
    ds_read_b128 v[44:47], v1 offset:38912
    buffer_load_dwordx4 v4, s[4:7], s38 offen offset:1024 sc1 lds
    s_waitcnt lgkmcnt(4)
    v_mfma_f32_32x32x16_bf16 v[48:63], a[244:247], v[28:31], v[48:63]
    ds_read_b128 v[24:27], v1 offset:9216
    buffer_load_dwordx4 v4, s[4:7], s38 offen offset:2048 sc1 lds
    s_waitcnt lgkmcnt(4)
    v_mfma_f32_32x32x16_bf16 v[48:63], a[128:131], v[32:35], v[48:63]
    ds_read_b128 v[28:31], v1 offset:19456
    buffer_load_dwordx4 v4, s[4:7], s38 offen offset:3072 sc1 lds
    s_waitcnt lgkmcnt(4)
    v_mfma_f32_32x32x16_bf16 v[48:63], a[168:171], v[36:39], v[48:63]
    ds_read_b128 v[32:35], v1 offset:29696
    s_add_u32 s38, s38, 4096
    s_add_u32 s39, s39, 4096
    s_mov_b32 m0, s39
    s_nop 0
    buffer_load_dwordx4 v4, s[4:7], s38 offen offset:0 sc1 lds
    s_waitcnt lgkmcnt(4)
    v_mfma_f32_32x32x16_bf16 v[48:63], a[208:211], v[40:43], v[48:63]
    ds_read_b128 v[36:39], v1 offset:39936
    buffer_load_dwordx4 v4, s[4:7], s38 offen offset:1024 sc1 lds
    s_waitcnt lgkmcnt(4)
    v_mfma_f32_32x32x16_bf16 v[48:63], a[248:251], v[44:47], v[48:63]
    s_waitcnt lgkmcnt(3)
    v_mfma_f32_32x32x16_bf16 v[48:63], a[132:135], v[24:27], v[48:63]
    s_waitcnt lgkmcnt(2)
    v_mfma_f32_32x32x16_bf16 v[48:63], a[172:175], v[28:31], v[48:63]
    s_waitcnt lgkmcnt(1)
    v_mfma_f32_32x32x16_bf16 v[48:63], a[212:215], v[32:35], v[48:63]
    s_waitcnt lgkmcnt(0)
    v_mfma_f32_32x32x16_bf16 v[48:63], a[252:255], v[36:39], v[48:63]
G_89:
    s_cmp_lg_u32 s22, 0
    s_cbranch_scc1 G_90
    s_sub_u32 s31, s62, 0
    buffer_load_dword v21, v20, s[4:7], s31 offen sc1
G_90:
    s_mul_i32 s30, s16, 40960
    s_add_u32 s32, s30, s28
    s_add_u32 s30, s30, s19
    v_mov_b32 v16, v14
    v_mov_b32 v17, v14
    v_mov_b32 v40, s40
    v_mov_b32 v41, s40
    v_mov_b32 v42, s41
    v_mov_b32 v43, s41
    v_mov_b32 v44, 1.0
    v_mov_b32 v45, 1.0
    s_nop 6
    v_pk_mul_f32 v[48:49], v[48:49], v[16:17]
    v_pk_mul_f32 v[50:51], v[50:51], v[16:17]
    v_pk_mul_f32 v[52:53], v[52:53], v[16:17]
    v_pk_mul_f32 v[54:55], v[54:55], v[16:17]
    v_pk_mul_f32 v[24:25], v[48:49], v[48:49]
    v_pk_mul_f32 v[26:27], v[50:51], v[50:51]
    v_pk_mul_f32 v[28:29], v[52:53], v[52:53]
    v_pk_mul_f32 v[30:31], v[54:55], v[54:55]
    v_pk_fma_f32 v[24:25], v[24:25], v[42:43], v[40:41]
    v_pk_fma_f32 v[26:27], v[26:27], v[42:43], v[40:41]
    v_pk_fma_f32 v[28:29], v[28:29], v[42:43], v[40:41]
    v_pk_fma_f32 v[30:31], v[30:31], v[42:43], v[40:41]
    v_pk_mul_f32 v[24:25], v[24:25], v[48:49]
    v_pk_mul_f32 v[26:27], v[26:27], v[50:51]
    v_pk_mul_f32 v[28:29], v[28:29], v[52:53]
    v_pk_mul_f32 v[30:31], v[30:31], v[54:55]
    v_exp_f32 v24, v24
    v_exp_f32 v25, v25
    v_exp_f32 v26, v26
    v_exp_f32 v27, v27
    v_exp_f32 v28, v28
    v_exp_f32 v29, v29
    v_exp_f32 v30, v30
    v_exp_f32 v31, v31
    v_pk_add_f32 v[24:25], v[24:25], v[44:45]
    v_pk_add_f32 v[26:27], v[26:27], v[44:45]
    v_pk_add_f32 v[28:29], v[28:29], v[44:45]
    v_pk_add_f32 v[30:31], v[30:31], v[44:45]
    v_rcp_f32 v24, v24
    v_rcp_f32 v25, v25
    v_rcp_f32 v26, v26
    v_rcp_f32 v27, v27
    v_rcp_f32 v28, v28
    v_rcp_f32 v29, v29
    v_rcp_f32 v30, v30
    v_rcp_f32 v31, v31
    v_pk_mul_f32 v[48:49], v[48:49], v[24:25]
    v_pk_mul_f32 v[50:51], v[50:51], v[26:27]
    v_pk_mul_f32 v[52:53], v[52:53], v[28:29]
    v_pk_mul_f32 v[54:55], v[54:55], v[30:31]
    v_cvt_pk_bf16_f32 v32, v48, v49
    v_cvt_pk_bf16_f32 v33, v50, v51
    v_cvt_pk_bf16_f32 v34, v52, v53
    v_cvt_pk_bf16_f32 v35, v54, v55
    buffer_store_dwordx4 v[32:35], v6, s[4:7], s30 offen sc1
    v_pk_mul_f32 v[56:57], v[56:57], v[16:17]
    v_pk_mul_f32 v[58:59], v[58:59], v[16:17]
    v_pk_mul_f32 v[60:61], v[60:61], v[16:17]
    v_pk_mul_f32 v[62:63], v[62:63], v[16:17]
    v_pk_mul_f32 v[24:25], v[56:57], v[56:57]
    v_pk_mul_f32 v[26:27], v[58:59], v[58:59]
    v_pk_mul_f32 v[28:29], v[60:61], v[60:61]
    v_pk_mul_f32 v[30:31], v[62:63], v[62:63]
    v_pk_fma_f32 v[24:25], v[24:25], v[42:43], v[40:41]
    v_pk_fma_f32 v[26:27], v[26:27], v[42:43], v[40:41]
    v_pk_fma_f32 v[28:29], v[28:29], v[42:43], v[40:41]
    v_pk_fma_f32 v[30:31], v[30:31], v[42:43], v[40:41]
    v_pk_mul_f32 v[24:25], v[24:25], v[56:57]
    v_pk_mul_f32 v[26:27], v[26:27], v[58:59]
    v_pk_mul_f32 v[28:29], v[28:29], v[60:61]
    v_pk_mul_f32 v[30:31], v[30:31], v[62:63]
    v_exp_f32 v24, v24
    v_exp_f32 v25, v25
    v_exp_f32 v26, v26
    v_exp_f32 v27, v27
    v_exp_f32 v28, v28
    v_exp_f32 v29, v29
    v_exp_f32 v30, v30
    v_exp_f32 v31, v31
    v_pk_add_f32 v[24:25], v[24:25], v[44:45]
    v_pk_add_f32 v[26:27], v[26:27], v[44:45]
    v_pk_add_f32 v[28:29], v[28:29], v[44:45]
    v_pk_add_f32 v[30:31], v[30:31], v[44:45]
    v_rcp_f32 v24, v24
    v_rcp_f32 v25, v25
    v_rcp_f32 v26, v26
    v_rcp_f32 v27, v27
    v_rcp_f32 v28, v28
    v_rcp_f32 v29, v29
    v_rcp_f32 v30, v30
    v_rcp_f32 v31, v31
    v_pk_mul_f32 v[56:57], v[56:57], v[24:25]
    v_pk_mul_f32 v[58:59], v[58:59], v[26:27]
    v_pk_mul_f32 v[60:61], v[60:61], v[28:29]
    v_pk_mul_f32 v[62:63], v[62:63], v[30:31]
    v_cvt_pk_bf16_f32 v36, v56, v57
    v_cvt_pk_bf16_f32 v37, v58, v59
    v_cvt_pk_bf16_f32 v38, v60, v61
    v_cvt_pk_bf16_f32 v39, v62, v63
    buffer_store_dwordx4 v[36:39], v7, s[4:7], s30 offen sc1
    v_mov_b32 v16, v13
    v_mul_f32 v17, -v12, v13
    v_lshrrev_b32 v10, 1, v6
    s_mul_i32 s31, s16, 40960
    s_add_u32 s31, s31, s36
    buffer_store_dwordx2 v[16:17], v10, s[4:7], s31 offen sc1
    s_add_u32 s32, s16, 1
    s_sub_u32 s24, 46080, s24
    s_mov_b32 s26, s32
    s_cmp_lg_u32 s22, 0
    s_cbranch_scc1 G_93
    s_mov_b32 s26, 0
    s_waitcnt lgkmcnt(0)
    s_cmp_ge_u32 s29, s46
    s_cbranch_scc1 G_94
    s_waitcnt vmcnt(3)
    v_cmp_gt_u32 vcc, s37, v21
    s_cbranch_vccnz G_91
    s_mov_b32 s22, 2
    s_mul_i32 s38, s29, 49152
    s_add_u32 s38, s38, s18
    s_mov_b32 s39, s24
    s_mul_i32 s30, s12, 1280
    s_add_u32 s30, s30, 40960
    s_add_u32 m0, s30, s39
    s_add_u32 s30, s30, s38
    buffer_load_dwordx4 v0, s[4:7], s30 offen sc1 lds
    buffer_load_dword v5, s[4:7], s30 offen offset:1024 sc1 lds
    s_mul_i32 s30, s12, 10240
    s_add_u32 s38, s38, s30
    s_add_u32 s39, s39, s30
    s_mov_b32 m0, s39
    s_nop 0
    buffer_load_dwordx4 v4, s[4:7], s38 offen offset:0 sc1 lds
    buffer_load_dwordx4 v4, s[4:7], s38 offen offset:1024 sc1 lds
    buffer_load_dwordx4 v4, s[4:7], s38 offen offset:2048 sc1 lds
    buffer_load_dwordx4 v4, s[4:7], s38 offen offset:3072 sc1 lds
    s_add_u32 s38, s38, 4096
    s_add_u32 s39, s39, 4096
    s_mov_b32 m0, s39
    s_nop 0
    buffer_load_dwordx4 v4, s[4:7], s38 offen offset:0 sc1 lds
    buffer_load_dwordx4 v4, s[4:7], s38 offen offset:1024 sc1 lds
    buffer_load_dwordx4 v4, s[4:7], s38 offen offset:2048 sc1 lds
    buffer_load_dwordx4 v4, s[4:7], s38 offen offset:3072 sc1 lds
    s_add_u32 s38, s38, 4096
    s_add_u32 s39, s39, 4096
    s_mov_b32 m0, s39
    s_nop 0
    buffer_load_dwordx4 v4, s[4:7], s38 offen offset:0 sc1 lds
    buffer_load_dwordx4 v4, s[4:7], s38 offen offset:1024 sc1 lds
    s_waitcnt vmcnt(12)
    s_branch G_92
G_91:
    buffer_load_dword v21, v20, s[4:7], s62 offen sc1
    s_waitcnt vmcnt(1)
    s_sub_u32 s63, s32, s47
    s_mov_b32 s47, s32
    s_atomic_add s63, s[4:5], s21
    s_mov_b32 s16, s29
    s_waitcnt vmcnt(0)
    v_cmp_gt_u32 vcc, s37, v21
    s_cbranch_vccnz RM1_poll
    s_mov_b32 s22, 0
    s_branch RM1_dma
G_94:
    s_waitcnt vmcnt(0)
G_92:
    s_sub_u32 s63, s32, s47
    s_mov_b32 s47, s32
    s_atomic_add s63, s[4:5], s21
G_93:
    s_mov_b32 s16, s29
    s_cmp_lt_u32 s16, s46
    s_cbranch_scc1 RM1_loop
RM1_done:
    s_cmp_lg_u32 s14, 0
    s_cbranch_scc1 G_95
    s_mov_b32 s14, 1
    s_mov_b32 s80, 1
    s_branch RM1_job
G_95:
    s_branch L_next
RM2:
    v_mbcnt_lo_u32_b32 v12, -1, 0
    v_mbcnt_hi_u32_b32 v12, -1, v12
    v_lshlrev_b32 v0, 4, v12
    v_lshlrev_b32 v8, 3, v12
    v_lshlrev_b32 v5, 2, v12
    s_mov_b32 s44, 0
    s_mov_b32 s45, -1
    s_barrier
    s_load_dwordx2 s[8:9], s[0:1], 72
    s_mov_b32 s10, 819200
    s_mov_b32 s11, 0x20000
    s_lshl_b32 s32, s13, 8
    s_waitcnt lgkmcnt(0)
    v_lshrrev_b32 v13, 2, v12
    v_and_b32 v14, 3, v12
    s_mov_b32 s30, 1280
    v_mul_lo_u32 v13, v13, s30
    v_lshl_add_u32 v13, v14, 4, v13
    s_mul_i32 s30, s12, 64
    s_add_u32 s30, s30, s32
    v_add_u32 v13, s30, v13
    v_lshrrev_b32 v14, 5, v12
    v_bfe_u32 v15, v12, 2, 2
    v_lshl_add_u32 v15, v14, 3, v15
    v_mul_u32_u24 v15, 64, v15
    v_bfe_u32 v16, v12, 4, 1
    v_lshl_add_u32 v15, v16, 5, v15
    v_and_b32 v16, 1, v12
    v_lshl_add_u32 v15, v16, 4, v15
    v_bfe_u32 v16, v12, 1, 1
    v_lshl_add_u32 v15, v16, 3, v15
    s_mul_i32 s33, s12, 40960
    v_add_u32 v15, s33, v15
    s_add_u32 m0, s33, 0
    s_mov_b32 s30, 0
    buffer_load_dwordx4 v13, s[8:11], s30 offen lds
    s_add_u32 m0, s33, 1024
    s_mov_b32 s30, 20480
    buffer_load_dwordx4 v13, s[8:11], s30 offen lds
    s_add_u32 m0, s33, 2048
    s_mov_b32 s30, 40960
    buffer_load_dwordx4 v13, s[8:11], s30 offen lds
    s_add_u32 m0, s33, 3072
    s_mov_b32 s30, 61440
    buffer_load_dwordx4 v13, s[8:11], s30 offen lds
    s_add_u32 m0, s33, 4096
    s_mov_b32 s30, 81920
    buffer_load_dwordx4 v13, s[8:11], s30 offen lds
    s_add_u32 m0, s33, 5120
    s_mov_b32 s30, 102400
    buffer_load_dwordx4 v13, s[8:11], s30 offen lds
    s_add_u32 m0, s33, 6144
    s_mov_b32 s30, 122880
    buffer_load_dwordx4 v13, s[8:11], s30 offen lds
    s_add_u32 m0, s33, 7168
    s_mov_b32 s30, 143360
    buffer_load_dwordx4 v13, s[8:11], s30 offen lds
    s_add_u32 m0, s33, 8192
    s_mov_b32 s30, 163840
    buffer_load_dwordx4 v13, s[8:11], s30 offen lds
    s_add_u32 m0, s33, 9216
    s_mov_b32 s30, 184320
    buffer_load_dwordx4 v13, s[8:11], s30 offen lds
    s_add_u32 m0, s33, 10240
    s_mov_b32 s30, 204800
    buffer_load_dwordx4 v13, s[8:11], s30 offen lds
    s_add_u32 m0, s33, 11264
    s_mov_b32 s30, 225280
    buffer_load_dwordx4 v13, s[8:11], s30 offen lds
    s_add_u32 m0, s33, 12288
    s_mov_b32 s30, 245760
    buffer_load_dwordx4 v13, s[8:11], s30 offen lds
    s_add_u32 m0, s33, 13312
    s_mov_b32 s30, 266240
    buffer_load_dwordx4 v13, s[8:11], s30 offen lds
    s_add_u32 m0, s33, 14336
    s_mov_b32 s30, 286720
    buffer_load_dwordx4 v13, s[8:11], s30 offen lds
    s_add_u32 m0, s33, 15360
    s_mov_b32 s30, 307200
    buffer_load_dwordx4 v13, s[8:11], s30 offen lds
    s_add_u32 m0, s33, 16384
    s_mov_b32 s30, 327680
    buffer_load_dwordx4 v13, s[8:11], s30 offen lds
    s_add_u32 m0, s33, 17408
    s_mov_b32 s30, 348160
    buffer_load_dwordx4 v13, s[8:11], s30 offen lds
    s_add_u32 m0, s33, 18432
    s_mov_b32 s30, 368640
    buffer_load_dwordx4 v13, s[8:11], s30 offen lds
    s_add_u32 m0, s33, 19456
    s_mov_b32 s30, 389120
    buffer_load_dwordx4 v13, s[8:11], s30 offen lds
    s_add_u32 m0, s33, 20480
    s_mov_b32 s30, 409600
    buffer_load_dwordx4 v13, s[8:11], s30 offen lds
    s_add_u32 m0, s33, 21504
    s_mov_b32 s30, 430080
    buffer_load_dwordx4 v13, s[8:11], s30 offen lds
    s_add_u32 m0, s33, 22528
    s_mov_b32 s30, 450560
    buffer_load_dwordx4 v13, s[8:11], s30 offen lds
    s_add_u32 m0, s33, 23552
    s_mov_b32 s30, 471040
    buffer_load_dwordx4 v13, s[8:11], s30 offen lds
    s_add_u32 m0, s33, 24576
    s_mov_b32 s30, 491520
    buffer_load_dwordx4 v13, s[8:11], s30 offen lds
    s_add_u32 m0, s33, 25600
    s_mov_b32 s30, 512000
    buffer_load_dwordx4 v13, s[8:11], s30 offen lds
    s_add_u32 m0, s33, 26624
    s_mov_b32 s30, 532480
    buffer_load_dwordx4 v13, s[8:11], s30 offen lds
    s_add_u32 m0, s33, 27648
    s_mov_b32 s30, 552960
    buffer_load_dwordx4 v13, s[8:11], s30 offen lds
    s_add_u32 m0, s33, 28672
    s_mov_b32 s30, 573440
    buffer_load_dwordx4 v13, s[8:11], s30 offen lds
    s_add_u32 m0, s33, 29696
    s_mov_b32 s30, 593920
    buffer_load_dwordx4 v13, s[8:11], s30 offen lds
    s_add_u32 m0, s33, 30720
    s_mov_b32 s30, 614400
    buffer_load_dwordx4 v13, s[8:11], s30 offen lds
    s_add_u32 m0, s33, 31744
    s_mov_b32 s30, 634880
    buffer_load_dwordx4 v13, s[8:11], s30 offen lds
    s_add_u32 m0, s33, 32768
    s_mov_b32 s30, 655360
    buffer_load_dwordx4 v13, s[8:11], s30 offen lds
    s_add_u32 m0, s33, 33792
    s_mov_b32 s30, 675840
    buffer_load_dwordx4 v13, s[8:11], s30 offen lds
    s_add_u32 m0, s33, 34816
    s_mov_b32 s30, 696320
    buffer_load_dwordx4 v13, s[8:11], s30 offen lds
    s_add_u32 m0, s33, 35840
    s_mov_b32 s30, 716800
    buffer_load_dwordx4 v13, s[8:11], s30 offen lds
    s_waitcnt vmcnt(35)
    ds_read_b64_tr_b16 a[96:97], v15 offset:0
    ds_read_b64_tr_b16 a[98:99], v15 offset:256
    s_add_u32 m0, s33, 36864
    s_mov_b32 s30, 737280
    buffer_load_dwordx4 v13, s[8:11], s30 offen lds
    s_waitcnt vmcnt(35)
    ds_read_b64_tr_b16 a[100:101], v15 offset:1024
    ds_read_b64_tr_b16 a[102:103], v15 offset:1280
    s_add_u32 m0, s33, 37888
    s_mov_b32 s30, 757760
    buffer_load_dwordx4 v13, s[8:11], s30 offen lds
    s_waitcnt vmcnt(35)
    ds_read_b64_tr_b16 a[104:105], v15 offset:2048
    ds_read_b64_tr_b16 a[106:107], v15 offset:2304
    s_add_u32 m0, s33, 38912
    s_mov_b32 s30, 778240
    buffer_load_dwordx4 v13, s[8:11], s30 offen lds
    s_waitcnt vmcnt(35)
    ds_read_b64_tr_b16 a[108:109], v15 offset:3072
    ds_read_b64_tr_b16 a[110:111], v15 offset:3328
    s_add_u32 m0, s33, 39936
    s_mov_b32 s30, 798720
    buffer_load_dwordx4 v13, s[8:11], s30 offen lds
    s_waitcnt vmcnt(35)
    ds_read_b64_tr_b16 a[112:113], v15 offset:4096
    ds_read_b64_tr_b16 a[114:115], v15 offset:4352
    s_waitcnt vmcnt(34)
    ds_read_b64_tr_b16 a[116:117], v15 offset:5120
    ds_read_b64_tr_b16 a[118:119], v15 offset:5376
    s_waitcnt vmcnt(33)
    ds_read_b64_tr_b16 a[120:121], v15 offset:6144
    ds_read_b64_tr_b16 a[122:123], v15 offset:6400
    s_waitcnt vmcnt(32)
    ds_read_b64_tr_b16 a[124:125], v15 offset:7168
    ds_read_b64_tr_b16 a[126:127], v15 offset:7424
    s_waitcnt vmcnt(31)
    ds_read_b64_tr_b16 a[128:129], v15 offset:8192
    ds_read_b64_tr_b16 a[130:131], v15 offset:8448
    s_waitcnt vmcnt(30)
    ds_read_b64_tr_b16 a[132:133], v15 offset:9216
    ds_read_b64_tr_b16 a[134:135], v15 offset:9472
    s_waitcnt vmcnt(29)
    ds_read_b64_tr_b16 a[136:137], v15 offset:10240
    ds_read_b64_tr_b16 a[138:139], v15 offset:10496
    s_waitcnt vmcnt(28)
    ds_read_b64_tr_b16 a[140:141], v15 offset:11264
    ds_read_b64_tr_b16 a[142:143], v15 offset:11520
    s_waitcnt vmcnt(27)
    ds_read_b64_tr_b16 a[144:145], v15 offset:12288
    ds_read_b64_tr_b16 a[146:147], v15 offset:12544
    s_waitcnt vmcnt(26)
    ds_read_b64_tr_b16 a[148:149], v15 offset:13312
    ds_read_b64_tr_b16 a[150:151], v15 offset:13568
    s_waitcnt vmcnt(25)
    ds_read_b64_tr_b16 a[152:153], v15 offset:14336
    ds_read_b64_tr_b16 a[154:155], v15 offset:14592
    s_waitcnt vmcnt(24)
    ds_read_b64_tr_b16 a[156:157], v15 offset:15360
    ds_read_b64_tr_b16 a[158:159], v15 offset:15616
    s_waitcnt vmcnt(23)
    ds_read_b64_tr_b16 a[160:161], v15 offset:16384
    ds_read_b64_tr_b16 a[162:163], v15 offset:16640
    s_waitcnt vmcnt(22)
    ds_read_b64_tr_b16 a[164:165], v15 offset:17408
    ds_read_b64_tr_b16 a[166:167], v15 offset:17664
    s_waitcnt vmcnt(21)
    ds_read_b64_tr_b16 a[168:169], v15 offset:18432
    ds_read_b64_tr_b16 a[170:171], v15 offset:18688
    s_waitcnt vmcnt(20)
    ds_read_b64_tr_b16 a[172:173], v15 offset:19456
    ds_read_b64_tr_b16 a[174:175], v15 offset:19712
    s_waitcnt vmcnt(19)
    ds_read_b64_tr_b16 a[176:177], v15 offset:20480
    ds_read_b64_tr_b16 a[178:179], v15 offset:20736
    s_waitcnt vmcnt(18)
    ds_read_b64_tr_b16 a[180:181], v15 offset:21504
    ds_read_b64_tr_b16 a[182:183], v15 offset:21760
    s_waitcnt vmcnt(17)
    ds_read_b64_tr_b16 a[184:185], v15 offset:22528
    ds_read_b64_tr_b16 a[186:187], v15 offset:22784
    s_waitcnt vmcnt(16)
    ds_read_b64_tr_b16 a[188:189], v15 offset:23552
    ds_read_b64_tr_b16 a[190:191], v15 offset:23808
    s_waitcnt vmcnt(15)
    ds_read_b64_tr_b16 a[192:193], v15 offset:24576
    ds_read_b64_tr_b16 a[194:195], v15 offset:24832
    s_waitcnt vmcnt(14)
    ds_read_b64_tr_b16 a[196:197], v15 offset:25600
    ds_read_b64_tr_b16 a[198:199], v15 offset:25856
    s_waitcnt vmcnt(13)
    ds_read_b64_tr_b16 a[200:201], v15 offset:26624
    ds_read_b64_tr_b16 a[202:203], v15 offset:26880
    s_waitcnt vmcnt(12)
    ds_read_b64_tr_b16 a[204:205], v15 offset:27648
    ds_read_b64_tr_b16 a[206:207], v15 offset:27904
    s_waitcnt vmcnt(11)
    ds_read_b64_tr_b16 a[208:209], v15 offset:28672
    ds_read_b64_tr_b16 a[210:211], v15 offset:28928
    s_waitcnt vmcnt(10)
    ds_read_b64_tr_b16 a[212:213], v15 offset:29696
    ds_read_b64_tr_b16 a[214:215], v15 offset:29952
    s_waitcnt vmcnt(9)
    ds_read_b64_tr_b16 a[216:217], v15 offset:30720
    ds_read_b64_tr_b16 a[218:219], v15 offset:30976
    s_waitcnt vmcnt(8)
    ds_read_b64_tr_b16 a[220:221], v15 offset:31744
    ds_read_b64_tr_b16 a[222:223], v15 offset:32000
    s_waitcnt vmcnt(7)
    ds_read_b64_tr_b16 a[224:225], v15 offset:32768
    ds_read_b64_tr_b16 a[226:227], v15 offset:33024
    s_waitcnt vmcnt(6)
    ds_read_b64_tr_b16 a[228:229], v15 offset:33792
    ds_read_b64_tr_b16 a[230:231], v15 offset:34048
    s_waitcnt vmcnt(5)
    ds_read_b64_tr_b16 a[232:233], v15 offset:34816
    ds_read_b64_tr_b16 a[234:235], v15 offset:35072
    s_waitcnt vmcnt(4)
    ds_read_b64_tr_b16 a[236:237], v15 offset:35840
    ds_read_b64_tr_b16 a[238:239], v15 offset:36096
    s_waitcnt vmcnt(3)
    ds_read_b64_tr_b16 a[240:241], v15 offset:36864
    ds_read_b64_tr_b16 a[242:243], v15 offset:37120
    s_waitcnt vmcnt(2)
    ds_read_b64_tr_b16 a[244:245], v15 offset:37888
    ds_read_b64_tr_b16 a[246:247], v15 offset:38144
    s_waitcnt vmcnt(1)
    ds_read_b64_tr_b16 a[248:249], v15 offset:38912
    ds_read_b64_tr_b16 a[250:251], v15 offset:39168
    s_waitcnt vmcnt(0)
    ds_read_b64_tr_b16 a[252:253], v15 offset:39936
    ds_read_b64_tr_b16 a[254:255], v15 offset:40192
    s_waitcnt lgkmcnt(0)
    v_and_b32 v13, 31, v12
    v_lshrrev_b32 v14, 5, v12
    s_lshr_b32 s30, s12, 1
    s_add_u32 s30, s30, 1
    s_sub_u32 s31, 0, s30
    s_bitcmp1_b32 s12, 0
    s_cselect_b32 s30, s30, s31
    s_add_u32 s30, s30, 32
    v_add_u32 v15, s30, v13
    v_lshrrev_b32 v16, 5, v15
    v_mul_u32_u24 v16, 40960, v16
    v_and_b32 v15, 31, v15
    v_lshl_add_u32 v15, v14, 5, v15
    v_lshl_add_u32 v4, v15, 4, v16
    v_mul_u32_u24 v3, 2560, v14
    v_lshl_add_u32 v3, v13, 3, v3
    v_add_u32 v3, 40960, v3
    s_mul_i32 s30, s12, 2048
    v_add_u32 v6, s30, v0
    v_add_u32 v7, 1024, v6
    s_mov_b32 s40, 0xc0135761
    s_mov_b32 s41, 0xbdd2d3e8
    s_mov_b32 s42, 0x3acccccd
    s_mov_b32 s43, 0x3727c5ac
    s_mov_b32 s23, 0
    v_mov_b32 v16, 128
P_96:
    global_load_dword v17, v16, s[90:91] sc1
    s_waitcnt vmcnt(0)
    v_readfirstlane_b32 s85, v17
    s_and_b32 s86, s85, 255
    s_cmp_ge_u32 s86, 70
    s_cbranch_scc1 P_97
    s_add_u32 s23, s23, 1
    s_cmp_gt_u32 s23, 65536
    s_cbranch_scc1 L_exit
    s_sleep 16
    s_branch P_96
P_97:
    s_lshr_b32 s85, s85, 8
    s_mov_b32 s80, 0
RM2_job:
    s_mul_i32 s18, s14, 41943040
    s_add_u32 s18, s18, 184549376
    s_mul_i32 s19, s14, 41943040
    s_add_u32 s19, s19, 181403648
    s_mul_i32 s20, s14, 393216
    s_add_u32 s20, s20, 167968768
    s_mul_i32 s21, s14, 393216
    s_add_u32 s21, s21, 168001536
    s_lshl_b32 s30, s13, 2
    s_add_u32 s30, s30, s12
    s_lshl_b32 s31, s30, 7
    s_add_u32 s21, s21, s31
    s_add_u32 s27, s20, s31
    s_lshl_b32 s31, s30, 8
    s_add_u32 s28, s19, s31
    s_add_u32 s28, s28, 40960
    s_lshl_b32 s32, s30, 11
    s_mul_i32 s31, s12, 20
    s_and_b32 s31, s31, -4
    s_lshl_b32 s31, s31, 5
    s_add_u32 s20, s20, s31
    s_mov_b32 s25, 0
    s_mov_b32 s16, 0
    s_mov_b32 s17, 1
    s_mov_b32 s46, 64
    s_lshl_b32 s33, s13, 13
    s_mul_i32 s34, s14, 41943040
    s_add_u32 s34, s34, 175112192
    s_mul_i32 s35, s14, 41943040
    s_add_u32 s35, s35, 178257920
    s_add_u32 s19, s19, s33
    s_add_u32 s34, s34, s32
    s_add_u32 s35, s35, s33
    s_lshl_b32 s30, s12, 10
    s_add_u32 s35, s35, s30
    s_sub_u32 s27, s27, s20
    s_mov_b32 s22, 0
    s_mov_b32 s47, 0
    s_mov_b32 s26, 0
    s_mov_b32 s24, 0
    s_mov_b32 s81, 0
    s_lshr_b32 s30, s85, 4
    s_and_b32 s30, s30, 1
    s_lshl_b32 s30, s30, 13
    s_andn2_b32 s20, s20, 0x2000
    s_or_b32 s20, s20, s30
    s_lshr_b32 s30, s85, 5
    s_and_b32 s30, s30, 1
    s_lshl_b32 s30, s30, 13
    s_andn2_b32 s21, s21, 0x2000
    s_or_b32 s21, s21, s30
    s_sub_u32 s86, s20, 393216
    s_lshr_b32 s30, s85, 4
    s_and_b32 s30, s30, 1
    s_lshl_b32 s30, s30, 13
    s_andn2_b32 s86, s86, 0x2000
    s_or_b32 s86, s86, s30
    s_sub_u32 s86, s20, s86
    s_sub_u32 s46, 64, s14
    s_cmp_eq_u32 s80, 0
    s_cbranch_scc1 G_98
    s_mov_b32 s16, 63
    s_mov_b32 s46, 64
    s_mov_b32 s47, 63
    s_sub_u32 s21, s21, 393216
    s_lshr_b32 s30, s85, 5
    s_and_b32 s30, s30, 1
    s_lshl_b32 s30, s30, 13
    s_andn2_b32 s21, s21, 0x2000
    s_or_b32 s21, s21, s30
    s_mov_b32 s37, 63
    v_mbcnt_lo_u32_b32 v16, -1, 0
    v_min_u32 v16, 4, v16
    v_lshlrev_b32 v16, 7, v16
    s_mov_b32 s23, 0
    s_mov_b64 exec, 0xffffffff
P_99:
    buffer_load_dword v17, v16, s[4:7], s20 offen sc1
    s_waitcnt vmcnt(0)
    v_cmp_gt_u32 vcc, s37, v17
    s_cbranch_vccz P_100
    s_add_u32 s23, s23, 1
    s_cmp_gt_u32 s23, 65536
    s_cbranch_scc1 L_exit
    s_sleep 8
    s_branch P_99
P_100:
    s_mov_b64 exec, -1
    s_sub_u32 s20, s20, 393216
    s_mov_b32 s81, 1
    s_lshr_b32 s30, s85, 4
    s_and_b32 s30, s30, 1
    s_lshl_b32 s30, s30, 13
    s_andn2_b32 s20, s20, 0x2000
    s_or_b32 s20, s20, s30
G_98:
    s_barrier
    v_min_u32 v20, 16, v5
    v_lshlrev_b32 v20, 5, v20
    s_add_u32 s30, s27, 4096
    v_add_u32 v20, 4096, v20
    v_writelane_b32 v20, s30, 63
.p2align 6
RM2_loop:
    s_cmp_eq_u32 s22, 1
    s_cbranch_scc1 G_101
    s_cmp_eq_u32 s22, 2
    s_cbranch_scc1 G_103
RM2_poll:
    s_and_b32 s31, s16, s25
    s_lshl_b32 s31, s31, 15
    s_add_u32 s31, s31, s20
    s_add_u32 s37, s16, 2
    s_min_u32 s37, s37, 64
    s_add_u32 s37, s37, s81
    s_mul_i32 s84, s16, s14
    s_cmp_eq_u32 s84, 62
    s_cselect_b32 s37, 65, s37
    s_cselect_b32 s84, s86, 0
    s_sub_u32 s31, s31, s84
    s_add_u32 s84, s31, s27
    v_mbcnt_lo_u32_b32 v16, -1, 0
    v_min_u32 v16, 4, v16
    v_lshlrev_b32 v16, 7, v16
    s_sub_u32 s23, s84, s31
    s_add_u32 s23, s23, 4096
    v_add_u32 v16, 4096, v16
    v_writelane_b32 v16, s23, 31
    s_sub_u32 s31, s31, 4096
    s_mov_b32 s23, 0
    s_mov_b64 exec, 0xffffffff
P_104:
    buffer_load_dword v17, v16, s[4:7], s31 offen sc1
    s_waitcnt vmcnt(0)
    v_cmp_gt_u32 vcc, s37, v17
    s_cbranch_vccz P_105
    s_add_u32 s23, s23, 1
    s_cmp_gt_u32 s23, 65536
    s_cbranch_scc1 L_exit
    s_sleep 1
    s_branch P_104
P_105:
    s_mov_b64 exec, -1
RM2_dma:
    s_mul_i32 s38, s16, 40960
    s_add_u32 s38, s38, s18
    s_mov_b32 s39, s24
    s_mul_i32 s30, s16, 49152
    s_add_u32 s30, s30, s34
    buffer_load_dwordx4 v[64:67], v0, s[4:7], s30 offen sc1
    buffer_load_dwordx4 v[68:71], v0, s[4:7], s30 offen offset:1024 sc1
    s_mul_i32 s30, s16, 40960
    s_add_u32 s30, s30, s35
    buffer_load_dwordx2 v[72:73], v8, s[4:7], s30 offen sc1
    s_mul_i32 s30, s12, 10240
    s_add_u32 s38, s38, s30
    s_add_u32 s39, s39, s30
    s_mov_b32 m0, s39
    s_nop 0
    buffer_load_dwordx4 v4, s[4:7], s38 offen offset:0 sc1 lds
    buffer_load_dwordx4 v4, s[4:7], s38 offen offset:1024 sc1 lds
    buffer_load_dwordx4 v4, s[4:7], s38 offen offset:2048 sc1 lds
    buffer_load_dwordx4 v4, s[4:7], s38 offen offset:3072 sc1 lds
    s_add_u32 s38, s38, 4096
    s_add_u32 s39, s39, 4096
    s_mov_b32 m0, s39
    s_nop 0
    buffer_load_dwordx4 v4, s[4:7], s38 offen offset:0 sc1 lds
    buffer_load_dwordx4 v4, s[4:7], s38 offen offset:1024 sc1 lds
    buffer_load_dwordx4 v4, s[4:7], s38 offen offset:2048 sc1 lds
    buffer_load_dwordx4 v4, s[4:7], s38 offen offset:3072 sc1 lds
    s_add_u32 s38, s38, 4096
    s_add_u32 s39, s39, 4096
    s_mov_b32 m0, s39
    s_nop 0
    buffer_load_dwordx4 v4, s[4:7], s38 offen offset:0 sc1 lds
    buffer_load_dwordx4 v4, s[4:7], s38 offen offset:1024 sc1 lds
G_103:
    s_waitcnt vmcnt(7)
    s_branch G_102
G_101:
    s_waitcnt vmcnt(3)
G_102:
    v_add_u32 v1, s24, v0
    v_add_u32 v2, 0x10000, v1
    v_add_u32 v9, s24, v3
    s_add_u32 s29, s16, s17
    s_cmp_eq_u32 s22, 1
    s_cselect_b64 vcc, -1, 0
    s_barrier
    ds_read_b128 v[24:27], v1 offset:0
    ds_read_b128 v[28:31], v1 offset:10240
    ds_read_b128 v[32:35], v1 offset:20480
    ds_read_b128 v[36:39], v1 offset:30720
    ds_read_b128 v[40:43], v1 offset:1024
    s_and_b32 s31, s29, s25
    s_lshl_b32 s31, s31, 15
    s_add_u32 s31, s31, s20
    s_add_u32 s37, s29, 2
    s_min_u32 s37, s37, 64
    s_add_u32 s37, s37, s81
    s_mul_i32 s84, s29, s14
    s_cmp_eq_u32 s84, 62
    s_cselect_b32 s37, 65, s37
    s_cselect_b32 s84, s86, 0
    s_sub_u32 s31, s31, s84
    s_add_u32 s84, s31, s27
    s_mov_b32 s62, s31
    v_lshlrev_b32 v48, 16, v64
    v_and_b32 v49, 0xffff0000, v64
    v_lshlrev_b32 v50, 16, v65
    v_and_b32 v51, 0xffff0000, v65
    v_lshlrev_b32 v52, 16, v66
    v_and_b32 v53, 0xffff0000, v66
    v_lshlrev_b32 v54, 16, v67
    v_and_b32 v55, 0xffff0000, v67
    v_lshlrev_b32 v56, 16, v68
    v_and_b32 v57, 0xffff0000, v68
    v_lshlrev_b32 v58, 16, v69
    v_and_b32 v59, 0xffff0000, v69
    v_lshlrev_b32 v60, 16, v70
    v_and_b32 v61, 0xffff0000, v70
    v_lshlrev_b32 v62, 16, v71
    v_and_b32 v63, 0xffff0000, v71
    v_mov_b32 v74, v73
    v_mov_b32 v75, v73
    v_mov_b32 v73, v72
    v_pk_fma_f32 v[48:49], v[48:49], v[72:73], v[74:75]
    v_pk_fma_f32 v[50:51], v[50:51], v[72:73], v[74:75]
    v_pk_fma_f32 v[52:53], v[52:53], v[72:73], v[74:75]
    v_pk_fma_f32 v[54:55], v[54:55], v[72:73], v[74:75]
    v_pk_fma_f32 v[56:57], v[56:57], v[72:73], v[74:75]
    v_pk_fma_f32 v[58:59], v[58:59], v[72:73], v[74:75]
    v_pk_fma_f32 v[60:61], v[60:61], v[72:73], v[74:75]
    v_pk_fma_f32 v[62:63], v[62:63], v[72:73], v[74:75]
    s_nop 1
    s_waitcnt lgkmcnt(4)
    v_mfma_f32_32x32x16_bf16 v[48:63], a[96:99], v[24:27], v[48:63]
    ds_read_b128 v[44:47], v1 offset:11264
    s_sub_u32 s31, s62, 4096
    s_mov_b32 s32, s22
    s_cmp_eq_u32 s22, 0
    s_cbranch_scc1 G_108
    buffer_load_dword v21, v20, s[4:7], s31 offen sc1
G_108:
    s_waitcnt lgkmcnt(4)
    v_mfma_f32_32x32x16_bf16 v[48:63], a[136:139], v[28:31], v[48:63]
    ds_read_b128 v[24:27], v1 offset:21504
    s_waitcnt lgkmcnt(4)
    v_mfma_f32_32x32x16_bf16 v[48:63], a[176:179], v[32:35], v[48:63]
    ds_read_b128 v[28:31], v1 offset:31744
    s_waitcnt lgkmcnt(4)
    v_mfma_f32_32x32x16_bf16 v[48:63], a[216:219], v[36:39], v[48:63]
    ds_read_b128 v[32:35], v1 offset:2048
    s_waitcnt lgkmcnt(4)
    v_mfma_f32_32x32x16_bf16 v[48:63], a[100:103], v[40:43], v[48:63]
    ds_read_b128 v[36:39], v1 offset:12288
    s_waitcnt lgkmcnt(4)
    v_mfma_f32_32x32x16_bf16 v[48:63], a[140:143], v[44:47], v[48:63]
    ds_read_b128 v[40:43], v1 offset:22528
    s_waitcnt lgkmcnt(4)
    v_mfma_f32_32x32x16_bf16 v[48:63], a[180:183], v[24:27], v[48:63]
    ds_read_b128 v[44:47], v1 offset:32768
    s_waitcnt lgkmcnt(4)
    v_mfma_f32_32x32x16_bf16 v[48:63], a[220:223], v[28:31], v[48:63]
    s_cbranch_vccnz G_109
    s_waitcnt vmcnt(4)
G_109:
    s_barrier
    ds_read_b128 v[24:27], v1 offset:3072
    s_waitcnt lgkmcnt(4)
    v_mfma_f32_32x32x16_bf16 v[48:63], a[104:107], v[32:35], v[48:63]
    ds_read_b128 v[28:31], v1 offset:13312
    s_waitcnt lgkmcnt(4)
    v_mfma_f32_32x32x16_bf16 v[48:63], a[144:147], v[36:39], v[48:63]
    ds_read_b128 v[32:35], v1 offset:23552
    s_waitcnt lgkmcnt(4)
    v_mfma_f32_32x32x16_bf16 v[48:63], a[184:187], v[40:43], v[48:63]
    ds_read_b128 v[36:39], v1 offset:33792
    s_waitcnt lgkmcnt(4)
    v_mfma_f32_32x32x16_bf16 v[48:63], a[224:227], v[44:47], v[48:63]
    ds_read_b128 v[40:43], v1 offset:4096
    s_waitcnt lgkmcnt(4)
    v_mfma_f32_32x32x16_bf16 v[48:63], a[108:111], v[24:27], v[48:63]
    ds_read_b128 v[44:47], v1 offset:14336
    s_waitcnt lgkmcnt(4)
    v_mfma_f32_32x32x16_bf16 v[48:63], a[148:151], v[28:31], v[48:63]
    ds_read_b128 v[24:27], v1 offset:24576
    s_cmp_lg_u32 s26, 0
    s_cbranch_scc1 G_106
G_107:
    s_waitcnt lgkmcnt(4)
    v_mfma_f32_32x32x16_bf16 v[48:63], a[188:191], v[32:35], v[48:63]
    ds_read_b128 v[28:31], v1 offset:34816
    s_waitcnt lgkmcnt(4)
    v_mfma_f32_32x32x16_bf16 v[48:63], a[228:231], v[36:39], v[48:63]
    ds_read_b128 v[32:35], v1 offset:5120
    s_waitcnt lgkmcnt(4)
    v_mfma_f32_32x32x16_bf16 v[48:63], a[112:115], v[40:43], v[48:63]
    ds_read_b128 v[36:39], v1 offset:15360
    s_waitcnt lgkmcnt(4)
    v_mfma_f32_32x32x16_bf16 v[48:63], a[152:155], v[44:47], v[48:63]
    ds_read_b128 v[40:43], v1 offset:25600
    s_waitcnt lgkmcnt(4)
    v_mfma_f32_32x32x16_bf16 v[48:63], a[192:195], v[24:27], v[48:63]
    ds_read_b128 v[44:47], v1 offset:35840
    s_waitcnt lgkmcnt(4)
    v_mfma_f32_32x32x16_bf16 v[48:63], a[232:235], v[28:31], v[48:63]
    s_cbranch_vccnz G_110
    s_waitcnt vmcnt(0)
G_110:
    s_barrier
    ds_read_b128 v[24:27], v1 offset:6144
    s_waitcnt lgkmcnt(4)
    v_mfma_f32_32x32x16_bf16 v[48:63], a[116:119], v[32:35], v[48:63]
    ds_read_b128 v[28:31], v1 offset:16384
    s_waitcnt lgkmcnt(4)
    v_mfma_f32_32x32x16_bf16 v[48:63], a[156:159], v[36:39], v[48:63]
    ds_read_b128 v[32:35], v1 offset:26624
    s_waitcnt lgkmcnt(4)
    v_mfma_f32_32x32x16_bf16 v[48:63], a[196:199], v[40:43], v[48:63]
    ds_read_b128 v[36:39], v1 offset:36864
    s_waitcnt lgkmcnt(4)
    v_mfma_f32_32x32x16_bf16 v[48:63], a[236:239], v[44:47], v[48:63]
    ds_read_b128 v[40:43], v1 offset:7168
    s_cmp_lg_u32 s32, 0
    s_cbranch_scc1 G_112
G_113:
    s_waitcnt lgkmcnt(4)
    v_mfma_f32_32x32x16_bf16 v[48:63], a[120:123], v[24:27], v[48:63]
    ds_read_b128 v[44:47], v1 offset:17408
    s_waitcnt lgkmcnt(4)
    v_mfma_f32_32x32x16_bf16 v[48:63], a[160:163], v[28:31], v[48:63]
    ds_read_b128 v[24:27], v1 offset:27648
    s_waitcnt lgkmcnt(4)
    v_mfma_f32_32x32x16_bf16 v[48:63], a[200:203], v[32:35], v[48:63]
    ds_read_b128 v[28:31], v1 offset:37888
    s_waitcnt lgkmcnt(4)
    v_mfma_f32_32x32x16_bf16 v[48:63], a[240:243], v[36:39], v[48:63]
    ds_read_b128 v[32:35], v1 offset:8192
    s_waitcnt lgkmcnt(4)
    v_mfma_f32_32x32x16_bf16 v[48:63], a[124:127], v[40:43], v[48:63]
    ds_read_b128 v[36:39], v1 offset:18432
    s_waitcnt lgkmcnt(4)
    v_mfma_f32_32x32x16_bf16 v[48:63], a[164:167], v[44:47], v[48:63]
    ds_read_b128 v[40:43], v1 offset:28672
    s_waitcnt lgkmcnt(4)
    v_mfma_f32_32x32x16_bf16 v[48:63], a[204:207], v[24:27], v[48:63]
    ds_read_b128 v[44:47], v1 offset:38912
    s_waitcnt lgkmcnt(4)
    v_mfma_f32_32x32x16_bf16 v[48:63], a[244:247], v[28:31], v[48:63]
    ds_read_b128 v[24:27], v1 offset:9216
    s_waitcnt lgkmcnt(4)
    v_mfma_f32_32x32x16_bf16 v[48:63], a[128:131], v[32:35], v[48:63]
    ds_read_b128 v[28:31], v1 offset:19456
    s_waitcnt lgkmcnt(4)
    v_mfma_f32_32x32x16_bf16 v[48:63], a[168:171], v[36:39], v[48:63]
    ds_read_b128 v[32:35], v1 offset:29696
    s_waitcnt lgkmcnt(4)
    v_mfma_f32_32x32x16_bf16 v[48:63], a[208:211], v[40:43], v[48:63]
    ds_read_b128 v[36:39], v1 offset:39936
    s_waitcnt lgkmcnt(4)
    v_mfma_f32_32x32x16_bf16 v[48:63], a[248:251], v[44:47], v[48:63]
    s_waitcnt lgkmcnt(3)
    v_mfma_f32_32x32x16_bf16 v[48:63], a[132:135], v[24:27], v[48:63]
    s_waitcnt lgkmcnt(2)
    v_mfma_f32_32x32x16_bf16 v[48:63], a[172:175], v[28:31], v[48:63]
    s_waitcnt lgkmcnt(1)
    v_mfma_f32_32x32x16_bf16 v[48:63], a[212:215], v[32:35], v[48:63]
    s_waitcnt lgkmcnt(0)
    v_mfma_f32_32x32x16_bf16 v[48:63], a[252:255], v[36:39], v[48:63]
    s_branch G_114
G_106:
    s_waitcnt vmcnt(1)
    s_sub_u32 s63, s26, s47
    s_mov_b32 s47, s26
    s_atomic_add s63, s[4:5], s21
    s_mov_b32 s26, 0
    s_branch G_107
G_112:
    s_waitcnt vmcnt(0)
    v_cmp_gt_u32 vcc, s37, v21
    s_sub_u32 s33, 40960, s24
    s_mov_b32 s22, 0
    s_cbranch_vccnz G_113
    s_cmp_ge_u32 s29, s46
    s_cbranch_scc1 G_113
    s_mov_b32 s22, 1
    s_waitcnt lgkmcnt(4)
    v_mfma_f32_32x32x16_bf16 v[48:63], a[120:123], v[24:27], v[48:63]
    ds_read_b128 v[44:47], v1 offset:17408
    s_mul_i32 s38, s29, 40960
    s_add_u32 s38, s38, s18
    s_mov_b32 s39, s33
    s_mul_i32 s30, s29, 49152
    s_add_u32 s30, s30, s34
    buffer_load_dwordx4 v[64:67], v0, s[4:7], s30 offen sc1
    buffer_load_dwordx4 v[68:71], v0, s[4:7], s30 offen offset:1024 sc1
    s_mul_i32 s30, s29, 40960
    s_add_u32 s30, s30, s35
    buffer_load_dwordx2 v[72:73], v8, s[4:7], s30 offen sc1
    s_waitcnt lgkmcnt(4)
    v_mfma_f32_32x32x16_bf16 v[48:63], a[160:163], v[28:31], v[48:63]
    ds_read_b128 v[24:27], v1 offset:27648
    s_mul_i32 s30, s12, 10240
    s_add_u32 s38, s38, s30
    s_add_u32 s39, s39, s30
    s_mov_b32 m0, s39
    s_nop 0
    buffer_load_dwordx4 v4, s[4:7], s38 offen offset:0 sc1 lds
    s_waitcnt lgkmcnt(4)
    v_mfma_f32_32x32x16_bf16 v[48:63], a[200:203], v[32:35], v[48:63]
    ds_read_b128 v[28:31], v1 offset:37888
    buffer_load_dwordx4 v4, s[4:7], s38 offen offset:1024 sc1 lds
    s_waitcnt lgkmcnt(4)
    v_mfma_f32_32x32x16_bf16 v[48:63], a[240:243], v[36:39], v[48:63]
    ds_read_b128 v[32:35], v1 offset:8192
    buffer_load_dwordx4 v4, s[4:7], s38 offen offset:2048 sc1 lds
    s_waitcnt lgkmcnt(4)
    v_mfma_f32_32x32x16_bf16 v[48:63], a[124:127], v[40:43], v[48:63]
    ds_read_b128 v[36:39], v1 offset:18432
    buffer_load_dwordx4 v4, s[4:7], s38 offen offset:3072 sc1 lds
    s_waitcnt lgkmcnt(4)
    v_mfma_f32_32x32x16_bf16 v[48:63], a[164:167], v[44:47], v[48:63]
    ds_read_b128 v[40:43], v1 offset:28672
    s_add_u32 s38, s38, 4096
    s_add_u32 s39, s39, 4096
    s_mov_b32 m0, s39
    s_nop 0
    buffer_load_dwordx4 v4, s[4:7], s38 offen offset:0 sc1 lds
    s_waitcnt lgkmcnt(4)
    v_mfma_f32_32x32x16_bf16 v[48:63], a[204:207], v[24:27], v[48:63]
    ds_read_b128 v[44:47], v1 offset:38912
    buffer_load_dwordx4 v4, s[4:7], s38 offen offset:1024 sc1 lds
    s_waitcnt lgkmcnt(4)
    v_mfma_f32_32x32x16_bf16 v[48:63], a[244:247], v[28:31], v[48:63]
    ds_read_b128 v[24:27], v1 offset:9216
    buffer_load_dwordx4 v4, s[4:7], s38 offen offset:2048 sc1 lds
    s_waitcnt lgkmcnt(4)
    v_mfma_f32_32x32x16_bf16 v[48:63], a[128:131], v[32:35], v[48:63]
    ds_read_b128 v[28:31], v1 offset:19456
    buffer_load_dwordx4 v4, s[4:7], s38 offen offset:3072 sc1 lds
    s_waitcnt lgkmcnt(4)
    v_mfma_f32_32x32x16_bf16 v[48:63], a[168:171], v[36:39], v[48:63]
    ds_read_b128 v[32:35], v1 offset:29696
    s_add_u32 s38, s38, 4096
    s_add_u32 s39, s39, 4096
    s_mov_b32 m0, s39
    s_nop 0
    buffer_load_dwordx4 v4, s[4:7], s38 offen offset:0 sc1 lds
    s_waitcnt lgkmcnt(4)
    v_mfma_f32_32x32x16_bf16 v[48:63], a[208:211], v[40:43], v[48:63]
    ds_read_b128 v[36:39], v1 offset:39936
    buffer_load_dwordx4 v4, s[4:7], s38 offen offset:1024 sc1 lds
    s_waitcnt lgkmcnt(4)
    v_mfma_f32_32x32x16_bf16 v[48:63], a[248:251], v[44:47], v[48:63]
    s_waitcnt lgkmcnt(3)
    v_mfma_f32_32x32x16_bf16 v[48:63], a[132:135], v[24:27], v[48:63]
    s_waitcnt lgkmcnt(2)
    v_mfma_f32_32x32x16_bf16 v[48:63], a[172:175], v[28:31], v[48:63]
    s_waitcnt lgkmcnt(1)
    v_mfma_f32_32x32x16_bf16 v[48:63], a[212:215], v[32:35], v[48:63]
    s_waitcnt lgkmcnt(0)
    v_mfma_f32_32x32x16_bf16 v[48:63], a[252:255], v[36:39], v[48:63]
G_114:
    s_cmp_lg_u32 s22, 0
    s_cbranch_scc1 G_115
    s_sub_u32 s31, s62, 4096
    buffer_load_dword v21, v20, s[4:7], s31 offen sc1
G_115:
    s_mul_i32 s30, s16, 49152
    s_add_u32 s32, s30, s28
    s_add_u32 s30, s30, s19
    s_nop 6
    v_cvt_pk_bf16_f32 v24, v48, v49
    v_cvt_pk_bf16_f32 v25, v50, v51
    v_cvt_pk_bf16_f32 v26, v52, v53
    v_cvt_pk_bf16_f32 v27, v54, v55
    buffer_store_dwordx4 v[24:27], v6, s[4:7], s30 offen offset:0 sc1
    v_cvt_pk_bf16_f32 v28, v56, v57
    v_cvt_pk_bf16_f32 v29, v58, v59
    v_cvt_pk_bf16_f32 v30, v60, v61
    v_cvt_pk_bf16_f32 v31, v62, v63
    buffer_store_dwordx4 v[28:31], v7, s[4:7], s30 offen offset:0 sc1
    v_pk_add_f32 v[40:41], v[48:49], v[50:51]
    v_pk_mul_f32 v[42:43], v[48:49], v[48:49]
    v_pk_fma_f32 v[42:43], v[50:51], v[50:51], v[42:43]
    v_pk_add_f32 v[40:41], v[40:41], v[52:53]
    v_pk_fma_f32 v[42:43], v[52:53], v[52:53], v[42:43]
    v_pk_add_f32 v[40:41], v[40:41], v[54:55]
    v_pk_fma_f32 v[42:43], v[54:55], v[54:55], v[42:43]
    v_pk_add_f32 v[40:41], v[40:41], v[56:57]
    v_pk_fma_f32 v[42:43], v[56:57], v[56:57], v[42:43]
    v_pk_add_f32 v[40:41], v[40:41], v[58:59]
    v_pk_fma_f32 v[42:43], v[58:59], v[58:59], v[42:43]
    v_pk_add_f32 v[40:41], v[40:41], v[60:61]
    v_pk_fma_f32 v[42:43], v[60:61], v[60:61], v[42:43]
    v_pk_add_f32 v[40:41], v[40:41], v[62:63]
    v_pk_fma_f32 v[42:43], v[62:63], v[62:63], v[42:43]
    v_add_f32 v40, v40, v41
    v_add_f32 v41, v42, v43
    v_mov_b32 v42, v40
    v_mov_b32 v43, v41
    s_nop 1
    v_permlane32_swap_b32 v40, v42
    v_permlane32_swap_b32 v41, v43
    v_pk_add_f32 v[40:41], v[40:41], v[42:43]
    s_mov_b64 exec, 0xffffffff
    buffer_store_dwordx2 v[40:41], v8, s[4:7], s32 offen sc1
    s_mov_b64 exec, -1
G_116:
    s_add_u32 s32, s16, 1
    s_sub_u32 s24, 40960, s24
    s_mov_b32 s26, s32
    s_cmp_lg_u32 s22, 0
    s_cbranch_scc1 G_119
    s_mov_b32 s26, 0
    s_waitcnt lgkmcnt(0)
    s_cmp_ge_u32 s29, s46
    s_cbranch_scc1 G_120
    s_waitcnt vmcnt(3)
    v_cmp_gt_u32 vcc, s37, v21
    s_cbranch_vccnz G_117
    s_mov_b32 s22, 2
    s_mul_i32 s38, s29, 40960
    s_add_u32 s38, s38, s18
    s_mov_b32 s39, s24
    s_mul_i32 s30, s29, 49152
    s_add_u32 s30, s30, s34
    buffer_load_dwordx4 v[64:67], v0, s[4:7], s30 offen sc1
    buffer_load_dwordx4 v[68:71], v0, s[4:7], s30 offen offset:1024 sc1
    s_mul_i32 s30, s29, 40960
    s_add_u32 s30, s30, s35
    buffer_load_dwordx2 v[72:73], v8, s[4:7], s30 offen sc1
    s_mul_i32 s30, s12, 10240
    s_add_u32 s38, s38, s30
    s_add_u32 s39, s39, s30
    s_mov_b32 m0, s39
    s_nop 0
    buffer_load_dwordx4 v4, s[4:7], s38 offen offset:0 sc1 lds
    buffer_load_dwordx4 v4, s[4:7], s38 offen offset:1024 sc1 lds
    buffer_load_dwordx4 v4, s[4:7], s38 offen offset:2048 sc1 lds
    buffer_load_dwordx4 v4, s[4:7], s38 offen offset:3072 sc1 lds
    s_add_u32 s38, s38, 4096
    s_add_u32 s39, s39, 4096
    s_mov_b32 m0, s39
    s_nop 0
    buffer_load_dwordx4 v4, s[4:7], s38 offen offset:0 sc1 lds
    buffer_load_dwordx4 v4, s[4:7], s38 offen offset:1024 sc1 lds
    buffer_load_dwordx4 v4, s[4:7], s38 offen offset:2048 sc1 lds
    buffer_load_dwordx4 v4, s[4:7], s38 offen offset:3072 sc1 lds
    s_add_u32 s38, s38, 4096
    s_add_u32 s39, s39, 4096
    s_mov_b32 m0, s39
    s_nop 0
    buffer_load_dwordx4 v4, s[4:7], s38 offen offset:0 sc1 lds
    buffer_load_dwordx4 v4, s[4:7], s38 offen offset:1024 sc1 lds
    s_waitcnt vmcnt(13)
    s_branch G_118
G_117:
    s_sub_u32 s62, s62, 4096
    buffer_load_dword v21, v20, s[4:7], s62 offen sc1
    s_waitcnt vmcnt(1)
    s_sub_u32 s63, s32, s47
    s_mov_b32 s47, s32
    s_atomic_add s63, s[4:5], s21
    s_mov_b32 s16, s29
    s_waitcnt vmcnt(0)
    v_cmp_gt_u32 vcc, s37, v21
    s_cbranch_vccnz RM2_poll
    s_mov_b32 s22, 0
    s_branch RM2_dma
G_120:
    s_waitcnt vmcnt(0)
G_118:
    s_sub_u32 s63, s32, s47
    s_mov_b32 s47, s32
    s_atomic_add s63, s[4:5], s21
G_119:
    s_mov_b32 s16, s29
    s_cmp_lt_u32 s16, s46
    s_cbranch_scc1 RM2_loop
RM2_done:
    s_cmp_lg_u32 s14, 0
    s_cbranch_scc1 G_121
    s_mov_b32 s14, 1
    s_mov_b32 s80, 1
    s_branch RM2_job
G_121:
    s_branch L_next
RM3:
    v_mbcnt_lo_u32_b32 v12, -1, 0
    v_mbcnt_hi_u32_b32 v12, -1, v12
    v_lshlrev_b32 v0, 4, v12
    v_lshlrev_b32 v8, 3, v12
    v_lshlrev_b32 v5, 2, v12
    s_mov_b32 s44, 0
    s_mov_b32 s45, -1
    s_barrier
    s_load_dwordx2 s[8:9], s[0:1], 80
    s_mov_b32 s10, 2211840
    s_mov_b32 s11, 0x20000
    s_lshl_b32 s32, s13, 8
    s_waitcnt lgkmcnt(0)
    v_lshrrev_b32 v13, 2, v12
    v_and_b32 v14, 3, v12
    s_mov_b32 s30, 3456
    v_mul_lo_u32 v13, v13, s30
    v_lshl_add_u32 v13, v14, 4, v13
    s_mul_i32 s30, s12, 64
    s_add_u32 s30, s30, s32
    v_add_u32 v13, s30, v13
    v_lshrrev_b32 v14, 5, v12
    v_bfe_u32 v15, v12, 2, 2
    v_lshl_add_u32 v15, v14, 3, v15
    v_mul_u32_u24 v15, 64, v15
    v_bfe_u32 v16, v12, 4, 1
    v_lshl_add_u32 v15, v16, 5, v15
    v_and_b32 v16, 1, v12
    v_lshl_add_u32 v15, v16, 4, v15
    v_bfe_u32 v16, v12, 1, 1
    v_lshl_add_u32 v15, v16, 3, v15
    s_mul_i32 s33, s12, 40960
    v_add_u32 v15, s33, v15
    s_add_u32 m0, s33, 0
    s_mov_b32 s30, 0
    buffer_load_dwordx4 v13, s[8:11], s30 offen lds
    s_add_u32 m0, s33, 1024
    s_mov_b32 s30, 55296
    buffer_load_dwordx4 v13, s[8:11], s30 offen lds
    s_add_u32 m0, s33, 2048
    s_mov_b32 s30, 110592
    buffer_load_dwordx4 v13, s[8:11], s30 offen lds
    s_add_u32 m0, s33, 3072
    s_mov_b32 s30, 165888
    buffer_load_dwordx4 v13, s[8:11], s30 offen lds
    s_add_u32 m0, s33, 4096
    s_mov_b32 s30, 221184
    buffer_load_dwordx4 v13, s[8:11], s30 offen lds
    s_add_u32 m0, s33, 5120
    s_mov_b32 s30, 276480
    buffer_load_dwordx4 v13, s[8:11], s30 offen lds
    s_add_u32 m0, s33, 6144
    s_mov_b32 s30, 331776
    buffer_load_dwordx4 v13, s[8:11], s30 offen lds
    s_add_u32 m0, s33, 7168
    s_mov_b32 s30, 387072
    buffer_load_dwordx4 v13, s[8:11], s30 offen lds
    s_add_u32 m0, s33, 8192
    s_mov_b32 s30, 442368
    buffer_load_dwordx4 v13, s[8:11], s30 offen lds
    s_add_u32 m0, s33, 9216
    s_mov_b32 s30, 497664
    buffer_load_dwordx4 v13, s[8:11], s30 offen lds
    s_add_u32 m0, s33, 10240
    s_mov_b32 s30, 552960
    buffer_load_dwordx4 v13, s[8:11], s30 offen lds
    s_add_u32 m0, s33, 11264
    s_mov_b32 s30, 608256
    buffer_load_dwordx4 v13, s[8:11], s30 offen lds
    s_add_u32 m0, s33, 12288
    s_mov_b32 s30, 663552
    buffer_load_dwordx4 v13, s[8:11], s30 offen lds
    s_add_u32 m0, s33, 13312
    s_mov_b32 s30, 718848
    buffer_load_dwordx4 v13, s[8:11], s30 offen lds
    s_add_u32 m0, s33, 14336
    s_mov_b32 s30, 774144
    buffer_load_dwordx4 v13, s[8:11], s30 offen lds
    s_add_u32 m0, s33, 15360
    s_mov_b32 s30, 829440
    buffer_load_dwordx4 v13, s[8:11], s30 offen lds
    s_add_u32 m0, s33, 16384
    s_mov_b32 s30, 884736
    buffer_load_dwordx4 v13, s[8:11], s30 offen lds
    s_add_u32 m0, s33, 17408
    s_mov_b32 s30, 940032
    buffer_load_dwordx4 v13, s[8:11], s30 offen lds
    s_add_u32 m0, s33, 18432
    s_mov_b32 s30, 995328
    buffer_load_dwordx4 v13, s[8:11], s30 offen lds
    s_add_u32 m0, s33, 19456
    s_mov_b32 s30, 1050624
    buffer_load_dwordx4 v13, s[8:11], s30 offen lds
    s_add_u32 m0, s33, 20480
    s_mov_b32 s30, 1105920
    buffer_load_dwordx4 v13, s[8:11], s30 offen lds
    s_add_u32 m0, s33, 21504
    s_mov_b32 s30, 1161216
    buffer_load_dwordx4 v13, s[8:11], s30 offen lds
    s_add_u32 m0, s33, 22528
    s_mov_b32 s30, 1216512
    buffer_load_dwordx4 v13, s[8:11], s30 offen lds
    s_add_u32 m0, s33, 23552
    s_mov_b32 s30, 1271808
    buffer_load_dwordx4 v13, s[8:11], s30 offen lds
    s_add_u32 m0, s33, 24576
    s_mov_b32 s30, 1327104
    buffer_load_dwordx4 v13, s[8:11], s30 offen lds
    s_add_u32 m0, s33, 25600
    s_mov_b32 s30, 1382400
    buffer_load_dwordx4 v13, s[8:11], s30 offen lds
    s_add_u32 m0, s33, 26624
    s_mov_b32 s30, 1437696
    buffer_load_dwordx4 v13, s[8:11], s30 offen lds
    s_add_u32 m0, s33, 27648
    s_mov_b32 s30, 1492992
    buffer_load_dwordx4 v13, s[8:11], s30 offen lds
    s_add_u32 m0, s33, 28672
    s_mov_b32 s30, 1548288
    buffer_load_dwordx4 v13, s[8:11], s30 offen lds
    s_add_u32 m0, s33, 29696
    s_mov_b32 s30, 1603584
    buffer_load_dwordx4 v13, s[8:11], s30 offen lds
    s_add_u32 m0, s33, 30720
    s_mov_b32 s30, 1658880
    buffer_load_dwordx4 v13, s[8:11], s30 offen lds
    s_add_u32 m0, s33, 31744
    s_mov_b32 s30, 1714176
    buffer_load_dwordx4 v13, s[8:11], s30 offen lds
    s_add_u32 m0, s33, 32768
    s_mov_b32 s30, 1769472
    buffer_load_dwordx4 v13, s[8:11], s30 offen lds
    s_add_u32 m0, s33, 33792
    s_mov_b32 s30, 1824768
    buffer_load_dwordx4 v13, s[8:11], s30 offen lds
    s_add_u32 m0, s33, 34816
    s_mov_b32 s30, 1880064
    buffer_load_dwordx4 v13, s[8:11], s30 offen lds
    s_add_u32 m0, s33, 35840
    s_mov_b32 s30, 1935360
    buffer_load_dwordx4 v13, s[8:11], s30 offen lds
    s_waitcnt vmcnt(35)
    ds_read_b64_tr_b16 a[96:97], v15 offset:0
    ds_read_b64_tr_b16 a[98:99], v15 offset:256
    s_add_u32 m0, s33, 36864
    s_mov_b32 s30, 1990656
    buffer_load_dwordx4 v13, s[8:11], s30 offen lds
    s_waitcnt vmcnt(35)
    ds_read_b64_tr_b16 a[100:101], v15 offset:1024
    ds_read_b64_tr_b16 a[102:103], v15 offset:1280
    s_add_u32 m0, s33, 37888
    s_mov_b32 s30, 2045952
    buffer_load_dwordx4 v13, s[8:11], s30 offen lds
    s_waitcnt vmcnt(35)
    ds_read_b64_tr_b16 a[104:105], v15 offset:2048
    ds_read_b64_tr_b16 a[106:107], v15 offset:2304
    s_add_u32 m0, s33, 38912
    s_mov_b32 s30, 2101248
    buffer_load_dwordx4 v13, s[8:11], s30 offen lds
    s_waitcnt vmcnt(35)
    ds_read_b64_tr_b16 a[108:109], v15 offset:3072
    ds_read_b64_tr_b16 a[110:111], v15 offset:3328
    s_add_u32 m0, s33, 39936
    s_mov_b32 s30, 2156544
    buffer_load_dwordx4 v13, s[8:11], s30 offen lds
    s_waitcnt vmcnt(35)
    ds_read_b64_tr_b16 a[112:113], v15 offset:4096
    ds_read_b64_tr_b16 a[114:115], v15 offset:4352
    s_waitcnt vmcnt(34)
    ds_read_b64_tr_b16 a[116:117], v15 offset:5120
    ds_read_b64_tr_b16 a[118:119], v15 offset:5376
    s_waitcnt vmcnt(33)
    ds_read_b64_tr_b16 a[120:121], v15 offset:6144
    ds_read_b64_tr_b16 a[122:123], v15 offset:6400
    s_waitcnt vmcnt(32)
    ds_read_b64_tr_b16 a[124:125], v15 offset:7168
    ds_read_b64_tr_b16 a[126:127], v15 offset:7424
    s_waitcnt vmcnt(31)
    ds_read_b64_tr_b16 a[128:129], v15 offset:8192
    ds_read_b64_tr_b16 a[130:131], v15 offset:8448
    s_waitcnt vmcnt(30)
    ds_read_b64_tr_b16 a[132:133], v15 offset:9216
    ds_read_b64_tr_b16 a[134:135], v15 offset:9472
    s_waitcnt vmcnt(29)
    ds_read_b64_tr_b16 a[136:137], v15 offset:10240
    ds_read_b64_tr_b16 a[138:139], v15 offset:10496
    s_waitcnt vmcnt(28)
    ds_read_b64_tr_b16 a[140:141], v15 offset:11264
    ds_read_b64_tr_b16 a[142:143], v15 offset:11520
    s_waitcnt vmcnt(27)
    ds_read_b64_tr_b16 a[144:145], v15 offset:12288
    ds_read_b64_tr_b16 a[146:147], v15 offset:12544
    s_waitcnt vmcnt(26)
    ds_read_b64_tr_b16 a[148:149], v15 offset:13312
    ds_read_b64_tr_b16 a[150:151], v15 offset:13568
    s_waitcnt vmcnt(25)
    ds_read_b64_tr_b16 a[152:153], v15 offset:14336
    ds_read_b64_tr_b16 a[154:155], v15 offset:14592
    s_waitcnt vmcnt(24)
    ds_read_b64_tr_b16 a[156:157], v15 offset:15360
    ds_read_b64_tr_b16 a[158:159], v15 offset:15616
    s_waitcnt vmcnt(23)
    ds_read_b64_tr_b16 a[160:161], v15 offset:16384
    ds_read_b64_tr_b16 a[162:163], v15 offset:16640
    s_waitcnt vmcnt(22)
    ds_read_b64_tr_b16 a[164:165], v15 offset:17408
    ds_read_b64_tr_b16 a[166:167], v15 offset:17664
    s_waitcnt vmcnt(21)
    ds_read_b64_tr_b16 a[168:169], v15 offset:18432
    ds_read_b64_tr_b16 a[170:171], v15 offset:18688
    s_waitcnt vmcnt(20)
    ds_read_b64_tr_b16 a[172:173], v15 offset:19456
    ds_read_b64_tr_b16 a[174:175], v15 offset:19712
    s_waitcnt vmcnt(19)
    ds_read_b64_tr_b16 a[176:177], v15 offset:20480
    ds_read_b64_tr_b16 a[178:179], v15 offset:20736
    s_waitcnt vmcnt(18)
    ds_read_b64_tr_b16 a[180:181], v15 offset:21504
    ds_read_b64_tr_b16 a[182:183], v15 offset:21760
    s_waitcnt vmcnt(17)
    ds_read_b64_tr_b16 a[184:185], v15 offset:22528
    ds_read_b64_tr_b16 a[186:187], v15 offset:22784
    s_waitcnt vmcnt(16)
    ds_read_b64_tr_b16 a[188:189], v15 offset:23552
    ds_read_b64_tr_b16 a[190:191], v15 offset:23808
    s_waitcnt vmcnt(15)
    ds_read_b64_tr_b16 a[192:193], v15 offset:24576
    ds_read_b64_tr_b16 a[194:195], v15 offset:24832
    s_waitcnt vmcnt(14)
    ds_read_b64_tr_b16 a[196:197], v15 offset:25600
    ds_read_b64_tr_b16 a[198:199], v15 offset:25856
    s_waitcnt vmcnt(13)
    ds_read_b64_tr_b16 a[200:201], v15 offset:26624
    ds_read_b64_tr_b16 a[202:203], v15 offset:26880
    s_waitcnt vmcnt(12)
    ds_read_b64_tr_b16 a[204:205], v15 offset:27648
    ds_read_b64_tr_b16 a[206:207], v15 offset:27904
    s_waitcnt vmcnt(11)
    ds_read_b64_tr_b16 a[208:209], v15 offset:28672
    ds_read_b64_tr_b16 a[210:211], v15 offset:28928
    s_waitcnt vmcnt(10)
    ds_read_b64_tr_b16 a[212:213], v15 offset:29696
    ds_read_b64_tr_b16 a[214:215], v15 offset:29952
    s_waitcnt vmcnt(9)
    ds_read_b64_tr_b16 a[216:217], v15 offset:30720
    ds_read_b64_tr_b16 a[218:219], v15 offset:30976
    s_waitcnt vmcnt(8)
    ds_read_b64_tr_b16 a[220:221], v15 offset:31744
    ds_read_b64_tr_b16 a[222:223], v15 offset:32000
    s_waitcnt vmcnt(7)
    ds_read_b64_tr_b16 a[224:225], v15 offset:32768
    ds_read_b64_tr_b16 a[226:227], v15 offset:33024
    s_waitcnt vmcnt(6)
    ds_read_b64_tr_b16 a[228:229], v15 offset:33792
    ds_read_b64_tr_b16 a[230:231], v15 offset:34048
    s_waitcnt vmcnt(5)
    ds_read_b64_tr_b16 a[232:233], v15 offset:34816
    ds_read_b64_tr_b16 a[234:235], v15 offset:35072
    s_waitcnt vmcnt(4)
    ds_read_b64_tr_b16 a[236:237], v15 offset:35840
    ds_read_b64_tr_b16 a[238:239], v15 offset:36096
    s_waitcnt vmcnt(3)
    ds_read_b64_tr_b16 a[240:241], v15 offset:36864
    ds_read_b64_tr_b16 a[242:243], v15 offset:37120
    s_waitcnt vmcnt(2)
    ds_read_b64_tr_b16 a[244:245], v15 offset:37888
    ds_read_b64_tr_b16 a[246:247], v15 offset:38144
    s_waitcnt vmcnt(1)
    ds_read_b64_tr_b16 a[248:249], v15 offset:38912
    ds_read_b64_tr_b16 a[250:251], v15 offset:39168
    s_waitcnt vmcnt(0)
    ds_read_b64_tr_b16 a[252:253], v15 offset:39936
    ds_read_b64_tr_b16 a[254:255], v15 offset:40192
    s_waitcnt lgkmcnt(0)
    v_mov_b32 v24, 0x3f803f80
    v_mov_b32 v25, 0x3f803f80
    v_mov_b32 v26, 0x3f803f80
    v_mov_b32 v27, 0x3f803f80
    s_nop 1
    v_mfma_f32_32x32x16_bf16 v[48:63], v[24:27], a[96:99], 0
    v_mfma_f32_32x32x16_bf16 v[48:63], v[24:27], a[100:103], v[48:63]
    v_mfma_f32_32x32x16_bf16 v[48:63], v[24:27], a[104:107], v[48:63]
    v_mfma_f32_32x32x16_bf16 v[48:63], v[24:27], a[108:111], v[48:63]
    v_mfma_f32_32x32x16_bf16 v[48:63], v[24:27], a[112:115], v[48:63]
    v_mfma_f32_32x32x16_bf16 v[48:63], v[24:27], a[116:119], v[48:63]
    v_mfma_f32_32x32x16_bf16 v[48:63], v[24:27], a[120:123], v[48:63]
    v_mfma_f32_32x32x16_bf16 v[48:63], v[24:27], a[124:127], v[48:63]
    v_mfma_f32_32x32x16_bf16 v[48:63], v[24:27], a[128:131], v[48:63]
    v_mfma_f32_32x32x16_bf16 v[48:63], v[24:27], a[132:135], v[48:63]
    v_mfma_f32_32x32x16_bf16 v[48:63], v[24:27], a[136:139], v[48:63]
    v_mfma_f32_32x32x16_bf16 v[48:63], v[24:27], a[140:143], v[48:63]
    v_mfma_f32_32x32x16_bf16 v[48:63], v[24:27], a[144:147], v[48:63]
    v_mfma_f32_32x32x16_bf16 v[48:63], v[24:27], a[148:151], v[48:63]
    v_mfma_f32_32x32x16_bf16 v[48:63], v[24:27], a[152:155], v[48:63]
    v_mfma_f32_32x32x16_bf16 v[48:63], v[24:27], a[156:159], v[48:63]
    v_mfma_f32_32x32x16_bf16 v[48:63], v[24:27], a[160:163], v[48:63]
    v_mfma_f32_32x32x16_bf16 v[48:63], v[24:27], a[164:167], v[48:63]
    v_mfma_f32_32x32x16_bf16 v[48:63], v[24:27], a[168:171], v[48:63]
    v_mfma_f32_32x32x16_bf16 v[48:63], v[24:27], a[172:175], v[48:63]
    v_mfma_f32_32x32x16_bf16 v[48:63], v[24:27], a[176:179], v[48:63]
    v_mfma_f32_32x32x16_bf16 v[48:63], v[24:27], a[180:183], v[48:63]
    v_mfma_f32_32x32x16_bf16 v[48:63], v[24:27], a[184:187], v[48:63]
    v_mfma_f32_32x32x16_bf16 v[48:63], v[24:27], a[188:191], v[48:63]
    v_mfma_f32_32x32x16_bf16 v[48:63], v[24:27], a[192:195], v[48:63]
    v_mfma_f32_32x32x16_bf16 v[48:63], v[24:27], a[196:199], v[48:63]
    v_mfma_f32_32x32x16_bf16 v[48:63], v[24:27], a[200:203], v[48:63]
    v_mfma_f32_32x32x16_bf16 v[48:63], v[24:27], a[204:207], v[48:63]
    v_mfma_f32_32x32x16_bf16 v[48:63], v[24:27], a[208:211], v[48:63]
    v_mfma_f32_32x32x16_bf16 v[48:63], v[24:27], a[212:215], v[48:63]
    v_mfma_f32_32x32x16_bf16 v[48:63], v[24:27], a[216:219], v[48:63]
    v_mfma_f32_32x32x16_bf16 v[48:63], v[24:27], a[220:223], v[48:63]
    v_mfma_f32_32x32x16_bf16 v[48:63], v[24:27], a[224:227], v[48:63]
    v_mfma_f32_32x32x16_bf16 v[48:63], v[24:27], a[228:231], v[48:63]
    v_mfma_f32_32x32x16_bf16 v[48:63], v[24:27], a[232:235], v[48:63]
    v_mfma_f32_32x32x16_bf16 v[48:63], v[24:27], a[236:239], v[48:63]
    v_mfma_f32_32x32x16_bf16 v[48:63], v[24:27], a[240:243], v[48:63]
    v_mfma_f32_32x32x16_bf16 v[48:63], v[24:27], a[244:247], v[48:63]
    v_mfma_f32_32x32x16_bf16 v[48:63], v[24:27], a[248:251], v[48:63]
    v_mfma_f32_32x32x16_bf16 v[48:63], v[24:27], a[252:255], v[48:63]
    s_nop 15
    v_cvt_pk_bf16_f32 v96, v48, v48
    v_and_b32 v13, 0xffff0000, v96
    v_sub_f32 v13, v48, v13
    v_cvt_pk_bf16_f32 v97, v13, 0
    v_cndmask_b32 v96, v96, 0, s[44:45]
    v_cndmask_b32 v97, v97, 0, s[44:45]
    v_mov_b64 v[98:99], 0
    v_mov_b64 v[106:107], 0
    v_and_b32 v13, 31, v12
    v_lshrrev_b32 v14, 5, v12
    v_mov_b32 v4, v0
    v_mul_u32_u24 v3, 2560, v14
    v_lshl_add_u32 v3, v13, 3, v3
    v_add_u32 v3, 40960, v3
    s_mul_i32 s30, s12, 2048
    v_add_u32 v6, s30, v0
    v_add_u32 v7, 1024, v6
    s_mov_b32 s40, 0xc0135761
    s_mov_b32 s41, 0xbdd2d3e8
    s_mov_b32 s42, 0x3acccccd
    s_mov_b32 s43, 0x3727c5ac
    s_mov_b32 s23, 0
    v_mov_b32 v16, 128
P_122:
    global_load_dword v17, v16, s[90:91] sc1
    s_waitcnt vmcnt(0)
    v_readfirstlane_b32 s85, v17
    s_and_b32 s86, s85, 255
    s_cmp_ge_u32 s86, 70
    s_cbranch_scc1 P_123
    s_add_u32 s23, s23, 1
    s_cmp_gt_u32 s23, 65536
    s_cbranch_scc1 L_exit
    s_sleep 16
    s_branch P_122
P_123:
    s_lshr_b32 s85, s85, 8
    s_mov_b32 s80, 0
RM3_job:
    s_mul_i32 s18, s14, 41943040
    s_add_u32 s18, s18, 181403648
    s_mul_i32 s19, s14, 41943040
    s_add_u32 s19, s19, 188743680
    s_mul_i32 s20, s14, 393216
    s_add_u32 s20, s20, 168001536
    s_mul_i32 s21, s14, 393216
    s_add_u32 s21, s21, 168034304
    s_lshl_b32 s30, s13, 2
    s_add_u32 s30, s30, s12
    s_lshl_b32 s31, s30, 7
    s_add_u32 s21, s21, s31
    s_add_u32 s27, s20, s31
    s_lshl_b32 s31, s30, 8
    s_add_u32 s28, s19, s31
    s_add_u32 s28, s28, 40960
    s_lshl_b32 s32, s30, 11
    s_mul_i32 s31, s12, 20
    s_and_b32 s31, s31, -4
    s_lshl_b32 s31, s31, 5
    s_add_u32 s20, s20, s31
    s_mov_b32 s25, 0
    s_mov_b32 s16, 0
    s_mov_b32 s17, 1
    s_mov_b32 s46, 64
    s_lshl_b32 s33, s13, 13
    s_add_u32 s19, s19, s33
    s_mov_b32 s22, 0
    s_mov_b32 s47, 0
    s_mov_b32 s26, 0
    s_mov_b32 s24, 0
    s_mov_b32 s81, 0
    s_lshr_b32 s30, s85, 5
    s_and_b32 s30, s30, 1
    s_lshl_b32 s30, s30, 13
    s_andn2_b32 s20, s20, 0x2000
    s_or_b32 s20, s20, s30
    s_cmp_eq_u32 s14, 0
    s_cselect_b32 s30, 6, 7
    s_lshr_b32 s30, s85, s30
    s_and_b32 s30, s30, 1
    s_lshl_b32 s30, s30, 13
    s_andn2_b32 s21, s21, 0x2000
    s_or_b32 s21, s21, s30
    s_sub_u32 s46, 64, s14
    s_cmp_eq_u32 s80, 0
    s_cbranch_scc1 G_124
    s_mov_b32 s16, 63
    s_mov_b32 s46, 64
    s_mov_b32 s47, 63
    s_sub_u32 s21, s21, 393216
    s_lshr_b32 s30, s85, 6
    s_and_b32 s30, s30, 1
    s_lshl_b32 s30, s30, 13
    s_andn2_b32 s21, s21, 0x2000
    s_or_b32 s21, s21, s30
    s_sub_u32 s20, s20, 393216
    s_mov_b32 s81, 1
    s_lshr_b32 s30, s85, 5
    s_and_b32 s30, s30, 1
    s_lshl_b32 s30, s30, 13
    s_andn2_b32 s20, s20, 0x2000
    s_or_b32 s20, s20, s30
G_124:
    s_barrier
    v_min_u32 v20, 16, v5
    v_lshlrev_b32 v20, 5, v20
.p2align 6
RM3_loop:
    s_cmp_eq_u32 s22, 1
    s_cbranch_scc1 G_125
    s_cmp_eq_u32 s22, 2
    s_cbranch_scc1 G_127
RM3_poll:
    s_and_b32 s31, s16, s25
    s_lshl_b32 s31, s31, 15
    s_add_u32 s31, s31, s20
    s_add_u32 s37, s16, 1
    s_min_u32 s37, s37, 64
    s_add_u32 s37, s37, s81
    v_mbcnt_lo_u32_b32 v16, -1, 0
    v_min_u32 v16, 4, v16
    v_lshlrev_b32 v16, 7, v16
    s_mov_b32 s23, 0
    s_mov_b64 exec, 0xffffffff
P_128:
    buffer_load_dword v17, v16, s[4:7], s31 offen sc1
    s_waitcnt vmcnt(0)
    v_cmp_gt_u32 vcc, s37, v17
    s_cbranch_vccz P_129
    s_add_u32 s23, s23, 1
    s_cmp_gt_u32 s23, 65536
    s_cbranch_scc1 L_exit
    s_sleep 1
    s_branch P_128
P_129:
    s_mov_b64 exec, -1
RM3_dma:
    s_mul_i32 s38, s16, 49152
    s_add_u32 s38, s38, s18
    s_mov_b32 s39, s24
    s_mul_i32 s30, s12, 1280
    s_add_u32 s30, s30, 40960
    s_add_u32 m0, s30, s39
    s_add_u32 s30, s30, s38
    buffer_load_dwordx4 v0, s[4:7], s30 offen sc1 lds
    buffer_load_dword v5, s[4:7], s30 offen offset:1024 sc1 lds
    s_mul_i32 s30, s12, 10240
    s_add_u32 s38, s38, s30
    s_add_u32 s39, s39, s30
    s_mov_b32 m0, s39
    s_nop 0
    buffer_load_dwordx4 v4, s[4:7], s38 offen offset:0 sc1 lds
    buffer_load_dwordx4 v4, s[4:7], s38 offen offset:1024 sc1 lds
    buffer_load_dwordx4 v4, s[4:7], s38 offen offset:2048 sc1 lds
    buffer_load_dwordx4 v4, s[4:7], s38 offen offset:3072 sc1 lds
    s_add_u32 s38, s38, 4096
    s_add_u32 s39, s39, 4096
    s_mov_b32 m0, s39
    s_nop 0
    buffer_load_dwordx4 v4, s[4:7], s38 offen offset:0 sc1 lds
    buffer_load_dwordx4 v4, s[4:7], s38 offen offset:1024 sc1 lds
    buffer_load_dwordx4 v4, s[4:7], s38 offen offset:2048 sc1 lds
    buffer_load_dwordx4 v4, s[4:7], s38 offen offset:3072 sc1 lds
    s_add_u32 s38, s38, 4096
    s_add_u32 s39, s39, 4096
    s_mov_b32 m0, s39
    s_nop 0
    buffer_load_dwordx4 v4, s[4:7], s38 offen offset:0 sc1 lds
    buffer_load_dwordx4 v4, s[4:7], s38 offen offset:1024 sc1 lds
G_127:
    s_waitcnt vmcnt(7)
    s_branch G_126
G_125:
    s_waitcnt vmcnt(2)
G_126:
    v_add_u32 v1, s24, v0
    v_add_u32 v2, 0x10000, v1
    v_add_u32 v9, s24, v3
    s_add_u32 s29, s16, s17
    s_cmp_eq_u32 s22, 1
    s_cselect_b64 vcc, -1, 0
    s_barrier
    ds_read_b128 v[24:27], v1 offset:0
    ds_read_b128 v[28:31], v1 offset:10240
    ds_read_b128 v[32:35], v1 offset:20480
    ds_read_b128 v[36:39], v1 offset:30720
    ds_read_b128 v[40:43], v1 offset:1024
    s_and_b32 s31, s29, s25
    s_lshl_b32 s31, s31, 15
    s_add_u32 s31, s31, s20
    s_add_u32 s37, s29, 1
    s_min_u32 s37, s37, 64
    s_add_u32 s37, s37, s81
    s_mov_b32 s62, s31
    s_waitcnt lgkmcnt(4)
    v_mfma_f32_32x32x16_bf16 v[48:63], a[96:99], v[24:27], 0
    ds_read_b128 v[44:47], v1 offset:11264
    s_sub_u32 s31, s62, 0
    s_mov_b32 s32, s22
    s_cmp_eq_u32 s22, 0
    s_cbranch_scc1 G_132
    buffer_load_dword v21, v20, s[4:7], s31 offen sc1
G_132:
    ds_read_b64 v[64:65], v9 offset:0
    ds_read_b64 v[66:67], v9 offset:256
    ds_read_b64 v[68:69], v9 offset:512
    s_waitcnt lgkmcnt(7)
    v_mfma_f32_32x32x16_bf16 v[48:63], a[136:139], v[28:31], v[48:63]
    ds_read_b128 v[24:27], v1 offset:21504
    ds_read_b64 v[70:71], v9 offset:768
    s_waitcnt lgkmcnt(4)
    v_mov_b32 v16, v64
    v_mov_b32 v17, v65
    v_mfma_f32_32x32x16_bf16 v[48:63], a[176:179], v[32:35], v[48:63]
    ds_read_b128 v[28:31], v1 offset:31744
    s_waitcnt lgkmcnt(4)
    v_mov_b32 v18, v66
    v_mov_b32 v19, v67
    s_waitcnt lgkmcnt(3)
    v_add_f32 v16, v16, v68
    v_mfma_f32_32x32x16_bf16 v[48:63], a[216:219], v[36:39], v[48:63]
    ds_read_b128 v[32:35], v1 offset:2048
    v_add_f32 v17, v17, v69
    s_waitcnt lgkmcnt(2)
    v_add_f32 v18, v18, v70
    v_add_f32 v19, v19, v71
    v_mfma_f32_32x32x16_bf16 v[48:63], a[100:103], v[40:43], v[48:63]
    ds_read_b128 v[36:39], v1 offset:12288
    ds_read_b64 v[64:65], v9 offset:1024
    ds_read_b64 v[66:67], v9 offset:1280
    ds_read_b64 v[68:69], v9 offset:1536
    v_mfma_f32_32x32x16_bf16 v[48:63], a[140:143], v[44:47], v[48:63]
    ds_read_b128 v[40:43], v1 offset:22528
    ds_read_b64 v[70:71], v9 offset:1792
    s_waitcnt lgkmcnt(4)
    v_add_f32 v16, v16, v64
    v_add_f32 v17, v17, v65
    v_mfma_f32_32x32x16_bf16 v[48:63], a[180:183], v[24:27], v[48:63]
    ds_read_b128 v[44:47], v1 offset:32768
    s_waitcnt lgkmcnt(4)
    v_add_f32 v18, v18, v66
    v_add_f32 v19, v19, v67
    s_waitcnt lgkmcnt(3)
    v_add_f32 v16, v16, v68
    v_mfma_f32_32x32x16_bf16 v[48:63], a[220:223], v[28:31], v[48:63]
    s_cbranch_vccnz G_133
    s_waitcnt vmcnt(4)
G_133:
    s_barrier
    ds_read_b128 v[24:27], v1 offset:3072
    v_add_f32 v17, v17, v69
    s_waitcnt lgkmcnt(2)
    v_add_f32 v18, v18, v70
    v_add_f32 v19, v19, v71
    v_mfma_f32_32x32x16_bf16 v[48:63], a[104:107], v[32:35], v[48:63]
    ds_read_b128 v[28:31], v1 offset:13312
    ds_read_b64 v[64:65], v9 offset:2048
    ds_read_b64 v[66:67], v9 offset:2304
    s_waitcnt lgkmcnt(1)
    v_add_f32 v16, v16, v64
    v_mfma_f32_32x32x16_bf16 v[48:63], a[144:147], v[36:39], v[48:63]
    ds_read_b128 v[32:35], v1 offset:23552
    v_add_f32 v17, v17, v65
    s_waitcnt lgkmcnt(1)
    v_add_f32 v18, v18, v66
    v_add_f32 v19, v19, v67
    v_mfma_f32_32x32x16_bf16 v[48:63], a[184:187], v[40:43], v[48:63]
    ds_read_b128 v[36:39], v1 offset:33792
    v_add_f32 v16, v16, v18
    v_add_f32 v17, v17, v19
    v_mov_b32 v18, v16
    v_mfma_f32_32x32x16_bf16 v[48:63], a[224:227], v[44:47], v[48:63]
    ds_read_b128 v[40:43], v1 offset:4096
    v_mov_b32 v19, v17
    s_nop 1
    v_permlane32_swap_b32 v16, v18
    v_mfma_f32_32x32x16_bf16 v[48:63], a[108:111], v[24:27], v[48:63]
    ds_read_b128 v[44:47], v1 offset:14336
    v_permlane32_swap_b32 v17, v19
    v_add_f32 v16, v16, v18
    v_add_f32 v17, v17, v19
    v_mfma_f32_32x32x16_bf16 v[48:63], a[148:151], v[28:31], v[48:63]
    ds_read_b128 v[24:27], v1 offset:24576
    v_mul_f32 v12, s42, v16
    v_mul_f32 v15, s42, v17
    v_sub_f32 v16, 0, v12
    s_cmp_lg_u32 s26, 0
    s_cbranch_scc1 G_130
G_131:
    s_waitcnt lgkmcnt(4)
    v_mfma_f32_32x32x16_bf16 v[48:63], a[188:191], v[32:35], v[48:63]
    ds_read_b128 v[28:31], v1 offset:34816
    v_cvt_pk_bf16_f32 v105, v16, v16
    v_fma_f32 v15, -v12, v12, v15
    v_and_b32 v17, 0xffff0000, v105
    s_waitcnt lgkmcnt(4)
    v_mfma_f32_32x32x16_bf16 v[48:63], a[228:231], v[36:39], v[48:63]
    ds_read_b128 v[32:35], v1 offset:5120
    v_max_f32 v15, 0, v15
    v_sub_f32 v16, v16, v17
    v_add_f32 v18, s43, v15
    s_waitcnt lgkmcnt(4)
    v_mfma_f32_32x32x16_bf16 v[48:63], a[112:115], v[40:43], v[48:63]
    ds_read_b128 v[36:39], v1 offset:15360
    v_cvt_pk_bf16_f32 v104, v17, v16
    v_rsq_f32 v13, v18
    s_nop 0
    s_waitcnt lgkmcnt(4)
    v_mfma_f32_32x32x16_bf16 v[48:63], a[152:155], v[44:47], v[48:63]
    ds_read_b128 v[40:43], v1 offset:25600
    v_mfma_f32_32x32x16_bf16 v[48:63], v[96:99], v[104:107], v[48:63]
    s_waitcnt lgkmcnt(4)
    v_mfma_f32_32x32x16_bf16 v[48:63], a[192:195], v[24:27], v[48:63]
    ds_read_b128 v[44:47], v1 offset:35840
    s_waitcnt lgkmcnt(4)
    v_mfma_f32_32x32x16_bf16 v[48:63], a[232:235], v[28:31], v[48:63]
    s_cbranch_vccnz G_134
    s_waitcnt vmcnt(0)
G_134:
    s_barrier
    ds_read_b128 v[24:27], v1 offset:6144
    s_waitcnt lgkmcnt(4)
    v_mfma_f32_32x32x16_bf16 v[48:63], a[116:119], v[32:35], v[48:63]
    ds_read_b128 v[28:31], v1 offset:16384
    s_waitcnt lgkmcnt(4)
    v_mfma_f32_32x32x16_bf16 v[48:63], a[156:159], v[36:39], v[48:63]
    ds_read_b128 v[32:35], v1 offset:26624
    s_waitcnt lgkmcnt(4)
    v_mfma_f32_32x32x16_bf16 v[48:63], a[196:199], v[40:43], v[48:63]
    ds_read_b128 v[36:39], v1 offset:36864
    s_waitcnt lgkmcnt(4)
    v_mfma_f32_32x32x16_bf16 v[48:63], a[236:239], v[44:47], v[48:63]
    ds_read_b128 v[40:43], v1 offset:7168
    s_cmp_lg_u32 s32, 0
    s_cbranch_scc1 G_136
G_137:
    s_waitcnt lgkmcnt(4)
    v_mfma_f32_32x32x16_bf16 v[48:63], a[120:123], v[24:27], v[48:63]
    ds_read_b128 v[44:47], v1 offset:17408
    s_waitcnt lgkmcnt(4)
    v_mfma_f32_32x32x16_bf16 v[48:63], a[160:163], v[28:31], v[48:63]
    ds_read_b128 v[24:27], v1 offset:27648
    s_waitcnt lgkmcnt(4)
    v_mfma_f32_32x32x16_bf16 v[48:63], a[200:203], v[32:35], v[48:63]
    ds_read_b128 v[28:31], v1 offset:37888
    s_waitcnt lgkmcnt(4)
    v_mfma_f32_32x32x16_bf16 v[48:63], a[240:243], v[36:39], v[48:63]
    ds_read_b128 v[32:35], v1 offset:8192
    s_waitcnt lgkmcnt(4)
    v_mfma_f32_32x32x16_bf16 v[48:63], a[124:127], v[40:43], v[48:63]
    ds_read_b128 v[36:39], v1 offset:18432
    s_waitcnt lgkmcnt(4)
    v_mfma_f32_32x32x16_bf16 v[48:63], a[164:167], v[44:47], v[48:63]
    ds_read_b128 v[40:43], v1 offset:28672
    s_waitcnt lgkmcnt(4)
    v_mfma_f32_32x32x16_bf16 v[48:63], a[204:207], v[24:27], v[48:63]
    ds_read_b128 v[44:47], v1 offset:38912
    s_waitcnt lgkmcnt(4)
    v_mfma_f32_32x32x16_bf16 v[48:63], a[244:247], v[28:31], v[48:63]
    ds_read_b128 v[24:27], v1 offset:9216
    s_waitcnt lgkmcnt(4)
    v_mfma_f32_32x32x16_bf16 v[48:63], a[128:131], v[32:35], v[48:63]
    ds_read_b128 v[28:31], v1 offset:19456
    s_waitcnt lgkmcnt(4)
    v_mfma_f32_32x32x16_bf16 v[48:63], a[168:171], v[36:39], v[48:63]
    ds_read_b128 v[32:35], v1 offset:29696
    s_waitcnt lgkmcnt(4)
    v_mfma_f32_32x32x16_bf16 v[48:63], a[208:211], v[40:43], v[48:63]
    ds_read_b128 v[36:39], v1 offset:39936
    s_waitcnt lgkmcnt(4)
    v_mfma_f32_32x32x16_bf16 v[48:63], a[248:251], v[44:47], v[48:63]
    s_waitcnt lgkmcnt(3)
    v_mfma_f32_32x32x16_bf16 v[48:63], a[132:135], v[24:27], v[48:63]
    s_waitcnt lgkmcnt(2)
    v_mfma_f32_32x32x16_bf16 v[48:63], a[172:175], v[28:31], v[48:63]
    s_waitcnt lgkmcnt(1)
    v_mfma_f32_32x32x16_bf16 v[48:63], a[212:215], v[32:35], v[48:63]
    s_waitcnt lgkmcnt(0)
    v_mfma_f32_32x32x16_bf16 v[48:63], a[252:255], v[36:39], v[48:63]
    s_branch G_138
G_130:
    s_waitcnt vmcnt(1)
    s_sub_u32 s63, s26, s47
    s_mov_b32 s47, s26
    s_atomic_add s63, s[4:5], s21
    s_mov_b32 s26, 0
    s_branch G_131
G_136:
    s_waitcnt vmcnt(0)
    v_cmp_gt_u32 vcc, s37, v21
    s_sub_u32 s33, 46080, s24
    s_mov_b32 s22, 0
    s_cbranch_vccnz G_137
    s_cmp_ge_u32 s29, s46
    s_cbranch_scc1 G_137
    s_mov_b32 s22, 1
    s_waitcnt lgkmcnt(4)
    v_mfma_f32_32x32x16_bf16 v[48:63], a[120:123], v[24:27], v[48:63]
    ds_read_b128 v[44:47], v1 offset:17408
    s_mul_i32 s38, s29, 49152
    s_add_u32 s38, s38, s18
    s_mov_b32 s39, s33
    s_mul_i32 s30, s12, 1280
    s_add_u32 s30, s30, 40960
    s_add_u32 m0, s30, s39
    s_add_u32 s30, s30, s38
    buffer_load_dwordx4 v0, s[4:7], s30 offen sc1 lds
    buffer_load_dword v5, s[4:7], s30 offen offset:1024 sc1 lds
    s_waitcnt lgkmcnt(4)
    v_mfma_f32_32x32x16_bf16 v[48:63], a[160:163], v[28:31], v[48:63]
    ds_read_b128 v[24:27], v1 offset:27648
    s_mul_i32 s30, s12, 10240
    s_add_u32 s38, s38, s30
    s_add_u32 s39, s39, s30
    s_mov_b32 m0, s39
    s_nop 0
    buffer_load_dwordx4 v4, s[4:7], s38 offen offset:0 sc1 lds
    s_waitcnt lgkmcnt(4)
    v_mfma_f32_32x32x16_bf16 v[48:63], a[200:203], v[32:35], v[48:63]
    ds_read_b128 v[28:31], v1 offset:37888
    buffer_load_dwordx4 v4, s[4:7], s38 offen offset:1024 sc1 lds
    s_waitcnt lgkmcnt(4)
    v_mfma_f32_32x32x16_bf16 v[48:63], a[240:243], v[36:39], v[48:63]
    ds_read_b128 v[32:35], v1 offset:8192
    buffer_load_dwordx4 v4, s[4:7], s38 offen offset:2048 sc1 lds
    s_waitcnt lgkmcnt(4)
    v_mfma_f32_32x32x16_bf16 v[48:63], a[124:127], v[40:43], v[48:63]
    ds_read_b128 v[36:39], v1 offset:18432
    buffer_load_dwordx4 v4, s[4:7], s38 offen offset:3072 sc1 lds
    s_waitcnt lgkmcnt(4)
    v_mfma_f32_32x32x16_bf16 v[48:63], a[164:167], v[44:47], v[48:63]
    ds_read_b128 v[40:43], v1 offset:28672
    s_add_u32 s38, s38, 4096
    s_add_u32 s39, s39, 4096
    s_mov_b32 m0, s39
    s_nop 0
    buffer_load_dwordx4 v4, s[4:7], s38 offen offset:0 sc1 lds
    s_waitcnt lgkmcnt(4)
    v_mfma_f32_32x32x16_bf16 v[48:63], a[204:207], v[24:27], v[48:63]
    ds_read_b128 v[44:47], v1 offset:38912
    buffer_load_dwordx4 v4, s[4:7], s38 offen offset:1024 sc1 lds
    s_waitcnt lgkmcnt(4)
    v_mfma_f32_32x32x16_bf16 v[48:63], a[244:247], v[28:31], v[48:63]
    ds_read_b128 v[24:27], v1 offset:9216
    buffer_load_dwordx4 v4, s[4:7], s38 offen offset:2048 sc1 lds
    s_waitcnt lgkmcnt(4)
    v_mfma_f32_32x32x16_bf16 v[48:63], a[128:131], v[32:35], v[48:63]
    ds_read_b128 v[28:31], v1 offset:19456
    buffer_load_dwordx4 v4, s[4:7], s38 offen offset:3072 sc1 lds
    s_waitcnt lgkmcnt(4)
    v_mfma_f32_32x32x16_bf16 v[48:63], a[168:171], v[36:39], v[48:63]
    ds_read_b128 v[32:35], v1 offset:29696
    s_add_u32 s38, s38, 4096
    s_add_u32 s39, s39, 4096
    s_mov_b32 m0, s39
    s_nop 0
    buffer_load_dwordx4 v4, s[4:7], s38 offen offset:0 sc1 lds
    s_waitcnt lgkmcnt(4)
    v_mfma_f32_32x32x16_bf16 v[48:63], a[208:211], v[40:43], v[48:63]
    ds_read_b128 v[36:39], v1 offset:39936
    buffer_load_dwordx4 v4, s[4:7], s38 offen offset:1024 sc1 lds
    s_waitcnt lgkmcnt(4)
    v_mfma_f32_32x32x16_bf16 v[48:63], a[248:251], v[44:47], v[48:63]
    s_waitcnt lgkmcnt(3)
    v_mfma_f32_32x32x16_bf16 v[48:63], a[132:135], v[24:27], v[48:63]
    s_waitcnt lgkmcnt(2)
    v_mfma_f32_32x32x16_bf16 v[48:63], a[172:175], v[28:31], v[48:63]
    s_waitcnt lgkmcnt(1)
    v_mfma_f32_32x32x16_bf16 v[48:63], a[212:215], v[32:35], v[48:63]
    s_waitcnt lgkmcnt(0)
    v_mfma_f32_32x32x16_bf16 v[48:63], a[252:255], v[36:39], v[48:63]
G_138:
    s_cmp_lg_u32 s22, 0
    s_cbranch_scc1 G_139
    s_sub_u32 s31, s62, 0
    buffer_load_dword v21, v20, s[4:7], s31 offen sc1
G_139:
    s_mul_i32 s30, s16, 114688
    s_add_u32 s32, s30, s28
    s_add_u32 s30, s30, s19
    v_mov_b32 v16, v13
    v_mov_b32 v17, v13
    v_mov_b32 v40, s40
    v_mov_b32 v41, s40
    v_mov_b32 v42, s41
    v_mov_b32 v43, s41
    v_mov_b32 v44, 1.0
    v_mov_b32 v45, 1.0
    s_nop 6
    v_pk_mul_f32 v[48:49], v[48:49], v[16:17]
    v_pk_mul_f32 v[50:51], v[50:51], v[16:17]
    v_pk_mul_f32 v[52:53], v[52:53], v[16:17]
    v_pk_mul_f32 v[54:55], v[54:55], v[16:17]
    v_pk_mul_f32 v[24:25], v[48:49], v[48:49]
    v_pk_mul_f32 v[26:27], v[50:51], v[50:51]
    v_pk_mul_f32 v[28:29], v[52:53], v[52:53]
    v_pk_mul_f32 v[30:31], v[54:55], v[54:55]
    v_pk_fma_f32 v[24:25], v[24:25], v[42:43], v[40:41]
    v_pk_fma_f32 v[26:27], v[26:27], v[42:43], v[40:41]
    v_pk_fma_f32 v[28:29], v[28:29], v[42:43], v[40:41]
    v_pk_fma_f32 v[30:31], v[30:31], v[42:43], v[40:41]
    v_pk_mul_f32 v[24:25], v[24:25], v[48:49]
    v_pk_mul_f32 v[26:27], v[26:27], v[50:51]
    v_pk_mul_f32 v[28:29], v[28:29], v[52:53]
    v_pk_mul_f32 v[30:31], v[30:31], v[54:55]
    v_exp_f32 v24, v24
    v_exp_f32 v25, v25
    v_exp_f32 v26, v26
    v_exp_f32 v27, v27
    v_exp_f32 v28, v28
    v_exp_f32 v29, v29
    v_exp_f32 v30, v30
    v_exp_f32 v31, v31
    v_pk_add_f32 v[24:25], v[24:25], v[44:45]
    v_pk_add_f32 v[26:27], v[26:27], v[44:45]
    v_pk_add_f32 v[28:29], v[28:29], v[44:45]
    v_pk_add_f32 v[30:31], v[30:31], v[44:45]
    v_rcp_f32 v24, v24
    v_rcp_f32 v25, v25
    v_rcp_f32 v26, v26
    v_rcp_f32 v27, v27
    v_rcp_f32 v28, v28
    v_rcp_f32 v29, v29
    v_rcp_f32 v30, v30
    v_rcp_f32 v31, v31
    v_pk_mul_f32 v[48:49], v[48:49], v[24:25]
    v_pk_mul_f32 v[50:51], v[50:51], v[26:27]
    v_pk_mul_f32 v[52:53], v[52:53], v[28:29]
    v_pk_mul_f32 v[54:55], v[54:55], v[30:31]
    v_cvt_pk_bf16_f32 v32, v48, v49
    v_cvt_pk_bf16_f32 v33, v50, v51
    v_cvt_pk_bf16_f32 v34, v52, v53
    v_cvt_pk_bf16_f32 v35, v54, v55
    buffer_store_dwordx4 v[32:35], v6, s[4:7], s30 offen sc1
    v_pk_mul_f32 v[56:57], v[56:57], v[16:17]
    v_pk_mul_f32 v[58:59], v[58:59], v[16:17]
    v_pk_mul_f32 v[60:61], v[60:61], v[16:17]
    v_pk_mul_f32 v[62:63], v[62:63], v[16:17]
    v_pk_mul_f32 v[24:25], v[56:57], v[56:57]
    v_pk_mul_f32 v[26:27], v[58:59], v[58:59]
    v_pk_mul_f32 v[28:29], v[60:61], v[60:61]
    v_pk_mul_f32 v[30:31], v[62:63], v[62:63]
    v_pk_fma_f32 v[24:25], v[24:25], v[42:43], v[40:41]
    v_pk_fma_f32 v[26:27], v[26:27], v[42:43], v[40:41]
    v_pk_fma_f32 v[28:29], v[28:29], v[42:43], v[40:41]
    v_pk_fma_f32 v[30:31], v[30:31], v[42:43], v[40:41]
    v_pk_mul_f32 v[24:25], v[24:25], v[56:57]
    v_pk_mul_f32 v[26:27], v[26:27], v[58:59]
    v_pk_mul_f32 v[28:29], v[28:29], v[60:61]
    v_pk_mul_f32 v[30:31], v[30:31], v[62:63]
    v_exp_f32 v24, v24
    v_exp_f32 v25, v25
    v_exp_f32 v26, v26
    v_exp_f32 v27, v27
    v_exp_f32 v28, v28
    v_exp_f32 v29, v29
    v_exp_f32 v30, v30
    v_exp_f32 v31, v31
    v_pk_add_f32 v[24:25], v[24:25], v[44:45]
    v_pk_add_f32 v[26:27], v[26:27], v[44:45]
    v_pk_add_f32 v[28:29], v[28:29], v[44:45]
    v_pk_add_f32 v[30:31], v[30:31], v[44:45]
    v_rcp_f32 v24, v24
    v_rcp_f32 v25, v25
    v_rcp_f32 v26, v26
    v_rcp_f32 v27, v27
    v_rcp_f32 v28, v28
    v_rcp_f32 v29, v29
    v_rcp_f32 v30, v30
    v_rcp_f32 v31, v31
    v_pk_mul_f32 v[56:57], v[56:57], v[24:25]
    v_pk_mul_f32 v[58:59], v[58:59], v[26:27]
    v_pk_mul_f32 v[60:61], v[60:61], v[28:29]
    v_pk_mul_f32 v[62:63], v[62:63], v[30:31]
    v_cvt_pk_bf16_f32 v36, v56, v57
    v_cvt_pk_bf16_f32 v37, v58, v59
    v_cvt_pk_bf16_f32 v38, v60, v61
    v_cvt_pk_bf16_f32 v39, v62, v63
    buffer_store_dwordx4 v[36:39], v7, s[4:7], s30 offen sc1
    s_add_u32 s32, s16, 1
    s_sub_u32 s24, 46080, s24
    s_mov_b32 s26, s32
    s_cmp_lg_u32 s22, 0
    s_cbranch_scc1 G_142
    s_mov_b32 s26, 0
    s_waitcnt lgkmcnt(0)
    s_cmp_ge_u32 s29, s46
    s_cbranch_scc1 G_143
    s_waitcnt vmcnt(2)
    v_cmp_gt_u32 vcc, s37, v21
    s_cbranch_vccnz G_140
    s_mov_b32 s22, 2
    s_mul_i32 s38, s29, 49152
    s_add_u32 s38, s38, s18
    s_mov_b32 s39, s24
    s_mul_i32 s30, s12, 1280
    s_add_u32 s30, s30, 40960
    s_add_u32 m0, s30, s39
    s_add_u32 s30, s30, s38
    buffer_load_dwordx4 v0, s[4:7], s30 offen sc1 lds
    buffer_load_dword v5, s[4:7], s30 offen offset:1024 sc1 lds
    s_mul_i32 s30, s12, 10240
    s_add_u32 s38, s38, s30
    s_add_u32 s39, s39, s30
    s_mov_b32 m0, s39
    s_nop 0
    buffer_load_dwordx4 v4, s[4:7], s38 offen offset:0 sc1 lds
    buffer_load_dwordx4 v4, s[4:7], s38 offen offset:1024 sc1 lds
    buffer_load_dwordx4 v4, s[4:7], s38 offen offset:2048 sc1 lds
    buffer_load_dwordx4 v4, s[4:7], s38 offen offset:3072 sc1 lds
    s_add_u32 s38, s38, 4096
    s_add_u32 s39, s39, 4096
    s_mov_b32 m0, s39
    s_nop 0
    buffer_load_dwordx4 v4, s[4:7], s38 offen offset:0 sc1 lds
    buffer_load_dwordx4 v4, s[4:7], s38 offen offset:1024 sc1 lds
    buffer_load_dwordx4 v4, s[4:7], s38 offen offset:2048 sc1 lds
    buffer_load_dwordx4 v4, s[4:7], s38 offen offset:3072 sc1 lds
    s_add_u32 s38, s38, 4096
    s_add_u32 s39, s39, 4096
    s_mov_b32 m0, s39
    s_nop 0
    buffer_load_dwordx4 v4, s[4:7], s38 offen offset:0 sc1 lds
    buffer_load_dwordx4 v4, s[4:7], s38 offen offset:1024 sc1 lds
    s_waitcnt vmcnt(12)
    s_branch G_141
G_140:
    buffer_load_dword v21, v20, s[4:7], s62 offen sc1
    s_waitcnt vmcnt(1)
    s_sub_u32 s63, s32, s47
    s_mov_b32 s47, s32
    s_atomic_add s63, s[4:5], s21
    s_mov_b32 s16, s29
    s_waitcnt vmcnt(0)
    v_cmp_gt_u32 vcc, s37, v21
    s_cbranch_vccnz RM3_poll
    s_mov_b32 s22, 0
    s_branch RM3_dma
G_143:
    s_waitcnt vmcnt(0)
G_141:
    s_sub_u32 s63, s32, s47
    s_mov_b32 s47, s32
    s_atomic_add s63, s[4:5], s21
G_142:
    s_mov_b32 s16, s29
    s_cmp_lt_u32 s16, s46
    s_cbranch_scc1 RM3_loop
RM3_done:
    s_cmp_lg_u32 s14, 0
    s_cbranch_scc1 G_144
    s_mov_b32 s14, 1
    s_mov_b32 s80, 1
    s_branch RM3_job
G_144:
    s_branch L_next
RM4:
    v_mbcnt_lo_u32_b32 v12, -1, 0
    v_mbcnt_hi_u32_b32 v12, -1, v12
    v_lshlrev_b32 v0, 4, v12
    v_lshlrev_b32 v8, 3, v12
    v_lshlrev_b32 v5, 2, v12
    s_mov_b32 s44, 0
    s_mov_b32 s45, -1
    s_barrier
    s_load_dwordx2 s[8:9], s[0:1], 88
    s_mov_b32 s10, 2211840
    s_mov_b32 s11, 0x20000
    s_lshl_b32 s32, s13, 8
    s_waitcnt lgkmcnt(0)
    v_lshrrev_b32 v13, 2, v12
    v_and_b32 v14, 3, v12
    s_mov_b32 s30, 1280
    v_mul_lo_u32 v13, v13, s30
    v_lshl_add_u32 v13, v14, 4, v13
    s_mul_i32 s30, s12, 64
    s_add_u32 s30, s30, s32
    v_add_u32 v13, s30, v13
    v_lshrrev_b32 v14, 5, v12
    v_bfe_u32 v15, v12, 2, 2
    v_lshl_add_u32 v15, v14, 3, v15
    v_mul_u32_u24 v15, 64, v15
    v_bfe_u32 v16, v12, 4, 1
    v_lshl_add_u32 v15, v16, 5, v15
    v_and_b32 v16, 1, v12
    v_lshl_add_u32 v15, v16, 4, v15
    v_bfe_u32 v16, v12, 1, 1
    v_lshl_add_u32 v15, v16, 3, v15
    s_mul_i32 s33, s12, 40960
    v_add_u32 v15, s33, v15
    s_add_u32 m0, s33, 0
    s_mov_b32 s30, 0
    buffer_load_dwordx4 v13, s[8:11], s30 offen lds
    s_add_u32 m0, s33, 1024
    s_mov_b32 s30, 20480
    buffer_load_dwordx4 v13, s[8:11], s30 offen lds
    s_add_u32 m0, s33, 2048
    s_mov_b32 s30, 40960
    buffer_load_dwordx4 v13, s[8:11], s30 offen lds
    s_add_u32 m0, s33, 3072
    s_mov_b32 s30, 61440
    buffer_load_dwordx4 v13, s[8:11], s30 offen lds
    s_add_u32 m0, s33, 4096
    s_mov_b32 s30, 81920
    buffer_load_dwordx4 v13, s[8:11], s30 offen lds
    s_add_u32 m0, s33, 5120
    s_mov_b32 s30, 102400
    buffer_load_dwordx4 v13, s[8:11], s30 offen lds
    s_add_u32 m0, s33, 6144
    s_mov_b32 s30, 122880
    buffer_load_dwordx4 v13, s[8:11], s30 offen lds
    s_add_u32 m0, s33, 7168
    s_mov_b32 s30, 143360
    buffer_load_dwordx4 v13, s[8:11], s30 offen lds
    s_add_u32 m0, s33, 8192
    s_mov_b32 s30, 163840
    buffer_load_dwordx4 v13, s[8:11], s30 offen lds
    s_add_u32 m0, s33, 9216
    s_mov_b32 s30, 184320
    buffer_load_dwordx4 v13, s[8:11], s30 offen lds
    s_add_u32 m0, s33, 10240
    s_mov_b32 s30, 204800
    buffer_load_dwordx4 v13, s[8:11], s30 offen lds
    s_add_u32 m0, s33, 11264
    s_mov_b32 s30, 225280
    buffer_load_dwordx4 v13, s[8:11], s30 offen lds
    s_add_u32 m0, s33, 12288
    s_mov_b32 s30, 245760
    buffer_load_dwordx4 v13, s[8:11], s30 offen lds
    s_add_u32 m0, s33, 13312
    s_mov_b32 s30, 266240
    buffer_load_dwordx4 v13, s[8:11], s30 offen lds
    s_add_u32 m0, s33, 14336
    s_mov_b32 s30, 286720
    buffer_load_dwordx4 v13, s[8:11], s30 offen lds
    s_add_u32 m0, s33, 15360
    s_mov_b32 s30, 307200
    buffer_load_dwordx4 v13, s[8:11], s30 offen lds
    s_add_u32 m0, s33, 16384
    s_mov_b32 s30, 327680
    buffer_load_dwordx4 v13, s[8:11], s30 offen lds
    s_add_u32 m0, s33, 17408
    s_mov_b32 s30, 348160
    buffer_load_dwordx4 v13, s[8:11], s30 offen lds
    s_add_u32 m0, s33, 18432
    s_mov_b32 s30, 368640
    buffer_load_dwordx4 v13, s[8:11], s30 offen lds
    s_add_u32 m0, s33, 19456
    s_mov_b32 s30, 389120
    buffer_load_dwordx4 v13, s[8:11], s30 offen lds
    s_add_u32 m0, s33, 20480
    s_mov_b32 s30, 409600
    buffer_load_dwordx4 v13, s[8:11], s30 offen lds
    s_add_u32 m0, s33, 21504
    s_mov_b32 s30, 430080
    buffer_load_dwordx4 v13, s[8:11], s30 offen lds
    s_add_u32 m0, s33, 22528
    s_mov_b32 s30, 450560
    buffer_load_dwordx4 v13, s[8:11], s30 offen lds
    s_add_u32 m0, s33, 23552
    s_mov_b32 s30, 471040
    buffer_load_dwordx4 v13, s[8:11], s30 offen lds
    s_add_u32 m0, s33, 24576
    s_mov_b32 s30, 491520
    buffer_load_dwordx4 v13, s[8:11], s30 offen lds
    s_add_u32 m0, s33, 25600
    s_mov_b32 s30, 512000
    buffer_load_dwordx4 v13, s[8:11], s30 offen lds
    s_add_u32 m0, s33, 26624
    s_mov_b32 s30, 532480
    buffer_load_dwordx4 v13, s[8:11], s30 offen lds
    s_add_u32 m0, s33, 27648
    s_mov_b32 s30, 552960
    buffer_load_dwordx4 v13, s[8:11], s30 offen lds
    s_add_u32 m0, s33, 28672
    s_mov_b32 s30, 573440
    buffer_load_dwordx4 v13, s[8:11], s30 offen lds
    s_add_u32 m0, s33, 29696
    s_mov_b32 s30, 593920
    buffer_load_dwordx4 v13, s[8:11], s30 offen lds
    s_add_u32 m0, s33, 30720
    s_mov_b32 s30, 614400
    buffer_load_dwordx4 v13, s[8:11], s30 offen lds
    s_add_u32 m0, s33, 31744
    s_mov_b32 s30, 634880
    buffer_load_dwordx4 v13, s[8:11], s30 offen lds
    s_add_u32 m0, s33, 32768
    s_mov_b32 s30, 655360
    buffer_load_dwordx4 v13, s[8:11], s30 offen lds
    s_add_u32 m0, s33, 33792
    s_mov_b32 s30, 675840
    buffer_load_dwordx4 v13, s[8:11], s30 offen lds
    s_add_u32 m0, s33, 34816
    s_mov_b32 s30, 696320
    buffer_load_dwordx4 v13, s[8:11], s30 offen lds
    s_add_u32 m0, s33, 35840
    s_mov_b32 s30, 716800
    buffer_load_dwordx4 v13, s[8:11], s30 offen lds
    s_waitcnt vmcnt(35)
    ds_read_b64_tr_b16 v[80:81], v15 offset:0
    ds_read_b64_tr_b16 v[82:83], v15 offset:256
    s_add_u32 m0, s33, 36864
    s_mov_b32 s30, 737280
    buffer_load_dwordx4 v13, s[8:11], s30 offen lds
    s_waitcnt vmcnt(35)
    ds_read_b64_tr_b16 v[84:85], v15 offset:1024
    ds_read_b64_tr_b16 v[86:87], v15 offset:1280
    s_add_u32 m0, s33, 37888
    s_mov_b32 s30, 757760
    buffer_load_dwordx4 v13, s[8:11], s30 offen lds
    s_waitcnt vmcnt(35)
    ds_read_b64_tr_b16 v[88:89], v15 offset:2048
    ds_read_b64_tr_b16 v[90:91], v15 offset:2304
    s_add_u32 m0, s33, 38912
    s_mov_b32 s30, 778240
    buffer_load_dwordx4 v13, s[8:11], s30 offen lds
    s_waitcnt vmcnt(35)
    ds_read_b64_tr_b16 v[92:93], v15 offset:3072
    ds_read_b64_tr_b16 v[94:95], v15 offset:3328
    s_add_u32 m0, s33, 39936
    s_mov_b32 s30, 798720
    buffer_load_dwordx4 v13, s[8:11], s30 offen lds
    s_waitcnt vmcnt(35)
    ds_read_b64_tr_b16 v[96:97], v15 offset:4096
    ds_read_b64_tr_b16 v[98:99], v15 offset:4352
    s_waitcnt lgkmcnt(8)
    s_add_u32 m0, s33, 0
    s_mov_b32 s30, 819200
    buffer_load_dwordx4 v13, s[8:11], s30 offen lds
    s_waitcnt vmcnt(35)
    ds_read_b64_tr_b16 v[100:101], v15 offset:5120
    ds_read_b64_tr_b16 v[102:103], v15 offset:5376
    s_waitcnt lgkmcnt(8)
    s_add_u32 m0, s33, 1024
    s_mov_b32 s30, 839680
    buffer_load_dwordx4 v13, s[8:11], s30 offen lds
    s_waitcnt vmcnt(35)
    ds_read_b64_tr_b16 v[104:105], v15 offset:6144
    ds_read_b64_tr_b16 v[106:107], v15 offset:6400
    s_waitcnt lgkmcnt(8)
    s_add_u32 m0, s33, 2048
    s_mov_b32 s30, 860160
    buffer_load_dwordx4 v13, s[8:11], s30 offen lds
    s_waitcnt vmcnt(35)
    ds_read_b64_tr_b16 v[108:109], v15 offset:7168
    ds_read_b64_tr_b16 v[110:111], v15 offset:7424
    s_waitcnt lgkmcnt(8)
    s_add_u32 m0, s33, 3072
    s_mov_b32 s30, 880640
    buffer_load_dwordx4 v13, s[8:11], s30 offen lds
    s_waitcnt vmcnt(35)
    ds_read_b64_tr_b16 v[112:113], v15 offset:8192
    ds_read_b64_tr_b16 v[114:115], v15 offset:8448
    s_waitcnt lgkmcnt(8)
    s_add_u32 m0, s33, 4096
    s_mov_b32 s30, 901120
    buffer_load_dwordx4 v13, s[8:11], s30 offen lds
    s_waitcnt vmcnt(35)
    ds_read_b64_tr_b16 v[116:117], v15 offset:9216
    ds_read_b64_tr_b16 v[118:119], v15 offset:9472
    s_waitcnt lgkmcnt(8)
    s_add_u32 m0, s33, 5120
    s_mov_b32 s30, 921600
    buffer_load_dwordx4 v13, s[8:11], s30 offen lds
    s_waitcnt vmcnt(35)
    ds_read_b64_tr_b16 v[120:121], v15 offset:10240
    ds_read_b64_tr_b16 v[122:123], v15 offset:10496
    s_waitcnt lgkmcnt(8)
    s_add_u32 m0, s33, 6144
    s_mov_b32 s30, 942080
    buffer_load_dwordx4 v13, s[8:11], s30 offen lds
    s_waitcnt vmcnt(35)
    ds_read_b64_tr_b16 v[124:125], v15 offset:11264
    ds_read_b64_tr_b16 v[126:127], v15 offset:11520
    s_waitcnt lgkmcnt(8)
    s_add_u32 m0, s33, 7168
    s_mov_b32 s30, 962560
    buffer_load_dwordx4 v13, s[8:11], s30 offen lds
    s_waitcnt vmcnt(35)
    ds_read_b64_tr_b16 v[128:129], v15 offset:12288
    ds_read_b64_tr_b16 v[130:131], v15 offset:12544
    s_waitcnt lgkmcnt(8)
    s_add_u32 m0, s33, 8192
    s_mov_b32 s30, 983040
    buffer_load_dwordx4 v13, s[8:11], s30 offen lds
    s_waitcnt vmcnt(35)
    ds_read_b64_tr_b16 v[132:133], v15 offset:13312
    ds_read_b64_tr_b16 v[134:135], v15 offset:13568
    s_waitcnt lgkmcnt(8)
    s_add_u32 m0, s33, 9216
    s_mov_b32 s30, 1003520
    buffer_load_dwordx4 v13, s[8:11], s30 offen lds
    s_waitcnt vmcnt(35)
    ds_read_b64_tr_b16 v[136:137], v15 offset:14336
    ds_read_b64_tr_b16 v[138:139], v15 offset:14592
    s_waitcnt lgkmcnt(8)
    s_add_u32 m0, s33, 10240
    s_mov_b32 s30, 1024000
    buffer_load_dwordx4 v13, s[8:11], s30 offen lds
    s_waitcnt vmcnt(35)
    ds_read_b64_tr_b16 v[140:141], v15 offset:15360
    ds_read_b64_tr_b16 v[142:143], v15 offset:15616
    s_waitcnt lgkmcnt(8)
    s_add_u32 m0, s33, 11264
    s_mov_b32 s30, 1044480
    buffer_load_dwordx4 v13, s[8:11], s30 offen lds
    s_waitcnt vmcnt(35)
    ds_read_b64_tr_b16 v[144:145], v15 offset:16384
    ds_read_b64_tr_b16 v[146:147], v15 offset:16640
    s_waitcnt lgkmcnt(8)
    s_add_u32 m0, s33, 12288
    s_mov_b32 s30, 1064960
    buffer_load_dwordx4 v13, s[8:11], s30 offen lds
    s_waitcnt vmcnt(35)
    ds_read_b64_tr_b16 v[148:149], v15 offset:17408
    ds_read_b64_tr_b16 v[150:151], v15 offset:17664
    s_waitcnt lgkmcnt(8)
    s_add_u32 m0, s33, 13312
    s_mov_b32 s30, 1085440
    buffer_load_dwordx4 v13, s[8:11], s30 offen lds
    s_waitcnt vmcnt(35)
    ds_read_b64_tr_b16 v[152:153], v15 offset:18432
    ds_read_b64_tr_b16 v[154:155], v15 offset:18688
    s_waitcnt lgkmcnt(8)
    s_add_u32 m0, s33, 14336
    s_mov_b32 s30, 1105920
    buffer_load_dwordx4 v13, s[8:11], s30 offen lds
    s_waitcnt vmcnt(35)
    ds_read_b64_tr_b16 v[156:157], v15 offset:19456
    ds_read_b64_tr_b16 v[158:159], v15 offset:19712
    s_waitcnt lgkmcnt(8)
    s_add_u32 m0, s33, 15360
    s_mov_b32 s30, 1126400
    buffer_load_dwordx4 v13, s[8:11], s30 offen lds
    s_waitcnt vmcnt(35)
    ds_read_b64_tr_b16 v[160:161], v15 offset:20480
    ds_read_b64_tr_b16 v[162:163], v15 offset:20736
    s_waitcnt lgkmcnt(8)
    s_add_u32 m0, s33, 16384
    s_mov_b32 s30, 1146880
    buffer_load_dwordx4 v13, s[8:11], s30 offen lds
    s_waitcnt vmcnt(35)
    ds_read_b64_tr_b16 v[164:165], v15 offset:21504
    ds_read_b64_tr_b16 v[166:167], v15 offset:21760
    s_waitcnt lgkmcnt(8)
    s_add_u32 m0, s33, 17408
    s_mov_b32 s30, 1167360
    buffer_load_dwordx4 v13, s[8:11], s30 offen lds
    s_waitcnt vmcnt(35)
    ds_read_b64_tr_b16 v[168:169], v15 offset:22528
    ds_read_b64_tr_b16 v[170:171], v15 offset:22784
    s_waitcnt lgkmcnt(8)
    s_add_u32 m0, s33, 18432
    s_mov_b32 s30, 1187840
    buffer_load_dwordx4 v13, s[8:11], s30 offen lds
    s_waitcnt vmcnt(35)
    ds_read_b64_tr_b16 v[172:173], v15 offset:23552
    ds_read_b64_tr_b16 v[174:175], v15 offset:23808
    s_waitcnt lgkmcnt(8)
    s_add_u32 m0, s33, 19456
    s_mov_b32 s30, 1208320
    buffer_load_dwordx4 v13, s[8:11], s30 offen lds
    s_waitcnt vmcnt(35)
    ds_read_b64_tr_b16 v[176:177], v15 offset:24576
    ds_read_b64_tr_b16 v[178:179], v15 offset:24832
    s_waitcnt lgkmcnt(8)
    s_add_u32 m0, s33, 20480
    s_mov_b32 s30, 1228800
    buffer_load_dwordx4 v13, s[8:11], s30 offen lds
    s_waitcnt vmcnt(35)
    ds_read_b64_tr_b16 v[180:181], v15 offset:25600
    ds_read_b64_tr_b16 v[182:183], v15 offset:25856
    s_waitcnt lgkmcnt(8)
    s_add_u32 m0, s33, 21504
    s_mov_b32 s30, 1249280
    buffer_load_dwordx4 v13, s[8:11], s30 offen lds
    s_waitcnt vmcnt(35)
    ds_read_b64_tr_b16 v[184:185], v15 offset:26624
    ds_read_b64_tr_b16 v[186:187], v15 offset:26880
    s_waitcnt lgkmcnt(8)
    s_add_u32 m0, s33, 22528
    s_mov_b32 s30, 1269760
    buffer_load_dwordx4 v13, s[8:11], s30 offen lds
    s_waitcnt vmcnt(35)
    ds_read_b64_tr_b16 v[188:189], v15 offset:27648
    ds_read_b64_tr_b16 v[190:191], v15 offset:27904
    s_waitcnt lgkmcnt(8)
    s_add_u32 m0, s33, 23552
    s_mov_b32 s30, 1290240
    buffer_load_dwordx4 v13, s[8:11], s30 offen lds
    s_waitcnt vmcnt(35)
    ds_read_b64_tr_b16 v[192:193], v15 offset:28672
    ds_read_b64_tr_b16 v[194:195], v15 offset:28928
    s_waitcnt lgkmcnt(8)
    s_add_u32 m0, s33, 24576
    s_mov_b32 s30, 1310720
    buffer_load_dwordx4 v13, s[8:11], s30 offen lds
    s_waitcnt vmcnt(35)
    ds_read_b64_tr_b16 v[196:197], v15 offset:29696
    ds_read_b64_tr_b16 v[198:199], v15 offset:29952
    s_waitcnt lgkmcnt(8)
    s_add_u32 m0, s33, 25600
    s_mov_b32 s30, 1331200
    buffer_load_dwordx4 v13, s[8:11], s30 offen lds
    s_waitcnt vmcnt(35)
    ds_read_b64_tr_b16 v[200:201], v15 offset:30720
    ds_read_b64_tr_b16 v[202:203], v15 offset:30976
    s_waitcnt lgkmcnt(8)
    s_add_u32 m0, s33, 26624
    s_mov_b32 s30, 1351680
    buffer_load_dwordx4 v13, s[8:11], s30 offen lds
    s_waitcnt vmcnt(35)
    ds_read_b64_tr_b16 v[204:205], v15 offset:31744
    ds_read_b64_tr_b16 v[206:207], v15 offset:32000
    s_waitcnt lgkmcnt(8)
    s_add_u32 m0, s33, 27648
    s_mov_b32 s30, 1372160
    buffer_load_dwordx4 v13, s[8:11], s30 offen lds
    s_waitcnt vmcnt(35)
    ds_read_b64_tr_b16 v[208:209], v15 offset:32768
    ds_read_b64_tr_b16 v[210:211], v15 offset:33024
    s_waitcnt lgkmcnt(8)
    s_add_u32 m0, s33, 28672
    s_mov_b32 s30, 1392640
    buffer_load_dwordx4 v13, s[8:11], s30 offen lds
    s_waitcnt vmcnt(35)
    ds_read_b64_tr_b16 v[212:213], v15 offset:33792
    ds_read_b64_tr_b16 v[214:215], v15 offset:34048
    s_waitcnt lgkmcnt(8)
    s_add_u32 m0, s33, 29696
    s_mov_b32 s30, 1413120
    buffer_load_dwordx4 v13, s[8:11], s30 offen lds
    s_waitcnt vmcnt(35)
    ds_read_b64_tr_b16 v[216:217], v15 offset:34816
    ds_read_b64_tr_b16 v[218:219], v15 offset:35072
    s_waitcnt lgkmcnt(8)
    s_add_u32 m0, s33, 30720
    s_mov_b32 s30, 1433600
    buffer_load_dwordx4 v13, s[8:11], s30 offen lds
    s_waitcnt vmcnt(35)
    ds_read_b64_tr_b16 v[220:221], v15 offset:35840
    ds_read_b64_tr_b16 v[222:223], v15 offset:36096
    s_waitcnt lgkmcnt(8)
    s_add_u32 m0, s33, 31744
    s_mov_b32 s30, 1454080
    buffer_load_dwordx4 v13, s[8:11], s30 offen lds
    s_waitcnt vmcnt(35)
    ds_read_b64_tr_b16 v[224:225], v15 offset:36864
    ds_read_b64_tr_b16 v[226:227], v15 offset:37120
    s_waitcnt lgkmcnt(8)
    s_add_u32 m0, s33, 32768
    s_mov_b32 s30, 1474560
    buffer_load_dwordx4 v13, s[8:11], s30 offen lds
    s_waitcnt vmcnt(35)
    ds_read_b64_tr_b16 v[228:229], v15 offset:37888
    ds_read_b64_tr_b16 v[230:231], v15 offset:38144
    s_waitcnt lgkmcnt(8)
    s_add_u32 m0, s33, 33792
    s_mov_b32 s30, 1495040
    buffer_load_dwordx4 v13, s[8:11], s30 offen lds
    s_waitcnt vmcnt(35)
    ds_read_b64_tr_b16 v[232:233], v15 offset:38912
    ds_read_b64_tr_b16 v[234:235], v15 offset:39168
    s_waitcnt lgkmcnt(8)
    s_add_u32 m0, s33, 34816
    s_mov_b32 s30, 1515520
    buffer_load_dwordx4 v13, s[8:11], s30 offen lds
    s_waitcnt vmcnt(35)
    ds_read_b64_tr_b16 v[236:237], v15 offset:39936
    ds_read_b64_tr_b16 v[238:239], v15 offset:40192
    s_waitcnt lgkmcnt(8)
    s_add_u32 m0, s33, 35840
    s_mov_b32 s30, 1536000
    buffer_load_dwordx4 v13, s[8:11], s30 offen lds
    s_waitcnt vmcnt(35)
    ds_read_b64_tr_b16 v[240:241], v15 offset:0
    ds_read_b64_tr_b16 v[242:243], v15 offset:256
    s_waitcnt lgkmcnt(8)
    s_add_u32 m0, s33, 36864
    s_mov_b32 s30, 1556480
    buffer_load_dwordx4 v13, s[8:11], s30 offen lds
    s_waitcnt vmcnt(35)
    ds_read_b64_tr_b16 v[244:245], v15 offset:1024
    ds_read_b64_tr_b16 v[246:247], v15 offset:1280
    s_waitcnt lgkmcnt(8)
    s_add_u32 m0, s33, 37888
    s_mov_b32 s30, 1576960
    buffer_load_dwordx4 v13, s[8:11], s30 offen lds
    s_waitcnt vmcnt(35)
    ds_read_b64_tr_b16 v[248:249], v15 offset:2048
    ds_read_b64_tr_b16 v[250:251], v15 offset:2304
    s_waitcnt lgkmcnt(8)
    s_add_u32 m0, s33, 38912
    s_mov_b32 s30, 1597440
    buffer_load_dwordx4 v13, s[8:11], s30 offen lds
    s_waitcnt vmcnt(35)
    ds_read_b64_tr_b16 v[252:253], v15 offset:3072
    ds_read_b64_tr_b16 v[254:255], v15 offset:3328
    s_waitcnt lgkmcnt(8)
    s_add_u32 m0, s33, 39936
    s_mov_b32 s30, 1617920
    buffer_load_dwordx4 v13, s[8:11], s30 offen lds
    s_waitcnt vmcnt(35)
    ds_read_b64_tr_b16 a[0:1], v15 offset:4096
    ds_read_b64_tr_b16 a[2:3], v15 offset:4352
    s_waitcnt lgkmcnt(8)
    s_add_u32 m0, s33, 0
    s_mov_b32 s30, 1638400
    buffer_load_dwordx4 v13, s[8:11], s30 offen lds
    s_waitcnt vmcnt(35)
    ds_read_b64_tr_b16 a[4:5], v15 offset:5120
    ds_read_b64_tr_b16 a[6:7], v15 offset:5376
    s_waitcnt lgkmcnt(8)
    s_add_u32 m0, s33, 1024
    s_mov_b32 s30, 1658880
    buffer_load_dwordx4 v13, s[8:11], s30 offen lds
    s_waitcnt vmcnt(35)
    ds_read_b64_tr_b16 a[8:9], v15 offset:6144
    ds_read_b64_tr_b16 a[10:11], v15 offset:6400
    s_waitcnt lgkmcnt(8)
    s_add_u32 m0, s33, 2048
    s_mov_b32 s30, 1679360
    buffer_load_dwordx4 v13, s[8:11], s30 offen lds
    s_waitcnt vmcnt(35)
    ds_read_b64_tr_b16 a[12:13], v15 offset:7168
    ds_read_b64_tr_b16 a[14:15], v15 offset:7424
    s_waitcnt lgkmcnt(8)
    s_add_u32 m0, s33, 3072
    s_mov_b32 s30, 1699840
    buffer_load_dwordx4 v13, s[8:11], s30 offen lds
    s_waitcnt vmcnt(35)
    ds_read_b64_tr_b16 a[16:17], v15 offset:8192
    ds_read_b64_tr_b16 a[18:19], v15 offset:8448
    s_waitcnt lgkmcnt(8)
    s_add_u32 m0, s33, 4096
    s_mov_b32 s30, 1720320
    buffer_load_dwordx4 v13, s[8:11], s30 offen lds
    s_waitcnt vmcnt(35)
    ds_read_b64_tr_b16 a[20:21], v15 offset:9216
    ds_read_b64_tr_b16 a[22:23], v15 offset:9472
    s_waitcnt lgkmcnt(8)
    s_add_u32 m0, s33, 5120
    s_mov_b32 s30, 1740800
    buffer_load_dwordx4 v13, s[8:11], s30 offen lds
    s_waitcnt vmcnt(35)
    ds_read_b64_tr_b16 a[24:25], v15 offset:10240
    ds_read_b64_tr_b16 a[26:27], v15 offset:10496
    s_waitcnt lgkmcnt(8)
    s_add_u32 m0, s33, 6144
    s_mov_b32 s30, 1761280
    buffer_load_dwordx4 v13, s[8:11], s30 offen lds
    s_waitcnt vmcnt(35)
    ds_read_b64_tr_b16 a[28:29], v15 offset:11264
    ds_read_b64_tr_b16 a[30:31], v15 offset:11520
    s_waitcnt lgkmcnt(8)
    s_add_u32 m0, s33, 7168
    s_mov_b32 s30, 1781760
    buffer_load_dwordx4 v13, s[8:11], s30 offen lds
    s_waitcnt vmcnt(35)
    ds_read_b64_tr_b16 a[32:33], v15 offset:12288
    ds_read_b64_tr_b16 a[34:35], v15 offset:12544
    s_waitcnt lgkmcnt(8)
    s_add_u32 m0, s33, 8192
    s_mov_b32 s30, 1802240
    buffer_load_dwordx4 v13, s[8:11], s30 offen lds
    s_waitcnt vmcnt(35)
    ds_read_b64_tr_b16 a[36:37], v15 offset:13312
    ds_read_b64_tr_b16 a[38:39], v15 offset:13568
    s_waitcnt lgkmcnt(8)
    s_add_u32 m0, s33, 9216
    s_mov_b32 s30, 1822720
    buffer_load_dwordx4 v13, s[8:11], s30 offen lds
    s_waitcnt vmcnt(35)
    ds_read_b64_tr_b16 a[40:41], v15 offset:14336
    ds_read_b64_tr_b16 a[42:43], v15 offset:14592
    s_waitcnt lgkmcnt(8)
    s_add_u32 m0, s33, 10240
    s_mov_b32 s30, 1843200
    buffer_load_dwordx4 v13, s[8:11], s30 offen lds
    s_waitcnt vmcnt(35)
    ds_read_b64_tr_b16 a[44:45], v15 offset:15360
    ds_read_b64_tr_b16 a[46:47], v15 offset:15616
    s_waitcnt lgkmcnt(8)
    s_add_u32 m0, s33, 11264
    s_mov_b32 s30, 1863680
    buffer_load_dwordx4 v13, s[8:11], s30 offen lds
    s_waitcnt vmcnt(35)
    ds_read_b64_tr_b16 a[48:49], v15 offset:16384
    ds_read_b64_tr_b16 a[50:51], v15 offset:16640
    s_waitcnt lgkmcnt(8)
    s_add_u32 m0, s33, 12288
    s_mov_b32 s30, 1884160
    buffer_load_dwordx4 v13, s[8:11], s30 offen lds
    s_waitcnt vmcnt(35)
    ds_read_b64_tr_b16 a[52:53], v15 offset:17408
    ds_read_b64_tr_b16 a[54:55], v15 offset:17664
    s_waitcnt lgkmcnt(8)
    s_add_u32 m0, s33, 13312
    s_mov_b32 s30, 1904640
    buffer_load_dwordx4 v13, s[8:11], s30 offen lds
    s_waitcnt vmcnt(35)
    ds_read_b64_tr_b16 a[56:57], v15 offset:18432
    ds_read_b64_tr_b16 a[58:59], v15 offset:18688
    s_waitcnt lgkmcnt(8)
    s_add_u32 m0, s33, 14336
    s_mov_b32 s30, 1925120
    buffer_load_dwordx4 v13, s[8:11], s30 offen lds
    s_waitcnt vmcnt(35)
    ds_read_b64_tr_b16 a[60:61], v15 offset:19456
    ds_read_b64_tr_b16 a[62:63], v15 offset:19712
    s_waitcnt lgkmcnt(8)
    s_add_u32 m0, s33, 15360
    s_mov_b32 s30, 1945600
    buffer_load_dwordx4 v13, s[8:11], s30 offen lds
    s_waitcnt vmcnt(35)
    ds_read_b64_tr_b16 a[64:65], v15 offset:20480
    ds_read_b64_tr_b16 a[66:67], v15 offset:20736
    s_waitcnt lgkmcnt(8)
    s_add_u32 m0, s33, 16384
    s_mov_b32 s30, 1966080
    buffer_load_dwordx4 v13, s[8:11], s30 offen lds
    s_waitcnt vmcnt(35)
    ds_read_b64_tr_b16 a[68:69], v15 offset:21504
    ds_read_b64_tr_b16 a[70:71], v15 offset:21760
    s_waitcnt lgkmcnt(8)
    s_add_u32 m0, s33, 17408
    s_mov_b32 s30, 1986560
    buffer_load_dwordx4 v13, s[8:11], s30 offen lds
    s_waitcnt vmcnt(35)
    ds_read_b64_tr_b16 a[72:73], v15 offset:22528
    ds_read_b64_tr_b16 a[74:75], v15 offset:22784
    s_waitcnt lgkmcnt(8)
    s_add_u32 m0, s33, 18432
    s_mov_b32 s30, 2007040
    buffer_load_dwordx4 v13, s[8:11], s30 offen lds
    s_waitcnt vmcnt(35)
    ds_read_b64_tr_b16 a[76:77], v15 offset:23552
    ds_read_b64_tr_b16 a[78:79], v15 offset:23808
    s_waitcnt lgkmcnt(8)
    s_add_u32 m0, s33, 19456
    s_mov_b32 s30, 2027520
    buffer_load_dwordx4 v13, s[8:11], s30 offen lds
    s_waitcnt vmcnt(35)
    ds_read_b64_tr_b16 a[80:81], v15 offset:24576
    ds_read_b64_tr_b16 a[82:83], v15 offset:24832
    s_waitcnt lgkmcnt(8)
    s_add_u32 m0, s33, 20480
    s_mov_b32 s30, 2048000
    buffer_load_dwordx4 v13, s[8:11], s30 offen lds
    s_waitcnt vmcnt(35)
    ds_read_b64_tr_b16 a[84:85], v15 offset:25600
    ds_read_b64_tr_b16 a[86:87], v15 offset:25856
    s_waitcnt lgkmcnt(8)
    s_add_u32 m0, s33, 21504
    s_mov_b32 s30, 2068480
    buffer_load_dwordx4 v13, s[8:11], s30 offen lds
    s_waitcnt vmcnt(35)
    ds_read_b64_tr_b16 a[88:89], v15 offset:26624
    ds_read_b64_tr_b16 a[90:91], v15 offset:26880
    s_waitcnt lgkmcnt(8)
    s_add_u32 m0, s33, 22528
    s_mov_b32 s30, 2088960
    buffer_load_dwordx4 v13, s[8:11], s30 offen lds
    s_waitcnt vmcnt(35)
    ds_read_b64_tr_b16 a[92:93], v15 offset:27648
    ds_read_b64_tr_b16 a[94:95], v15 offset:27904
    s_waitcnt lgkmcnt(8)
    s_add_u32 m0, s33, 23552
    s_mov_b32 s30, 2109440
    buffer_load_dwordx4 v13, s[8:11], s30 offen lds
    s_waitcnt vmcnt(35)
    ds_read_b64_tr_b16 a[96:97], v15 offset:28672
    ds_read_b64_tr_b16 a[98:99], v15 offset:28928
    s_waitcnt lgkmcnt(8)
    s_add_u32 m0, s33, 24576
    s_mov_b32 s30, 2129920
    buffer_load_dwordx4 v13, s[8:11], s30 offen lds
    s_waitcnt vmcnt(35)
    ds_read_b64_tr_b16 a[100:101], v15 offset:29696
    ds_read_b64_tr_b16 a[102:103], v15 offset:29952
    s_waitcnt lgkmcnt(8)
    s_add_u32 m0, s33, 25600
    s_mov_b32 s30, 2150400
    buffer_load_dwordx4 v13, s[8:11], s30 offen lds
    s_waitcnt vmcnt(35)
    ds_read_b64_tr_b16 a[104:105], v15 offset:30720
    ds_read_b64_tr_b16 a[106:107], v15 offset:30976
    s_waitcnt lgkmcnt(8)
    s_add_u32 m0, s33, 26624
    s_mov_b32 s30, 2170880
    buffer_load_dwordx4 v13, s[8:11], s30 offen lds
    s_waitcnt vmcnt(35)
    ds_read_b64_tr_b16 a[108:109], v15 offset:31744
    ds_read_b64_tr_b16 a[110:111], v15 offset:32000
    s_waitcnt lgkmcnt(8)
    s_add_u32 m0, s33, 27648
    s_mov_b32 s30, 2191360
    buffer_load_dwordx4 v13, s[8:11], s30 offen lds
    s_waitcnt vmcnt(35)
    ds_read_b64_tr_b16 a[112:113], v15 offset:32768
    ds_read_b64_tr_b16 a[114:115], v15 offset:33024
    s_waitcnt vmcnt(34)
    ds_read_b64_tr_b16 a[116:117], v15 offset:33792
    ds_read_b64_tr_b16 a[118:119], v15 offset:34048
    s_waitcnt vmcnt(33)
    ds_read_b64_tr_b16 a[120:121], v15 offset:34816
    ds_read_b64_tr_b16 a[122:123], v15 offset:35072
    s_waitcnt vmcnt(32)
    ds_read_b64_tr_b16 a[124:125], v15 offset:35840
    ds_read_b64_tr_b16 a[126:127], v15 offset:36096
    s_waitcnt vmcnt(31)
    ds_read_b64_tr_b16 a[128:129], v15 offset:36864
    ds_read_b64_tr_b16 a[130:131], v15 offset:37120
    s_waitcnt vmcnt(30)
    ds_read_b64_tr_b16 a[132:133], v15 offset:37888
    ds_read_b64_tr_b16 a[134:135], v15 offset:38144
    s_waitcnt vmcnt(29)
    ds_read_b64_tr_b16 a[136:137], v15 offset:38912
    ds_read_b64_tr_b16 a[138:139], v15 offset:39168
    s_waitcnt vmcnt(28)
    ds_read_b64_tr_b16 a[140:141], v15 offset:39936
    ds_read_b64_tr_b16 a[142:143], v15 offset:40192
    s_waitcnt vmcnt(27)
    ds_read_b64_tr_b16 a[144:145], v15 offset:0
    ds_read_b64_tr_b16 a[146:147], v15 offset:256
    s_waitcnt vmcnt(26)
    ds_read_b64_tr_b16 a[148:149], v15 offset:1024
    ds_read_b64_tr_b16 a[150:151], v15 offset:1280
    s_waitcnt vmcnt(25)
    ds_read_b64_tr_b16 a[152:153], v15 offset:2048
    ds_read_b64_tr_b16 a[154:155], v15 offset:2304
    s_waitcnt vmcnt(24)
    ds_read_b64_tr_b16 a[156:157], v15 offset:3072
    ds_read_b64_tr_b16 a[158:159], v15 offset:3328
    s_waitcnt vmcnt(23)
    ds_read_b64_tr_b16 a[160:161], v15 offset:4096
    ds_read_b64_tr_b16 a[162:163], v15 offset:4352
    s_waitcnt vmcnt(22)
    ds_read_b64_tr_b16 a[164:165], v15 offset:5120
    ds_read_b64_tr_b16 a[166:167], v15 offset:5376
    s_waitcnt vmcnt(21)
    ds_read_b64_tr_b16 a[168:169], v15 offset:6144
    ds_read_b64_tr_b16 a[170:171], v15 offset:6400
    s_waitcnt vmcnt(20)
    ds_read_b64_tr_b16 a[172:173], v15 offset:7168
    ds_read_b64_tr_b16 a[174:175], v15 offset:7424
    s_waitcnt vmcnt(19)
    ds_read_b64_tr_b16 a[176:177], v15 offset:8192
    ds_read_b64_tr_b16 a[178:179], v15 offset:8448
    s_waitcnt vmcnt(18)
    ds_read_b64_tr_b16 a[180:181], v15 offset:9216
    ds_read_b64_tr_b16 a[182:183], v15 offset:9472
    s_waitcnt vmcnt(17)
    ds_read_b64_tr_b16 a[184:185], v15 offset:10240
    ds_read_b64_tr_b16 a[186:187], v15 offset:10496
    s_waitcnt vmcnt(16)
    ds_read_b64_tr_b16 a[188:189], v15 offset:11264
    ds_read_b64_tr_b16 a[190:191], v15 offset:11520
    s_waitcnt vmcnt(15)
    ds_read_b64_tr_b16 a[192:193], v15 offset:12288
    ds_read_b64_tr_b16 a[194:195], v15 offset:12544
    s_waitcnt vmcnt(14)
    ds_read_b64_tr_b16 a[196:197], v15 offset:13312
    ds_read_b64_tr_b16 a[198:199], v15 offset:13568
    s_waitcnt vmcnt(13)
    ds_read_b64_tr_b16 a[200:201], v15 offset:14336
    ds_read_b64_tr_b16 a[202:203], v15 offset:14592
    s_waitcnt vmcnt(12)
    ds_read_b64_tr_b16 a[204:205], v15 offset:15360
    ds_read_b64_tr_b16 a[206:207], v15 offset:15616
    s_waitcnt vmcnt(11)
    ds_read_b64_tr_b16 a[208:209], v15 offset:16384
    ds_read_b64_tr_b16 a[210:211], v15 offset:16640
    s_waitcnt vmcnt(10)
    ds_read_b64_tr_b16 a[212:213], v15 offset:17408
    ds_read_b64_tr_b16 a[214:215], v15 offset:17664
    s_waitcnt vmcnt(9)
    ds_read_b64_tr_b16 a[216:217], v15 offset:18432
    ds_read_b64_tr_b16 a[218:219], v15 offset:18688
    s_waitcnt vmcnt(8)
    ds_read_b64_tr_b16 a[220:221], v15 offset:19456
    ds_read_b64_tr_b16 a[222:223], v15 offset:19712
    s_waitcnt vmcnt(7)
    ds_read_b64_tr_b16 a[224:225], v15 offset:20480
    ds_read_b64_tr_b16 a[226:227], v15 offset:20736
    s_waitcnt vmcnt(6)
    ds_read_b64_tr_b16 a[228:229], v15 offset:21504
    ds_read_b64_tr_b16 a[230:231], v15 offset:21760
    s_waitcnt vmcnt(5)
    ds_read_b64_tr_b16 a[232:233], v15 offset:22528
    ds_read_b64_tr_b16 a[234:235], v15 offset:22784
    s_waitcnt vmcnt(4)
    ds_read_b64_tr_b16 a[236:237], v15 offset:23552
    ds_read_b64_tr_b16 a[238:239], v15 offset:23808
    s_waitcnt vmcnt(3)
    ds_read_b64_tr_b16 a[240:241], v15 offset:24576
    ds_read_b64_tr_b16 a[242:243], v15 offset:24832
    s_waitcnt vmcnt(2)
    ds_read_b64_tr_b16 a[244:245], v15 offset:25600
    ds_read_b64_tr_b16 a[246:247], v15 offset:25856
    s_waitcnt vmcnt(1)
    ds_read_b64_tr_b16 a[248:249], v15 offset:26624
    ds_read_b64_tr_b16 a[250:251], v15 offset:26880
    s_waitcnt vmcnt(0)
    ds_read_b64_tr_b16 a[252:253], v15 offset:27648
    ds_read_b64_tr_b16 a[254:255], v15 offset:27904
    s_waitcnt lgkmcnt(0)
    v_and_b32 v13, 31, v12
    v_lshrrev_b32 v14, 5, v12
    v_mov_b32 v4, v0
    v_mul_u32_u24 v3, 2560, v14
    v_lshl_add_u32 v3, v13, 3, v3
    v_add_u32 v3, 40960, v3
    s_mul_i32 s30, s12, 2048
    v_add_u32 v6, s30, v0
    v_add_u32 v7, 1024, v6
    s_mov_b32 s40, 0xc0135761
    s_mov_b32 s41, 0xbdd2d3e8
    s_mov_b32 s42, 0x3acccccd
    s_mov_b32 s43, 0x3727c5ac
    s_mov_b32 s23, 0
    v_mov_b32 v16, 128
P_145:
    global_load_dword v17, v16, s[90:91] sc1
    s_waitcnt vmcnt(0)
    v_readfirstlane_b32 s85, v17
    s_and_b32 s86, s85, 255
    s_cmp_ge_u32 s86, 70
    s_cbranch_scc1 P_146
    s_add_u32 s23, s23, 1
    s_cmp_gt_u32 s23, 65536
    s_cbranch_scc1 L_exit
    s_sleep 16
    s_branch P_145
P_146:
    s_lshr_b32 s85, s85, 8
    s_mov_b32 s80, 0
RM4_job:
    s_mul_i32 s18, s14, 41943040
    s_add_u32 s18, s18, 188743680
    s_mul_i32 s19, s14, 0
    s_add_u32 s19, s19, 213909504
    s_mul_i32 s20, s14, 393216
    s_add_u32 s20, s20, 168034304
    s_mul_i32 s21, s14, 393216
    s_add_u32 s21, s21, 168067072
    s_lshl_b32 s30, s13, 2
    s_add_u32 s30, s30, s12
    s_lshl_b32 s31, s30, 7
    s_add_u32 s21, s21, s31
    s_add_u32 s27, s20, s31
    s_lshl_b32 s31, s30, 8
    s_add_u32 s28, s19, s31
    s_add_u32 s28, s28, 40960
    s_lshl_b32 s32, s30, 11
    s_mul_i32 s31, s12, 54
    s_and_b32 s31, s31, -4
    s_lshl_b32 s31, s31, 5
    s_add_u32 s20, s20, s31
    s_mov_b32 s25, 0
    s_mov_b32 s16, 0
    s_mov_b32 s17, 2
    s_mov_b32 s46, 64
    s_lshl_b32 s33, s13, 13
    s_mul_i32 s34, s14, 41943040
    s_add_u32 s34, s34, 181403648
    s_mul_i32 s35, s14, 41943040
    s_add_u32 s35, s35, 175112192
    s_add_u32 s34, s34, s32
    s_add_u32 s35, s35, s32
    s_mov_b32 s16, s15
    s_lshl_b32 s30, s15, 15
    s_add_u32 s21, s21, s30
    s_cmp_eq_u32 s14, 0
    s_cbranch_scc0 G_147
    s_mov_b32 s36, 49152
    s_add_u32 s19, s19, s33
    s_mov_b32 s8, s4
    s_mov_b32 s9, s5
    s_mov_b32 s10, 268435456
    s_branch G_148
G_147:
    s_load_dwordx2 s[8:9], s[0:1], 96
    s_mov_b32 s10, 2621440
    s_mov_b32 s36, 40960
    s_lshl_b32 s19, s13, 8
    v_mul_u32_u24 v6, 1280, v13
    v_lshl_add_u32 v6, v14, 4, v6
    s_lshl_b32 s30, s12, 6
    v_add_u32 v6, s30, v6
    v_add_u32 v7, 32, v6
    s_waitcnt lgkmcnt(0)
G_148:
    s_mov_b32 s22, 0
    s_mov_b32 s47, 0
    s_mov_b32 s26, 0
    s_mov_b32 s24, 0
    s_mov_b32 s81, 0
    s_cmp_eq_u32 s14, 0
    s_cselect_b32 s30, 6, 7
    s_lshr_b32 s30, s85, s30
    s_and_b32 s30, s30, 1
    s_lshl_b32 s30, s30, 13
    s_andn2_b32 s20, s20, 0x2000
    s_or_b32 s20, s20, s30
    s_lshr_b32 s30, s85, 5
    s_and_b32 s30, s30, 1
    s_lshl_b32 s30, s30, 13
    s_andn2_b32 s21, s21, 0x2000
    s_or_b32 s21, s21, s30
    s_sub_u32 s86, s20, 393216
    s_lshr_b32 s30, s85, 6
    s_and_b32 s30, s30, 1
    s_lshl_b32 s30, s30, 13
    s_andn2_b32 s86, s86, 0x2000
    s_or_b32 s86, s86, s30
    s_sub_u32 s86, s20, s86
    s_barrier
    v_min_u32 v20, 52, v5
    v_lshlrev_b32 v20, 5, v20
.p2align 6
RM4_loop:
    s_cmp_eq_u32 s22, 1
    s_cbranch_scc1 G_149
    s_cmp_eq_u32 s22, 2
    s_cbranch_scc1 G_151
RM4_poll:
    s_and_b32 s31, s16, s25
    s_lshl_b32 s31, s31, 15
    s_add_u32 s31, s31, s20
    s_add_u32 s37, s16, 1
    s_min_u32 s37, s37, 64
    s_mul_i32 s84, s16, s14
    s_cmp_eq_u32 s84, 63
    s_cselect_b32 s37, 65, s37
    s_cselect_b32 s84, s86, 0
    s_sub_u32 s31, s31, s84
    v_mbcnt_lo_u32_b32 v16, -1, 0
    v_min_u32 v16, 13, v16
    v_lshlrev_b32 v16, 7, v16
    s_mov_b32 s23, 0
    s_mov_b64 exec, 0xffffffff
P_152:
    buffer_load_dword v17, v16, s[4:7], s31 offen sc1
    s_waitcnt vmcnt(0)
    v_cmp_gt_u32 vcc, s37, v17
    s_cbranch_vccz P_153
    s_add_u32 s23, s23, 1
    s_cmp_gt_u32 s23, 65536
    s_cbranch_scc1 L_exit
    s_sleep 1
    s_branch P_152
P_153:
    s_mov_b64 exec, -1
RM4_dma:
    s_mul_i32 s38, s16, 114688
    s_add_u32 s38, s38, s18
    s_mov_b32 s39, s24
    s_mul_i32 s30, s16, 49152
    s_add_u32 s30, s30, s34
    buffer_load_dwordx4 v[64:67], v0, s[4:7], s30 offen sc1
    buffer_load_dwordx4 v[68:71], v0, s[4:7], s30 offen offset:1024 sc1
    s_mul_i32 s30, s16, 49152
    s_add_u32 s30, s30, s35
    buffer_load_dwordx4 v[72:75], v0, s[4:7], s30 offen sc1
    buffer_load_dwordx4 v[76:79], v0, s[4:7], s30 offen offset:1024 sc1
    s_mul_i32 s30, s12, 27648
    s_add_u32 s38, s38, s30
    s_add_u32 s39, s39, s30
    s_mov_b32 m0, s39
    s_nop 0
    buffer_load_dwordx4 v4, s[4:7], s38 offen offset:0 sc1 lds
    buffer_load_dwordx4 v4, s[4:7], s38 offen offset:1024 sc1 lds
    buffer_load_dwordx4 v4, s[4:7], s38 offen offset:2048 sc1 lds
    buffer_load_dwordx4 v4, s[4:7], s38 offen offset:3072 sc1 lds
    s_add_u32 s38, s38, 4096
    s_add_u32 s39, s39, 4096
    s_mov_b32 m0, s39
    s_nop 0
    buffer_load_dwordx4 v4, s[4:7], s38 offen offset:0 sc1 lds
    buffer_load_dwordx4 v4, s[4:7], s38 offen offset:1024 sc1 lds
    buffer_load_dwordx4 v4, s[4:7], s38 offen offset:2048 sc1 lds
    buffer_load_dwordx4 v4, s[4:7], s38 offen offset:3072 sc1 lds
    s_add_u32 s38, s38, 4096
    s_add_u32 s39, s39, 4096
    s_mov_b32 m0, s39
    s_nop 0
    buffer_load_dwordx4 v4, s[4:7], s38 offen offset:0 sc1 lds
    buffer_load_dwordx4 v4, s[4:7], s38 offen offset:1024 sc1 lds
G_151:
    s_waitcnt vmcnt(6)
    s_branch G_150
G_149:
    s_waitcnt vmcnt(0)
G_150:
    v_add_u32 v1, s24, v0
    v_add_u32 v2, 0x10000, v1
    v_add_u32 v9, s24, v3
    s_add_u32 s29, s16, s17
    s_cmp_eq_u32 s22, 1
    s_cselect_b64 vcc, -1, 0
    s_barrier
    ds_read_b128 v[24:27], v1 offset:0
    ds_read_b128 v[28:31], v1 offset:27648
    ds_read_b128 v[32:35], v1 offset:55296
    ds_read_b128 v[36:39], v2 offset:17408
    ds_read_b128 v[40:43], v1 offset:1024
    s_and_b32 s31, s29, s25
    s_lshl_b32 s31, s31, 15
    s_add_u32 s31, s31, s20
    s_add_u32 s37, s29, 1
    s_min_u32 s37, s37, 64
    s_mul_i32 s84, s29, s14
    s_cmp_eq_u32 s84, 63
    s_cselect_b32 s37, 65, s37
    s_cselect_b32 s84, s86, 0
    s_sub_u32 s31, s31, s84
    s_mov_b32 s62, s31
    v_lshlrev_b32 v48, 16, v64
    v_and_b32 v49, 0xffff0000, v64
    v_lshlrev_b32 v50, 16, v65
    v_and_b32 v51, 0xffff0000, v65
    v_lshlrev_b32 v52, 16, v66
    v_and_b32 v53, 0xffff0000, v66
    v_lshlrev_b32 v54, 16, v67
    v_and_b32 v55, 0xffff0000, v67
    v_lshlrev_b32 v56, 16, v68
    v_and_b32 v57, 0xffff0000, v68
    v_lshlrev_b32 v58, 16, v69
    v_and_b32 v59, 0xffff0000, v69
    v_lshlrev_b32 v60, 16, v70
    v_and_b32 v61, 0xffff0000, v70
    v_lshlrev_b32 v62, 16, v71
    v_and_b32 v63, 0xffff0000, v71
    v_lshlrev_b32 v14, 16, v72
    v_and_b32 v15, 0xffff0000, v72
    v_pk_add_f32 v[48:49], v[48:49], v[14:15]
    v_lshlrev_b32 v14, 16, v73
    v_and_b32 v15, 0xffff0000, v73
    v_pk_add_f32 v[50:51], v[50:51], v[14:15]
    v_lshlrev_b32 v14, 16, v74
    v_and_b32 v15, 0xffff0000, v74
    v_pk_add_f32 v[52:53], v[52:53], v[14:15]
    v_lshlrev_b32 v14, 16, v75
    v_and_b32 v15, 0xffff0000, v75
    v_pk_add_f32 v[54:55], v[54:55], v[14:15]
    v_lshlrev_b32 v14, 16, v76
    v_and_b32 v15, 0xffff0000, v76
    v_pk_add_f32 v[56:57], v[56:57], v[14:15]
    v_lshlrev_b32 v14, 16, v77
    v_and_b32 v15, 0xffff0000, v77
    v_pk_add_f32 v[58:59], v[58:59], v[14:15]
    v_lshlrev_b32 v14, 16, v78
    v_and_b32 v15, 0xffff0000, v78
    v_pk_add_f32 v[60:61], v[60:61], v[14:15]
    v_lshlrev_b32 v14, 16, v79
    v_and_b32 v15, 0xffff0000, v79
    v_pk_add_f32 v[62:63], v[62:63], v[14:15]
    s_nop 1
    s_waitcnt lgkmcnt(4)
    v_mfma_f32_32x32x16_bf16 v[48:63], v[80:83], v[24:27], v[48:63]
    ds_read_b128 v[44:47], v1 offset:28672
    s_waitcnt lgkmcnt(4)
    v_mfma_f32_32x32x16_bf16 v[48:63], v[188:191], v[28:31], v[48:63]
    ds_read_b128 v[24:27], v1 offset:56320
    buffer_load_dwordx4 v4, s[4:7], s38 offen offset:2048 sc1 lds
    s_waitcnt lgkmcnt(4)
    v_mfma_f32_32x32x16_bf16 v[48:63], a[40:43], v[32:35], v[48:63]
    ds_read_b128 v[28:31], v2 offset:18432
    s_waitcnt lgkmcnt(4)
    v_mfma_f32_32x32x16_bf16 v[48:63], a[148:151], v[36:39], v[48:63]
    ds_read_b128 v[32:35], v1 offset:2048
    buffer_load_dwordx4 v4, s[4:7], s38 offen offset:3072 sc1 lds
    s_waitcnt lgkmcnt(4)
    v_mfma_f32_32x32x16_bf16 v[48:63], v[84:87], v[40:43], v[48:63]
    ds_read_b128 v[36:39], v1 offset:29696
    s_waitcnt lgkmcnt(4)
    v_mfma_f32_32x32x16_bf16 v[48:63], v[192:195], v[44:47], v[48:63]
    ds_read_b128 v[40:43], v1 offset:57344
    s_add_u32 s38, s38, 4096
    s_add_u32 s39, s39, 4096
    s_mov_b32 m0, s39
    s_nop 0
    buffer_load_dwordx4 v4, s[4:7], s38 offen offset:0 sc1 lds
    s_waitcnt lgkmcnt(4)
    v_mfma_f32_32x32x16_bf16 v[48:63], a[44:47], v[24:27], v[48:63]
    ds_read_b128 v[44:47], v2 offset:19456
    s_waitcnt lgkmcnt(4)
    v_mfma_f32_32x32x16_bf16 v[48:63], a[152:155], v[28:31], v[48:63]
    ds_read_b128 v[24:27], v1 offset:3072
    buffer_load_dwordx4 v4, s[4:7], s38 offen offset:1024 sc1 lds
    s_waitcnt lgkmcnt(4)
    v_mfma_f32_32x32x16_bf16 v[48:63], v[88:91], v[32:35], v[48:63]
    ds_read_b128 v[28:31], v1 offset:30720
    s_waitcnt lgkmcnt(4)
    v_mfma_f32_32x32x16_bf16 v[48:63], v[196:199], v[36:39], v[48:63]
    ds_read_b128 v[32:35], v1 offset:58368
    buffer_load_dwordx4 v4, s[4:7], s38 offen offset:2048 sc1 lds
    s_waitcnt lgkmcnt(4)
    v_mfma_f32_32x32x16_bf16 v[48:63], a[48:51], v[40:43], v[48:63]
    ds_read_b128 v[36:39], v2 offset:20480
    s_waitcnt lgkmcnt(4)
    v_mfma_f32_32x32x16_bf16 v[48:63], a[156:159], v[44:47], v[48:63]
    s_waitcnt vmcnt(7)
    s_barrier
    ds_read_b128 v[40:43], v1 offset:4096
    buffer_load_dwordx4 v4, s[4:7], s38 offen offset:3072 sc1 lds
    s_waitcnt lgkmcnt(4)
    v_mfma_f32_32x32x16_bf16 v[48:63], v[92:95], v[24:27], v[48:63]
    ds_read_b128 v[44:47], v1 offset:31744
    s_waitcnt lgkmcnt(4)
    v_mfma_f32_32x32x16_bf16 v[48:63], v[200:203], v[28:31], v[48:63]
    ds_read_b128 v[24:27], v1 offset:59392
    s_add_u32 s38, s38, 4096
    s_add_u32 s39, s39, 4096
    s_mov_b32 m0, s39
    s_nop 0
    buffer_load_dwordx4 v4, s[4:7], s38 offen offset:0 sc1 lds
    s_waitcnt lgkmcnt(4)
    v_mfma_f32_32x32x16_bf16 v[48:63], a[52:55], v[32:35], v[48:63]
    ds_read_b128 v[28:31], v2 offset:21504
    s_waitcnt lgkmcnt(4)
    v_mfma_f32_32x32x16_bf16 v[48:63], a[160:163], v[36:39], v[48:63]
    ds_read_b128 v[32:35], v1 offset:5120
    buffer_load_dwordx4 v4, s[4:7], s38 offen offset:1024 sc1 lds
    s_waitcnt lgkmcnt(4)
    v_mfma_f32_32x32x16_bf16 v[48:63], v[96:99], v[40:43], v[48:63]
    ds_read_b128 v[36:39], v1 offset:32768
    s_waitcnt lgkmcnt(4)
    v_mfma_f32_32x32x16_bf16 v[48:63], v[204:207], v[44:47], v[48:63]
    ds_read_b128 v[40:43], v1 offset:60416
    buffer_load_dwordx4 v4, s[4:7], s38 offen offset:2048 sc1 lds
    s_waitcnt lgkmcnt(4)
    v_mfma_f32_32x32x16_bf16 v[48:63], a[56:59], v[24:27], v[48:63]
    ds_read_b128 v[44:47], v2 offset:22528
    s_waitcnt lgkmcnt(4)
    v_mfma_f32_32x32x16_bf16 v[48:63], a[164:167], v[28:31], v[48:63]
    ds_read_b128 v[24:27], v1 offset:6144
    buffer_load_dwordx4 v4, s[4:7], s38 offen offset:3072 sc1 lds
    s_waitcnt lgkmcnt(4)
    v_mfma_f32_32x32x16_bf16 v[48:63], v[100:103], v[32:35], v[48:63]
    ds_read_b128 v[28:31], v1 offset:33792
    s_waitcnt lgkmcnt(4)
    v_mfma_f32_32x32x16_bf16 v[48:63], v[208:211], v[36:39], v[48:63]
    ds_read_b128 v[32:35], v1 offset:61440
    s_add_u32 s38, s38, 4096
    s_add_u32 s39, s39, 4096
    s_mov_b32 m0, s39
    s_nop 0
    buffer_load_dwordx4 v4, s[4:7], s38 offen offset:0 sc1 lds
    s_waitcnt lgkmcnt(4)
    v_mfma_f32_32x32x16_bf16 v[48:63], a[60:63], v[40:43], v[48:63]
    ds_read_b128 v[36:39], v2 offset:23552
    s_waitcnt lgkmcnt(4)
    v_mfma_f32_32x32x16_bf16 v[48:63], a[168:171], v[44:47], v[48:63]
    ds_read_b128 v[40:43], v1 offset:7168
    buffer_load_dwordx4 v4, s[4:7], s38 offen offset:1024 sc1 lds
    s_waitcnt lgkmcnt(4)
    v_mfma_f32_32x32x16_bf16 v[48:63], v[104:107], v[24:27], v[48:63]
    ds_read_b128 v[44:47], v1 offset:34816
    s_waitcnt lgkmcnt(4)
    v_mfma_f32_32x32x16_bf16 v[48:63], v[212:215], v[28:31], v[48:63]
    ds_read_b128 v[24:27], v1 offset:62464
    buffer_load_dwordx4 v4, s[4:7], s38 offen offset:2048 sc1 lds
    s_waitcnt lgkmcnt(4)
    v_mfma_f32_32x32x16_bf16 v[48:63], a[64:67], v[32:35], v[48:63]
    ds_read_b128 v[28:31], v2 offset:24576
    s_waitcnt lgkmcnt(4)
    v_mfma_f32_32x32x16_bf16 v[48:63], a[172:175], v[36:39], v[48:63]
    s_waitcnt vmcnt(11)
    s_barrier
    ds_read_b128 v[32:35], v1 offset:8192
    buffer_load_dwordx4 v4, s[4:7], s38 offen offset:3072 sc1 lds
    s_waitcnt lgkmcnt(4)
    v_mfma_f32_32x32x16_bf16 v[48:63], v[108:111], v[40:43], v[48:63]
    ds_read_b128 v[36:39], v1 offset:35840
    s_waitcnt lgkmcnt(4)
    v_mfma_f32_32x32x16_bf16 v[48:63], v[216:219], v[44:47], v[48:63]
    ds_read_b128 v[40:43], v1 offset:63488
    s_add_u32 s38, s38, 4096
    s_add_u32 s39, s39, 4096
    s_mov_b32 m0, s39
    s_nop 0
    buffer_load_dwordx4 v4, s[4:7], s38 offen offset:0 sc1 lds
    s_waitcnt lgkmcnt(4)
    v_mfma_f32_32x32x16_bf16 v[48:63], a[68:71], v[24:27], v[48:63]
    ds_read_b128 v[44:47], v2 offset:25600
    s_waitcnt lgkmcnt(4)
    v_mfma_f32_32x32x16_bf16 v[48:63], a[176:179], v[28:31], v[48:63]
    ds_read_b128 v[24:27], v1 offset:9216
    buffer_load_dwordx4 v4, s[4:7], s38 offen offset:1024 sc1 lds
    s_waitcnt lgkmcnt(4)
    v_mfma_f32_32x32x16_bf16 v[48:63], v[112:115], v[32:35], v[48:63]
    ds_read_b128 v[28:31], v1 offset:36864
    s_waitcnt lgkmcnt(4)
    v_mfma_f32_32x32x16_bf16 v[48:63], v[220:223], v[36:39], v[48:63]
    ds_read_b128 v[32:35], v1 offset:64512
    buffer_load_dwordx4 v4, s[4:7], s38 offen offset:2048 sc1 lds
    s_waitcnt lgkmcnt(4)
    v_mfma_f32_32x32x16_bf16 v[48:63], a[72:75], v[40:43], v[48:63]
    ds_read_b128 v[36:39], v2 offset:26624
    s_waitcnt lgkmcnt(4)
    v_mfma_f32_32x32x16_bf16 v[48:63], a[180:183], v[44:47], v[48:63]
    ds_read_b128 v[40:43], v1 offset:10240
    s_waitcnt lgkmcnt(4)
    v_mfma_f32_32x32x16_bf16 v[48:63], v[116:119], v[24:27], v[48:63]
    ds_read_b128 v[44:47], v1 offset:37888
    s_waitcnt lgkmcnt(4)
    v_mfma_f32_32x32x16_bf16 v[48:63], v[224:227], v[28:31], v[48:63]
    ds_read_b128 v[24:27], v2 offset:0
    s_waitcnt lgkmcnt(4)
    v_mfma_f32_32x32x16_bf16 v[48:63], a[76:79], v[32:35], v[48:63]
    ds_read_b128 v[28:31], v2 offset:27648
    s_waitcnt lgkmcnt(4)
    v_mfma_f32_32x32x16_bf16 v[48:63], a[184:187], v[36:39], v[48:63]
    ds_read_b128 v[32:35], v1 offset:11264
    s_waitcnt lgkmcnt(4)
    v_mfma_f32_32x32x16_bf16 v[48:63], v[120:123], v[40:43], v[48:63]
    ds_read_b128 v[36:39], v1 offset:38912
    s_waitcnt lgkmcnt(4)
    v_mfma_f32_32x32x16_bf16 v[48:63], v[228:231], v[44:47], v[48:63]
    ds_read_b128 v[40:43], v2 offset:1024
    s_waitcnt lgkmcnt(4)
    v_mfma_f32_32x32x16_bf16 v[48:63], a[80:83], v[24:27], v[48:63]
    ds_read_b128 v[44:47], v2 offset:28672
    s_waitcnt lgkmcnt(4)
    v_mfma_f32_32x32x16_bf16 v[48:63], a[188:191], v[28:31], v[48:63]
    s_waitcnt vmcnt(10)
    s_barrier
    ds_read_b128 v[24:27], v1 offset:12288
    s_waitcnt lgkmcnt(4)
    v_mfma_f32_32x32x16_bf16 v[48:63], v[124:127], v[32:35], v[48:63]
    ds_read_b128 v[28:31], v1 offset:39936
    s_waitcnt lgkmcnt(4)
    v_mfma_f32_32x32x16_bf16 v[48:63], v[232:235], v[36:39], v[48:63]
    ds_read_b128 v[32:35], v2 offset:2048
    s_waitcnt lgkmcnt(4)
    v_mfma_f32_32x32x16_bf16 v[48:63], a[84:87], v[40:43], v[48:63]
    ds_read_b128 v[36:39], v2 offset:29696
    s_waitcnt lgkmcnt(4)
    v_mfma_f32_32x32x16_bf16 v[48:63], a[192:195], v[44:47], v[48:63]
    ds_read_b128 v[40:43], v1 offset:13312
    s_waitcnt lgkmcnt(4)
    v_mfma_f32_32x32x16_bf16 v[48:63], v[128:131], v[24:27], v[48:63]
    ds_read_b128 v[44:47], v1 offset:40960
    s_waitcnt lgkmcnt(4)
    v_mfma_f32_32x32x16_bf16 v[48:63], v[236:239], v[28:31], v[48:63]
    ds_read_b128 v[24:27], v2 offset:3072
    s_waitcnt lgkmcnt(4)
    v_mfma_f32_32x32x16_bf16 v[48:63], a[88:91], v[32:35], v[48:63]
    ds_read_b128 v[28:31], v2 offset:30720
    s_waitcnt lgkmcnt(4)
    v_mfma_f32_32x32x16_bf16 v[48:63], a[196:199], v[36:39], v[48:63]
    ds_read_b128 v[32:35], v1 offset:14336
    s_waitcnt lgkmcnt(4)
    v_mfma_f32_32x32x16_bf16 v[48:63], v[132:135], v[40:43], v[48:63]
    ds_read_b128 v[36:39], v1 offset:41984
    s_waitcnt lgkmcnt(4)
    v_mfma_f32_32x32x16_bf16 v[48:63], v[240:243], v[44:47], v[48:63]
    ds_read_b128 v[40:43], v2 offset:4096
    s_waitcnt lgkmcnt(4)
    v_mfma_f32_32x32x16_bf16 v[48:63], a[92:95], v[24:27], v[48:63]
    ds_read_b128 v[44:47], v2 offset:31744
    s_waitcnt lgkmcnt(4)
    v_mfma_f32_32x32x16_bf16 v[48:63], a[200:203], v[28:31], v[48:63]
    ds_read_b128 v[24:27], v1 offset:15360
    s_waitcnt lgkmcnt(4)
    v_mfma_f32_32x32x16_bf16 v[48:63], v[136:139], v[32:35], v[48:63]
    ds_read_b128 v[28:31], v1 offset:43008
    s_waitcnt lgkmcnt(4)
    v_mfma_f32_32x32x16_bf16 v[48:63], v[244:247], v[36:39], v[48:63]
    ds_read_b128 v[32:35], v2 offset:5120
    s_waitcnt lgkmcnt(4)
    v_mfma_f32_32x32x16_bf16 v[48:63], a[96:99], v[40:43], v[48:63]
    ds_read_b128 v[36:39], v2 offset:32768
    s_waitcnt lgkmcnt(4)
    v_mfma_f32_32x32x16_bf16 v[48:63], a[204:207], v[44:47], v[48:63]
    ds_read_b128 v[40:43], v1 offset:16384
    s_waitcnt lgkmcnt(4)
    v_mfma_f32_32x32x16_bf16 v[48:63], v[140:143], v[24:27], v[48:63]
    ds_read_b128 v[44:47], v1 offset:44032
    s_waitcnt lgkmcnt(4)
    v_mfma_f32_32x32x16_bf16 v[48:63], v[248:251], v[28:31], v[48:63]
    ds_read_b128 v[24:27], v2 offset:6144
    s_waitcnt lgkmcnt(4)
    v_mfma_f32_32x32x16_bf16 v[48:63], a[100:103], v[32:35], v[48:63]
    ds_read_b128 v[28:31], v2 offset:33792
    s_waitcnt lgkmcnt(4)
    v_mfma_f32_32x32x16_bf16 v[48:63], a[208:211], v[36:39], v[48:63]
    s_waitcnt vmcnt(5)
    s_barrier
    ds_read_b128 v[32:35], v1 offset:17408
    s_waitcnt lgkmcnt(4)
    v_mfma_f32_32x32x16_bf16 v[48:63], v[144:147], v[40:43], v[48:63]
    ds_read_b128 v[36:39], v1 offset:45056
    s_waitcnt lgkmcnt(4)
    v_mfma_f32_32x32x16_bf16 v[48:63], v[252:255], v[44:47], v[48:63]
    ds_read_b128 v[40:43], v2 offset:7168
    s_waitcnt lgkmcnt(4)
    v_mfma_f32_32x32x16_bf16 v[48:63], a[104:107], v[24:27], v[48:63]
    ds_read_b128 v[44:47], v2 offset:34816
    s_waitcnt lgkmcnt(4)
    v_mfma_f32_32x32x16_bf16 v[48:63], a[212:215], v[28:31], v[48:63]
    ds_read_b128 v[24:27], v1 offset:18432
    s_waitcnt lgkmcnt(4)
    v_mfma_f32_32x32x16_bf16 v[48:63], v[148:151], v[32:35], v[48:63]
    ds_read_b128 v[28:31], v1 offset:46080
    s_waitcnt lgkmcnt(4)
    v_mfma_f32_32x32x16_bf16 v[48:63], a[0:3], v[36:39], v[48:63]
    ds_read_b128 v[32:35], v2 offset:8192
    s_waitcnt lgkmcnt(4)
    v_mfma_f32_32x32x16_bf16 v[48:63], a[108:111], v[40:43], v[48:63]
    ds_read_b128 v[36:39], v2 offset:35840
    s_waitcnt lgkmcnt(4)
    v_mfma_f32_32x32x16_bf16 v[48:63], a[216:219], v[44:47], v[48:63]
    ds_read_b128 v[40:43], v1 offset:19456
    s_waitcnt lgkmcnt(4)
    v_mfma_f32_32x32x16_bf16 v[48:63], v[152:155], v[24:27], v[48:63]
    ds_read_b128 v[44:47], v1 offset:47104
    s_waitcnt lgkmcnt(4)
    v_mfma_f32_32x32x16_bf16 v[48:63], a[4:7], v[28:31], v[48:63]
    ds_read_b128 v[24:27], v2 offset:9216
    s_waitcnt lgkmcnt(4)
    v_mfma_f32_32x32x16_bf16 v[48:63], a[112:115], v[32:35], v[48:63]
    ds_read_b128 v[28:31], v2 offset:36864
    s_waitcnt lgkmcnt(4)
    v_mfma_f32_32x32x16_bf16 v[48:63], a[220:223], v[36:39], v[48:63]
    ds_read_b128 v[32:35], v1 offset:20480
    s_waitcnt lgkmcnt(4)
    v_mfma_f32_32x32x16_bf16 v[48:63], v[156:159], v[40:43], v[48:63]
    ds_read_b128 v[36:39], v1 offset:48128
    s_waitcnt lgkmcnt(4)
    v_mfma_f32_32x32x16_bf16 v[48:63], a[8:11], v[44:47], v[48:63]
    ds_read_b128 v[40:43], v2 offset:10240
    s_waitcnt lgkmcnt(4)
    v_mfma_f32_32x32x16_bf16 v[48:63], a[116:119], v[24:27], v[48:63]
    ds_read_b128 v[44:47], v2 offset:37888
    s_waitcnt lgkmcnt(4)
    v_mfma_f32_32x32x16_bf16 v[48:63], a[224:227], v[28:31], v[48:63]
    ds_read_b128 v[24:27], v1 offset:21504
    s_waitcnt lgkmcnt(4)
    v_mfma_f32_32x32x16_bf16 v[48:63], v[160:163], v[32:35], v[48:63]
    ds_read_b128 v[28:31], v1 offset:49152
    s_waitcnt lgkmcnt(4)
    v_mfma_f32_32x32x16_bf16 v[48:63], a[12:15], v[36:39], v[48:63]
    ds_read_b128 v[32:35], v2 offset:11264
    s_waitcnt lgkmcnt(4)
    v_mfma_f32_32x32x16_bf16 v[48:63], a[120:123], v[40:43], v[48:63]
    ds_read_b128 v[36:39], v2 offset:38912
    s_waitcnt lgkmcnt(4)
    v_mfma_f32_32x32x16_bf16 v[48:63], a[228:231], v[44:47], v[48:63]
    s_waitcnt vmcnt(0)
    s_barrier
    ds_read_b128 v[40:43], v1 offset:22528
    s_waitcnt lgkmcnt(4)
    v_mfma_f32_32x32x16_bf16 v[48:63], v[164:167], v[24:27], v[48:63]
    ds_read_b128 v[44:47], v1 offset:50176
    s_waitcnt lgkmcnt(4)
    v_mfma_f32_32x32x16_bf16 v[48:63], a[16:19], v[28:31], v[48:63]
    ds_read_b128 v[24:27], v2 offset:12288
    s_waitcnt lgkmcnt(4)
    v_mfma_f32_32x32x16_bf16 v[48:63], a[124:127], v[32:35], v[48:63]
    ds_read_b128 v[28:31], v2 offset:39936
    s_waitcnt lgkmcnt(4)
    v_mfma_f32_32x32x16_bf16 v[48:63], a[232:235], v[36:39], v[48:63]
    ds_read_b128 v[32:35], v1 offset:23552
    s_waitcnt lgkmcnt(4)
    v_mfma_f32_32x32x16_bf16 v[48:63], v[168:171], v[40:43], v[48:63]
    ds_read_b128 v[36:39], v1 offset:51200
    s_waitcnt lgkmcnt(4)
    v_mfma_f32_32x32x16_bf16 v[48:63], a[20:23], v[44:47], v[48:63]
    ds_read_b128 v[40:43], v2 offset:13312
    s_waitcnt lgkmcnt(4)
    v_mfma_f32_32x32x16_bf16 v[48:63], a[128:131], v[24:27], v[48:63]
    ds_read_b128 v[44:47], v2 offset:40960
    s_waitcnt lgkmcnt(4)
    v_mfma_f32_32x32x16_bf16 v[48:63], a[236:239], v[28:31], v[48:63]
    ds_read_b128 v[24:27], v1 offset:24576
    s_waitcnt lgkmcnt(4)
    v_mfma_f32_32x32x16_bf16 v[48:63], v[172:175], v[32:35], v[48:63]
    ds_read_b128 v[28:31], v1 offset:52224
    s_waitcnt lgkmcnt(4)
    v_mfma_f32_32x32x16_bf16 v[48:63], a[24:27], v[36:39], v[48:63]
    ds_read_b128 v[32:35], v2 offset:14336
    s_waitcnt lgkmcnt(4)
    v_mfma_f32_32x32x16_bf16 v[48:63], a[132:135], v[40:43], v[48:63]
    ds_read_b128 v[36:39], v2 offset:41984
    s_waitcnt lgkmcnt(4)
    v_mfma_f32_32x32x16_bf16 v[48:63], a[240:243], v[44:47], v[48:63]
    ds_read_b128 v[40:43], v1 offset:25600
    s_waitcnt lgkmcnt(4)
    v_mfma_f32_32x32x16_bf16 v[48:63], v[176:179], v[24:27], v[48:63]
    ds_read_b128 v[44:47], v1 offset:53248
    s_waitcnt lgkmcnt(4)
    v_mfma_f32_32x32x16_bf16 v[48:63], a[28:31], v[28:31], v[48:63]
    ds_read_b128 v[24:27], v2 offset:15360
    s_waitcnt lgkmcnt(4)
    v_mfma_f32_32x32x16_bf16 v[48:63], a[136:139], v[32:35], v[48:63]
    ds_read_b128 v[28:31], v2 offset:43008
    s_waitcnt lgkmcnt(4)
    v_mfma_f32_32x32x16_bf16 v[48:63], a[244:247], v[36:39], v[48:63]
    ds_read_b128 v[32:35], v1 offset:26624
    s_waitcnt lgkmcnt(4)
    v_mfma_f32_32x32x16_bf16 v[48:63], v[180:183], v[40:43], v[48:63]
    ds_read_b128 v[36:39], v1 offset:54272
    s_waitcnt lgkmcnt(4)
    v_mfma_f32_32x32x16_bf16 v[48:63], a[32:35], v[44:47], v[48:63]
    ds_read_b128 v[40:43], v2 offset:16384
    s_waitcnt lgkmcnt(4)
    v_mfma_f32_32x32x16_bf16 v[48:63], a[140:143], v[24:27], v[48:63]
    ds_read_b128 v[44:47], v2 offset:44032
    s_waitcnt lgkmcnt(4)
    v_mfma_f32_32x32x16_bf16 v[48:63], a[248:251], v[28:31], v[48:63]
    s_waitcnt lgkmcnt(3)
    v_mfma_f32_32x32x16_bf16 v[48:63], v[184:187], v[32:35], v[48:63]
    s_waitcnt lgkmcnt(2)
    v_mfma_f32_32x32x16_bf16 v[48:63], a[36:39], v[36:39], v[48:63]
    s_waitcnt lgkmcnt(1)
    v_mfma_f32_32x32x16_bf16 v[48:63], a[144:147], v[40:43], v[48:63]
    s_waitcnt lgkmcnt(0)
    v_mfma_f32_32x32x16_bf16 v[48:63], a[252:255], v[44:47], v[48:63]
    s_mov_b32 s22, 0
    s_barrier
    s_mul_i32 s30, s16, s36
    s_add_u32 s32, s30, s28
    s_add_u32 s30, s30, s19
    s_nop 6
    v_cvt_pk_bf16_f32 v24, v48, v49
    v_cvt_pk_bf16_f32 v25, v50, v51
    v_cvt_pk_bf16_f32 v26, v52, v53
    v_cvt_pk_bf16_f32 v27, v54, v55
    s_cmp_eq_u32 s14, 0
    s_cbranch_scc1 G_154
    buffer_store_dwordx4 v[24:27], v6, s[8:11], s30 offen offset:0
    s_branch G_155
G_154:
    buffer_store_dwordx4 v[24:27], v6, s[8:11], s30 offen offset:0 sc1
G_155:
    v_cvt_pk_bf16_f32 v28, v56, v57
    v_cvt_pk_bf16_f32 v29, v58, v59
    v_cvt_pk_bf16_f32 v30, v60, v61
    v_cvt_pk_bf16_f32 v31, v62, v63
    s_cmp_eq_u32 s14, 0
    s_cbranch_scc1 G_156
    buffer_store_dwordx4 v[28:31], v7, s[8:11], s30 offen offset:0
    s_branch G_157
G_156:
    buffer_store_dwordx4 v[28:31], v7, s[8:11], s30 offen offset:0 sc1
G_157:
    s_cmp_lg_u32 s14, 0
    s_cbranch_scc1 G_158
    v_pk_add_f32 v[40:41], v[48:49], v[50:51]
    v_pk_mul_f32 v[42:43], v[48:49], v[48:49]
    v_pk_fma_f32 v[42:43], v[50:51], v[50:51], v[42:43]
    v_pk_add_f32 v[40:41], v[40:41], v[52:53]
    v_pk_fma_f32 v[42:43], v[52:53], v[52:53], v[42:43]
    v_pk_add_f32 v[40:41], v[40:41], v[54:55]
    v_pk_fma_f32 v[42:43], v[54:55], v[54:55], v[42:43]
    v_pk_add_f32 v[40:41], v[40:41], v[56:57]
    v_pk_fma_f32 v[42:43], v[56:57], v[56:57], v[42:43]
    v_pk_add_f32 v[40:41], v[40:41], v[58:59]
    v_pk_fma_f32 v[42:43], v[58:59], v[58:59], v[42:43]
    v_pk_add_f32 v[40:41], v[40:41], v[60:61]
    v_pk_fma_f32 v[42:43], v[60:61], v[60:61], v[42:43]
    v_pk_add_f32 v[40:41], v[40:41], v[62:63]
    v_pk_fma_f32 v[42:43], v[62:63], v[62:63], v[42:43]
    v_add_f32 v40, v40, v41
    v_add_f32 v41, v42, v43
    v_mov_b32 v42, v40
    v_mov_b32 v43, v41
    s_nop 1
    v_permlane32_swap_b32 v40, v42
    v_permlane32_swap_b32 v41, v43
    v_pk_add_f32 v[40:41], v[40:41], v[42:43]
    s_mov_b64 exec, 0xffffffff
    buffer_store_dwordx2 v[40:41], v8, s[4:7], s32 offen sc1
    s_mov_b64 exec, -1
G_158:
    s_add_u32 s32, s16, 1
    s_mov_b32 s26, s32
    s_cmp_lg_u32 s22, 0
    s_cbranch_scc1 G_161
    s_mov_b32 s26, 0
    s_waitcnt lgkmcnt(0)
    s_cmp_ge_u32 s29, s46
    s_cbranch_scc1 G_162
    buffer_load_dword v21, v20, s[4:7], s62 offen sc1
    s_waitcnt vmcnt(1)
    s_sub_u32 s63, s32, s47
    s_mov_b32 s47, s32
    s_atomic_add s63, s[4:5], s21
    s_mov_b32 s16, s29
    s_waitcnt vmcnt(0)
    v_cmp_gt_u32 vcc, s37, v21
    s_cbranch_vccnz RM4_poll
    s_mov_b32 s22, 0
    s_branch RM4_dma
G_162:
    s_waitcnt vmcnt(0)
G_160:
    s_sub_u32 s63, s32, s47
    s_mov_b32 s47, s32
    s_atomic_add s63, s[4:5], s21
G_161:
    s_mov_b32 s16, s29
    s_cmp_lt_u32 s16, s46
    s_cbranch_scc1 RM4_loop
RM4_done:
    s_branch L_next
RRL:
    v_mbcnt_lo_u32_b32 v4, -1, 0
    v_mbcnt_hi_u32_b32 v4, -1, v4
    v_lshlrev_b32 v0, 4, v4
    v_lshlrev_b32 v1, 3, v4
    v_mov_b32 v2, 0
    s_mov_b32 s23, 0
    v_mov_b32 v8, 128
P_163:
    global_load_dword v9, v8, s[90:91] sc1
    s_waitcnt vmcnt(0)
    v_readfirstlane_b32 s85, v9
    s_and_b32 s86, s85, 255
    s_cmp_ge_u32 s86, 70
    s_cbranch_scc1 P_164
    s_add_u32 s23, s23, 1
    s_cmp_gt_u32 s23, 65536
    s_cbranch_scc1 L_exit
    s_sleep 16
    s_branch P_163
P_164:
    s_lshr_b32 s85, s85, 8
    s_sub_u32 s46, 65, s14
    s_sub_u32 s46, s46, s14
    s_mul_i32 s18, s14, 41943040
    s_add_u32 s18, s18, 197132288
    s_mul_i32 s34, s14, 41943040
    s_add_u32 s34, s34, 171966464
    s_mul_i32 s19, s14, 41943040
    s_add_u32 s19, s19, 175112192
    s_mul_i32 s20, s14, 393216
    s_add_u32 s20, s20, 167903232
    s_mul_i32 s21, s14, 393216
    s_add_u32 s21, s21, 167936000
    s_lshl_b32 s30, s13, 2
    s_add_u32 s30, s30, s12
    s_lshl_b32 s31, s30, 9
    s_add_u32 s20, s20, s31
    s_and_b32 s31, s20, 0x2000
    s_add_u32 s20, s20, s31
    s_lshl_b32 s31, s30, 7
    s_add_u32 s21, s21, s31
    s_lshl_b32 s31, s30, 8
    s_add_u32 s31, s31, 40960
    v_add_u32 v1, s31, v1
    s_lshl_b32 s31, s30, 11
    v_add_u32 v0, s31, v0
    s_mov_b32 s16, 0
    s_mov_b32 s47, 0
    s_cmp_eq_u32 s14, 0
    s_cselect_b32 s30, 2, 7
    s_lshr_b32 s30, s85, s30
    s_and_b32 s30, s30, 1
    s_lshl_b32 s30, s30, 13
    s_andn2_b32 s20, s20, 0x2000
    s_or_b32 s20, s20, s30
    s_cmp_eq_u32 s14, 0
    s_cselect_b32 s30, 4, 3
    s_lshr_b32 s30, s85, s30
    s_and_b32 s30, s30, 1
    s_lshl_b32 s30, s30, 13
    s_andn2_b32 s21, s21, 0x2000
    s_or_b32 s21, s21, s30
.p2align 6
RRL_loop:
    s_add_u32 s37, s16, 1
    v_mbcnt_lo_u32_b32 v8, -1, 0
    v_min_u32 v8, 3, v8
    v_lshlrev_b32 v8, 7, v8
    s_mov_b32 s23, 0
    s_mov_b64 exec, 0xffffffff
P_165:
    buffer_load_dword v9, v8, s[4:7], s20 offen sc1
    s_waitcnt vmcnt(0)
    v_cmp_gt_u32 vcc, s37, v9
    s_cbranch_vccz P_166
    s_add_u32 s23, s23, 1
    s_cmp_gt_u32 s23, 65536
    s_cbranch_scc1 L_exit
    s_sleep 1
    s_branch P_165
P_166:
    s_mov_b64 exec, -1
    s_mov_b32 s30, s18
    buffer_load_dwordx4 v[16:19], v0, s[4:7], s30 offen sc1
    buffer_load_dwordx4 v[20:23], v0, s[4:7], s30 offen offset:1024 sc1
    s_add_u32 s30, s30, 2621440
    buffer_load_dwordx4 v[24:27], v0, s[4:7], s30 offen sc1
    buffer_load_dwordx4 v[28:31], v0, s[4:7], s30 offen offset:1024 sc1
    s_add_u32 s30, s30, 2621440
    buffer_load_dwordx4 v[32:35], v0, s[4:7], s30 offen sc1
    buffer_load_dwordx4 v[36:39], v0, s[4:7], s30 offen offset:1024 sc1
    s_add_u32 s30, s30, 2621440
    buffer_load_dwordx4 v[40:43], v0, s[4:7], s30 offen sc1
    buffer_load_dwordx4 v[44:47], v0, s[4:7], s30 offen offset:1024 sc1
    buffer_load_dwordx4 v[48:51], v0, s[4:7], s34 offen sc1
    buffer_load_dwordx4 v[52:55], v0, s[4:7], s34 offen offset:1024 sc1
    s_waitcnt vmcnt(8)
    v_lshlrev_b32 v64, 16, v16
    v_and_b32 v65, 0xffff0000, v16
    v_lshlrev_b32 v66, 16, v17
    v_and_b32 v67, 0xffff0000, v17
    v_lshlrev_b32 v68, 16, v18
    v_and_b32 v69, 0xffff0000, v18
    v_lshlrev_b32 v70, 16, v19
    v_and_b32 v71, 0xffff0000, v19
    v_lshlrev_b32 v72, 16, v20
    v_and_b32 v73, 0xffff0000, v20
    v_lshlrev_b32 v74, 16, v21
    v_and_b32 v75, 0xffff0000, v21
    v_lshlrev_b32 v76, 16, v22
    v_and_b32 v77, 0xffff0000, v22
    v_lshlrev_b32 v78, 16, v23
    v_and_b32 v79, 0xffff0000, v23
    s_waitcnt vmcnt(6)
    v_lshlrev_b32 v4, 16, v24
    v_and_b32 v5, 0xffff0000, v24
    v_pk_add_f32 v[64:65], v[64:65], v[4:5]
    v_lshlrev_b32 v6, 16, v25
    v_and_b32 v7, 0xffff0000, v25
    v_pk_add_f32 v[66:67], v[66:67], v[6:7]
    v_lshlrev_b32 v4, 16, v26
    v_and_b32 v5, 0xffff0000, v26
    v_pk_add_f32 v[68:69], v[68:69], v[4:5]
    v_lshlrev_b32 v6, 16, v27
    v_and_b32 v7, 0xffff0000, v27
    v_pk_add_f32 v[70:71], v[70:71], v[6:7]
    v_lshlrev_b32 v4, 16, v28
    v_and_b32 v5, 0xffff0000, v28
    v_pk_add_f32 v[72:73], v[72:73], v[4:5]
    v_lshlrev_b32 v6, 16, v29
    v_and_b32 v7, 0xffff0000, v29
    v_pk_add_f32 v[74:75], v[74:75], v[6:7]
    v_lshlrev_b32 v4, 16, v30
    v_and_b32 v5, 0xffff0000, v30
    v_pk_add_f32 v[76:77], v[76:77], v[4:5]
    v_lshlrev_b32 v6, 16, v31
    v_and_b32 v7, 0xffff0000, v31
    v_pk_add_f32 v[78:79], v[78:79], v[6:7]
    s_waitcnt vmcnt(4)
    v_lshlrev_b32 v4, 16, v32
    v_and_b32 v5, 0xffff0000, v32
    v_pk_add_f32 v[64:65], v[64:65], v[4:5]
    v_lshlrev_b32 v6, 16, v33
    v_and_b32 v7, 0xffff0000, v33
    v_pk_add_f32 v[66:67], v[66:67], v[6:7]
    v_lshlrev_b32 v4, 16, v34
    v_and_b32 v5, 0xffff0000, v34
    v_pk_add_f32 v[68:69], v[68:69], v[4:5]
    v_lshlrev_b32 v6, 16, v35
    v_and_b32 v7, 0xffff0000, v35
    v_pk_add_f32 v[70:71], v[70:71], v[6:7]
    v_lshlrev_b32 v4, 16, v36
    v_and_b32 v5, 0xffff0000, v36
    v_pk_add_f32 v[72:73], v[72:73], v[4:5]
    v_lshlrev_b32 v6, 16, v37
    v_and_b32 v7, 0xffff0000, v37
    v_pk_add_f32 v[74:75], v[74:75], v[6:7]
    v_lshlrev_b32 v4, 16, v38
    v_and_b32 v5, 0xffff0000, v38
    v_pk_add_f32 v[76:77], v[76:77], v[4:5]
    v_lshlrev_b32 v6, 16, v39
    v_and_b32 v7, 0xffff0000, v39
    v_pk_add_f32 v[78:79], v[78:79], v[6:7]
    s_waitcnt vmcnt(2)
    v_lshlrev_b32 v4, 16, v40
    v_and_b32 v5, 0xffff0000, v40
    v_pk_add_f32 v[64:65], v[64:65], v[4:5]
    v_lshlrev_b32 v6, 16, v41
    v_and_b32 v7, 0xffff0000, v41
    v_pk_add_f32 v[66:67], v[66:67], v[6:7]
    v_lshlrev_b32 v4, 16, v42
    v_and_b32 v5, 0xffff0000, v42
    v_pk_add_f32 v[68:69], v[68:69], v[4:5]
    v_lshlrev_b32 v6, 16, v43
    v_and_b32 v7, 0xffff0000, v43
    v_pk_add_f32 v[70:71], v[70:71], v[6:7]
    v_lshlrev_b32 v4, 16, v44
    v_and_b32 v5, 0xffff0000, v44
    v_pk_add_f32 v[72:73], v[72:73], v[4:5]
    v_lshlrev_b32 v6, 16, v45
    v_and_b32 v7, 0xffff0000, v45
    v_pk_add_f32 v[74:75], v[74:75], v[6:7]
    v_lshlrev_b32 v4, 16, v46
    v_and_b32 v5, 0xffff0000, v46
    v_pk_add_f32 v[76:77], v[76:77], v[4:5]
    v_lshlrev_b32 v6, 16, v47
    v_and_b32 v7, 0xffff0000, v47
    v_pk_add_f32 v[78:79], v[78:79], v[6:7]
    s_waitcnt vmcnt(0)
    v_lshlrev_b32 v4, 16, v48
    v_and_b32 v5, 0xffff0000, v48
    v_pk_add_f32 v[64:65], v[64:65], v[4:5]
    v_lshlrev_b32 v6, 16, v49
    v_and_b32 v7, 0xffff0000, v49
    v_pk_add_f32 v[66:67], v[66:67], v[6:7]
    v_lshlrev_b32 v4, 16, v50
    v_and_b32 v5, 0xffff0000, v50
    v_pk_add_f32 v[68:69], v[68:69], v[4:5]
    v_lshlrev_b32 v6, 16, v51
    v_and_b32 v7, 0xffff0000, v51
    v_pk_add_f32 v[70:71], v[70:71], v[6:7]
    v_lshlrev_b32 v4, 16, v52
    v_and_b32 v5, 0xffff0000, v52
    v_pk_add_f32 v[72:73], v[72:73], v[4:5]
    v_lshlrev_b32 v6, 16, v53
    v_and_b32 v7, 0xffff0000, v53
    v_pk_add_f32 v[74:75], v[74:75], v[6:7]
    v_lshlrev_b32 v4, 16, v54
    v_and_b32 v5, 0xffff0000, v54
    v_pk_add_f32 v[76:77], v[76:77], v[4:5]
    v_lshlrev_b32 v6, 16, v55
    v_and_b32 v7, 0xffff0000, v55
    v_pk_add_f32 v[78:79], v[78:79], v[6:7]
    v_cvt_pk_bf16_f32 v16, v64, v65
    v_cvt_pk_bf16_f32 v17, v66, v67
    v_cvt_pk_bf16_f32 v18, v68, v69
    v_cvt_pk_bf16_f32 v19, v70, v71
    v_cvt_pk_bf16_f32 v20, v72, v73
    v_cvt_pk_bf16_f32 v21, v74, v75
    v_cvt_pk_bf16_f32 v22, v76, v77
    v_cvt_pk_bf16_f32 v23, v78, v79
    buffer_store_dwordx4 v[16:19], v0, s[4:7], s19 offen sc1
    buffer_store_dwordx4 v[20:23], v0, s[4:7], s19 offen offset:1024 sc1
    v_pk_add_f32 v[4:5], v[64:65], v[66:67]
    v_pk_mul_f32 v[6:7], v[64:65], v[64:65]
    v_pk_fma_f32 v[6:7], v[66:67], v[66:67], v[6:7]
    v_pk_add_f32 v[4:5], v[4:5], v[68:69]
    v_pk_fma_f32 v[6:7], v[68:69], v[68:69], v[6:7]
    v_pk_add_f32 v[4:5], v[4:5], v[70:71]
    v_pk_fma_f32 v[6:7], v[70:71], v[70:71], v[6:7]
    v_pk_add_f32 v[4:5], v[4:5], v[72:73]
    v_pk_fma_f32 v[6:7], v[72:73], v[72:73], v[6:7]
    v_pk_add_f32 v[4:5], v[4:5], v[74:75]
    v_pk_fma_f32 v[6:7], v[74:75], v[74:75], v[6:7]
    v_pk_add_f32 v[4:5], v[4:5], v[76:77]
    v_pk_fma_f32 v[6:7], v[76:77], v[76:77], v[6:7]
    v_pk_add_f32 v[4:5], v[4:5], v[78:79]
    v_pk_fma_f32 v[6:7], v[78:79], v[78:79], v[6:7]
    v_add_f32 v4, v4, v5
    v_add_f32 v5, v6, v7
    v_mov_b32 v6, v4
    v_mov_b32 v7, v5
    s_nop 1
    v_permlane32_swap_b32 v4, v6
    v_permlane32_swap_b32 v5, v7
    v_pk_add_f32 v[4:5], v[4:5], v[6:7]
    s_mov_b64 exec, 0xffffffff
    buffer_store_dwordx2 v[4:5], v1, s[4:7], s19 offen sc1
    s_mov_b64 exec, -1
    s_waitcnt vmcnt(0)
    s_sub_u32 s63, s37, s47
    s_mov_b32 s47, s37
    s_atomic_add s63, s[4:5], s21
    s_add_u32 s18, s18, 40960
    s_add_u32 s34, s34, 49152
    s_add_u32 s19, s19, 49152
    s_add_u32 s16, s16, 1
    s_cmp_eq_u32 s16, 64
    s_cselect_b32 s18, 241655808, s18
    s_cselect_b32 s34, 217006080, s34
    s_cselect_b32 s19, 220151808, s19
    s_cmp_lt_u32 s16, s46
    s_cbranch_scc1 RRL_loop
    s_branch L_next
RAT:
    v_mbcnt_lo_u32_b32 v4, -1, 0
    v_mbcnt_hi_u32_b32 v4, -1, v4
    v_lshlrev_b32 v0, 4, v4
    s_mul_i32 s34, s13, 3
    s_add_u32 s34, s34, s12
    s_cmp_eq_u32 s12, 3
    s_cbranch_scc1 L_next
    s_cmp_ge_u32 s34, 32
    s_cbranch_scc1 L_next
    v_and_b32 v5, 31, v4
    v_lshrrev_b32 v6, 5, v4
    v_lshlrev_b32 v7, 2, v6
    v_sub_u32 v7, v5, v7
    v_mov_b32 v8, 0xf149f2ca
    v_cmp_gt_i32 vcc, 0, v7
    s_nop 1
    v_cndmask_b32 v16, 0, v8, vcc
    v_cmp_gt_i32 vcc, 1, v7
    s_nop 1
    v_cndmask_b32 v17, 0, v8, vcc
    v_cmp_gt_i32 vcc, 2, v7
    s_nop 1
    v_cndmask_b32 v18, 0, v8, vcc
    v_cmp_gt_i32 vcc, 3, v7
    s_nop 1
    v_cndmask_b32 v19, 0, v8, vcc
    v_cmp_gt_i32 vcc, 8, v7
    s_nop 1
    v_cndmask_b32 v20, 0, v8, vcc
    v_cmp_gt_i32 vcc, 9, v7
    s_nop 1
    v_cndmask_b32 v21, 0, v8, vcc
    v_cmp_gt_i32 vcc, 10, v7
    s_nop 1
    v_cndmask_b32 v22, 0, v8, vcc
    v_cmp_gt_i32 vcc, 11, v7
    s_nop 1
    v_cndmask_b32 v23, 0, v8, vcc
    v_cmp_gt_i32 vcc, 16, v7
    s_nop 1
    v_cndmask_b32 v24, 0, v8, vcc
    v_cmp_gt_i32 vcc, 17, v7
    s_nop 1
    v_cndmask_b32 v25, 0, v8, vcc
    v_cmp_gt_i32 vcc, 18, v7
    s_nop 1
    v_cndmask_b32 v26, 0, v8, vcc
    v_cmp_gt_i32 vcc, 19, v7
    s_nop 1
    v_cndmask_b32 v27, 0, v8, vcc
    v_cmp_gt_i32 vcc, 24, v7
    s_nop 1
    v_cndmask_b32 v28, 0, v8, vcc
    v_cmp_gt_i32 vcc, 25, v7
    s_nop 1
    v_cndmask_b32 v29, 0, v8, vcc
    v_cmp_gt_i32 vcc, 26, v7
    s_nop 1
    v_cndmask_b32 v30, 0, v8, vcc
    v_cmp_gt_i32 vcc, 27, v7
    s_nop 1
    v_cndmask_b32 v31, 0, v8, vcc
    s_mov_b32 s23, 0
    v_mov_b32 v12, 128
P_167:
    global_load_dword v13, v12, s[90:91] sc1
    s_waitcnt vmcnt(0)
    v_readfirstlane_b32 s85, v13
    s_and_b32 s86, s85, 255
    s_cmp_ge_u32 s86, 70
    s_cbranch_scc1 P_168
    s_add_u32 s23, s23, 1
    s_cmp_gt_u32 s23, 65536
    s_cbranch_scc1 L_exit
    s_sleep 16
    s_branch P_167
P_168:
    s_lshr_b32 s85, s85, 8
    s_mov_b32 s80, 0
RAT_job:
    s_mul_i32 s18, s14, 50331648
    s_add_u32 s18, s18, 0
    s_mul_i32 s35, s14, 8388608
    s_add_u32 s35, s35, 134217728
    s_mul_i32 s19, s14, 16777216
    s_add_u32 s19, s19, 100663296
    s_mul_i32 s20, s14, 393216
    s_add_u32 s20, s20, 167772160
    s_mul_i32 s36, s14, 393216
    s_add_u32 s36, s36, 167837696
    s_mul_i32 s21, s14, 393216
    s_add_u32 s21, s21, 167870464
    s_lshl_b32 s30, s34, 13
    s_add_u32 s18, s18, s30
    s_add_u32 s19, s19, s30
    s_lshl_b32 s30, s34, 12
    s_add_u32 s35, s35, s30
    s_lshl_b32 s30, s34, 7
    s_add_u32 s36, s36, s30
    s_add_u32 s21, s21, s30
    s_lshl_b32 s30, s34, 10
    s_add_u32 s20, s20, s30
    s_sub_u32 s25, 1, s14
    s_mul_i32 s28, s25, 58
    s_lshl_b32 s25, s25, 15
    s_mov_b32 s40, 0x3e0293ee
    s_mov_b32 s16, 0
    s_mov_b32 s37, 1
    s_mov_b32 s47, 0
    s_mov_b32 s22, 0
    s_mov_b32 s46, 64
    s_cmp_eq_u32 s14, 0
    s_cselect_b32 s30, 2, 7
    s_lshr_b32 s30, s85, s30
    s_and_b32 s30, s30, 1
    s_lshl_b32 s30, s30, 13
    s_andn2_b32 s21, s21, 0x2000
    s_or_b32 s21, s21, s30
    s_sub_u32 s46, 64, s14
    s_cmp_eq_u32 s80, 0
    s_cbranch_scc1 G_169
    s_mov_b32 s46, 64
    s_mov_b32 s16, 63
    s_mov_b32 s37, 64
    s_mov_b32 s47, 63
    s_sub_u32 s21, s21, 393216
    s_add_u32 s18, s18, 16515072
    s_add_u32 s19, s19, 16515072
    s_add_u32 s35, s35, 8257536
    s_lshr_b32 s30, s85, 2
    s_and_b32 s30, s30, 1
    s_lshl_b32 s30, s30, 13
    s_andn2_b32 s21, s21, 0x2000
    s_or_b32 s21, s21, s30
G_169:
    s_cmp_lg_u32 s80, 0
    s_cbranch_scc1 G_171
    v_mov_b64 v[224:225], -1
    v_mov_b64 v[226:227], -1
    s_mov_b32 s30, s35
    s_mov_b32 s31, 0
G_170:
    buffer_store_dwordx4 v[224:227], v0, s[4:7], s30 offen offset:0 sc1
    buffer_store_dwordx4 v[224:227], v0, s[4:7], s30 offen offset:1024 sc1
    buffer_store_dwordx4 v[224:227], v0, s[4:7], s30 offen offset:2048 sc1
    buffer_store_dwordx4 v[224:227], v0, s[4:7], s30 offen offset:3072 sc1
    s_add_u32 s30, s30, 131072
    s_add_u32 s31, s31, 1
    s_cmp_lt_u32 s31, 64
    s_cbranch_scc1 G_170
    s_mov_b32 s31, 1
    s_waitcnt vmcnt(0)
    s_atomic_add s31, s[4:5], s36
    s_waitcnt lgkmcnt(0)
G_171:
    s_mov_b32 s31, 1
    v_mbcnt_lo_u32_b32 v12, -1, 0
    v_min_u32 v12, 0, v12
    v_lshlrev_b32 v12, 7, v12
    s_mov_b32 s23, 0
    s_mov_b64 exec, 0xffffffff
P_172:
    buffer_load_dword v13, v12, s[4:7], s36 offen sc1
    s_waitcnt vmcnt(0)
    v_cmp_gt_u32 vcc, s31, v13
    s_cbranch_vccz P_173
    s_add_u32 s23, s23, 1
    s_cmp_gt_u32 s23, 65536
    s_cbranch_scc1 L_exit
    s_sleep 1
    s_branch P_172
P_173:
    s_mov_b64 exec, -1
    v_mbcnt_lo_u32_b32 v12, -1, 0
    v_min_u32 v12, 5, v12
    v_lshlrev_b32 v12, 7, v12
    s_mov_b32 s23, 0
    s_mov_b64 exec, 0xffffffff
P_174:
    buffer_load_dword v13, v12, s[4:7], s20 offen sc1
    s_waitcnt vmcnt(0)
    v_cmp_gt_u32 vcc, s37, v13
    s_cbranch_vccz P_175
    s_add_u32 s23, s23, 1
    s_cmp_gt_u32 s23, 65536
    s_cbranch_scc1 L_exit
    s_sleep 1
    s_branch P_174
P_175:
    s_mov_b64 exec, -1
    s_add_u32 s56, s18, 0
    s_add_u32 s57, s18, 4096
    s_add_u32 s58, s18, 16777216
    s_add_u32 s59, s18, 16781312
    s_add_u32 s60, s18, 33554432
    s_add_u32 s61, s18, 33558528
    buffer_load_dwordx4 a[0:3], v0, s[4:7], s56 offen offset:0 sc1
    buffer_load_dwordx4 a[4:7], v0, s[4:7], s56 offen offset:1024 sc1
    buffer_load_dwordx4 a[8:11], v0, s[4:7], s56 offen offset:2048 sc1
    buffer_load_dwordx4 a[12:15], v0, s[4:7], s56 offen offset:3072 sc1
    buffer_load_dwordx4 a[16:19], v0, s[4:7], s57 offen offset:0 sc1
    buffer_load_dwordx4 a[20:23], v0, s[4:7], s57 offen offset:1024 sc1
    buffer_load_dwordx4 a[24:27], v0, s[4:7], s57 offen offset:2048 sc1
    buffer_load_dwordx4 a[28:31], v0, s[4:7], s57 offen offset:3072 sc1
    buffer_load_dwordx4 a[64:67], v0, s[4:7], s58 offen offset:0 sc1
    buffer_load_dwordx4 a[68:71], v0, s[4:7], s58 offen offset:1024 sc1
    buffer_load_dwordx4 a[72:75], v0, s[4:7], s58 offen offset:2048 sc1
    buffer_load_dwordx4 a[76:79], v0, s[4:7], s58 offen offset:3072 sc1
    buffer_load_dwordx4 a[80:83], v0, s[4:7], s59 offen offset:0 sc1
    buffer_load_dwordx4 a[84:87], v0, s[4:7], s59 offen offset:1024 sc1
    buffer_load_dwordx4 a[88:91], v0, s[4:7], s59 offen offset:2048 sc1
    buffer_load_dwordx4 a[92:95], v0, s[4:7], s59 offen offset:3072 sc1
    buffer_load_dwordx4 a[96:99], v0, s[4:7], s60 offen offset:0 sc1
    buffer_load_dwordx4 a[100:103], v0, s[4:7], s60 offen offset:1024 sc1
    buffer_load_dwordx4 a[104:107], v0, s[4:7], s60 offen offset:2048 sc1
    buffer_load_dwordx4 a[108:111], v0, s[4:7], s60 offen offset:3072 sc1
    buffer_load_dwordx4 a[112:115], v0, s[4:7], s61 offen offset:0 sc1
    buffer_load_dwordx4 a[116:119], v0, s[4:7], s61 offen offset:1024 sc1
    buffer_load_dwordx4 a[120:123], v0, s[4:7], s61 offen offset:2048 sc1
    buffer_load_dwordx4 a[124:127], v0, s[4:7], s61 offen offset:3072 sc1
    s_add_u32 s20, s20, 512
    s_waitcnt vmcnt(0)
    v_mfma_f32_32x32x16_bf16 v[32:47], a[64:67], a[0:3], v[16:31]
    v_mfma_f32_32x32x16_bf16 v[32:47], a[68:71], a[4:7], v[32:47]
    v_mfma_f32_32x32x16_bf16 v[32:47], a[72:75], a[8:11], v[32:47]
    v_mfma_f32_32x32x16_bf16 v[32:47], a[76:79], a[12:15], v[32:47]
    v_mfma_f32_32x32x16_bf16 v[32:47], a[80:83], a[16:19], v[32:47]
    v_mfma_f32_32x32x16_bf16 v[32:47], a[84:87], a[20:23], v[32:47]
    v_mfma_f32_32x32x16_bf16 v[32:47], a[88:91], a[24:27], v[32:47]
    v_mfma_f32_32x32x16_bf16 v[32:47], a[92:95], a[28:31], v[32:47]
    v_mov_b32 v10, s40
    v_mov_b32 v11, s40
    s_nop 9
    v_max3_f32 v6, v32, v33, v34
    v_max3_f32 v7, v35, v36, v37
    v_max3_f32 v6, v6, v38, v39
    v_max3_f32 v7, v7, v40, v41
    v_max3_f32 v6, v6, v42, v43
    v_max3_f32 v7, v7, v44, v45
    v_max3_f32 v6, v6, v46, v47
    v_max_f32 v6, v6, v7
    v_mov_b32 v7, v6
    s_nop 1
    v_permlane32_swap_b32 v6, v7
    v_max_f32 v6, v6, v7
    s_cmp_eq_u32 s16, s47
    s_cbranch_scc1 G_176
    s_cmp_lg_u32 s22, 0
    s_cbranch_scc1 G_177
    s_waitcnt vmcnt(0)
G_177:
    s_waitcnt vmcnt(8)
    s_sub_u32 s63, s16, s47
    s_mov_b32 s47, s16
    s_atomic_add s63, s[4:5], s21
G_176:
    buffer_load_dwordx4 v[224:227], v0, s[4:7], s35 offen offset:0 sc1
    buffer_load_dwordx4 v[228:231], v0, s[4:7], s35 offen offset:1024 sc1
    buffer_load_dwordx4 v[232:235], v0, s[4:7], s35 offen offset:2048 sc1
    buffer_load_dwordx4 v[236:239], v0, s[4:7], s35 offen offset:3072 sc1
    v_mul_f32 v4, s40, v6
    v_sub_f32 v6, 0, v4
    v_sub_f32 v7, 0, v4
    v_pk_fma_f32 v[32:33], v[32:33], v[10:11], v[6:7]
    v_pk_fma_f32 v[34:35], v[34:35], v[10:11], v[6:7]
    v_pk_fma_f32 v[36:37], v[36:37], v[10:11], v[6:7]
    v_pk_fma_f32 v[38:39], v[38:39], v[10:11], v[6:7]
    v_pk_fma_f32 v[40:41], v[40:41], v[10:11], v[6:7]
    v_pk_fma_f32 v[42:43], v[42:43], v[10:11], v[6:7]
    v_pk_fma_f32 v[44:45], v[44:45], v[10:11], v[6:7]
    v_pk_fma_f32 v[46:47], v[46:47], v[10:11], v[6:7]
    v_exp_f32 v32, v32
    v_exp_f32 v33, v33
    v_exp_f32 v34, v34
    v_exp_f32 v35, v35
    v_exp_f32 v36, v36
    v_exp_f32 v37, v37
    v_exp_f32 v38, v38
    v_exp_f32 v39, v39
    v_exp_f32 v40, v40
    v_exp_f32 v41, v41
    v_exp_f32 v42, v42
    v_exp_f32 v43, v43
    v_exp_f32 v44, v44
    v_exp_f32 v45, v45
    v_exp_f32 v46, v46
    v_exp_f32 v47, v47
    v_pk_add_f32 v[6:7], v[32:33], v[34:35]
    v_pk_add_f32 v[6:7], v[6:7], v[36:37]
    v_pk_add_f32 v[6:7], v[6:7], v[38:39]
    v_pk_add_f32 v[6:7], v[6:7], v[40:41]
    v_pk_add_f32 v[6:7], v[6:7], v[42:43]
    v_pk_add_f32 v[6:7], v[6:7], v[44:45]
    v_pk_add_f32 v[6:7], v[6:7], v[46:47]
    v_add_f32 v5, v6, v7
    v_cvt_pk_bf16_f32 v32, v32, v33
    v_cvt_pk_bf16_f32 v33, v34, v35
    v_cvt_pk_bf16_f32 v34, v36, v37
    v_cvt_pk_bf16_f32 v35, v38, v39
    v_cvt_pk_bf16_f32 v36, v40, v41
    v_cvt_pk_bf16_f32 v37, v42, v43
    v_cvt_pk_bf16_f32 v38, v44, v45
    v_cvt_pk_bf16_f32 v39, v46, v47
    v_mfma_f32_32x32x16_bf16 v[64:79], a[96:99], v[32:35], 0
    s_nop 0
    v_mfma_f32_32x32x16_bf16 v[64:79], a[100:103], v[36:39], v[64:79]
    v_mfma_f32_32x32x16_bf16 v[80:95], a[104:107], v[32:35], 0
    v_mfma_f32_32x32x16_bf16 v[80:95], a[108:111], v[36:39], v[80:95]
    v_mfma_f32_32x32x16_bf16 v[96:111], a[112:115], v[32:35], 0
    v_mfma_f32_32x32x16_bf16 v[96:111], a[116:119], v[36:39], v[96:111]
    v_mfma_f32_32x32x16_bf16 v[112:127], a[120:123], v[32:35], 0
    v_mfma_f32_32x32x16_bf16 v[112:127], a[124:127], v[36:39], v[112:127]
    s_cmp_ge_u32 s37, s46
    s_cbranch_scc1 RAT_loop
    s_add_u32 s29, s37, 1
    s_and_b32 s32, s37, 1
    s_cmp_lt_u32 s37, 36
    s_cselect_b32 s32, s32, 1
    s_cmp_lt_u32 s37, 58
    s_cselect_b32 s32, s32, 11
    s_mul_i32 s32, s32, s25
    s_add_u32 s32, s32, s20
    v_mbcnt_lo_u32_b32 v12, -1, 0
    v_min_u32 v12, 1, v12
    v_lshlrev_b32 v12, 7, v12
    s_mov_b32 s23, 0
    s_mov_b64 exec, 0xffffffff
P_178:
    buffer_load_dword v13, v12, s[4:7], s32 offen sc1
    s_waitcnt vmcnt(0)
    v_cmp_gt_u32 vcc, s29, v13
    s_cbranch_vccz P_179
    s_add_u32 s23, s23, 1
    s_cmp_gt_u32 s23, 65536
    s_cbranch_scc1 L_exit
    s_sleep 1
    s_branch P_178
P_179:
    s_mov_b64 exec, -1
    s_add_u32 s32, s18, 262144
    s_mov_b32 s22, 1
    s_add_u32 s56, s32, 0
    s_add_u32 s57, s32, 4096
    buffer_load_dwordx4 a[32:35], v0, s[4:7], s56 offen offset:0 sc1
    buffer_load_dwordx4 a[36:39], v0, s[4:7], s56 offen offset:1024 sc1
    buffer_load_dwordx4 a[40:43], v0, s[4:7], s56 offen offset:2048 sc1
    buffer_load_dwordx4 a[44:47], v0, s[4:7], s56 offen offset:3072 sc1
    buffer_load_dwordx4 a[48:51], v0, s[4:7], s57 offen offset:0 sc1
    buffer_load_dwordx4 a[52:55], v0, s[4:7], s57 offen offset:1024 sc1
    buffer_load_dwordx4 a[56:59], v0, s[4:7], s57 offen offset:2048 sc1
    buffer_load_dwordx4 a[60:63], v0, s[4:7], s57 offen offset:3072 sc1
.p2align 6
RAT_loop:
    s_add_u32 s29, s37, 1
    s_add_u32 s38, s18, 262144
    s_cmp_lt_u32 s37, s46
    s_cselect_b32 s39, s38, s18
    s_add_u32 s33, s29, 1
    s_cmp_lt_u32 s29, s46
    s_cselect_b32 s33, s33, 999
    s_add_u32 s58, s39, 16777216
    s_add_u32 s59, s39, 16781312
    s_add_u32 s60, s39, 33554432
    s_add_u32 s61, s39, 33558528
    s_and_b32 s27, s29, 1
    s_cmp_lt_u32 s29, 36
    s_cselect_b32 s27, s27, 1
    s_cmp_lt_u32 s29, 58
    s_cselect_b32 s27, s27, 11
    s_mul_i32 s27, s27, s25
    s_add_u32 s27, s27, s20
    s_mov_b32 s23, 0
    s_branch G_181
G_180:
    s_add_u32 s23, s23, 1
    s_cmp_gt_u32 s23, 65536
    s_cbranch_scc1 L_exit
    s_sleep 1
    buffer_load_dwordx4 v[224:227], v0, s[4:7], s35 offen offset:0 sc1
    buffer_load_dwordx4 v[228:231], v0, s[4:7], s35 offen offset:1024 sc1
    buffer_load_dwordx4 v[232:235], v0, s[4:7], s35 offen offset:2048 sc1
    buffer_load_dwordx4 v[236:239], v0, s[4:7], s35 offen offset:3072 sc1
G_181:
    s_waitcnt vmcnt(2)
    v_max3_u32 v12, v224, v225, v226
    v_max3_u32 v13, v227, v228, v229
    v_max3_u32 v12, v12, v230, v231
    s_waitcnt vmcnt(0)
    v_max3_u32 v13, v13, v232, v233
    v_max3_u32 v12, v12, v234, v235
    v_max3_u32 v13, v13, v236, v237
    v_max3_u32 v12, v12, v238, v239
    v_max_u32 v12, v12, v13
    v_cmp_eq_u32 vcc, -1, v12
    s_cbranch_vccnz G_180
    s_load_dword s48, s[4:5], s27 offset:0 glc
    s_load_dword s49, s[4:5], s27 offset:128 glc
    v_mfma_f32_32x32x16_bf16 v[160:175], v[224:227], a[0:3], 0
    buffer_load_dwordx4 a[64:67], v0, s[4:7], s58 offen offset:0 sc1
    v_mfma_f32_32x32x16_bf16 v[176:191], v[224:227], a[4:7], 0
    buffer_load_dwordx4 a[68:71], v0, s[4:7], s58 offen offset:1024 sc1
    v_mfma_f32_32x32x16_bf16 v[192:207], v[224:227], a[8:11], 0
    buffer_load_dwordx4 a[72:75], v0, s[4:7], s58 offen offset:2048 sc1
    v_mfma_f32_32x32x16_bf16 v[208:223], v[224:227], a[12:15], 0
    buffer_load_dwordx4 a[76:79], v0, s[4:7], s58 offen offset:3072 sc1
    v_mfma_f32_32x32x16_bf16 v[160:175], v[228:231], a[16:19], v[160:175]
    buffer_load_dwordx4 a[80:83], v0, s[4:7], s59 offen offset:0 sc1
    v_mfma_f32_32x32x16_bf16 v[176:191], v[228:231], a[20:23], v[176:191]
    buffer_load_dwordx4 a[84:87], v0, s[4:7], s59 offen offset:1024 sc1
    v_mfma_f32_32x32x16_bf16 v[192:207], v[228:231], a[24:27], v[192:207]
    buffer_load_dwordx4 a[88:91], v0, s[4:7], s59 offen offset:2048 sc1
    v_mfma_f32_32x32x16_bf16 v[208:223], v[228:231], a[28:31], v[208:223]
    buffer_load_dwordx4 a[92:95], v0, s[4:7], s59 offen offset:3072 sc1
    s_nop 7
    buffer_load_dwordx4 a[96:99], v0, s[4:7], s60 offen offset:0 sc1
    v_pk_add_f32 v[160:161], v[160:161], v[180:181]
    v_pk_add_f32 v[162:163], v[162:163], v[182:183]
    v_pk_add_f32 v[160:161], v[160:161], v[200:201]
    v_pk_add_f32 v[162:163], v[162:163], v[202:203]
    v_pk_add_f32 v[160:161], v[160:161], v[220:221]
    v_pk_add_f32 v[162:163], v[162:163], v[222:223]
    v_max3_f32 v6, v160, v161, v162
    v_max_f32 v6, v6, v163
    v_mov_b32 v7, v6
    s_nop 1
    v_permlane32_swap_b32 v6, v7
    v_max_f32 v6, v6, v7
    buffer_load_dwordx4 a[100:103], v0, s[4:7], s60 offen offset:1024 sc1
    v_mul_f32 v6, s40, v6
    v_max_f32 v6, v6, v4
    v_sub_f32 v8, v4, v6
    v_fma_f32 v160, v160, s40, -v6
    v_fma_f32 v161, v161, s40, -v6
    v_fma_f32 v162, v162, s40, -v6
    v_fma_f32 v163, v163, s40, -v6
    v_exp_f32 v8, v8
    v_exp_f32 v160, v160
    v_exp_f32 v161, v161
    v_exp_f32 v162, v162
    v_exp_f32 v163, v163
    buffer_load_dwordx4 a[104:107], v0, s[4:7], s60 offen offset:2048 sc1
    v_fma_f32 v5, v5, v8, v160
    v_add_f32 v7, v161, v162
    v_add_f32 v5, v5, v163
    v_add_f32 v5, v5, v7
    v_mov_b32 v7, v5
    s_nop 1
    v_permlane32_swap_b32 v5, v7
    v_add_f32 v5, v5, v7
    v_rcp_f32 v5, v5
    buffer_load_dwordx4 a[108:111], v0, s[4:7], s60 offen offset:3072 sc1
    v_mul_f32 v160, v160, v5
    v_mul_f32 v161, v161, v5
    v_mul_f32 v162, v162, v5
    v_mul_f32 v163, v163, v5
    v_mul_f32 v8, v8, v5
    v_cvt_pk_bf16_f32 v160, v160, v161
    v_cvt_pk_bf16_f32 v161, v162, v163
    v_mov_b32 v9, v8
    s_add_u32 s30, s19, 4096
    v_pk_mul_f32 v[64:65], v[64:65], v[8:9]
    v_pk_mul_f32 v[66:67], v[66:67], v[8:9]
    v_pk_mul_f32 v[68:69], v[68:69], v[8:9]
    v_pk_mul_f32 v[70:71], v[70:71], v[8:9]
    v_pk_mul_f32 v[72:73], v[72:73], v[8:9]
    v_pk_mul_f32 v[74:75], v[74:75], v[8:9]
    v_pk_mul_f32 v[76:77], v[76:77], v[8:9]
    v_pk_mul_f32 v[78:79], v[78:79], v[8:9]
    v_pk_mul_f32 v[80:81], v[80:81], v[8:9]
    v_pk_mul_f32 v[82:83], v[82:83], v[8:9]
    v_pk_mul_f32 v[84:85], v[84:85], v[8:9]
    v_pk_mul_f32 v[86:87], v[86:87], v[8:9]
    v_pk_mul_f32 v[88:89], v[88:89], v[8:9]
    v_pk_mul_f32 v[90:91], v[90:91], v[8:9]
    v_pk_mul_f32 v[92:93], v[92:93], v[8:9]
    v_pk_mul_f32 v[94:95], v[94:95], v[8:9]
    buffer_load_dwordx4 a[112:115], v0, s[4:7], s61 offen offset:0 sc1
    v_pk_mul_f32 v[96:97], v[96:97], v[8:9]
    v_pk_mul_f32 v[98:99], v[98:99], v[8:9]
    v_pk_mul_f32 v[100:101], v[100:101], v[8:9]
    v_pk_mul_f32 v[102:103], v[102:103], v[8:9]
    v_pk_mul_f32 v[104:105], v[104:105], v[8:9]
    v_pk_mul_f32 v[106:107], v[106:107], v[8:9]
    v_pk_mul_f32 v[108:109], v[108:109], v[8:9]
    v_pk_mul_f32 v[110:111], v[110:111], v[8:9]
    v_pk_mul_f32 v[112:113], v[112:113], v[8:9]
    v_pk_mul_f32 v[114:115], v[114:115], v[8:9]
    v_pk_mul_f32 v[116:117], v[116:117], v[8:9]
    v_pk_mul_f32 v[118:119], v[118:119], v[8:9]
    v_pk_mul_f32 v[120:121], v[120:121], v[8:9]
    v_pk_mul_f32 v[122:123], v[122:123], v[8:9]
    v_pk_mul_f32 v[124:125], v[124:125], v[8:9]
    v_pk_mul_f32 v[126:127], v[126:127], v[8:9]
    buffer_load_dwordx4 a[116:119], v0, s[4:7], s61 offen offset:1024 sc1
    s_nop 0
    v_mfma_f32_32x32x8_bf16 v[64:79], v[232:233], v[160:161], v[64:79]
    v_mfma_f32_32x32x8_bf16 v[80:95], v[234:235], v[160:161], v[80:95]
    buffer_load_dwordx4 a[120:123], v0, s[4:7], s61 offen offset:2048 sc1
    v_mfma_f32_32x32x8_bf16 v[96:111], v[236:237], v[160:161], v[96:111]
    v_mfma_f32_32x32x8_bf16 v[112:127], v[238:239], v[160:161], v[112:127]
    buffer_load_dwordx4 a[124:127], v0, s[4:7], s61 offen offset:3072 sc1
    s_nop 6
    v_cvt_pk_bf16_f32 v128, v64, v65
    v_cvt_pk_bf16_f32 v129, v66, v67
    v_cvt_pk_bf16_f32 v130, v68, v69
    v_cvt_pk_bf16_f32 v131, v70, v71
    v_cvt_pk_bf16_f32 v132, v72, v73
    v_cvt_pk_bf16_f32 v133, v74, v75
    v_cvt_pk_bf16_f32 v134, v76, v77
    v_cvt_pk_bf16_f32 v135, v78, v79
    buffer_store_dwordx4 v[128:131], v0, s[4:7], s19 offen offset:0 sc1
    buffer_store_dwordx4 v[132:135], v0, s[4:7], s19 offen offset:1024 sc1
    v_cvt_pk_bf16_f32 v136, v80, v81
    v_cvt_pk_bf16_f32 v137, v82, v83
    v_cvt_pk_bf16_f32 v138, v84, v85
    v_cvt_pk_bf16_f32 v139, v86, v87
    v_cvt_pk_bf16_f32 v140, v88, v89
    v_cvt_pk_bf16_f32 v141, v90, v91
    v_cvt_pk_bf16_f32 v142, v92, v93
    v_cvt_pk_bf16_f32 v143, v94, v95
    buffer_store_dwordx4 v[136:139], v0, s[4:7], s19 offen offset:2048 sc1
    buffer_store_dwordx4 v[140:143], v0, s[4:7], s19 offen offset:3072 sc1
    v_cvt_pk_bf16_f32 v144, v96, v97
    v_cvt_pk_bf16_f32 v145, v98, v99
    v_cvt_pk_bf16_f32 v146, v100, v101
    v_cvt_pk_bf16_f32 v147, v102, v103
    v_cvt_pk_bf16_f32 v148, v104, v105
    v_cvt_pk_bf16_f32 v149, v106, v107
    v_cvt_pk_bf16_f32 v150, v108, v109
    v_cvt_pk_bf16_f32 v151, v110, v111
    buffer_store_dwordx4 v[144:147], v0, s[4:7], s30 offen offset:0 sc1
    buffer_store_dwordx4 v[148:151], v0, s[4:7], s30 offen offset:1024 sc1
    v_cvt_pk_bf16_f32 v152, v112, v113
    v_cvt_pk_bf16_f32 v153, v114, v115
    v_cvt_pk_bf16_f32 v154, v116, v117
    v_cvt_pk_bf16_f32 v155, v118, v119
    v_cvt_pk_bf16_f32 v156, v120, v121
    v_cvt_pk_bf16_f32 v157, v122, v123
    v_cvt_pk_bf16_f32 v158, v124, v125
    v_cvt_pk_bf16_f32 v159, v126, v127
    buffer_store_dwordx4 v[152:155], v0, s[4:7], s30 offen offset:2048 sc1
    buffer_store_dwordx4 v[156:159], v0, s[4:7], s30 offen offset:3072 sc1
    s_mov_b32 s16, s37
    s_mov_b32 s37, s29
    s_mov_b32 s18, s38
    s_add_u32 s19, s19, 262144
    s_add_u32 s35, s35, 131072
    s_cmp_lg_u32 s22, 0
    s_cbranch_scc1 G_182
    s_waitcnt vmcnt(0)
    s_sub_u32 s63, s16, s47
    s_mov_b32 s47, s16
    s_atomic_add s63, s[4:5], s21
    s_cmp_ge_u32 s16, s46
    s_cbranch_scc1 RAT_done
    s_and_b32 s32, s16, 1
    s_cmp_lt_u32 s16, 36
    s_cselect_b32 s32, s32, 1
    s_cmp_lt_u32 s16, 58
    s_cselect_b32 s32, s32, 11
    s_mul_i32 s32, s32, s25
    s_add_u32 s32, s32, s20
    v_mbcnt_lo_u32_b32 v12, -1, 0
    v_min_u32 v12, 1, v12
    v_lshlrev_b32 v12, 7, v12
    s_mov_b32 s23, 0
    s_mov_b64 exec, 0xffffffff
P_184:
    buffer_load_dword v13, v12, s[4:7], s32 offen sc1
    s_waitcnt vmcnt(0)
    v_cmp_gt_u32 vcc, s37, v13
    s_cbranch_vccz P_185
    s_add_u32 s23, s23, 1
    s_cmp_gt_u32 s23, 65536
    s_cbranch_scc1 L_exit
    s_sleep 1
    s_branch P_184
P_185:
    s_mov_b64 exec, -1
    s_add_u32 s56, s18, 0
    s_add_u32 s57, s18, 4096
    buffer_load_dwordx4 a[32:35], v0, s[4:7], s56 offen offset:0 sc1
    buffer_load_dwordx4 a[36:39], v0, s[4:7], s56 offen offset:1024 sc1
    buffer_load_dwordx4 a[40:43], v0, s[4:7], s56 offen offset:2048 sc1
    buffer_load_dwordx4 a[44:47], v0, s[4:7], s56 offen offset:3072 sc1
    buffer_load_dwordx4 a[48:51], v0, s[4:7], s57 offen offset:0 sc1
    buffer_load_dwordx4 a[52:55], v0, s[4:7], s57 offen offset:1024 sc1
    buffer_load_dwordx4 a[56:59], v0, s[4:7], s57 offen offset:2048 sc1
    buffer_load_dwordx4 a[60:63], v0, s[4:7], s57 offen offset:3072 sc1
    s_waitcnt vmcnt(0)
G_182:
    s_add_u32 s32, s18, 262144
    s_waitcnt lgkmcnt(0)
    s_min_u32 s48, s48, s49
    s_mov_b32 s22, 0
    s_cmp_lt_u32 s48, s33
    s_cbranch_scc1 G_183
    s_mov_b32 s22, 1
    s_add_u32 s56, s32, 0
    s_add_u32 s57, s32, 4096
    buffer_load_dwordx4 a[0:3], v0, s[4:7], s56 offen offset:0 sc1
    buffer_load_dwordx4 a[4:7], v0, s[4:7], s56 offen offset:1024 sc1
    buffer_load_dwordx4 a[8:11], v0, s[4:7], s56 offen offset:2048 sc1
    buffer_load_dwordx4 a[12:15], v0, s[4:7], s56 offen offset:3072 sc1
    buffer_load_dwordx4 a[16:19], v0, s[4:7], s57 offen offset:0 sc1
    buffer_load_dwordx4 a[20:23], v0, s[4:7], s57 offen offset:1024 sc1
    buffer_load_dwordx4 a[24:27], v0, s[4:7], s57 offen offset:2048 sc1
    buffer_load_dwordx4 a[28:31], v0, s[4:7], s57 offen offset:3072 sc1
    s_waitcnt vmcnt(16)
    s_branch G_186
G_183:
    s_waitcnt vmcnt(8)
G_186:
    v_mfma_f32_32x32x16_bf16 v[32:47], a[64:67], a[32:35], v[16:31]
    v_mfma_f32_32x32x16_bf16 v[32:47], a[68:71], a[36:39], v[32:47]
    v_mfma_f32_32x32x16_bf16 v[32:47], a[72:75], a[40:43], v[32:47]
    v_mfma_f32_32x32x16_bf16 v[32:47], a[76:79], a[44:47], v[32:47]
    v_mfma_f32_32x32x16_bf16 v[32:47], a[80:83], a[48:51], v[32:47]
    v_mfma_f32_32x32x16_bf16 v[32:47], a[84:87], a[52:55], v[32:47]
    v_mfma_f32_32x32x16_bf16 v[32:47], a[88:91], a[56:59], v[32:47]
    v_mfma_f32_32x32x16_bf16 v[32:47], a[92:95], a[60:63], v[32:47]
    v_mov_b32 v10, s40
    v_mov_b32 v11, s40
    s_nop 9
    v_max3_f32 v6, v32, v33, v34
    v_max3_f32 v7, v35, v36, v37
    v_max3_f32 v6, v6, v38, v39
    v_max3_f32 v7, v7, v40, v41
    v_max3_f32 v6, v6, v42, v43
    v_max3_f32 v7, v7, v44, v45
    v_max3_f32 v6, v6, v46, v47
    v_max_f32 v6, v6, v7
    v_mov_b32 v7, v6
    s_nop 1
    v_permlane32_swap_b32 v6, v7
    v_max_f32 v6, v6, v7
    s_cmp_eq_u32 s16, s47
    s_cbranch_scc1 G_187
    s_cmp_lg_u32 s22, 0
    s_cbranch_scc1 G_188
    s_waitcnt vmcnt(0)
G_188:
    s_waitcnt vmcnt(8)
    s_sub_u32 s63, s16, s47
    s_mov_b32 s47, s16
    s_atomic_add s63, s[4:5], s21
G_187:
    buffer_load_dwordx4 v[224:227], v0, s[4:7], s35 offen offset:0 sc1
    buffer_load_dwordx4 v[228:231], v0, s[4:7], s35 offen offset:1024 sc1
    buffer_load_dwordx4 v[232:235], v0, s[4:7], s35 offen offset:2048 sc1
    buffer_load_dwordx4 v[236:239], v0, s[4:7], s35 offen offset:3072 sc1
    v_mul_f32 v4, s40, v6
    v_sub_f32 v6, 0, v4
    v_sub_f32 v7, 0, v4
    v_pk_fma_f32 v[32:33], v[32:33], v[10:11], v[6:7]
    v_pk_fma_f32 v[34:35], v[34:35], v[10:11], v[6:7]
    v_pk_fma_f32 v[36:37], v[36:37], v[10:11], v[6:7]
    v_pk_fma_f32 v[38:39], v[38:39], v[10:11], v[6:7]
    v_pk_fma_f32 v[40:41], v[40:41], v[10:11], v[6:7]
    v_pk_fma_f32 v[42:43], v[42:43], v[10:11], v[6:7]
    v_pk_fma_f32 v[44:45], v[44:45], v[10:11], v[6:7]
    v_pk_fma_f32 v[46:47], v[46:47], v[10:11], v[6:7]
    v_exp_f32 v32, v32
    v_exp_f32 v33, v33
    v_exp_f32 v34, v34
    v_exp_f32 v35, v35
    v_exp_f32 v36, v36
    v_exp_f32 v37, v37
    v_exp_f32 v38, v38
    v_exp_f32 v39, v39
    v_exp_f32 v40, v40
    v_exp_f32 v41, v41
    v_exp_f32 v42, v42
    v_exp_f32 v43, v43
    v_exp_f32 v44, v44
    v_exp_f32 v45, v45
    v_exp_f32 v46, v46
    v_exp_f32 v47, v47
    v_pk_add_f32 v[6:7], v[32:33], v[34:35]
    v_pk_add_f32 v[6:7], v[6:7], v[36:37]
    v_pk_add_f32 v[6:7], v[6:7], v[38:39]
    v_pk_add_f32 v[6:7], v[6:7], v[40:41]
    v_pk_add_f32 v[6:7], v[6:7], v[42:43]
    v_pk_add_f32 v[6:7], v[6:7], v[44:45]
    v_pk_add_f32 v[6:7], v[6:7], v[46:47]
    v_add_f32 v5, v6, v7
    v_cvt_pk_bf16_f32 v32, v32, v33
    v_cvt_pk_bf16_f32 v33, v34, v35
    v_cvt_pk_bf16_f32 v34, v36, v37
    v_cvt_pk_bf16_f32 v35, v38, v39
    v_cvt_pk_bf16_f32 v36, v40, v41
    v_cvt_pk_bf16_f32 v37, v42, v43
    v_cvt_pk_bf16_f32 v38, v44, v45
    v_cvt_pk_bf16_f32 v39, v46, v47
    v_mfma_f32_32x32x16_bf16 v[64:79], a[96:99], v[32:35], 0
    s_nop 0
    v_mfma_f32_32x32x16_bf16 v[64:79], a[100:103], v[36:39], v[64:79]
    v_mfma_f32_32x32x16_bf16 v[80:95], a[104:107], v[32:35], 0
    v_mfma_f32_32x32x16_bf16 v[80:95], a[108:111], v[36:39], v[80:95]
    v_mfma_f32_32x32x16_bf16 v[96:111], a[112:115], v[32:35], 0
    v_mfma_f32_32x32x16_bf16 v[96:111], a[116:119], v[36:39], v[96:111]
    v_mfma_f32_32x32x16_bf16 v[112:127], a[120:123], v[32:35], 0
    v_mfma_f32_32x32x16_bf16 v[112:127], a[124:127], v[36:39], v[112:127]
    s_add_u32 s29, s37, 1
    s_add_u32 s38, s18, 262144
    s_cmp_lt_u32 s37, s46
    s_cselect_b32 s39, s38, s18
    s_add_u32 s33, s29, 1
    s_cmp_lt_u32 s29, s46
    s_cselect_b32 s33, s33, 999
    s_add_u32 s58, s39, 16777216
    s_add_u32 s59, s39, 16781312
    s_add_u32 s60, s39, 33554432
    s_add_u32 s61, s39, 33558528
    s_and_b32 s27, s29, 1
    s_cmp_lt_u32 s29, 36
    s_cselect_b32 s27, s27, 1
    s_cmp_lt_u32 s29, 58
    s_cselect_b32 s27, s27, 11
    s_mul_i32 s27, s27, s25
    s_add_u32 s27, s27, s20
    s_mov_b32 s23, 0
    s_branch G_190
G_189:
    s_add_u32 s23, s23, 1
    s_cmp_gt_u32 s23, 65536
    s_cbranch_scc1 L_exit
    s_sleep 1
    buffer_load_dwordx4 v[224:227], v0, s[4:7], s35 offen offset:0 sc1
    buffer_load_dwordx4 v[228:231], v0, s[4:7], s35 offen offset:1024 sc1
    buffer_load_dwordx4 v[232:235], v0, s[4:7], s35 offen offset:2048 sc1
    buffer_load_dwordx4 v[236:239], v0, s[4:7], s35 offen offset:3072 sc1
G_190:
    s_waitcnt vmcnt(2)
    v_max3_u32 v12, v224, v225, v226
    v_max3_u32 v13, v227, v228, v229
    v_max3_u32 v12, v12, v230, v231
    s_waitcnt vmcnt(0)
    v_max3_u32 v13, v13, v232, v233
    v_max3_u32 v12, v12, v234, v235
    v_max3_u32 v13, v13, v236, v237
    v_max3_u32 v12, v12, v238, v239
    v_max_u32 v12, v12, v13
    v_cmp_eq_u32 vcc, -1, v12
    s_cbranch_vccnz G_189
    s_load_dword s48, s[4:5], s27 offset:0 glc
    s_load_dword s49, s[4:5], s27 offset:128 glc
    v_mfma_f32_32x32x16_bf16 v[160:175], v[224:227], a[32:35], 0
    buffer_load_dwordx4 a[64:67], v0, s[4:7], s58 offen offset:0 sc1
    v_mfma_f32_32x32x16_bf16 v[176:191], v[224:227], a[36:39], 0
    buffer_load_dwordx4 a[68:71], v0, s[4:7], s58 offen offset:1024 sc1
    v_mfma_f32_32x32x16_bf16 v[192:207], v[224:227], a[40:43], 0
    buffer_load_dwordx4 a[72:75], v0, s[4:7], s58 offen offset:2048 sc1
    v_mfma_f32_32x32x16_bf16 v[208:223], v[224:227], a[44:47], 0
    buffer_load_dwordx4 a[76:79], v0, s[4:7], s58 offen offset:3072 sc1
    v_mfma_f32_32x32x16_bf16 v[160:175], v[228:231], a[48:51], v[160:175]
    buffer_load_dwordx4 a[80:83], v0, s[4:7], s59 offen offset:0 sc1
    v_mfma_f32_32x32x16_bf16 v[176:191], v[228:231], a[52:55], v[176:191]
    buffer_load_dwordx4 a[84:87], v0, s[4:7], s59 offen offset:1024 sc1
    v_mfma_f32_32x32x16_bf16 v[192:207], v[228:231], a[56:59], v[192:207]
    buffer_load_dwordx4 a[88:91], v0, s[4:7], s59 offen offset:2048 sc1
    v_mfma_f32_32x32x16_bf16 v[208:223], v[228:231], a[60:63], v[208:223]
    buffer_load_dwordx4 a[92:95], v0, s[4:7], s59 offen offset:3072 sc1
    s_nop 7
    buffer_load_dwordx4 a[96:99], v0, s[4:7], s60 offen offset:0 sc1
    v_pk_add_f32 v[160:161], v[160:161], v[180:181]
    v_pk_add_f32 v[162:163], v[162:163], v[182:183]
    v_pk_add_f32 v[160:161], v[160:161], v[200:201]
    v_pk_add_f32 v[162:163], v[162:163], v[202:203]
    v_pk_add_f32 v[160:161], v[160:161], v[220:221]
    v_pk_add_f32 v[162:163], v[162:163], v[222:223]
    v_max3_f32 v6, v160, v161, v162
    v_max_f32 v6, v6, v163
    v_mov_b32 v7, v6
    s_nop 1
    v_permlane32_swap_b32 v6, v7
    v_max_f32 v6, v6, v7
    buffer_load_dwordx4 a[100:103], v0, s[4:7], s60 offen offset:1024 sc1
    v_mul_f32 v6, s40, v6
    v_max_f32 v6, v6, v4
    v_sub_f32 v8, v4, v6
    v_fma_f32 v160, v160, s40, -v6
    v_fma_f32 v161, v161, s40, -v6
    v_fma_f32 v162, v162, s40, -v6
    v_fma_f32 v163, v163, s40, -v6
    v_exp_f32 v8, v8
    v_exp_f32 v160, v160
    v_exp_f32 v161, v161
    v_exp_f32 v162, v162
    v_exp_f32 v163, v163
    buffer_load_dwordx4 a[104:107], v0, s[4:7], s60 offen offset:2048 sc1
    v_fma_f32 v5, v5, v8, v160
    v_add_f32 v7, v161, v162
    v_add_f32 v5, v5, v163
    v_add_f32 v5, v5, v7
    v_mov_b32 v7, v5
    s_nop 1
    v_permlane32_swap_b32 v5, v7
    v_add_f32 v5, v5, v7
    v_rcp_f32 v5, v5
    buffer_load_dwordx4 a[108:111], v0, s[4:7], s60 offen offset:3072 sc1
    v_mul_f32 v160, v160, v5
    v_mul_f32 v161, v161, v5
    v_mul_f32 v162, v162, v5
    v_mul_f32 v163, v163, v5
    v_mul_f32 v8, v8, v5
    v_cvt_pk_bf16_f32 v160, v160, v161
    v_cvt_pk_bf16_f32 v161, v162, v163
    v_mov_b32 v9, v8
    s_add_u32 s30, s19, 4096
    v_pk_mul_f32 v[64:65], v[64:65], v[8:9]
    v_pk_mul_f32 v[66:67], v[66:67], v[8:9]
    v_pk_mul_f32 v[68:69], v[68:69], v[8:9]
    v_pk_mul_f32 v[70:71], v[70:71], v[8:9]
    v_pk_mul_f32 v[72:73], v[72:73], v[8:9]
    v_pk_mul_f32 v[74:75], v[74:75], v[8:9]
    v_pk_mul_f32 v[76:77], v[76:77], v[8:9]
    v_pk_mul_f32 v[78:79], v[78:79], v[8:9]
    v_pk_mul_f32 v[80:81], v[80:81], v[8:9]
    v_pk_mul_f32 v[82:83], v[82:83], v[8:9]
    v_pk_mul_f32 v[84:85], v[84:85], v[8:9]
    v_pk_mul_f32 v[86:87], v[86:87], v[8:9]
    v_pk_mul_f32 v[88:89], v[88:89], v[8:9]
    v_pk_mul_f32 v[90:91], v[90:91], v[8:9]
    v_pk_mul_f32 v[92:93], v[92:93], v[8:9]
    v_pk_mul_f32 v[94:95], v[94:95], v[8:9]
    buffer_load_dwordx4 a[112:115], v0, s[4:7], s61 offen offset:0 sc1
    v_pk_mul_f32 v[96:97], v[96:97], v[8:9]
    v_pk_mul_f32 v[98:99], v[98:99], v[8:9]
    v_pk_mul_f32 v[100:101], v[100:101], v[8:9]
    v_pk_mul_f32 v[102:103], v[102:103], v[8:9]
    v_pk_mul_f32 v[104:105], v[104:105], v[8:9]
    v_pk_mul_f32 v[106:107], v[106:107], v[8:9]
    v_pk_mul_f32 v[108:109], v[108:109], v[8:9]
    v_pk_mul_f32 v[110:111], v[110:111], v[8:9]
    v_pk_mul_f32 v[112:113], v[112:113], v[8:9]
    v_pk_mul_f32 v[114:115], v[114:115], v[8:9]
    v_pk_mul_f32 v[116:117], v[116:117], v[8:9]
    v_pk_mul_f32 v[118:119], v[118:119], v[8:9]
    v_pk_mul_f32 v[120:121], v[120:121], v[8:9]
    v_pk_mul_f32 v[122:123], v[122:123], v[8:9]
    v_pk_mul_f32 v[124:125], v[124:125], v[8:9]
    v_pk_mul_f32 v[126:127], v[126:127], v[8:9]
    buffer_load_dwordx4 a[116:119], v0, s[4:7], s61 offen offset:1024 sc1
    s_nop 0
    v_mfma_f32_32x32x8_bf16 v[64:79], v[232:233], v[160:161], v[64:79]
    v_mfma_f32_32x32x8_bf16 v[80:95], v[234:235], v[160:161], v[80:95]
    buffer_load_dwordx4 a[120:123], v0, s[4:7], s61 offen offset:2048 sc1
    v_mfma_f32_32x32x8_bf16 v[96:111], v[236:237], v[160:161], v[96:111]
    v_mfma_f32_32x32x8_bf16 v[112:127], v[238:239], v[160:161], v[112:127]
    buffer_load_dwordx4 a[124:127], v0, s[4:7], s61 offen offset:3072 sc1
    s_nop 6
    v_cvt_pk_bf16_f32 v128, v64, v65
    v_cvt_pk_bf16_f32 v129, v66, v67
    v_cvt_pk_bf16_f32 v130, v68, v69
    v_cvt_pk_bf16_f32 v131, v70, v71
    v_cvt_pk_bf16_f32 v132, v72, v73
    v_cvt_pk_bf16_f32 v133, v74, v75
    v_cvt_pk_bf16_f32 v134, v76, v77
    v_cvt_pk_bf16_f32 v135, v78, v79
    buffer_store_dwordx4 v[128:131], v0, s[4:7], s19 offen offset:0 sc1
    buffer_store_dwordx4 v[132:135], v0, s[4:7], s19 offen offset:1024 sc1
    v_cvt_pk_bf16_f32 v136, v80, v81
    v_cvt_pk_bf16_f32 v137, v82, v83
    v_cvt_pk_bf16_f32 v138, v84, v85
    v_cvt_pk_bf16_f32 v139, v86, v87
    v_cvt_pk_bf16_f32 v140, v88, v89
    v_cvt_pk_bf16_f32 v141, v90, v91
    v_cvt_pk_bf16_f32 v142, v92, v93
    v_cvt_pk_bf16_f32 v143, v94, v95
    buffer_store_dwordx4 v[136:139], v0, s[4:7], s19 offen offset:2048 sc1
    buffer_store_dwordx4 v[140:143], v0, s[4:7], s19 offen offset:3072 sc1
    v_cvt_pk_bf16_f32 v144, v96, v97
    v_cvt_pk_bf16_f32 v145, v98, v99
    v_cvt_pk_bf16_f32 v146, v100, v101
    v_cvt_pk_bf16_f32 v147, v102, v103
    v_cvt_pk_bf16_f32 v148, v104, v105
    v_cvt_pk_bf16_f32 v149, v106, v107
    v_cvt_pk_bf16_f32 v150, v108, v109
    v_cvt_pk_bf16_f32 v151, v110, v111
    buffer_store_dwordx4 v[144:147], v0, s[4:7], s30 offen offset:0 sc1
    buffer_store_dwordx4 v[148:151], v0, s[4:7], s30 offen offset:1024 sc1
    v_cvt_pk_bf16_f32 v152, v112, v113
    v_cvt_pk_bf16_f32 v153, v114, v115
    v_cvt_pk_bf16_f32 v154, v116, v117
    v_cvt_pk_bf16_f32 v155, v118, v119
    v_cvt_pk_bf16_f32 v156, v120, v121
    v_cvt_pk_bf16_f32 v157, v122, v123
    v_cvt_pk_bf16_f32 v158, v124, v125
    v_cvt_pk_bf16_f32 v159, v126, v127
    buffer_store_dwordx4 v[152:155], v0, s[4:7], s30 offen offset:2048 sc1
    buffer_store_dwordx4 v[156:159], v0, s[4:7], s30 offen offset:3072 sc1
    s_mov_b32 s16, s37
    s_mov_b32 s37, s29
    s_mov_b32 s18, s38
    s_add_u32 s19, s19, 262144
    s_add_u32 s35, s35, 131072
    s_cmp_lg_u32 s22, 0
    s_cbranch_scc1 G_191
    s_waitcnt vmcnt(0)
    s_sub_u32 s63, s16, s47
    s_mov_b32 s47, s16
    s_atomic_add s63, s[4:5], s21
    s_cmp_ge_u32 s16, s46
    s_cbranch_scc1 RAT_done
    s_and_b32 s32, s16, 1
    s_cmp_lt_u32 s16, 36
    s_cselect_b32 s32, s32, 1
    s_cmp_lt_u32 s16, 58
    s_cselect_b32 s32, s32, 11
    s_mul_i32 s32, s32, s25
    s_add_u32 s32, s32, s20
    v_mbcnt_lo_u32_b32 v12, -1, 0
    v_min_u32 v12, 1, v12
    v_lshlrev_b32 v12, 7, v12
    s_mov_b32 s23, 0
    s_mov_b64 exec, 0xffffffff
P_193:
    buffer_load_dword v13, v12, s[4:7], s32 offen sc1
    s_waitcnt vmcnt(0)
    v_cmp_gt_u32 vcc, s37, v13
    s_cbranch_vccz P_194
    s_add_u32 s23, s23, 1
    s_cmp_gt_u32 s23, 65536
    s_cbranch_scc1 L_exit
    s_sleep 1
    s_branch P_193
P_194:
    s_mov_b64 exec, -1
    s_add_u32 s56, s18, 0
    s_add_u32 s57, s18, 4096
    buffer_load_dwordx4 a[0:3], v0, s[4:7], s56 offen offset:0 sc1
    buffer_load_dwordx4 a[4:7], v0, s[4:7], s56 offen offset:1024 sc1
    buffer_load_dwordx4 a[8:11], v0, s[4:7], s56 offen offset:2048 sc1
    buffer_load_dwordx4 a[12:15], v0, s[4:7], s56 offen offset:3072 sc1
    buffer_load_dwordx4 a[16:19], v0, s[4:7], s57 offen offset:0 sc1
    buffer_load_dwordx4 a[20:23], v0, s[4:7], s57 offen offset:1024 sc1
    buffer_load_dwordx4 a[24:27], v0, s[4:7], s57 offen offset:2048 sc1
    buffer_load_dwordx4 a[28:31], v0, s[4:7], s57 offen offset:3072 sc1
    s_waitcnt vmcnt(0)
G_191:
    s_add_u32 s32, s18, 262144
    s_waitcnt lgkmcnt(0)
    s_min_u32 s48, s48, s49
    s_mov_b32 s22, 0
    s_cmp_lt_u32 s48, s33
    s_cbranch_scc1 G_192
    s_mov_b32 s22, 1
    s_add_u32 s56, s32, 0
    s_add_u32 s57, s32, 4096
    buffer_load_dwordx4 a[32:35], v0, s[4:7], s56 offen offset:0 sc1
    buffer_load_dwordx4 a[36:39], v0, s[4:7], s56 offen offset:1024 sc1
    buffer_load_dwordx4 a[40:43], v0, s[4:7], s56 offen offset:2048 sc1
    buffer_load_dwordx4 a[44:47], v0, s[4:7], s56 offen offset:3072 sc1
    buffer_load_dwordx4 a[48:51], v0, s[4:7], s57 offen offset:0 sc1
    buffer_load_dwordx4 a[52:55], v0, s[4:7], s57 offen offset:1024 sc1
    buffer_load_dwordx4 a[56:59], v0, s[4:7], s57 offen offset:2048 sc1
    buffer_load_dwordx4 a[60:63], v0, s[4:7], s57 offen offset:3072 sc1
    s_waitcnt vmcnt(16)
    s_branch G_195
G_192:
    s_waitcnt vmcnt(8)
G_195:
    v_mfma_f32_32x32x16_bf16 v[32:47], a[64:67], a[0:3], v[16:31]
    v_mfma_f32_32x32x16_bf16 v[32:47], a[68:71], a[4:7], v[32:47]
    v_mfma_f32_32x32x16_bf16 v[32:47], a[72:75], a[8:11], v[32:47]
    v_mfma_f32_32x32x16_bf16 v[32:47], a[76:79], a[12:15], v[32:47]
    v_mfma_f32_32x32x16_bf16 v[32:47], a[80:83], a[16:19], v[32:47]
    v_mfma_f32_32x32x16_bf16 v[32:47], a[84:87], a[20:23], v[32:47]
    v_mfma_f32_32x32x16_bf16 v[32:47], a[88:91], a[24:27], v[32:47]
    v_mfma_f32_32x32x16_bf16 v[32:47], a[92:95], a[28:31], v[32:47]
    v_mov_b32 v10, s40
    v_mov_b32 v11, s40
    s_nop 9
    v_max3_f32 v6, v32, v33, v34
    v_max3_f32 v7, v35, v36, v37
    v_max3_f32 v6, v6, v38, v39
    v_max3_f32 v7, v7, v40, v41
    v_max3_f32 v6, v6, v42, v43
    v_max3_f32 v7, v7, v44, v45
    v_max3_f32 v6, v6, v46, v47
    v_max_f32 v6, v6, v7
    v_mov_b32 v7, v6
    s_nop 1
    v_permlane32_swap_b32 v6, v7
    v_max_f32 v6, v6, v7
    s_cmp_eq_u32 s16, s47
    s_cbranch_scc1 G_196
    s_cmp_lg_u32 s22, 0
    s_cbranch_scc1 G_197
    s_waitcnt vmcnt(0)
G_197:
    s_waitcnt vmcnt(8)
    s_sub_u32 s63, s16, s47
    s_mov_b32 s47, s16
    s_atomic_add s63, s[4:5], s21
G_196:
    buffer_load_dwordx4 v[224:227], v0, s[4:7], s35 offen offset:0 sc1
    buffer_load_dwordx4 v[228:231], v0, s[4:7], s35 offen offset:1024 sc1
    buffer_load_dwordx4 v[232:235], v0, s[4:7], s35 offen offset:2048 sc1
    buffer_load_dwordx4 v[236:239], v0, s[4:7], s35 offen offset:3072 sc1
    v_mul_f32 v4, s40, v6
    v_sub_f32 v6, 0, v4
    v_sub_f32 v7, 0, v4
    v_pk_fma_f32 v[32:33], v[32:33], v[10:11], v[6:7]
    v_pk_fma_f32 v[34:35], v[34:35], v[10:11], v[6:7]
    v_pk_fma_f32 v[36:37], v[36:37], v[10:11], v[6:7]
    v_pk_fma_f32 v[38:39], v[38:39], v[10:11], v[6:7]
    v_pk_fma_f32 v[40:41], v[40:41], v[10:11], v[6:7]
    v_pk_fma_f32 v[42:43], v[42:43], v[10:11], v[6:7]
    v_pk_fma_f32 v[44:45], v[44:45], v[10:11], v[6:7]
    v_pk_fma_f32 v[46:47], v[46:47], v[10:11], v[6:7]
    v_exp_f32 v32, v32
    v_exp_f32 v33, v33
    v_exp_f32 v34, v34
    v_exp_f32 v35, v35
    v_exp_f32 v36, v36
    v_exp_f32 v37, v37
    v_exp_f32 v38, v38
    v_exp_f32 v39, v39
    v_exp_f32 v40, v40
    v_exp_f32 v41, v41
    v_exp_f32 v42, v42
    v_exp_f32 v43, v43
    v_exp_f32 v44, v44
    v_exp_f32 v45, v45
    v_exp_f32 v46, v46
    v_exp_f32 v47, v47
    v_pk_add_f32 v[6:7], v[32:33], v[34:35]
    v_pk_add_f32 v[6:7], v[6:7], v[36:37]
    v_pk_add_f32 v[6:7], v[6:7], v[38:39]
    v_pk_add_f32 v[6:7], v[6:7], v[40:41]
    v_pk_add_f32 v[6:7], v[6:7], v[42:43]
    v_pk_add_f32 v[6:7], v[6:7], v[44:45]
    v_pk_add_f32 v[6:7], v[6:7], v[46:47]
    v_add_f32 v5, v6, v7
    v_cvt_pk_bf16_f32 v32, v32, v33
    v_cvt_pk_bf16_f32 v33, v34, v35
    v_cvt_pk_bf16_f32 v34, v36, v37
    v_cvt_pk_bf16_f32 v35, v38, v39
    v_cvt_pk_bf16_f32 v36, v40, v41
    v_cvt_pk_bf16_f32 v37, v42, v43
    v_cvt_pk_bf16_f32 v38, v44, v45
    v_cvt_pk_bf16_f32 v39, v46, v47
    v_mfma_f32_32x32x16_bf16 v[64:79], a[96:99], v[32:35], 0
    s_nop 0
    v_mfma_f32_32x32x16_bf16 v[64:79], a[100:103], v[36:39], v[64:79]
    v_mfma_f32_32x32x16_bf16 v[80:95], a[104:107], v[32:35], 0
    v_mfma_f32_32x32x16_bf16 v[80:95], a[108:111], v[36:39], v[80:95]
    v_mfma_f32_32x32x16_bf16 v[96:111], a[112:115], v[32:35], 0
    v_mfma_f32_32x32x16_bf16 v[96:111], a[116:119], v[36:39], v[96:111]
    v_mfma_f32_32x32x16_bf16 v[112:127], a[120:123], v[32:35], 0
    v_mfma_f32_32x32x16_bf16 v[112:127], a[124:127], v[36:39], v[112:127]
    s_branch RAT_loop
RAT_done:
    s_cmp_lg_u32 s14, 0
    s_cbranch_scc1 L_next
    s_mov_b32 s14, 1
    s_mov_b32 s80, 1
    s_branch RAT_job
    s_branch L_next
    s_endpgm
.p2align 6
.type role_table,@object
role_table:
    .long 0x1, 0x0
    .long 0x101, 0x0
    .long 0x201, 0x0
    .long 0x301, 0x0
    .long 0x401, 0x0
    .long 0x501, 0x0
    .long 0x601, 0x0
    .long 0x701, 0x0
    .long 0x801, 0x0
    .long 0x901, 0x0
    .long 0xa01, 0x0
    .long 0xb01, 0x0
    .long 0xc01, 0x0
    .long 0xd01, 0x0
    .long 0xe01, 0x0
    .long 0xf01, 0x0
    .long 0x1001, 0x0
    .long 0x1101, 0x0
    .long 0x1201, 0x0
    .long 0x1301, 0x0
    .long 0x1401, 0x0
    .long 0x1501, 0x0
    .long 0x1601, 0x0
    .long 0x1701, 0x0
    .long 0x1801, 0x0
    .long 0x1901, 0x0
    .long 0x1a01, 0x0
    .long 0x1b01, 0x0
    .long 0x1c01, 0x0
    .long 0x1d01, 0x0
    .long 0x1e01, 0x0
    .long 0x1f01, 0x0
    .long 0x201002, 0x10001
    .long 0x201102, 0x10101
    .long 0x201202, 0x10201
    .long 0x201302, 0x10301
    .long 0x201402, 0x10401
    .long 0x201502, 0x10501
    .long 0x201602, 0x10601
    .long 0x201702, 0x10701
    .long 0x201802, 0x10801
    .long 0x201902, 0x10901
    .long 0x201a02, 0x10a01
    .long 0x201b02, 0x10b01
    .long 0x201c02, 0x10c01
    .long 0x201d02, 0x10d01
    .long 0x201e02, 0x10e01
    .long 0x201f02, 0x10f01
    .long 0x202003, 0x11001
    .long 0x202103, 0x11101
    .long 0x202203, 0x11201
    .long 0x202303, 0x11301
    .long 0x202403, 0x11401
    .long 0x202503, 0x11501
    .long 0x202603, 0x11601
    .long 0x202703, 0x11701
    .long 0x202803, 0x11801
    .long 0x202903, 0x11901
    .long 0x202a03, 0x11a01
    .long 0x202b03, 0x11b01
    .long 0x202c03, 0x11c01
    .long 0x202d03, 0x11d01
    .long 0x202e03, 0x11e01
    .long 0x202f03, 0x11f01
    .long 0x5, 0x0
    .long 0x405, 0x0
    .long 0x805, 0x0
    .long 0xc05, 0x0
    .long 0x1005, 0x0
    .long 0x105, 0x0
    .long 0x505, 0x0
    .long 0x905, 0x0
    .long 0xd05, 0x0
    .long 0x1105, 0x0
    .long 0x4, 0x0
    .long 0x104, 0x0
    .long 0x2, 0x0
    .long 0x602, 0x0
    .long 0xc02, 0x0
    .long 0x1202, 0x0
    .long 0x1802, 0x0
    .long 0x1e02, 0x0
    .long 0x2403, 0x0
    .long 0x2a03, 0x0
    .long 0x100002, 0x1000a
    .long 0x100602, 0x1010a
    .long 0x100c02, 0x1020a
    .long 0x101202, 0x1030a
    .long 0x101802, 0x1040a
    .long 0x101e02, 0x10b09
    .long 0x102403, 0x10c09
    .long 0x102a03, 0x10d09
    .long 0x200002, 0x10004
    .long 0x200102, 0x10104
    .long 0x6, 0x0
    .long 0x106, 0x0
    .long 0x205, 0x0
    .long 0x605, 0x0
    .long 0xa05, 0x0
    .long 0xe05, 0x0
    .long 0x1205, 0x0
    .long 0x305, 0x0
    .long 0x705, 0x0
    .long 0xb05, 0x0
    .long 0xf05, 0x0
    .long 0x1305, 0x0
    .long 0x204, 0x0
    .long 0x304, 0x0
    .long 0x102, 0x0
    .long 0x702, 0x0
    .long 0xd02, 0x0
    .long 0x1302, 0x0
    .long 0x1902, 0x0
    .long 0x1f02, 0x0
    .long 0x2503, 0x0
    .long 0x2b03, 0x0
    .long 0x100102, 0x10007
    .long 0x100702, 0x10107
    .long 0x100d02, 0x10207
    .long 0x101302, 0x10307
    .long 0x101902, 0x10407
    .long 0x101f02, 0x0
    .long 0x102503, 0x0
    .long 0x102b03, 0x0
    .long 0x200202, 0x10204
    .long 0x200302, 0x10304
    .long 0x206, 0x0
    .long 0x306, 0x0
    .long 0x7, 0x0
    .long 0x107, 0x0
    .long 0x207, 0x0
    .long 0x307, 0x0
    .long 0x407, 0x0
    .long 0x8, 0x0
    .long 0x108, 0x0
    .long 0x208, 0x0
    .long 0x308, 0x0
    .long 0x408, 0x0
    .long 0x404, 0x0
    .long 0x504, 0x0
    .long 0x202, 0x0
    .long 0x802, 0x0
    .long 0xe02, 0x0
    .long 0x1402, 0x0
    .long 0x1a02, 0x0
    .long 0x2003, 0x0
    .long 0x2603, 0x0
    .long 0x2c03, 0x0
    .long 0x100202, 0x10008
    .long 0x100802, 0x10108
    .long 0x100e02, 0x10208
    .long 0x101402, 0x10308
    .long 0x101a02, 0x10408
    .long 0x102003, 0x10009
    .long 0x102603, 0x10109
    .long 0x102c03, 0x10209
    .long 0x200402, 0x10404
    .long 0x200502, 0x10504
    .long 0x9, 0x0
    .long 0x109, 0x0
    .long 0x209, 0x0
    .long 0x309, 0x0
    .long 0x409, 0x0
    .long 0x509, 0x0
    .long 0x609, 0x0
    .long 0x709, 0x0
    .long 0x809, 0x0
    .long 0x909, 0x0
    .long 0xa09, 0x0
    .long 0xb09, 0x0
    .long 0xc09, 0x0
    .long 0xd09, 0x0
    .long 0x302, 0x0
    .long 0x902, 0x0
    .long 0xf02, 0x0
    .long 0x1502, 0x0
    .long 0x1b02, 0x0
    .long 0x2103, 0x0
    .long 0x2703, 0x0
    .long 0x2d03, 0x0
    .long 0x100302, 0x10309
    .long 0x100902, 0x10409
    .long 0x100f02, 0x10509
    .long 0x101502, 0x10609
    .long 0x101b02, 0x10709
    .long 0x102103, 0x10809
    .long 0x102703, 0x10909
    .long 0x102d03, 0x10a09
    .long 0x604, 0x0
    .long 0x704, 0x0
    .long 0x200602, 0x10604
    .long 0x200702, 0x10704
    .long 0xa, 0x0
    .long 0x10a, 0x0
    .long 0x20a, 0x0
    .long 0x30a, 0x0
    .long 0x40a, 0x0
    .long 0x10000a, 0x0
    .long 0x10010a, 0x0
    .long 0x10020a, 0x0
    .long 0x10030a, 0x0
    .long 0x10040a, 0x0
    .long 0x200b02, 0x10205
    .long 0x200c02, 0x10605
    .long 0x402, 0x0
    .long 0xa02, 0x0
    .long 0x1002, 0x0
    .long 0x1602, 0x0
    .long 0x1c02, 0x0
    .long 0x2203, 0x0
    .long 0x2803, 0x0
    .long 0x2e03, 0x0
    .long 0x100402, 0x10305
    .long 0x100a02, 0x10705
    .long 0x101002, 0x10b05
    .long 0x101602, 0x10f05
    .long 0x101c02, 0x11305
    .long 0x102203, 0x10306
    .long 0x102803, 0x10406
    .long 0x102e03, 0x0
    .long 0x200d02, 0x10a05
    .long 0x200e02, 0x10e05
    .long 0x200f02, 0x11205
    .long 0x406, 0x0
    .long 0x10005, 0x0
    .long 0x10405, 0x0
    .long 0x10805, 0x0
    .long 0x10c05, 0x0
    .long 0x11005, 0x0
    .long 0x10105, 0x0
    .long 0x10505, 0x0
    .long 0x10905, 0x0
    .long 0x10d05, 0x0
    .long 0x11105, 0x0
    .long 0x804, 0x0
    .long 0x904, 0x0
    .long 0x502, 0x0
    .long 0xb02, 0x0
    .long 0x1102, 0x0
    .long 0x1702, 0x0
    .long 0x1d02, 0x0
    .long 0x2303, 0x0
    .long 0x2903, 0x0
    .long 0x2f03, 0x0
    .long 0x100502, 0x11000a
    .long 0x100b02, 0x11010a
    .long 0x101102, 0x11020a
    .long 0x101702, 0x11030a
    .long 0x101d02, 0x11040a
    .long 0x102303, 0x10006
    .long 0x102903, 0x10106
    .long 0x102f03, 0x10206
    .long 0xa04, 0x0
    .long 0x200802, 0x10804
    .long 0x200902, 0x10904
    .long 0x200a02, 0x10a04
.section .rodata,"a"
.p2align 6
.amdhsa_kernel interleave_layers__memory_aug_recurrent_mem_tr__mixer_s_mlp__prompt_kernel
  .amdhsa_next_free_vgpr 512
  .amdhsa_next_free_sgpr 102
  .amdhsa_accum_offset 256
  .amdhsa_group_segment_fixed_size 0
  .amdhsa_kernarg_size 120
  .amdhsa_user_sgpr_count 2
  .amdhsa_user_sgpr_kernarg_segment_ptr 1
  .amdhsa_system_sgpr_workgroup_id_x 1
  .amdhsa_float_denorm_mode_32 3
.end_amdhsa_kernel
```
